```python
import torch

def _softmax(x, axis=-1):
    return torch.softmax(x, dim=axis)
def _gelu(x):
    return torch.nn.functional.gelu(x, approximate="tanh")
def _silu(x):
    return torch.nn.functional.silu(x)
def _sigmoid(x):
    return torch.sigmoid(x)
def _layernorm(x, axis=-1, eps=1e-5):
    m = x.mean(dim=axis, keepdim=True)
    v = x.var(dim=axis, keepdim=True, unbiased=False)
    return (x - m) / torch.sqrt(v + eps)
def _scatter_add(tgt, idx, src, axis=0):
    return tgt.clone().index_add_(axis, idx, src)
def _segment_sum(src, seg, n):
    out = torch.zeros((n,) + src.shape[1:], dtype=src.dtype)
    return out.index_add_(0, seg, src)
def _pad(x, pw):
    flat = tuple(v for pair in reversed(pw) for v in pair)
    return torch.nn.functional.pad(x, flat)

kernel_name = 'recurrent_scan__gqa_block_cached__glu_gated_bilinear__prompt'

def setup_inputs():

    _w = (lambda a: (lambda t: t.to(torch.bfloat16) if t.is_floating_point() else t)(torch.as_tensor(a)))
    def _A_setup():
        B, Sq, D = 1, 2048, 448
        Hq, Hkv, Sk, Dh = 16, 8, 2048, 256
        assert Hq % Hkv == 0, (Hq, Hkv)
        return {
            "x": _w((lambda *s: torch.randn(*s, dtype=torch.bfloat16) * 0.05)(B, Sq, D)),
            "k_cache": _w((lambda *s: torch.randn(*s, dtype=torch.bfloat16) * 1.6)(B, Hkv, Sk, Dh)),
            "v_cache": _w((lambda *s: torch.randn(*s, dtype=torch.bfloat16) * 1.6)(B, Hkv, Sk, Dh)),
            "wq": _w((lambda *s: torch.randn(*s, dtype=torch.bfloat16) * 1.6)(D, Hq * Dh) * (D ** -0.5)),
            "wo": _w((lambda *s: torch.randn(*s, dtype=torch.bfloat16) * 1.6)(Hq * Dh, D) * ((Hq * Dh) ** -0.5)),
        }
    _A_in = _A_setup()

    def _B_setup():
        B, S, D, F = 1, 2048, 448, 1792
        return {
            "x": _w((lambda *s: torch.randn(*s, dtype=torch.bfloat16) * 0.05)(B, S, D)),
            "w_gate": _w((lambda *s: torch.randn(*s, dtype=torch.bfloat16) * 0.2)(D, F) * (D ** -0.5)),
            "w_up": _w((lambda *s: torch.randn(*s, dtype=torch.bfloat16) * 0.2)(D, F) * (D ** -0.5)),
            "w_down": _w((lambda *s: torch.randn(*s, dtype=torch.bfloat16) * 0.2)(F, D) * (F ** -0.5)),
        }
    _B_in = _B_setup()

    return {
        "A_x": _A_in["x"],
        "A_k_cache": _A_in["k_cache"],
        "A_v_cache": _A_in["v_cache"],
        "A_wq": _A_in["wq"],
        "A_wo": _A_in["wo"],
        "B_x": _B_in["x"],
        "B_w_gate": _B_in["w_gate"],
        "B_w_up": _B_in["w_up"],
        "B_w_down": _B_in["w_down"],
    }

def reference(A_x, A_k_cache, A_v_cache, A_wq, A_wo, B_x, B_w_gate, B_w_up, B_w_down):
    def _A_ref(x, k_cache, v_cache, wq, wo):
        B, Sq, D = x.shape
        Hq, Dh = 16, 256
        Hkv = k_cache.shape[1]
        rep = Hq // Hkv
        q = (lambda x, *d: x.permute(*d))((x @ wq).reshape(B, Sq, Hq, Dh), 0, 2, 1, 3)
        k = (lambda x, n, axis: torch.repeat_interleave(x, n, dim=axis))(k_cache, rep, axis=1)
        v = (lambda x, n, axis: torch.repeat_interleave(x, n, dim=axis))(v_cache, rep, axis=1)
        scores = torch.einsum("bhqd,bhkd->bhqk", q, k) * (Dh ** -0.5)
        p = _softmax(scores, axis=-1)
        o = torch.einsum("bhqk,bhkd->bhqd", p, v)
        return (lambda x, *d: x.permute(*d))(o, 0, 2, 1, 3).reshape(B, Sq, Hq * Dh) @ wo

    def _B_ref(x, w_gate, w_up, w_down):
        g = torch.einsum("bsd,df->bsf", x, w_gate)
        u = torch.einsum("bsd,df->bsf", x, w_up)
        h = g * u
        return torch.einsum("bsf,fd->bsd", h, w_down)

    x = A_x
    xn = _layernorm(x, axis=-1)
    s = _A_ref(xn, A_k_cache, A_v_cache, A_wq, A_wo)
    g = _silu(_B_ref(xn, B_w_gate, B_w_up, B_w_down))
    return x + s * g
```

```asm
; @launch grid=(256,1,1) block=(256,1,1) lds=163840
.amdgcn_target "amdgcn-amd-amdhsa--gfx950"
.text
.globl recurrent_scan__gqa_block_cached__glu_gated_bilinear__prompt_kernel
.p2align 8
.type recurrent_scan__gqa_block_cached__glu_gated_bilinear__prompt_kernel,@function
recurrent_scan__gqa_block_cached__glu_gated_bilinear__prompt_kernel:

    s_cmp_ge_u32 s2, 256
    s_cbranch_scc1 L_done
    s_load_dwordx2 s[32:33], s[0:1], 0
    s_load_dwordx2 s[36:37], s[0:1], 48
    s_getpc_b64 s[28:29]
L_pc:
    s_lshr_b32 s27, s2, 3
    s_mul_i32 s27, s27, 20
    v_lshrrev_b32 v6, 6, v0
    v_and_b32 v0, 63, v0
    v_mad_u32_u24 v10, v6, 5, v0
    v_add_u32 v10, s27, v10
    v_min_u32 v10, (L_hot_end - L_pc) / 128, v10
    v_lshlrev_b32 v10, 7, v10
    s_mov_b64 exec, 0x1f
    v_mov_b32 v11, s29
    v_add_co_u32 v10, vcc, s28, v10
    s_nop 1
    v_addc_co_u32 v11, vcc, 0, v11, vcc
    global_load_dword v34, v[10:11], off
    s_mov_b64 exec, -1
    v_readfirstlane_b32 s16, v6
    s_and_b32 s19, s2, 7
    s_lshr_b32 s20, s2, 3
    s_and_b32 s17, s16, 1
    s_lshr_b32 s18, s16, 1
    v_and_b32 v7, 15, v0
    v_lshrrev_b32 v8, 4, v0
    v_mul_u32_u24 v9, 896, v7
    v_lshl_add_u32 v9, v8, 4, v9
    s_lshl_b32 s27, s20, 2
    s_add_u32 s27, s27, s16
    s_mul_i32 s30, s27, 14336
    v_lshlrev_b32 v121, 4, v7
    v_lshl_add_u32 v121, v8, 10, v121
    v_bfe_u32 v10, v0, 3, 1
    v_bfe_u32 v11, v0, 4, 1
    v_lshl_add_u32 v10, v11, 4, v10
    v_lshrrev_b32 v11, 5, v0
    v_lshl_add_u32 v10, v11, 2, v10
    v_mul_u32_u24 v10, 3584, v10
    v_and_b32 v11, 7, v0
    v_lshl_add_u32 v10, v11, 4, v10
    s_lshl_b32 s27, s16, 7
    v_add_u32 v100, s27, v10
    v_add_u32 v101, 6112, v100
    v_add_u32 v102, 26560, v100
    v_add_u32 v103, 32672, v100
    s_mul_i32 s60, s16, 25344
    s_add_u32 s60, s60, 57344
    s_waitcnt lgkmcnt(0)
    s_mov_b32 s34, 1835008
    s_mov_b32 s35, 0x20000
    s_lshl_b32 s29, s19, 9
    s_add_u32 s36, s36, s29
    s_addc_u32 s37, s37, 0
    s_sub_u32 s38, 1605632, s29
    s_cmp_eq_u32 s19, 7
    s_cselect_b32 s38, 0, s38
    s_mov_b32 s39, 0x20000
    s_mov_b32 s61, 0
    s_add_u32 m0, s60, 21120
    s_nop 0
    buffer_load_dwordx4 v100, s[36:39], s61 offen offset:0 lds
    s_nop 0
    buffer_load_dwordx4 v101, s[36:39], s61 offen offset:1056 lds
    s_nop 0
    buffer_load_dwordx4 v102, s[36:39], s61 offen offset:2112 lds
    s_nop 0
    buffer_load_dwordx4 v103, s[36:39], s61 offen offset:3168 lds
    buffer_load_dwordx4 v[36:39], v9, s[32:35], s30 offen offset:0
    buffer_load_dwordx4 v[40:43], v9, s[32:35], s30 offen offset:64
    buffer_load_dwordx4 v[44:47], v9, s[32:35], s30 offen offset:128
    buffer_load_dwordx4 v[48:51], v9, s[32:35], s30 offen offset:192
    buffer_load_dwordx4 v[52:55], v9, s[32:35], s30 offen offset:256
    buffer_load_dwordx4 v[56:59], v9, s[32:35], s30 offen offset:320
    buffer_load_dwordx4 v[60:63], v9, s[32:35], s30 offen offset:384
    buffer_load_dwordx4 v[64:67], v9, s[32:35], s30 offen offset:448
    buffer_load_dwordx4 v[68:71], v9, s[32:35], s30 offen offset:512
    buffer_load_dwordx4 v[72:75], v9, s[32:35], s30 offen offset:576
    buffer_load_dwordx4 v[76:79], v9, s[32:35], s30 offen offset:640
    buffer_load_dwordx4 v[80:83], v9, s[32:35], s30 offen offset:704
    buffer_load_dwordx4 v[84:87], v9, s[32:35], s30 offen offset:768
    buffer_load_dwordx4 v[88:91], v9, s[32:35], s30 offen offset:832
    s_load_dwordx2 s[40:41], s[0:1], 56
    s_load_dwordx2 s[44:45], s[0:1], 24
    s_load_dwordx2 s[48:49], s[0:1], 64
    s_load_dwordx2 s[52:53], s[0:1], 32
    s_load_dwordx2 s[4:5], s[0:1], 8
    s_load_dwordx2 s[8:9], s[0:1], 16
    s_load_dwordx2 s[12:13], s[0:1], 88
    s_lshl_b32 s29, s19, 9
    s_waitcnt lgkmcnt(0)
    s_add_u32 s40, s40, s29
    s_addc_u32 s41, s41, 0
    s_sub_u32 s42, 1605632, s29
    s_cmp_eq_u32 s19, 7
    s_cselect_b32 s42, 0, s42
    s_mov_b32 s43, 0x20000
    s_lshl_b32 s29, s19, 10
    s_add_u32 s44, s44, s29
    s_addc_u32 s45, s45, 0
    s_sub_u32 s46, 3670016, s29
    s_mov_b32 s47, 0x20000
    s_mul_i32 s29, s19, 229376
    s_add_u32 s48, s48, s29
    s_addc_u32 s49, s49, 0
    s_sub_u32 s50, 1605632, s29
    s_cmp_eq_u32 s19, 7
    s_cselect_b32 s50, 0, s50
    s_mov_b32 s51, 0x20000
    s_mul_i32 s27, s20, 14
    v_add_u32 v10, s27, v0
    v_mul_u32_u24 v11, 3584, v10
    s_lshl_b32 s28, s16, 7
    s_mov_b64 exec, 0x3fff
    buffer_load_dword v34, v11, s[36:39], s28 offen
    buffer_load_dword v34, v11, s[40:43], s28 offen
    s_mov_b64 exec, -1
    s_branch L_body
.p2align 12
L_body:
    s_mov_b32 s14, 0x10000000
    s_mov_b32 s15, 0x20000
    s_lshl_b32 s27, s20, 3
    s_add_u32 s27, s27, s19
    s_lshl_b32 s27, s27, 7
    s_add_u32 s27, s27, 50331648
    v_mov_b32 v14, 0
    s_mov_b64 exec, 1
    buffer_store_dword v14, v14, s[12:15], s27 offen sc1
    s_mov_b64 exec, -1
    v_bfe_u32 v10, v0, 3, 2
    v_mul_u32_u24 v120, 1056, v10
    v_bfe_u32 v10, v0, 2, 1
    v_lshl_add_u32 v120, v10, 7, v120
    v_lshrrev_b32 v10, 5, v0
    v_lshl_add_u32 v120, v10, 8, v120
    v_and_b32 v10, 3, v0
    v_lshl_add_u32 v120, v10, 3, v120
    v_add_u32 v120, s60, v120
    s_mov_b64 exec, 0
    s_cmp_eq_u32 s16, 0
    s_cbranch_scc1 L_pg1
    s_cmp_eq_u32 s16, 1
    s_cbranch_scc1 L_pg2
    s_cmp_eq_u32 s16, 2
    s_cbranch_scc1 L_pg3
    s_branch L_pg4
L_pgret:
    s_mov_b64 exec, -1
    v_bfe_u32 v10, v0, 3, 1
    v_bfe_u32 v11, v0, 4, 1
    v_lshl_add_u32 v10, v11, 4, v10
    v_lshrrev_b32 v11, 5, v0
    v_lshl_add_u32 v10, v11, 2, v10
    v_mul_u32_u24 v10, 8192, v10
    v_and_b32 v11, 7, v0
    v_lshl_add_u32 v10, v11, 4, v10
    s_lshl_b32 s27, s16, 8
    v_add_u32 v104, s27, v10
    v_add_u32 v105, 15328, v104
    v_add_u32 v106, 63424, v104
    v_add_u32 v107, 78752, v104
    s_mov_b32 s27, 128
    v_add_u32 v108, s27, v104
    v_add_u32 v109, s27, v105
    v_add_u32 v110, s27, v106
    v_add_u32 v111, s27, v107
    s_mul_i32 s29, s19, 458752
    s_add_u32 s52, s52, s29
    s_addc_u32 s53, s53, 0
    s_sub_u32 s54, 3670016, s29
    s_mov_b32 s55, 0x20000
    v_bfe_u32 v10, v0, 3, 1
    v_bfe_u32 v11, v0, 4, 1
    v_lshl_add_u32 v10, v11, 3, v10
    v_lshrrev_b32 v11, 5, v0
    v_lshl_add_u32 v10, v11, 4, v10
    v_mul_u32_u24 v10, 896, v10
    v_and_b32 v11, 7, v0
    v_lshl_add_u32 v10, v11, 4, v10
    s_lshl_b32 s27, s16, 8
    v_add_u32 v112, s27, v10
    v_add_u32 v113, 736, v112
    v_add_u32 v114, 1472, v112
    v_add_u32 v115, 2208, v112
    s_cmp_eq_u32 s16, 3
    s_cselect_b32 s27, 0x40000000, 128
    v_add_u32 v116, s27, v112
    v_add_u32 v117, s27, v113
    v_add_u32 v118, s27, v114
    v_add_u32 v119, s27, v115
    s_lshl_b32 s27, s19, 20
    s_lshl_b32 s28, s18, 19
    s_add_u32 s29, s27, s28
    s_add_u32 s4, s4, s29
    s_addc_u32 s5, s5, 0
    s_sub_u32 s6, 8388608, s29
    s_mov_b32 s7, 0x20000
    s_add_u32 s8, s8, s29
    s_addc_u32 s9, s9, 0
    s_sub_u32 s10, 8388608, s29
    s_mov_b32 s11, 0x20000
    s_mov_b32 s6, 0x80000
    s_mov_b32 s10, 0x80000
    s_cmp_eq_u32 s17, 0
    s_cselect_b32 s56, s4, s8
    s_cselect_b32 s57, s5, s9
    s_mov_b32 s58, 0x80000
    s_mov_b32 s59, 0x20000
    v_bfe_u32 v11, v0, 1, 3
    v_mul_u32_u24 v1, 1056, v11
    v_and_b32 v11, 1, v0
    v_lshrrev_b32 v12, 4, v0
    v_xor_b32 v13, v11, v12
    v_lshlrev_b32 v13, 4, v13
    v_lshl_add_u32 v13, v11, 9, v13
    v_add_u32 v1, v1, v13
    s_mul_i32 s27, s18, 16896
    v_add_u32 v1, s27, v1
    v_and_b32 v10, 31, v0
    v_lshrrev_b32 v12, 5, v0
    v_xor_b32 v13, v10, v12
    v_lshlrev_b32 v13, 4, v13
    v_lshl_add_u32 v13, v12, 9, v13
    s_lshl_b32 s28, s17, 13
    s_add_u32 s28, s28, 128
    v_add_u32 v3, s28, v13
    s_mul_i32 s29, s17, 8448
    s_add_u32 s24, s27, s29
    s_add_u32 s25, s24, 67584
    v_bfe_u32 v10, v0, 3, 2
    v_mul_u32_u24 v2, 1056, v10
    v_bfe_u32 v10, v0, 2, 1
    v_lshl_add_u32 v10, v12, 1, v10
    v_lshl_add_u32 v2, v10, 7, v2
    v_and_b32 v10, 3, v0
    v_lshl_add_u32 v2, v10, 3, v2
    s_add_u32 s27, s27, 67584
    s_mul_i32 s29, s18, 8448
    s_sub_u32 s28, s27, s29
    s_add_u32 s28, s28, 8448
    s_add_u32 s27, s27, s29
    v_add_u32 v32, s28, v2
    v_add_u32 v2, s27, v2
    v_lshrrev_b32 v10, 4, v0
    v_lshlrev_b32 v10, 3, v10
    v_bfe_u32 v11, v0, 3, 1
    v_add_u32 v10, v10, v11
    v_and_b32 v11, 7, v0
    v_lshlrev_b32 v11, 4, v11
    v_lshl_add_u32 v10, v10, 9, v11
    s_lshl_b32 s28, s17, 8
    s_add_u32 s28, s28, 128
    v_add_u32 v4, s28, v10
    s_add_u32 s72, s24, 0
    s_add_u32 s73, s24, 4224
    s_add_u32 s74, s24, 33792
    s_add_u32 s75, s24, 38016
    s_add_u32 s76, s25, 0
    s_add_u32 s77, s25, 4224
    s_add_u32 s78, s25, 33792
    s_add_u32 s79, s25, 38016
    s_sub_u32 s64, s4, 128
    s_subb_u32 s65, s5, 0
    s_mov_b32 s66, 524416
    s_mov_b32 s67, 0x20000
    s_add_u32 s68, s4, 3968
    s_addc_u32 s69, s5, 0
    s_mov_b32 s70, 520320
    s_mov_b32 s71, 0x20000
    s_add_u32 s80, s8, 0
    s_addc_u32 s81, s9, 0
    s_mov_b32 s82, 524288
    s_mov_b32 s83, 0x20000
    s_sub_u32 s8, s8, 128
    s_subb_u32 s9, s9, 0
    s_mov_b32 s10, 524416
    s_mov_b32 s11, 0x20000
    s_mov_b32 s21, 16384
    s_mov_b32 s63, 16384
    s_mov_b32 s32, s12
    s_mov_b32 s33, s13
    s_cmp_eq_u32 s19, 7
    s_cselect_b32 s34, 0, s14
    s_mov_b32 s35, 0x20000
    s_lshl_b32 s27, s20, 9
    v_lshlrev_b32 v10, 7, v0
    s_add_u32 s27, s27, 114688
    v_add_u32 v10, s27, v10
    v_mov_b32 v11, 0x40000000
    v_cmp_gt_u32 vcc, 4, v0
    s_nop 1
    v_cndmask_b32 v33, v11, v10, vcc
    s_mov_b32 s31, 0xffff0000
    s_waitcnt vmcnt(16)
    v_lshlrev_b32 v128, 16, v36
    v_and_b32 v129, s31, v36
    v_lshlrev_b32 v130, 16, v37
    v_and_b32 v131, s31, v37
    v_lshlrev_b32 v132, 16, v38
    v_and_b32 v133, s31, v38
    v_pk_add_f32 v[6:7], v[128:129], v[130:131]
    v_lshlrev_b32 v134, 16, v39
    v_and_b32 v135, s31, v39
    v_pk_add_f32 v[6:7], v[6:7], v[132:133]
    s_waitcnt vmcnt(15)
    v_lshlrev_b32 v136, 16, v40
    v_and_b32 v137, s31, v40
    v_pk_add_f32 v[6:7], v[6:7], v[134:135]
    v_lshlrev_b32 v138, 16, v41
    v_and_b32 v139, s31, v41
    v_pk_add_f32 v[6:7], v[6:7], v[136:137]
    v_lshlrev_b32 v140, 16, v42
    v_and_b32 v141, s31, v42
    v_pk_add_f32 v[6:7], v[6:7], v[138:139]
    v_lshlrev_b32 v142, 16, v43
    v_and_b32 v143, s31, v43
    v_pk_add_f32 v[6:7], v[6:7], v[140:141]
    s_waitcnt vmcnt(14)
    v_lshlrev_b32 v144, 16, v44
    v_and_b32 v145, s31, v44
    v_pk_add_f32 v[6:7], v[6:7], v[142:143]
    v_lshlrev_b32 v146, 16, v45
    v_and_b32 v147, s31, v45
    v_pk_add_f32 v[6:7], v[6:7], v[144:145]
    v_lshlrev_b32 v148, 16, v46
    v_and_b32 v149, s31, v46
    v_pk_add_f32 v[6:7], v[6:7], v[146:147]
    v_lshlrev_b32 v150, 16, v47
    v_and_b32 v151, s31, v47
    v_pk_add_f32 v[6:7], v[6:7], v[148:149]
    s_waitcnt vmcnt(13)
    v_lshlrev_b32 v152, 16, v48
    v_and_b32 v153, s31, v48
    v_pk_add_f32 v[6:7], v[6:7], v[150:151]
    v_lshlrev_b32 v154, 16, v49
    v_and_b32 v155, s31, v49
    v_pk_add_f32 v[6:7], v[6:7], v[152:153]
    v_lshlrev_b32 v156, 16, v50
    v_and_b32 v157, s31, v50
    v_pk_add_f32 v[6:7], v[6:7], v[154:155]
    v_lshlrev_b32 v158, 16, v51
    v_and_b32 v159, s31, v51
    v_pk_add_f32 v[6:7], v[6:7], v[156:157]
    s_waitcnt vmcnt(12)
    v_lshlrev_b32 v160, 16, v52
    v_and_b32 v161, s31, v52
    v_pk_add_f32 v[6:7], v[6:7], v[158:159]
    v_lshlrev_b32 v162, 16, v53
    v_and_b32 v163, s31, v53
    v_pk_add_f32 v[6:7], v[6:7], v[160:161]
    v_lshlrev_b32 v164, 16, v54
    v_and_b32 v165, s31, v54
    v_pk_add_f32 v[6:7], v[6:7], v[162:163]
    v_lshlrev_b32 v166, 16, v55
    v_and_b32 v167, s31, v55
    v_pk_add_f32 v[6:7], v[6:7], v[164:165]
    s_waitcnt vmcnt(11)
    v_lshlrev_b32 v168, 16, v56
    v_and_b32 v169, s31, v56
    v_pk_add_f32 v[6:7], v[6:7], v[166:167]
    v_lshlrev_b32 v170, 16, v57
    v_and_b32 v171, s31, v57
    v_pk_add_f32 v[6:7], v[6:7], v[168:169]
    v_lshlrev_b32 v172, 16, v58
    v_and_b32 v173, s31, v58
    v_pk_add_f32 v[6:7], v[6:7], v[170:171]
    v_lshlrev_b32 v174, 16, v59
    v_and_b32 v175, s31, v59
    v_pk_add_f32 v[6:7], v[6:7], v[172:173]
    s_waitcnt vmcnt(10)
    v_lshlrev_b32 v176, 16, v60
    v_and_b32 v177, s31, v60
    v_pk_add_f32 v[6:7], v[6:7], v[174:175]
    v_lshlrev_b32 v178, 16, v61
    v_and_b32 v179, s31, v61
    v_pk_add_f32 v[6:7], v[6:7], v[176:177]
    v_lshlrev_b32 v180, 16, v62
    v_and_b32 v181, s31, v62
    v_pk_add_f32 v[6:7], v[6:7], v[178:179]
    v_lshlrev_b32 v182, 16, v63
    v_and_b32 v183, s31, v63
    v_pk_add_f32 v[6:7], v[6:7], v[180:181]
    s_waitcnt vmcnt(9)
    v_lshlrev_b32 v184, 16, v64
    v_and_b32 v185, s31, v64
    v_pk_add_f32 v[6:7], v[6:7], v[182:183]
    v_lshlrev_b32 v186, 16, v65
    v_and_b32 v187, s31, v65
    v_pk_add_f32 v[6:7], v[6:7], v[184:185]
    v_lshlrev_b32 v188, 16, v66
    v_and_b32 v189, s31, v66
    v_pk_add_f32 v[6:7], v[6:7], v[186:187]
    v_lshlrev_b32 v190, 16, v67
    v_and_b32 v191, s31, v67
    v_pk_add_f32 v[6:7], v[6:7], v[188:189]
    s_waitcnt vmcnt(8)
    v_lshlrev_b32 v192, 16, v68
    v_and_b32 v193, s31, v68
    v_pk_add_f32 v[6:7], v[6:7], v[190:191]
    v_lshlrev_b32 v194, 16, v69
    v_and_b32 v195, s31, v69
    v_pk_add_f32 v[6:7], v[6:7], v[192:193]
    v_lshlrev_b32 v196, 16, v70
    v_and_b32 v197, s31, v70
    v_pk_add_f32 v[6:7], v[6:7], v[194:195]
    v_lshlrev_b32 v198, 16, v71
    v_and_b32 v199, s31, v71
    v_pk_add_f32 v[6:7], v[6:7], v[196:197]
    s_waitcnt vmcnt(7)
    v_lshlrev_b32 v200, 16, v72
    v_and_b32 v201, s31, v72
    v_pk_add_f32 v[6:7], v[6:7], v[198:199]
    v_lshlrev_b32 v202, 16, v73
    v_and_b32 v203, s31, v73
    v_pk_add_f32 v[6:7], v[6:7], v[200:201]
    v_lshlrev_b32 v204, 16, v74
    v_and_b32 v205, s31, v74
    v_pk_add_f32 v[6:7], v[6:7], v[202:203]
    v_lshlrev_b32 v206, 16, v75
    v_and_b32 v207, s31, v75
    v_pk_add_f32 v[6:7], v[6:7], v[204:205]
    s_waitcnt vmcnt(6)
    v_lshlrev_b32 v208, 16, v76
    v_and_b32 v209, s31, v76
    v_pk_add_f32 v[6:7], v[6:7], v[206:207]
    v_lshlrev_b32 v210, 16, v77
    v_and_b32 v211, s31, v77
    v_pk_add_f32 v[6:7], v[6:7], v[208:209]
    v_lshlrev_b32 v212, 16, v78
    v_and_b32 v213, s31, v78
    v_pk_add_f32 v[6:7], v[6:7], v[210:211]
    v_lshlrev_b32 v214, 16, v79
    v_and_b32 v215, s31, v79
    v_pk_add_f32 v[6:7], v[6:7], v[212:213]
    s_waitcnt vmcnt(5)
    v_lshlrev_b32 v216, 16, v80
    v_and_b32 v217, s31, v80
    v_pk_add_f32 v[6:7], v[6:7], v[214:215]
    v_lshlrev_b32 v218, 16, v81
    v_and_b32 v219, s31, v81
    v_pk_add_f32 v[6:7], v[6:7], v[216:217]
    v_lshlrev_b32 v220, 16, v82
    v_and_b32 v221, s31, v82
    v_pk_add_f32 v[6:7], v[6:7], v[218:219]
    v_lshlrev_b32 v222, 16, v83
    v_and_b32 v223, s31, v83
    v_pk_add_f32 v[6:7], v[6:7], v[220:221]
    s_waitcnt vmcnt(4)
    v_lshlrev_b32 v224, 16, v84
    v_and_b32 v225, s31, v84
    v_pk_add_f32 v[6:7], v[6:7], v[222:223]
    v_lshlrev_b32 v226, 16, v85
    v_and_b32 v227, s31, v85
    v_pk_add_f32 v[6:7], v[6:7], v[224:225]
    v_lshlrev_b32 v228, 16, v86
    v_and_b32 v229, s31, v86
    v_pk_add_f32 v[6:7], v[6:7], v[226:227]
    v_lshlrev_b32 v230, 16, v87
    v_and_b32 v231, s31, v87
    v_pk_add_f32 v[6:7], v[6:7], v[228:229]
    s_waitcnt vmcnt(3)
    v_lshlrev_b32 v232, 16, v88
    v_and_b32 v233, s31, v88
    v_pk_add_f32 v[6:7], v[6:7], v[230:231]
    v_lshlrev_b32 v234, 16, v89
    v_and_b32 v235, s31, v89
    v_pk_add_f32 v[6:7], v[6:7], v[232:233]
    v_lshlrev_b32 v236, 16, v90
    v_and_b32 v237, s31, v90
    v_pk_add_f32 v[6:7], v[6:7], v[234:235]
    v_lshlrev_b32 v238, 16, v91
    v_and_b32 v239, s31, v91
    v_pk_add_f32 v[6:7], v[6:7], v[236:237]
    v_pk_add_f32 v[6:7], v[6:7], v[238:239]
    v_add_f32 v6, v6, v7
    v_mov_b32 v7, v6
    s_nop 1
    v_permlane16_swap_b32 v7, v6
    s_nop 1
    v_add_f32 v6, v6, v7
    v_mov_b32 v7, v6
    s_nop 1
    v_permlane32_swap_b32 v7, v6
    s_nop 1
    v_add_f32 v6, v6, v7
    v_mul_f32 v6, 0x3b124925, v6
    v_mov_b32 v8, v6
    v_cvt_pk_bf16_f32 v8, v8, v8
    v_lshlrev_b32 v8, 16, v8
    v_sub_f32 v12, v6, v8
    v_pk_add_f32 v[128:129], v[128:129], v[8:9] op_sel_hi:[1,0] neg_lo:[0,1] neg_hi:[0,1]
    v_pk_add_f32 v[130:131], v[130:131], v[8:9] op_sel_hi:[1,0] neg_lo:[0,1] neg_hi:[0,1]
    v_pk_mul_f32 v[10:11], v[128:129], v[128:129]
    v_pk_add_f32 v[132:133], v[132:133], v[8:9] op_sel_hi:[1,0] neg_lo:[0,1] neg_hi:[0,1]
    v_pk_fma_f32 v[10:11], v[130:131], v[130:131], v[10:11]
    v_pk_add_f32 v[134:135], v[134:135], v[8:9] op_sel_hi:[1,0] neg_lo:[0,1] neg_hi:[0,1]
    v_pk_fma_f32 v[10:11], v[132:133], v[132:133], v[10:11]
    v_pk_add_f32 v[136:137], v[136:137], v[8:9] op_sel_hi:[1,0] neg_lo:[0,1] neg_hi:[0,1]
    v_pk_fma_f32 v[10:11], v[134:135], v[134:135], v[10:11]
    v_pk_add_f32 v[138:139], v[138:139], v[8:9] op_sel_hi:[1,0] neg_lo:[0,1] neg_hi:[0,1]
    v_pk_fma_f32 v[10:11], v[136:137], v[136:137], v[10:11]
    v_pk_add_f32 v[140:141], v[140:141], v[8:9] op_sel_hi:[1,0] neg_lo:[0,1] neg_hi:[0,1]
    v_pk_fma_f32 v[10:11], v[138:139], v[138:139], v[10:11]
    v_pk_add_f32 v[142:143], v[142:143], v[8:9] op_sel_hi:[1,0] neg_lo:[0,1] neg_hi:[0,1]
    v_pk_fma_f32 v[10:11], v[140:141], v[140:141], v[10:11]
    v_pk_add_f32 v[144:145], v[144:145], v[8:9] op_sel_hi:[1,0] neg_lo:[0,1] neg_hi:[0,1]
    v_pk_fma_f32 v[10:11], v[142:143], v[142:143], v[10:11]
    v_pk_add_f32 v[146:147], v[146:147], v[8:9] op_sel_hi:[1,0] neg_lo:[0,1] neg_hi:[0,1]
    v_pk_fma_f32 v[10:11], v[144:145], v[144:145], v[10:11]
    v_pk_add_f32 v[148:149], v[148:149], v[8:9] op_sel_hi:[1,0] neg_lo:[0,1] neg_hi:[0,1]
    v_pk_fma_f32 v[10:11], v[146:147], v[146:147], v[10:11]
    v_pk_add_f32 v[150:151], v[150:151], v[8:9] op_sel_hi:[1,0] neg_lo:[0,1] neg_hi:[0,1]
    v_pk_fma_f32 v[10:11], v[148:149], v[148:149], v[10:11]
    v_pk_add_f32 v[152:153], v[152:153], v[8:9] op_sel_hi:[1,0] neg_lo:[0,1] neg_hi:[0,1]
    v_pk_fma_f32 v[10:11], v[150:151], v[150:151], v[10:11]
    v_pk_add_f32 v[154:155], v[154:155], v[8:9] op_sel_hi:[1,0] neg_lo:[0,1] neg_hi:[0,1]
    v_pk_fma_f32 v[10:11], v[152:153], v[152:153], v[10:11]
    v_pk_add_f32 v[156:157], v[156:157], v[8:9] op_sel_hi:[1,0] neg_lo:[0,1] neg_hi:[0,1]
    v_pk_fma_f32 v[10:11], v[154:155], v[154:155], v[10:11]
    v_pk_add_f32 v[158:159], v[158:159], v[8:9] op_sel_hi:[1,0] neg_lo:[0,1] neg_hi:[0,1]
    v_pk_fma_f32 v[10:11], v[156:157], v[156:157], v[10:11]
    v_pk_add_f32 v[160:161], v[160:161], v[8:9] op_sel_hi:[1,0] neg_lo:[0,1] neg_hi:[0,1]
    v_pk_fma_f32 v[10:11], v[158:159], v[158:159], v[10:11]
    v_pk_add_f32 v[162:163], v[162:163], v[8:9] op_sel_hi:[1,0] neg_lo:[0,1] neg_hi:[0,1]
    v_pk_fma_f32 v[10:11], v[160:161], v[160:161], v[10:11]
    v_pk_add_f32 v[164:165], v[164:165], v[8:9] op_sel_hi:[1,0] neg_lo:[0,1] neg_hi:[0,1]
    v_pk_fma_f32 v[10:11], v[162:163], v[162:163], v[10:11]
    v_pk_add_f32 v[166:167], v[166:167], v[8:9] op_sel_hi:[1,0] neg_lo:[0,1] neg_hi:[0,1]
    v_pk_fma_f32 v[10:11], v[164:165], v[164:165], v[10:11]
    v_pk_add_f32 v[168:169], v[168:169], v[8:9] op_sel_hi:[1,0] neg_lo:[0,1] neg_hi:[0,1]
    v_pk_fma_f32 v[10:11], v[166:167], v[166:167], v[10:11]
    v_pk_add_f32 v[170:171], v[170:171], v[8:9] op_sel_hi:[1,0] neg_lo:[0,1] neg_hi:[0,1]
    v_pk_fma_f32 v[10:11], v[168:169], v[168:169], v[10:11]
    v_pk_add_f32 v[172:173], v[172:173], v[8:9] op_sel_hi:[1,0] neg_lo:[0,1] neg_hi:[0,1]
    v_pk_fma_f32 v[10:11], v[170:171], v[170:171], v[10:11]
    v_pk_add_f32 v[174:175], v[174:175], v[8:9] op_sel_hi:[1,0] neg_lo:[0,1] neg_hi:[0,1]
    v_pk_fma_f32 v[10:11], v[172:173], v[172:173], v[10:11]
    v_pk_add_f32 v[176:177], v[176:177], v[8:9] op_sel_hi:[1,0] neg_lo:[0,1] neg_hi:[0,1]
    v_pk_fma_f32 v[10:11], v[174:175], v[174:175], v[10:11]
    v_pk_add_f32 v[178:179], v[178:179], v[8:9] op_sel_hi:[1,0] neg_lo:[0,1] neg_hi:[0,1]
    v_pk_fma_f32 v[10:11], v[176:177], v[176:177], v[10:11]
    v_pk_add_f32 v[180:181], v[180:181], v[8:9] op_sel_hi:[1,0] neg_lo:[0,1] neg_hi:[0,1]
    v_pk_fma_f32 v[10:11], v[178:179], v[178:179], v[10:11]
    v_pk_add_f32 v[182:183], v[182:183], v[8:9] op_sel_hi:[1,0] neg_lo:[0,1] neg_hi:[0,1]
    v_pk_fma_f32 v[10:11], v[180:181], v[180:181], v[10:11]
    v_pk_add_f32 v[184:185], v[184:185], v[8:9] op_sel_hi:[1,0] neg_lo:[0,1] neg_hi:[0,1]
    v_pk_fma_f32 v[10:11], v[182:183], v[182:183], v[10:11]
    v_pk_add_f32 v[186:187], v[186:187], v[8:9] op_sel_hi:[1,0] neg_lo:[0,1] neg_hi:[0,1]
    v_pk_fma_f32 v[10:11], v[184:185], v[184:185], v[10:11]
    v_pk_add_f32 v[188:189], v[188:189], v[8:9] op_sel_hi:[1,0] neg_lo:[0,1] neg_hi:[0,1]
    v_pk_fma_f32 v[10:11], v[186:187], v[186:187], v[10:11]
    v_pk_add_f32 v[190:191], v[190:191], v[8:9] op_sel_hi:[1,0] neg_lo:[0,1] neg_hi:[0,1]
    v_pk_fma_f32 v[10:11], v[188:189], v[188:189], v[10:11]
    v_pk_add_f32 v[192:193], v[192:193], v[8:9] op_sel_hi:[1,0] neg_lo:[0,1] neg_hi:[0,1]
    v_pk_fma_f32 v[10:11], v[190:191], v[190:191], v[10:11]
    v_pk_add_f32 v[194:195], v[194:195], v[8:9] op_sel_hi:[1,0] neg_lo:[0,1] neg_hi:[0,1]
    v_pk_fma_f32 v[10:11], v[192:193], v[192:193], v[10:11]
    v_pk_add_f32 v[196:197], v[196:197], v[8:9] op_sel_hi:[1,0] neg_lo:[0,1] neg_hi:[0,1]
    v_pk_fma_f32 v[10:11], v[194:195], v[194:195], v[10:11]
    v_pk_add_f32 v[198:199], v[198:199], v[8:9] op_sel_hi:[1,0] neg_lo:[0,1] neg_hi:[0,1]
    v_pk_fma_f32 v[10:11], v[196:197], v[196:197], v[10:11]
    v_pk_add_f32 v[200:201], v[200:201], v[8:9] op_sel_hi:[1,0] neg_lo:[0,1] neg_hi:[0,1]
    v_pk_fma_f32 v[10:11], v[198:199], v[198:199], v[10:11]
    v_pk_add_f32 v[202:203], v[202:203], v[8:9] op_sel_hi:[1,0] neg_lo:[0,1] neg_hi:[0,1]
    v_pk_fma_f32 v[10:11], v[200:201], v[200:201], v[10:11]
    v_pk_add_f32 v[204:205], v[204:205], v[8:9] op_sel_hi:[1,0] neg_lo:[0,1] neg_hi:[0,1]
    v_pk_fma_f32 v[10:11], v[202:203], v[202:203], v[10:11]
    v_pk_add_f32 v[206:207], v[206:207], v[8:9] op_sel_hi:[1,0] neg_lo:[0,1] neg_hi:[0,1]
    v_pk_fma_f32 v[10:11], v[204:205], v[204:205], v[10:11]
    v_pk_add_f32 v[208:209], v[208:209], v[8:9] op_sel_hi:[1,0] neg_lo:[0,1] neg_hi:[0,1]
    v_pk_fma_f32 v[10:11], v[206:207], v[206:207], v[10:11]
    v_pk_add_f32 v[210:211], v[210:211], v[8:9] op_sel_hi:[1,0] neg_lo:[0,1] neg_hi:[0,1]
    v_pk_fma_f32 v[10:11], v[208:209], v[208:209], v[10:11]
    v_pk_add_f32 v[212:213], v[212:213], v[8:9] op_sel_hi:[1,0] neg_lo:[0,1] neg_hi:[0,1]
    v_pk_fma_f32 v[10:11], v[210:211], v[210:211], v[10:11]
    v_pk_add_f32 v[214:215], v[214:215], v[8:9] op_sel_hi:[1,0] neg_lo:[0,1] neg_hi:[0,1]
    v_pk_fma_f32 v[10:11], v[212:213], v[212:213], v[10:11]
    v_pk_add_f32 v[216:217], v[216:217], v[8:9] op_sel_hi:[1,0] neg_lo:[0,1] neg_hi:[0,1]
    v_pk_fma_f32 v[10:11], v[214:215], v[214:215], v[10:11]
    v_pk_add_f32 v[218:219], v[218:219], v[8:9] op_sel_hi:[1,0] neg_lo:[0,1] neg_hi:[0,1]
    v_pk_fma_f32 v[10:11], v[216:217], v[216:217], v[10:11]
    v_pk_add_f32 v[220:221], v[220:221], v[8:9] op_sel_hi:[1,0] neg_lo:[0,1] neg_hi:[0,1]
    v_pk_fma_f32 v[10:11], v[218:219], v[218:219], v[10:11]
    v_pk_add_f32 v[222:223], v[222:223], v[8:9] op_sel_hi:[1,0] neg_lo:[0,1] neg_hi:[0,1]
    v_pk_fma_f32 v[10:11], v[220:221], v[220:221], v[10:11]
    v_pk_add_f32 v[224:225], v[224:225], v[8:9] op_sel_hi:[1,0] neg_lo:[0,1] neg_hi:[0,1]
    v_pk_fma_f32 v[10:11], v[222:223], v[222:223], v[10:11]
    v_pk_add_f32 v[226:227], v[226:227], v[8:9] op_sel_hi:[1,0] neg_lo:[0,1] neg_hi:[0,1]
    v_pk_fma_f32 v[10:11], v[224:225], v[224:225], v[10:11]
    v_pk_add_f32 v[228:229], v[228:229], v[8:9] op_sel_hi:[1,0] neg_lo:[0,1] neg_hi:[0,1]
    v_pk_fma_f32 v[10:11], v[226:227], v[226:227], v[10:11]
    v_pk_add_f32 v[230:231], v[230:231], v[8:9] op_sel_hi:[1,0] neg_lo:[0,1] neg_hi:[0,1]
    v_pk_fma_f32 v[10:11], v[228:229], v[228:229], v[10:11]
    v_pk_add_f32 v[232:233], v[232:233], v[8:9] op_sel_hi:[1,0] neg_lo:[0,1] neg_hi:[0,1]
    v_pk_fma_f32 v[10:11], v[230:231], v[230:231], v[10:11]
    v_pk_add_f32 v[234:235], v[234:235], v[8:9] op_sel_hi:[1,0] neg_lo:[0,1] neg_hi:[0,1]
    v_pk_fma_f32 v[10:11], v[232:233], v[232:233], v[10:11]
    v_pk_add_f32 v[236:237], v[236:237], v[8:9] op_sel_hi:[1,0] neg_lo:[0,1] neg_hi:[0,1]
    v_pk_fma_f32 v[10:11], v[234:235], v[234:235], v[10:11]
    v_pk_add_f32 v[238:239], v[238:239], v[8:9] op_sel_hi:[1,0] neg_lo:[0,1] neg_hi:[0,1]
    v_pk_fma_f32 v[10:11], v[236:237], v[236:237], v[10:11]
    v_pk_fma_f32 v[10:11], v[238:239], v[238:239], v[10:11]
    v_add_f32 v10, v10, v11
    v_mov_b32 v11, v10
    s_nop 1
    v_permlane16_swap_b32 v11, v10
    s_nop 1
    v_add_f32 v10, v10, v11
    v_mov_b32 v11, v10
    s_nop 1
    v_permlane32_swap_b32 v11, v10
    s_nop 1
    v_add_f32 v10, v10, v11
    v_mul_f32 v10, 0x3b124925, v10
    v_fma_f32 v10, -v12, v12, v10
    v_cvt_pk_bf16_f32 v10, v10, v10
    v_lshlrev_b32 v10, 16, v10
    v_add_f32 v10, 0x3727c5ac, v10
    v_cvt_pk_bf16_f32 v10, v10, v10
    v_lshlrev_b32 v10, 16, v10
    v_sqrt_f32 v10, v10
    s_nop 0
    v_cvt_pk_bf16_f32 v10, v10, v10
    v_lshlrev_b32 v10, 16, v10
    v_rcp_f32 v10, v10
    s_lshl_b32 s27, s16, 8
    v_add_u32 v12, s27, v121
    v_mul_f32 v10, 0x3db8aa3b, v10
    v_pk_mul_f32 v[128:129], v[128:129], v[10:11] op_sel_hi:[1,0]
    v_pk_mul_f32 v[130:131], v[130:131], v[10:11] op_sel_hi:[1,0]
    v_pk_mul_f32 v[132:133], v[132:133], v[10:11] op_sel_hi:[1,0]
    s_add_u32 m0, s60, 0
    v_pk_mul_f32 v[134:135], v[134:135], v[10:11] op_sel_hi:[1,0]
    buffer_load_dwordx4 v100, s[40:43], s61 offen offset:0 lds
    v_cvt_pk_bf16_f32 v36, v128, v129
    v_cvt_pk_bf16_f32 v37, v130, v131
    v_cvt_pk_bf16_f32 v38, v132, v133
    v_cvt_pk_bf16_f32 v39, v134, v135
    ds_write_b128 v12, v[36:39] offset:0
    v_pk_mul_f32 v[136:137], v[136:137], v[10:11] op_sel_hi:[1,0]
    v_pk_mul_f32 v[138:139], v[138:139], v[10:11] op_sel_hi:[1,0]
    buffer_load_dwordx4 v101, s[40:43], s61 offen offset:1056 lds
    v_pk_mul_f32 v[140:141], v[140:141], v[10:11] op_sel_hi:[1,0]
    v_pk_mul_f32 v[142:143], v[142:143], v[10:11] op_sel_hi:[1,0]
    v_cvt_pk_bf16_f32 v40, v136, v137
    v_cvt_pk_bf16_f32 v41, v138, v139
    v_cvt_pk_bf16_f32 v42, v140, v141
    v_cvt_pk_bf16_f32 v43, v142, v143
    buffer_load_dwordx4 v102, s[40:43], s61 offen offset:2112 lds
    ds_write_b128 v12, v[40:43] offset:4096
    v_pk_mul_f32 v[144:145], v[144:145], v[10:11] op_sel_hi:[1,0]
    v_pk_mul_f32 v[146:147], v[146:147], v[10:11] op_sel_hi:[1,0]
    v_pk_mul_f32 v[148:149], v[148:149], v[10:11] op_sel_hi:[1,0]
    v_pk_mul_f32 v[150:151], v[150:151], v[10:11] op_sel_hi:[1,0]
    v_cvt_pk_bf16_f32 v44, v144, v145
    v_cvt_pk_bf16_f32 v45, v146, v147
    buffer_load_dwordx4 v103, s[40:43], s61 offen offset:3168 lds
    v_cvt_pk_bf16_f32 v46, v148, v149
    v_cvt_pk_bf16_f32 v47, v150, v151
    ds_write_b128 v12, v[44:47] offset:8192
    v_pk_mul_f32 v[152:153], v[152:153], v[10:11] op_sel_hi:[1,0]
    v_pk_mul_f32 v[154:155], v[154:155], v[10:11] op_sel_hi:[1,0]
    v_pk_mul_f32 v[156:157], v[156:157], v[10:11] op_sel_hi:[1,0]
    s_mov_b32 s61, 114688
    s_add_u32 m0, s60, 4224
    v_pk_mul_f32 v[158:159], v[158:159], v[10:11] op_sel_hi:[1,0]
    buffer_load_dwordx4 v100, s[36:39], s61 offen offset:0 lds
    v_cvt_pk_bf16_f32 v48, v152, v153
    v_cvt_pk_bf16_f32 v49, v154, v155
    v_cvt_pk_bf16_f32 v50, v156, v157
    v_cvt_pk_bf16_f32 v51, v158, v159
    ds_write_b128 v12, v[48:51] offset:12288
    v_pk_mul_f32 v[160:161], v[160:161], v[10:11] op_sel_hi:[1,0]
    v_pk_mul_f32 v[162:163], v[162:163], v[10:11] op_sel_hi:[1,0]
    buffer_load_dwordx4 v101, s[36:39], s61 offen offset:1056 lds
    v_pk_mul_f32 v[164:165], v[164:165], v[10:11] op_sel_hi:[1,0]
    v_pk_mul_f32 v[166:167], v[166:167], v[10:11] op_sel_hi:[1,0]
    v_cvt_pk_bf16_f32 v52, v160, v161
    v_cvt_pk_bf16_f32 v53, v162, v163
    v_cvt_pk_bf16_f32 v54, v164, v165
    v_cvt_pk_bf16_f32 v55, v166, v167
    buffer_load_dwordx4 v102, s[36:39], s61 offen offset:2112 lds
    ds_write_b128 v12, v[52:55] offset:16384
    v_pk_mul_f32 v[168:169], v[168:169], v[10:11] op_sel_hi:[1,0]
    v_pk_mul_f32 v[170:171], v[170:171], v[10:11] op_sel_hi:[1,0]
    v_pk_mul_f32 v[172:173], v[172:173], v[10:11] op_sel_hi:[1,0]
    v_pk_mul_f32 v[174:175], v[174:175], v[10:11] op_sel_hi:[1,0]
    v_cvt_pk_bf16_f32 v56, v168, v169
    v_cvt_pk_bf16_f32 v57, v170, v171
    buffer_load_dwordx4 v103, s[36:39], s61 offen offset:3168 lds
    v_cvt_pk_bf16_f32 v58, v172, v173
    v_cvt_pk_bf16_f32 v59, v174, v175
    ds_write_b128 v12, v[56:59] offset:20480
    v_pk_mul_f32 v[176:177], v[176:177], v[10:11] op_sel_hi:[1,0]
    v_pk_mul_f32 v[178:179], v[178:179], v[10:11] op_sel_hi:[1,0]
    v_pk_mul_f32 v[180:181], v[180:181], v[10:11] op_sel_hi:[1,0]
    s_add_u32 m0, s60, 8448
    v_pk_mul_f32 v[182:183], v[182:183], v[10:11] op_sel_hi:[1,0]
    buffer_load_dwordx4 v100, s[40:43], s61 offen offset:0 lds
    v_cvt_pk_bf16_f32 v60, v176, v177
    v_cvt_pk_bf16_f32 v61, v178, v179
    v_cvt_pk_bf16_f32 v62, v180, v181
    v_cvt_pk_bf16_f32 v63, v182, v183
    ds_write_b128 v12, v[60:63] offset:24576
    v_pk_mul_f32 v[184:185], v[184:185], v[10:11] op_sel_hi:[1,0]
    v_pk_mul_f32 v[186:187], v[186:187], v[10:11] op_sel_hi:[1,0]
    buffer_load_dwordx4 v101, s[40:43], s61 offen offset:1056 lds
    v_pk_mul_f32 v[188:189], v[188:189], v[10:11] op_sel_hi:[1,0]
    v_pk_mul_f32 v[190:191], v[190:191], v[10:11] op_sel_hi:[1,0]
    v_cvt_pk_bf16_f32 v64, v184, v185
    v_cvt_pk_bf16_f32 v65, v186, v187
    v_cvt_pk_bf16_f32 v66, v188, v189
    v_cvt_pk_bf16_f32 v67, v190, v191
    buffer_load_dwordx4 v102, s[40:43], s61 offen offset:2112 lds
    ds_write_b128 v12, v[64:67] offset:28672
    v_pk_mul_f32 v[192:193], v[192:193], v[10:11] op_sel_hi:[1,0]
    v_pk_mul_f32 v[194:195], v[194:195], v[10:11] op_sel_hi:[1,0]
    v_pk_mul_f32 v[196:197], v[196:197], v[10:11] op_sel_hi:[1,0]
    v_pk_mul_f32 v[198:199], v[198:199], v[10:11] op_sel_hi:[1,0]
    v_cvt_pk_bf16_f32 v68, v192, v193
    v_cvt_pk_bf16_f32 v69, v194, v195
    buffer_load_dwordx4 v103, s[40:43], s61 offen offset:3168 lds
    v_cvt_pk_bf16_f32 v70, v196, v197
    v_cvt_pk_bf16_f32 v71, v198, v199
    ds_write_b128 v12, v[68:71] offset:32768
    v_pk_mul_f32 v[200:201], v[200:201], v[10:11] op_sel_hi:[1,0]
    v_pk_mul_f32 v[202:203], v[202:203], v[10:11] op_sel_hi:[1,0]
    v_pk_mul_f32 v[204:205], v[204:205], v[10:11] op_sel_hi:[1,0]
    s_mov_b32 s61, 229376
    s_add_u32 m0, s60, 12672
    v_pk_mul_f32 v[206:207], v[206:207], v[10:11] op_sel_hi:[1,0]
    buffer_load_dwordx4 v100, s[36:39], s61 offen offset:0 lds
    v_cvt_pk_bf16_f32 v72, v200, v201
    v_cvt_pk_bf16_f32 v73, v202, v203
    v_cvt_pk_bf16_f32 v74, v204, v205
    v_cvt_pk_bf16_f32 v75, v206, v207
    ds_write_b128 v12, v[72:75] offset:36864
    v_pk_mul_f32 v[208:209], v[208:209], v[10:11] op_sel_hi:[1,0]
    v_pk_mul_f32 v[210:211], v[210:211], v[10:11] op_sel_hi:[1,0]
    buffer_load_dwordx4 v101, s[36:39], s61 offen offset:1056 lds
    v_pk_mul_f32 v[212:213], v[212:213], v[10:11] op_sel_hi:[1,0]
    v_pk_mul_f32 v[214:215], v[214:215], v[10:11] op_sel_hi:[1,0]
    v_cvt_pk_bf16_f32 v76, v208, v209
    v_cvt_pk_bf16_f32 v77, v210, v211
    v_cvt_pk_bf16_f32 v78, v212, v213
    v_cvt_pk_bf16_f32 v79, v214, v215
    buffer_load_dwordx4 v102, s[36:39], s61 offen offset:2112 lds
    ds_write_b128 v12, v[76:79] offset:40960
    v_pk_mul_f32 v[216:217], v[216:217], v[10:11] op_sel_hi:[1,0]
    v_pk_mul_f32 v[218:219], v[218:219], v[10:11] op_sel_hi:[1,0]
    v_pk_mul_f32 v[220:221], v[220:221], v[10:11] op_sel_hi:[1,0]
    v_pk_mul_f32 v[222:223], v[222:223], v[10:11] op_sel_hi:[1,0]
    v_cvt_pk_bf16_f32 v80, v216, v217
    v_cvt_pk_bf16_f32 v81, v218, v219
    buffer_load_dwordx4 v103, s[36:39], s61 offen offset:3168 lds
    v_cvt_pk_bf16_f32 v82, v220, v221
    v_cvt_pk_bf16_f32 v83, v222, v223
L_pg1:
    s_cbranch_execz L_pg5
    ds_write_b128 v12, v[80:83] offset:45056
    v_pk_mul_f32 v[224:225], v[224:225], v[10:11] op_sel_hi:[1,0]
    v_pk_mul_f32 v[226:227], v[226:227], v[10:11] op_sel_hi:[1,0]
    v_pk_mul_f32 v[228:229], v[228:229], v[10:11] op_sel_hi:[1,0]
    v_pk_mul_f32 v[230:231], v[230:231], v[10:11] op_sel_hi:[1,0]
    v_cvt_pk_bf16_f32 v84, v224, v225
    v_cvt_pk_bf16_f32 v85, v226, v227
    v_cvt_pk_bf16_f32 v86, v228, v229
    v_cvt_pk_bf16_f32 v87, v230, v231
    ds_write_b128 v12, v[84:87] offset:49152
    v_pk_mul_f32 v[232:233], v[232:233], v[10:11] op_sel_hi:[1,0]
    v_pk_mul_f32 v[234:235], v[234:235], v[10:11] op_sel_hi:[1,0]
    v_pk_mul_f32 v[236:237], v[236:237], v[10:11] op_sel_hi:[1,0]
    v_pk_mul_f32 v[238:239], v[238:239], v[10:11] op_sel_hi:[1,0]
    v_cvt_pk_bf16_f32 v88, v232, v233
    v_cvt_pk_bf16_f32 v89, v234, v235
    v_cvt_pk_bf16_f32 v90, v236, v237
    v_cvt_pk_bf16_f32 v91, v238, v239
    ds_write_b128 v12, v[88:91] offset:53248
    ds_read_b64_tr_b16 v[16:17], v120 offset:21120
    ds_read_b64_tr_b16 v[18:19], v120 offset:21632
    ds_read_b64_tr_b16 v[20:21], v120 offset:21152
    ds_read_b64_tr_b16 v[22:23], v120 offset:21664
    ds_read_b64_tr_b16 v[24:25], v120 offset:21184
    ds_read_b64_tr_b16 v[26:27], v120 offset:21696
    ds_read_b64_tr_b16 v[28:29], v120 offset:21216
    ds_read_b64_tr_b16 v[30:31], v120 offset:21728
    s_waitcnt lgkmcnt(8)
    s_barrier
    ds_read_b128 v[36:39], v121 offset:0
    ds_read_b128 v[40:43], v121 offset:256
    ds_read_b128 v[44:47], v121 offset:512
    ds_read_b128 v[48:51], v121 offset:768
    s_waitcnt lgkmcnt(0)
    v_mfma_f32_16x16x32_bf16 v[128:131], v[16:19], v[36:39], 0
    v_mfma_f32_16x16x32_bf16 v[144:147], v[20:23], v[36:39], 0
    s_add_u32 m0, s60, 16896
    v_mfma_f32_16x16x32_bf16 v[148:151], v[20:23], v[40:43], 0
    buffer_load_dwordx4 v100, s[40:43], s61 offen offset:0 lds
    v_mfma_f32_16x16x32_bf16 v[132:135], v[16:19], v[40:43], 0
    v_mfma_f32_16x16x32_bf16 v[136:139], v[16:19], v[44:47], 0
    buffer_load_dwordx4 v101, s[40:43], s61 offen offset:1056 lds
    v_mfma_f32_16x16x32_bf16 v[152:155], v[20:23], v[44:47], 0
    v_mfma_f32_16x16x32_bf16 v[156:159], v[20:23], v[48:51], 0
    s_waitcnt vmcnt(14)
    ds_read_b64_tr_b16 v[20:21], v120 offset:32
    v_mfma_f32_16x16x32_bf16 v[140:143], v[16:19], v[48:51], 0
    ds_read_b64_tr_b16 v[22:23], v120 offset:544
    v_mfma_f32_16x16x32_bf16 v[188:191], v[28:31], v[48:51], 0
    ds_read_b64_tr_b16 v[16:17], v120 offset:0
    v_mfma_f32_16x16x32_bf16 v[172:175], v[24:27], v[48:51], 0
    ds_read_b64_tr_b16 v[18:19], v120 offset:512
    v_mfma_f32_16x16x32_bf16 v[168:171], v[24:27], v[44:47], 0
    buffer_load_dwordx4 v102, s[40:43], s61 offen offset:2112 lds
    v_mfma_f32_16x16x32_bf16 v[184:187], v[28:31], v[44:47], 0
    v_mfma_f32_16x16x32_bf16 v[180:183], v[28:31], v[40:43], 0
    buffer_load_dwordx4 v103, s[40:43], s61 offen offset:3168 lds
    v_mfma_f32_16x16x32_bf16 v[164:167], v[24:27], v[40:43], 0
    v_mfma_f32_16x16x32_bf16 v[160:163], v[24:27], v[36:39], 0
    ds_read_b64_tr_b16 v[24:25], v120 offset:64
    v_mfma_f32_16x16x32_bf16 v[176:179], v[28:31], v[36:39], 0
    ds_read_b64_tr_b16 v[26:27], v120 offset:576
    s_waitcnt lgkmcnt(2)
    v_mfma_f32_16x16x32_bf16 v[192:195], v[16:19], v[36:39], 0
    ds_read_b64_tr_b16 v[28:29], v120 offset:96
    v_mfma_f32_16x16x32_bf16 v[208:211], v[20:23], v[36:39], 0
    ds_read_b64_tr_b16 v[30:31], v120 offset:608
    s_mov_b32 s61, 344064
    s_add_u32 m0, s60, 21120
    v_mfma_f32_16x16x32_bf16 v[212:215], v[20:23], v[40:43], 0
    buffer_load_dwordx4 v100, s[36:39], s61 offen offset:0 lds
    v_mfma_f32_16x16x32_bf16 v[196:199], v[16:19], v[40:43], 0
    ds_read_b128 v[52:55], v121 offset:4096
    v_mfma_f32_16x16x32_bf16 v[200:203], v[16:19], v[44:47], 0
    buffer_load_dwordx4 v101, s[36:39], s61 offen offset:1056 lds
    v_mfma_f32_16x16x32_bf16 v[216:219], v[20:23], v[44:47], 0
    ds_read_b128 v[56:59], v121 offset:4352
    v_mfma_f32_16x16x32_bf16 v[220:223], v[20:23], v[48:51], 0
    s_waitcnt vmcnt(14)
    ds_read_b64_tr_b16 v[20:21], v120 offset:4256
    v_mfma_f32_16x16x32_bf16 v[204:207], v[16:19], v[48:51], 0
    ds_read_b64_tr_b16 v[22:23], v120 offset:4768
    s_waitcnt lgkmcnt(4)
    v_mfma_f32_16x16x32_bf16 v[252:255], v[28:31], v[48:51], 0
    ds_read_b64_tr_b16 v[16:17], v120 offset:4224
    v_mfma_f32_16x16x32_bf16 v[236:239], v[24:27], v[48:51], 0
    ds_read_b64_tr_b16 v[18:19], v120 offset:4736
    v_mfma_f32_16x16x32_bf16 v[232:235], v[24:27], v[44:47], 0
    buffer_load_dwordx4 v102, s[36:39], s61 offen offset:2112 lds
    v_mfma_f32_16x16x32_bf16 v[248:251], v[28:31], v[44:47], 0
    ds_read_b128 v[60:63], v121 offset:4608
    v_mfma_f32_16x16x32_bf16 v[244:247], v[28:31], v[40:43], 0
    buffer_load_dwordx4 v103, s[36:39], s61 offen offset:3168 lds
    v_mfma_f32_16x16x32_bf16 v[228:231], v[24:27], v[40:43], 0
    ds_read_b128 v[64:67], v121 offset:4864
    v_mfma_f32_16x16x32_bf16 v[224:227], v[24:27], v[36:39], 0
    ds_read_b64_tr_b16 v[24:25], v120 offset:4288
    v_mfma_f32_16x16x32_bf16 v[240:243], v[28:31], v[36:39], 0
    ds_read_b64_tr_b16 v[26:27], v120 offset:4800
    s_waitcnt lgkmcnt(2)
    v_mfma_f32_16x16x32_bf16 v[128:131], v[16:19], v[52:55], v[128:131]
    ds_read_b64_tr_b16 v[28:29], v120 offset:4320
    v_mfma_f32_16x16x32_bf16 v[144:147], v[20:23], v[52:55], v[144:147]
    ds_read_b64_tr_b16 v[30:31], v120 offset:4832
    s_add_u32 m0, s60, 0
    v_mfma_f32_16x16x32_bf16 v[148:151], v[20:23], v[56:59], v[148:151]
    buffer_load_dwordx4 v100, s[40:43], s61 offen offset:0 lds
    v_mfma_f32_16x16x32_bf16 v[132:135], v[16:19], v[56:59], v[132:135]
    v_mfma_f32_16x16x32_bf16 v[136:139], v[16:19], v[60:63], v[136:139]
    buffer_load_dwordx4 v101, s[40:43], s61 offen offset:1056 lds
    v_mfma_f32_16x16x32_bf16 v[152:155], v[20:23], v[60:63], v[152:155]
    v_mfma_f32_16x16x32_bf16 v[156:159], v[20:23], v[64:67], v[156:159]
    s_waitcnt vmcnt(14)
    ds_read_b64_tr_b16 v[20:21], v120 offset:8480
    v_mfma_f32_16x16x32_bf16 v[140:143], v[16:19], v[64:67], v[140:143]
    ds_read_b64_tr_b16 v[22:23], v120 offset:8992
    s_waitcnt lgkmcnt(2)
    v_mfma_f32_16x16x32_bf16 v[188:191], v[28:31], v[64:67], v[188:191]
    ds_read_b64_tr_b16 v[16:17], v120 offset:8448
    v_mfma_f32_16x16x32_bf16 v[172:175], v[24:27], v[64:67], v[172:175]
    ds_read_b64_tr_b16 v[18:19], v120 offset:8960
    v_mfma_f32_16x16x32_bf16 v[168:171], v[24:27], v[60:63], v[168:171]
    buffer_load_dwordx4 v102, s[40:43], s61 offen offset:2112 lds
    v_mfma_f32_16x16x32_bf16 v[184:187], v[28:31], v[60:63], v[184:187]
    v_mfma_f32_16x16x32_bf16 v[180:183], v[28:31], v[56:59], v[180:183]
    buffer_load_dwordx4 v103, s[40:43], s61 offen offset:3168 lds
    v_mfma_f32_16x16x32_bf16 v[164:167], v[24:27], v[56:59], v[164:167]
    v_mfma_f32_16x16x32_bf16 v[160:163], v[24:27], v[52:55], v[160:163]
    ds_read_b64_tr_b16 v[24:25], v120 offset:8512
    v_mfma_f32_16x16x32_bf16 v[176:179], v[28:31], v[52:55], v[176:179]
    ds_read_b64_tr_b16 v[26:27], v120 offset:9024
    s_waitcnt lgkmcnt(2)
    v_mfma_f32_16x16x32_bf16 v[192:195], v[16:19], v[52:55], v[192:195]
    ds_read_b64_tr_b16 v[28:29], v120 offset:8544
    v_mfma_f32_16x16x32_bf16 v[208:211], v[20:23], v[52:55], v[208:211]
    ds_read_b64_tr_b16 v[30:31], v120 offset:9056
    s_mov_b32 s61, 458752
    s_add_u32 m0, s60, 4224
    v_mfma_f32_16x16x32_bf16 v[212:215], v[20:23], v[56:59], v[212:215]
    buffer_load_dwordx4 v100, s[36:39], s61 offen offset:0 lds
    v_mfma_f32_16x16x32_bf16 v[196:199], v[16:19], v[56:59], v[196:199]
    ds_read_b128 v[36:39], v121 offset:8192
    v_mfma_f32_16x16x32_bf16 v[200:203], v[16:19], v[60:63], v[200:203]
    buffer_load_dwordx4 v101, s[36:39], s61 offen offset:1056 lds
    v_mfma_f32_16x16x32_bf16 v[216:219], v[20:23], v[60:63], v[216:219]
    ds_read_b128 v[40:43], v121 offset:8448
    v_mfma_f32_16x16x32_bf16 v[220:223], v[20:23], v[64:67], v[220:223]
    s_waitcnt vmcnt(14)
    ds_read_b64_tr_b16 v[20:21], v120 offset:12704
    v_mfma_f32_16x16x32_bf16 v[204:207], v[16:19], v[64:67], v[204:207]
    ds_read_b64_tr_b16 v[22:23], v120 offset:13216
    s_waitcnt lgkmcnt(4)
    v_mfma_f32_16x16x32_bf16 v[252:255], v[28:31], v[64:67], v[252:255]
    ds_read_b64_tr_b16 v[16:17], v120 offset:12672
    v_mfma_f32_16x16x32_bf16 v[236:239], v[24:27], v[64:67], v[236:239]
    ds_read_b64_tr_b16 v[18:19], v120 offset:13184
    v_mfma_f32_16x16x32_bf16 v[232:235], v[24:27], v[60:63], v[232:235]
    buffer_load_dwordx4 v102, s[36:39], s61 offen offset:2112 lds
    v_mfma_f32_16x16x32_bf16 v[248:251], v[28:31], v[60:63], v[248:251]
    ds_read_b128 v[44:47], v121 offset:8704
    v_mfma_f32_16x16x32_bf16 v[244:247], v[28:31], v[56:59], v[244:247]
    buffer_load_dwordx4 v103, s[36:39], s61 offen offset:3168 lds
    v_mfma_f32_16x16x32_bf16 v[228:231], v[24:27], v[56:59], v[228:231]
    ds_read_b128 v[48:51], v121 offset:8960
    v_mfma_f32_16x16x32_bf16 v[224:227], v[24:27], v[52:55], v[224:227]
    ds_read_b64_tr_b16 v[24:25], v120 offset:12736
    v_mfma_f32_16x16x32_bf16 v[240:243], v[28:31], v[52:55], v[240:243]
    ds_read_b64_tr_b16 v[26:27], v120 offset:13248
    s_waitcnt lgkmcnt(2)
    v_mfma_f32_16x16x32_bf16 v[128:131], v[16:19], v[36:39], v[128:131]
    ds_read_b64_tr_b16 v[28:29], v120 offset:12768
    v_mfma_f32_16x16x32_bf16 v[144:147], v[20:23], v[36:39], v[144:147]
    ds_read_b64_tr_b16 v[30:31], v120 offset:13280
    s_add_u32 m0, s60, 8448
    v_mfma_f32_16x16x32_bf16 v[148:151], v[20:23], v[40:43], v[148:151]
    buffer_load_dwordx4 v100, s[40:43], s61 offen offset:0 lds
    v_mfma_f32_16x16x32_bf16 v[132:135], v[16:19], v[40:43], v[132:135]
    v_mfma_f32_16x16x32_bf16 v[136:139], v[16:19], v[44:47], v[136:139]
    buffer_load_dwordx4 v101, s[40:43], s61 offen offset:1056 lds
    v_mfma_f32_16x16x32_bf16 v[152:155], v[20:23], v[44:47], v[152:155]
    v_mfma_f32_16x16x32_bf16 v[156:159], v[20:23], v[48:51], v[156:159]
    s_waitcnt vmcnt(14)
    ds_read_b64_tr_b16 v[20:21], v120 offset:16928
    v_mfma_f32_16x16x32_bf16 v[140:143], v[16:19], v[48:51], v[140:143]
    ds_read_b64_tr_b16 v[22:23], v120 offset:17440
    s_waitcnt lgkmcnt(2)
    v_mfma_f32_16x16x32_bf16 v[188:191], v[28:31], v[48:51], v[188:191]
    ds_read_b64_tr_b16 v[16:17], v120 offset:16896
    v_mfma_f32_16x16x32_bf16 v[172:175], v[24:27], v[48:51], v[172:175]
    ds_read_b64_tr_b16 v[18:19], v120 offset:17408
    v_mfma_f32_16x16x32_bf16 v[168:171], v[24:27], v[44:47], v[168:171]
    buffer_load_dwordx4 v102, s[40:43], s61 offen offset:2112 lds
    v_mfma_f32_16x16x32_bf16 v[184:187], v[28:31], v[44:47], v[184:187]
    v_mfma_f32_16x16x32_bf16 v[180:183], v[28:31], v[40:43], v[180:183]
    buffer_load_dwordx4 v103, s[40:43], s61 offen offset:3168 lds
    v_mfma_f32_16x16x32_bf16 v[164:167], v[24:27], v[40:43], v[164:167]
    v_mfma_f32_16x16x32_bf16 v[160:163], v[24:27], v[36:39], v[160:163]
    ds_read_b64_tr_b16 v[24:25], v120 offset:16960
    v_mfma_f32_16x16x32_bf16 v[176:179], v[28:31], v[36:39], v[176:179]
    ds_read_b64_tr_b16 v[26:27], v120 offset:17472
    s_waitcnt lgkmcnt(2)
    v_mfma_f32_16x16x32_bf16 v[192:195], v[16:19], v[36:39], v[192:195]
    ds_read_b64_tr_b16 v[28:29], v120 offset:16992
    v_mfma_f32_16x16x32_bf16 v[208:211], v[20:23], v[36:39], v[208:211]
    ds_read_b64_tr_b16 v[30:31], v120 offset:17504
    s_mov_b32 s61, 573440
    s_add_u32 m0, s60, 12672
    v_mfma_f32_16x16x32_bf16 v[212:215], v[20:23], v[40:43], v[212:215]
    buffer_load_dwordx4 v100, s[36:39], s61 offen offset:0 lds
    v_mfma_f32_16x16x32_bf16 v[196:199], v[16:19], v[40:43], v[196:199]
    ds_read_b128 v[52:55], v121 offset:12288
    v_mfma_f32_16x16x32_bf16 v[200:203], v[16:19], v[44:47], v[200:203]
    buffer_load_dwordx4 v101, s[36:39], s61 offen offset:1056 lds
    v_mfma_f32_16x16x32_bf16 v[216:219], v[20:23], v[44:47], v[216:219]
    ds_read_b128 v[56:59], v121 offset:12544
    v_mfma_f32_16x16x32_bf16 v[220:223], v[20:23], v[48:51], v[220:223]
    s_waitcnt vmcnt(14)
    ds_read_b64_tr_b16 v[20:21], v120 offset:21152
    v_mfma_f32_16x16x32_bf16 v[204:207], v[16:19], v[48:51], v[204:207]
    ds_read_b64_tr_b16 v[22:23], v120 offset:21664
    s_waitcnt lgkmcnt(4)
    v_mfma_f32_16x16x32_bf16 v[252:255], v[28:31], v[48:51], v[252:255]
    ds_read_b64_tr_b16 v[16:17], v120 offset:21120
    v_mfma_f32_16x16x32_bf16 v[236:239], v[24:27], v[48:51], v[236:239]
    ds_read_b64_tr_b16 v[18:19], v120 offset:21632
    v_mfma_f32_16x16x32_bf16 v[232:235], v[24:27], v[44:47], v[232:235]
    buffer_load_dwordx4 v102, s[36:39], s61 offen offset:2112 lds
    v_mfma_f32_16x16x32_bf16 v[248:251], v[28:31], v[44:47], v[248:251]
    ds_read_b128 v[60:63], v121 offset:12800
    v_mfma_f32_16x16x32_bf16 v[244:247], v[28:31], v[40:43], v[244:247]
    buffer_load_dwordx4 v103, s[36:39], s61 offen offset:3168 lds
    v_mfma_f32_16x16x32_bf16 v[228:231], v[24:27], v[40:43], v[228:231]
    ds_read_b128 v[64:67], v121 offset:13056
    v_mfma_f32_16x16x32_bf16 v[224:227], v[24:27], v[36:39], v[224:227]
    ds_read_b64_tr_b16 v[24:25], v120 offset:21184
    v_mfma_f32_16x16x32_bf16 v[240:243], v[28:31], v[36:39], v[240:243]
    ds_read_b64_tr_b16 v[26:27], v120 offset:21696
    s_waitcnt lgkmcnt(2)
    v_mfma_f32_16x16x32_bf16 v[128:131], v[16:19], v[52:55], v[128:131]
    ds_read_b64_tr_b16 v[28:29], v120 offset:21216
    v_mfma_f32_16x16x32_bf16 v[144:147], v[20:23], v[52:55], v[144:147]
    ds_read_b64_tr_b16 v[30:31], v120 offset:21728
    s_add_u32 m0, s60, 16896
    v_mfma_f32_16x16x32_bf16 v[148:151], v[20:23], v[56:59], v[148:151]
    buffer_load_dwordx4 v100, s[40:43], s61 offen offset:0 lds
    v_mfma_f32_16x16x32_bf16 v[132:135], v[16:19], v[56:59], v[132:135]
    v_mfma_f32_16x16x32_bf16 v[136:139], v[16:19], v[60:63], v[136:139]
    buffer_load_dwordx4 v101, s[40:43], s61 offen offset:1056 lds
    v_mfma_f32_16x16x32_bf16 v[152:155], v[20:23], v[60:63], v[152:155]
    v_mfma_f32_16x16x32_bf16 v[156:159], v[20:23], v[64:67], v[156:159]
    s_waitcnt vmcnt(14)
    ds_read_b64_tr_b16 v[20:21], v120 offset:32
    v_mfma_f32_16x16x32_bf16 v[140:143], v[16:19], v[64:67], v[140:143]
    ds_read_b64_tr_b16 v[22:23], v120 offset:544
    s_waitcnt lgkmcnt(2)
    v_mfma_f32_16x16x32_bf16 v[188:191], v[28:31], v[64:67], v[188:191]
    ds_read_b64_tr_b16 v[16:17], v120 offset:0
    v_mfma_f32_16x16x32_bf16 v[172:175], v[24:27], v[64:67], v[172:175]
    ds_read_b64_tr_b16 v[18:19], v120 offset:512
    v_mfma_f32_16x16x32_bf16 v[168:171], v[24:27], v[60:63], v[168:171]
    buffer_load_dwordx4 v102, s[40:43], s61 offen offset:2112 lds
    v_mfma_f32_16x16x32_bf16 v[184:187], v[28:31], v[60:63], v[184:187]
    v_mfma_f32_16x16x32_bf16 v[180:183], v[28:31], v[56:59], v[180:183]
    buffer_load_dwordx4 v103, s[40:43], s61 offen offset:3168 lds
    v_mfma_f32_16x16x32_bf16 v[164:167], v[24:27], v[56:59], v[164:167]
    v_mfma_f32_16x16x32_bf16 v[160:163], v[24:27], v[52:55], v[160:163]
    ds_read_b64_tr_b16 v[24:25], v120 offset:64
    v_mfma_f32_16x16x32_bf16 v[176:179], v[28:31], v[52:55], v[176:179]
    ds_read_b64_tr_b16 v[26:27], v120 offset:576
    s_waitcnt lgkmcnt(2)
    v_mfma_f32_16x16x32_bf16 v[192:195], v[16:19], v[52:55], v[192:195]
    ds_read_b64_tr_b16 v[28:29], v120 offset:96
    v_mfma_f32_16x16x32_bf16 v[208:211], v[20:23], v[52:55], v[208:211]
    ds_read_b64_tr_b16 v[30:31], v120 offset:608
    s_mov_b32 s61, 688128
    s_add_u32 m0, s60, 21120
    v_mfma_f32_16x16x32_bf16 v[212:215], v[20:23], v[56:59], v[212:215]
    buffer_load_dwordx4 v100, s[36:39], s61 offen offset:0 lds
    v_mfma_f32_16x16x32_bf16 v[196:199], v[16:19], v[56:59], v[196:199]
    ds_read_b128 v[36:39], v121 offset:16384
    v_mfma_f32_16x16x32_bf16 v[200:203], v[16:19], v[60:63], v[200:203]
    buffer_load_dwordx4 v101, s[36:39], s61 offen offset:1056 lds
    v_mfma_f32_16x16x32_bf16 v[216:219], v[20:23], v[60:63], v[216:219]
    ds_read_b128 v[40:43], v121 offset:16640
    v_mfma_f32_16x16x32_bf16 v[220:223], v[20:23], v[64:67], v[220:223]
    s_waitcnt vmcnt(14)
    ds_read_b64_tr_b16 v[20:21], v120 offset:4256
    v_mfma_f32_16x16x32_bf16 v[204:207], v[16:19], v[64:67], v[204:207]
    ds_read_b64_tr_b16 v[22:23], v120 offset:4768
    s_waitcnt lgkmcnt(4)
    v_mfma_f32_16x16x32_bf16 v[252:255], v[28:31], v[64:67], v[252:255]
    ds_read_b64_tr_b16 v[16:17], v120 offset:4224
    v_mfma_f32_16x16x32_bf16 v[236:239], v[24:27], v[64:67], v[236:239]
    ds_read_b64_tr_b16 v[18:19], v120 offset:4736
    v_mfma_f32_16x16x32_bf16 v[232:235], v[24:27], v[60:63], v[232:235]
    buffer_load_dwordx4 v102, s[36:39], s61 offen offset:2112 lds
    v_mfma_f32_16x16x32_bf16 v[248:251], v[28:31], v[60:63], v[248:251]
    ds_read_b128 v[44:47], v121 offset:16896
    v_mfma_f32_16x16x32_bf16 v[244:247], v[28:31], v[56:59], v[244:247]
    buffer_load_dwordx4 v103, s[36:39], s61 offen offset:3168 lds
    v_mfma_f32_16x16x32_bf16 v[228:231], v[24:27], v[56:59], v[228:231]
    ds_read_b128 v[48:51], v121 offset:17152
    v_mfma_f32_16x16x32_bf16 v[224:227], v[24:27], v[52:55], v[224:227]
    ds_read_b64_tr_b16 v[24:25], v120 offset:4288
    v_mfma_f32_16x16x32_bf16 v[240:243], v[28:31], v[52:55], v[240:243]
    ds_read_b64_tr_b16 v[26:27], v120 offset:4800
    s_waitcnt lgkmcnt(2)
    v_mfma_f32_16x16x32_bf16 v[128:131], v[16:19], v[36:39], v[128:131]
    ds_read_b64_tr_b16 v[28:29], v120 offset:4320
    v_mfma_f32_16x16x32_bf16 v[144:147], v[20:23], v[36:39], v[144:147]
    ds_read_b64_tr_b16 v[30:31], v120 offset:4832
    s_add_u32 m0, s60, 0
    v_mfma_f32_16x16x32_bf16 v[148:151], v[20:23], v[40:43], v[148:151]
    buffer_load_dwordx4 v100, s[40:43], s61 offen offset:0 lds
    v_mfma_f32_16x16x32_bf16 v[132:135], v[16:19], v[40:43], v[132:135]
    v_mfma_f32_16x16x32_bf16 v[136:139], v[16:19], v[44:47], v[136:139]
    buffer_load_dwordx4 v101, s[40:43], s61 offen offset:1056 lds
    v_mfma_f32_16x16x32_bf16 v[152:155], v[20:23], v[44:47], v[152:155]
    v_mfma_f32_16x16x32_bf16 v[156:159], v[20:23], v[48:51], v[156:159]
    s_waitcnt vmcnt(14)
    ds_read_b64_tr_b16 v[20:21], v120 offset:8480
    v_mfma_f32_16x16x32_bf16 v[140:143], v[16:19], v[48:51], v[140:143]
    ds_read_b64_tr_b16 v[22:23], v120 offset:8992
    s_waitcnt lgkmcnt(2)
    v_mfma_f32_16x16x32_bf16 v[188:191], v[28:31], v[48:51], v[188:191]
    ds_read_b64_tr_b16 v[16:17], v120 offset:8448
    v_mfma_f32_16x16x32_bf16 v[172:175], v[24:27], v[48:51], v[172:175]
    ds_read_b64_tr_b16 v[18:19], v120 offset:8960
    v_mfma_f32_16x16x32_bf16 v[168:171], v[24:27], v[44:47], v[168:171]
    buffer_load_dwordx4 v102, s[40:43], s61 offen offset:2112 lds
    v_mfma_f32_16x16x32_bf16 v[184:187], v[28:31], v[44:47], v[184:187]
    v_mfma_f32_16x16x32_bf16 v[180:183], v[28:31], v[40:43], v[180:183]
    buffer_load_dwordx4 v103, s[40:43], s61 offen offset:3168 lds
    v_mfma_f32_16x16x32_bf16 v[164:167], v[24:27], v[40:43], v[164:167]
    v_mfma_f32_16x16x32_bf16 v[160:163], v[24:27], v[36:39], v[160:163]
    ds_read_b64_tr_b16 v[24:25], v120 offset:8512
    v_mfma_f32_16x16x32_bf16 v[176:179], v[28:31], v[36:39], v[176:179]
    ds_read_b64_tr_b16 v[26:27], v120 offset:9024
    s_waitcnt lgkmcnt(2)
    v_mfma_f32_16x16x32_bf16 v[192:195], v[16:19], v[36:39], v[192:195]
    ds_read_b64_tr_b16 v[28:29], v120 offset:8544
    v_mfma_f32_16x16x32_bf16 v[208:211], v[20:23], v[36:39], v[208:211]
    ds_read_b64_tr_b16 v[30:31], v120 offset:9056
    s_mov_b32 s61, 802816
    s_add_u32 m0, s60, 4224
    v_mfma_f32_16x16x32_bf16 v[212:215], v[20:23], v[40:43], v[212:215]
    buffer_load_dwordx4 v100, s[36:39], s61 offen offset:0 lds
    v_mfma_f32_16x16x32_bf16 v[196:199], v[16:19], v[40:43], v[196:199]
    ds_read_b128 v[52:55], v121 offset:20480
    v_mfma_f32_16x16x32_bf16 v[200:203], v[16:19], v[44:47], v[200:203]
    buffer_load_dwordx4 v101, s[36:39], s61 offen offset:1056 lds
    v_mfma_f32_16x16x32_bf16 v[216:219], v[20:23], v[44:47], v[216:219]
    ds_read_b128 v[56:59], v121 offset:20736
    v_mfma_f32_16x16x32_bf16 v[220:223], v[20:23], v[48:51], v[220:223]
    s_waitcnt vmcnt(14)
    ds_read_b64_tr_b16 v[20:21], v120 offset:12704
    v_mfma_f32_16x16x32_bf16 v[204:207], v[16:19], v[48:51], v[204:207]
    ds_read_b64_tr_b16 v[22:23], v120 offset:13216
    s_waitcnt lgkmcnt(4)
    v_mfma_f32_16x16x32_bf16 v[252:255], v[28:31], v[48:51], v[252:255]
    ds_read_b64_tr_b16 v[16:17], v120 offset:12672
    v_mfma_f32_16x16x32_bf16 v[236:239], v[24:27], v[48:51], v[236:239]
    ds_read_b64_tr_b16 v[18:19], v120 offset:13184
    v_mfma_f32_16x16x32_bf16 v[232:235], v[24:27], v[44:47], v[232:235]
    buffer_load_dwordx4 v102, s[36:39], s61 offen offset:2112 lds
    v_mfma_f32_16x16x32_bf16 v[248:251], v[28:31], v[44:47], v[248:251]
    ds_read_b128 v[60:63], v121 offset:20992
    v_mfma_f32_16x16x32_bf16 v[244:247], v[28:31], v[40:43], v[244:247]
    buffer_load_dwordx4 v103, s[36:39], s61 offen offset:3168 lds
    v_mfma_f32_16x16x32_bf16 v[228:231], v[24:27], v[40:43], v[228:231]
    ds_read_b128 v[64:67], v121 offset:21248
    v_mfma_f32_16x16x32_bf16 v[224:227], v[24:27], v[36:39], v[224:227]
    ds_read_b64_tr_b16 v[24:25], v120 offset:12736
    v_mfma_f32_16x16x32_bf16 v[240:243], v[28:31], v[36:39], v[240:243]
    ds_read_b64_tr_b16 v[26:27], v120 offset:13248
    s_waitcnt lgkmcnt(2)
    v_mfma_f32_16x16x32_bf16 v[128:131], v[16:19], v[52:55], v[128:131]
    ds_read_b64_tr_b16 v[28:29], v120 offset:12768
    v_mfma_f32_16x16x32_bf16 v[144:147], v[20:23], v[52:55], v[144:147]
    ds_read_b64_tr_b16 v[30:31], v120 offset:13280
    s_add_u32 m0, s60, 8448
    v_mfma_f32_16x16x32_bf16 v[148:151], v[20:23], v[56:59], v[148:151]
    buffer_load_dwordx4 v100, s[40:43], s61 offen offset:0 lds
    v_mfma_f32_16x16x32_bf16 v[132:135], v[16:19], v[56:59], v[132:135]
    s_mul_i32 s27, s20, 14
    v_lshrrev_b32 v13, 1, v0
    v_add_u32 v13, s27, v13
    v_lshlrev_b32 v13, 13, v13
    v_and_b32 v14, 1, v0
    v_lshl_add_u32 v13, v14, 7, v13
    s_lshl_b32 s28, s16, 8
    s_mov_b64 exec, 0xfffffff
    buffer_load_dword v34, v13, s[44:47], s28 offen
    s_mov_b64 exec, -1
    v_mfma_f32_16x16x32_bf16 v[136:139], v[16:19], v[60:63], v[136:139]
    buffer_load_dwordx4 v101, s[40:43], s61 offen offset:1056 lds
    v_mfma_f32_16x16x32_bf16 v[152:155], v[20:23], v[60:63], v[152:155]
    v_mfma_f32_16x16x32_bf16 v[156:159], v[20:23], v[64:67], v[156:159]
    s_waitcnt vmcnt(15)
    ds_read_b64_tr_b16 v[20:21], v120 offset:16928
    v_mfma_f32_16x16x32_bf16 v[140:143], v[16:19], v[64:67], v[140:143]
    ds_read_b64_tr_b16 v[22:23], v120 offset:17440
    s_waitcnt lgkmcnt(2)
    v_mfma_f32_16x16x32_bf16 v[188:191], v[28:31], v[64:67], v[188:191]
    ds_read_b64_tr_b16 v[16:17], v120 offset:16896
    v_mfma_f32_16x16x32_bf16 v[172:175], v[24:27], v[64:67], v[172:175]
    ds_read_b64_tr_b16 v[18:19], v120 offset:17408
    v_mfma_f32_16x16x32_bf16 v[168:171], v[24:27], v[60:63], v[168:171]
    buffer_load_dwordx4 v102, s[40:43], s61 offen offset:2112 lds
    v_mfma_f32_16x16x32_bf16 v[184:187], v[28:31], v[60:63], v[184:187]
    v_mfma_f32_16x16x32_bf16 v[180:183], v[28:31], v[56:59], v[180:183]
    buffer_load_dwordx4 v103, s[40:43], s61 offen offset:3168 lds
    v_mfma_f32_16x16x32_bf16 v[164:167], v[24:27], v[56:59], v[164:167]
    v_mfma_f32_16x16x32_bf16 v[160:163], v[24:27], v[52:55], v[160:163]
    ds_read_b64_tr_b16 v[24:25], v120 offset:16960
    v_mfma_f32_16x16x32_bf16 v[176:179], v[28:31], v[52:55], v[176:179]
    ds_read_b64_tr_b16 v[26:27], v120 offset:17472
    s_waitcnt lgkmcnt(2)
    v_mfma_f32_16x16x32_bf16 v[192:195], v[16:19], v[52:55], v[192:195]
    ds_read_b64_tr_b16 v[28:29], v120 offset:16992
    v_mfma_f32_16x16x32_bf16 v[208:211], v[20:23], v[52:55], v[208:211]
    ds_read_b64_tr_b16 v[30:31], v120 offset:17504
    s_mov_b32 s61, 917504
    s_add_u32 m0, s60, 12672
    v_mfma_f32_16x16x32_bf16 v[212:215], v[20:23], v[56:59], v[212:215]
    buffer_load_dwordx4 v100, s[36:39], s61 offen offset:0 lds
    v_mfma_f32_16x16x32_bf16 v[196:199], v[16:19], v[56:59], v[196:199]
    ds_read_b128 v[36:39], v121 offset:24576
    v_mfma_f32_16x16x32_bf16 v[200:203], v[16:19], v[60:63], v[200:203]
    buffer_load_dwordx4 v101, s[36:39], s61 offen offset:1056 lds
    v_mfma_f32_16x16x32_bf16 v[216:219], v[20:23], v[60:63], v[216:219]
    ds_read_b128 v[40:43], v121 offset:24832
    v_mfma_f32_16x16x32_bf16 v[220:223], v[20:23], v[64:67], v[220:223]
    s_waitcnt vmcnt(15)
    ds_read_b64_tr_b16 v[20:21], v120 offset:21152
    v_mfma_f32_16x16x32_bf16 v[204:207], v[16:19], v[64:67], v[204:207]
    ds_read_b64_tr_b16 v[22:23], v120 offset:21664
    s_waitcnt lgkmcnt(4)
    v_mfma_f32_16x16x32_bf16 v[252:255], v[28:31], v[64:67], v[252:255]
    ds_read_b64_tr_b16 v[16:17], v120 offset:21120
    v_mfma_f32_16x16x32_bf16 v[236:239], v[24:27], v[64:67], v[236:239]
    ds_read_b64_tr_b16 v[18:19], v120 offset:21632
    v_mfma_f32_16x16x32_bf16 v[232:235], v[24:27], v[60:63], v[232:235]
    buffer_load_dwordx4 v102, s[36:39], s61 offen offset:2112 lds
    v_mfma_f32_16x16x32_bf16 v[248:251], v[28:31], v[60:63], v[248:251]
    ds_read_b128 v[44:47], v121 offset:25088
    v_mfma_f32_16x16x32_bf16 v[244:247], v[28:31], v[56:59], v[244:247]
    buffer_load_dwordx4 v103, s[36:39], s61 offen offset:3168 lds
    v_mfma_f32_16x16x32_bf16 v[228:231], v[24:27], v[56:59], v[228:231]
    ds_read_b128 v[48:51], v121 offset:25344
    v_mfma_f32_16x16x32_bf16 v[224:227], v[24:27], v[52:55], v[224:227]
    ds_read_b64_tr_b16 v[24:25], v120 offset:21184
    v_mfma_f32_16x16x32_bf16 v[240:243], v[28:31], v[52:55], v[240:243]
    ds_read_b64_tr_b16 v[26:27], v120 offset:21696
    s_waitcnt lgkmcnt(2)
    v_mfma_f32_16x16x32_bf16 v[128:131], v[16:19], v[36:39], v[128:131]
    ds_read_b64_tr_b16 v[28:29], v120 offset:21216
    v_mfma_f32_16x16x32_bf16 v[144:147], v[20:23], v[36:39], v[144:147]
    ds_read_b64_tr_b16 v[30:31], v120 offset:21728
    s_add_u32 m0, s60, 16896
    v_mfma_f32_16x16x32_bf16 v[148:151], v[20:23], v[40:43], v[148:151]
    buffer_load_dwordx4 v100, s[40:43], s61 offen offset:0 lds
    v_mfma_f32_16x16x32_bf16 v[132:135], v[16:19], v[40:43], v[132:135]
    v_mfma_f32_16x16x32_bf16 v[136:139], v[16:19], v[44:47], v[136:139]
    buffer_load_dwordx4 v101, s[40:43], s61 offen offset:1056 lds
    v_mfma_f32_16x16x32_bf16 v[152:155], v[20:23], v[44:47], v[152:155]
    v_mfma_f32_16x16x32_bf16 v[156:159], v[20:23], v[48:51], v[156:159]
    s_waitcnt vmcnt(15)
    ds_read_b64_tr_b16 v[20:21], v120 offset:32
    v_mfma_f32_16x16x32_bf16 v[140:143], v[16:19], v[48:51], v[140:143]
    ds_read_b64_tr_b16 v[22:23], v120 offset:544
    s_waitcnt lgkmcnt(2)
    v_mfma_f32_16x16x32_bf16 v[188:191], v[28:31], v[48:51], v[188:191]
    ds_read_b64_tr_b16 v[16:17], v120 offset:0
    v_mfma_f32_16x16x32_bf16 v[172:175], v[24:27], v[48:51], v[172:175]
    ds_read_b64_tr_b16 v[18:19], v120 offset:512
    v_mfma_f32_16x16x32_bf16 v[168:171], v[24:27], v[44:47], v[168:171]
    buffer_load_dwordx4 v102, s[40:43], s61 offen offset:2112 lds
    v_mfma_f32_16x16x32_bf16 v[184:187], v[28:31], v[44:47], v[184:187]
    v_mfma_f32_16x16x32_bf16 v[180:183], v[28:31], v[40:43], v[180:183]
    buffer_load_dwordx4 v103, s[40:43], s61 offen offset:3168 lds
    v_mfma_f32_16x16x32_bf16 v[164:167], v[24:27], v[40:43], v[164:167]
    v_mfma_f32_16x16x32_bf16 v[160:163], v[24:27], v[36:39], v[160:163]
    ds_read_b64_tr_b16 v[24:25], v120 offset:64
    v_mfma_f32_16x16x32_bf16 v[176:179], v[28:31], v[36:39], v[176:179]
    ds_read_b64_tr_b16 v[26:27], v120 offset:576
    s_waitcnt lgkmcnt(2)
    v_mfma_f32_16x16x32_bf16 v[192:195], v[16:19], v[36:39], v[192:195]
    ds_read_b64_tr_b16 v[28:29], v120 offset:96
    v_mfma_f32_16x16x32_bf16 v[208:211], v[20:23], v[36:39], v[208:211]
    ds_read_b64_tr_b16 v[30:31], v120 offset:608
    s_mov_b32 s61, 1032192
    s_add_u32 m0, s60, 21120
    v_mfma_f32_16x16x32_bf16 v[212:215], v[20:23], v[40:43], v[212:215]
    buffer_load_dwordx4 v100, s[36:39], s61 offen offset:0 lds
    v_mfma_f32_16x16x32_bf16 v[196:199], v[16:19], v[40:43], v[196:199]
    ds_read_b128 v[52:55], v121 offset:28672
    v_mfma_f32_16x16x32_bf16 v[200:203], v[16:19], v[44:47], v[200:203]
    buffer_load_dwordx4 v101, s[36:39], s61 offen offset:1056 lds
    v_mfma_f32_16x16x32_bf16 v[216:219], v[20:23], v[44:47], v[216:219]
    ds_read_b128 v[56:59], v121 offset:28928
    v_mfma_f32_16x16x32_bf16 v[220:223], v[20:23], v[48:51], v[220:223]
    s_waitcnt vmcnt(15)
    ds_read_b64_tr_b16 v[20:21], v120 offset:4256
    v_mfma_f32_16x16x32_bf16 v[204:207], v[16:19], v[48:51], v[204:207]
    ds_read_b64_tr_b16 v[22:23], v120 offset:4768
    s_waitcnt lgkmcnt(4)
    v_mfma_f32_16x16x32_bf16 v[252:255], v[28:31], v[48:51], v[252:255]
    ds_read_b64_tr_b16 v[16:17], v120 offset:4224
    v_mfma_f32_16x16x32_bf16 v[236:239], v[24:27], v[48:51], v[236:239]
    ds_read_b64_tr_b16 v[18:19], v120 offset:4736
    v_mfma_f32_16x16x32_bf16 v[232:235], v[24:27], v[44:47], v[232:235]
    buffer_load_dwordx4 v102, s[36:39], s61 offen offset:2112 lds
    v_mfma_f32_16x16x32_bf16 v[248:251], v[28:31], v[44:47], v[248:251]
    ds_read_b128 v[60:63], v121 offset:29184
    v_mfma_f32_16x16x32_bf16 v[244:247], v[28:31], v[40:43], v[244:247]
    buffer_load_dwordx4 v103, s[36:39], s61 offen offset:3168 lds
    v_mfma_f32_16x16x32_bf16 v[228:231], v[24:27], v[40:43], v[228:231]
    ds_read_b128 v[64:67], v121 offset:29440
    v_mfma_f32_16x16x32_bf16 v[224:227], v[24:27], v[36:39], v[224:227]
    ds_read_b64_tr_b16 v[24:25], v120 offset:4288
    v_mfma_f32_16x16x32_bf16 v[240:243], v[28:31], v[36:39], v[240:243]
    ds_read_b64_tr_b16 v[26:27], v120 offset:4800
    s_waitcnt lgkmcnt(2)
    v_mfma_f32_16x16x32_bf16 v[128:131], v[16:19], v[52:55], v[128:131]
    ds_read_b64_tr_b16 v[28:29], v120 offset:4320
    v_mfma_f32_16x16x32_bf16 v[144:147], v[20:23], v[52:55], v[144:147]
    ds_read_b64_tr_b16 v[30:31], v120 offset:4832
    s_add_u32 m0, s60, 0
    v_mfma_f32_16x16x32_bf16 v[148:151], v[20:23], v[56:59], v[148:151]
    buffer_load_dwordx4 v100, s[40:43], s61 offen offset:0 lds
    v_mfma_f32_16x16x32_bf16 v[132:135], v[16:19], v[56:59], v[132:135]
    v_mfma_f32_16x16x32_bf16 v[136:139], v[16:19], v[60:63], v[136:139]
    buffer_load_dwordx4 v101, s[40:43], s61 offen offset:1056 lds
    v_mfma_f32_16x16x32_bf16 v[152:155], v[20:23], v[60:63], v[152:155]
    v_mfma_f32_16x16x32_bf16 v[156:159], v[20:23], v[64:67], v[156:159]
    s_waitcnt vmcnt(14)
    ds_read_b64_tr_b16 v[20:21], v120 offset:8480
    v_mfma_f32_16x16x32_bf16 v[140:143], v[16:19], v[64:67], v[140:143]
L_pg2:
    s_cbranch_execz L_pg6
    ds_read_b64_tr_b16 v[22:23], v120 offset:8992
    s_waitcnt lgkmcnt(2)
    v_mfma_f32_16x16x32_bf16 v[188:191], v[28:31], v[64:67], v[188:191]
    ds_read_b64_tr_b16 v[16:17], v120 offset:8448
    v_mfma_f32_16x16x32_bf16 v[172:175], v[24:27], v[64:67], v[172:175]
    ds_read_b64_tr_b16 v[18:19], v120 offset:8960
    v_mfma_f32_16x16x32_bf16 v[168:171], v[24:27], v[60:63], v[168:171]
    buffer_load_dwordx4 v102, s[40:43], s61 offen offset:2112 lds
    v_mfma_f32_16x16x32_bf16 v[184:187], v[28:31], v[60:63], v[184:187]
    v_mfma_f32_16x16x32_bf16 v[180:183], v[28:31], v[56:59], v[180:183]
    buffer_load_dwordx4 v103, s[40:43], s61 offen offset:3168 lds
    v_mfma_f32_16x16x32_bf16 v[164:167], v[24:27], v[56:59], v[164:167]
    v_mfma_f32_16x16x32_bf16 v[160:163], v[24:27], v[52:55], v[160:163]
    ds_read_b64_tr_b16 v[24:25], v120 offset:8512
    v_mfma_f32_16x16x32_bf16 v[176:179], v[28:31], v[52:55], v[176:179]
    ds_read_b64_tr_b16 v[26:27], v120 offset:9024
    s_waitcnt lgkmcnt(2)
    v_mfma_f32_16x16x32_bf16 v[192:195], v[16:19], v[52:55], v[192:195]
    ds_read_b64_tr_b16 v[28:29], v120 offset:8544
    v_mfma_f32_16x16x32_bf16 v[208:211], v[20:23], v[52:55], v[208:211]
    ds_read_b64_tr_b16 v[30:31], v120 offset:9056
    s_mov_b32 s61, 1146880
    s_add_u32 m0, s60, 4224
    v_mfma_f32_16x16x32_bf16 v[212:215], v[20:23], v[56:59], v[212:215]
    buffer_load_dwordx4 v100, s[36:39], s61 offen offset:0 lds
    v_mfma_f32_16x16x32_bf16 v[196:199], v[16:19], v[56:59], v[196:199]
    ds_read_b128 v[36:39], v121 offset:32768
    v_mfma_f32_16x16x32_bf16 v[200:203], v[16:19], v[60:63], v[200:203]
    buffer_load_dwordx4 v101, s[36:39], s61 offen offset:1056 lds
    v_mfma_f32_16x16x32_bf16 v[216:219], v[20:23], v[60:63], v[216:219]
    ds_read_b128 v[40:43], v121 offset:33024
    v_mfma_f32_16x16x32_bf16 v[220:223], v[20:23], v[64:67], v[220:223]
    s_waitcnt vmcnt(14)
    ds_read_b64_tr_b16 v[20:21], v120 offset:12704
    v_mfma_f32_16x16x32_bf16 v[204:207], v[16:19], v[64:67], v[204:207]
    ds_read_b64_tr_b16 v[22:23], v120 offset:13216
    s_waitcnt lgkmcnt(4)
    v_mfma_f32_16x16x32_bf16 v[252:255], v[28:31], v[64:67], v[252:255]
    ds_read_b64_tr_b16 v[16:17], v120 offset:12672
    v_mfma_f32_16x16x32_bf16 v[236:239], v[24:27], v[64:67], v[236:239]
    ds_read_b64_tr_b16 v[18:19], v120 offset:13184
    v_mfma_f32_16x16x32_bf16 v[232:235], v[24:27], v[60:63], v[232:235]
    buffer_load_dwordx4 v102, s[36:39], s61 offen offset:2112 lds
    v_mfma_f32_16x16x32_bf16 v[248:251], v[28:31], v[60:63], v[248:251]
    ds_read_b128 v[44:47], v121 offset:33280
    v_mfma_f32_16x16x32_bf16 v[244:247], v[28:31], v[56:59], v[244:247]
    buffer_load_dwordx4 v103, s[36:39], s61 offen offset:3168 lds
    v_mfma_f32_16x16x32_bf16 v[228:231], v[24:27], v[56:59], v[228:231]
    ds_read_b128 v[48:51], v121 offset:33536
    v_mfma_f32_16x16x32_bf16 v[224:227], v[24:27], v[52:55], v[224:227]
    ds_read_b64_tr_b16 v[24:25], v120 offset:12736
    v_mfma_f32_16x16x32_bf16 v[240:243], v[28:31], v[52:55], v[240:243]
    ds_read_b64_tr_b16 v[26:27], v120 offset:13248
    s_waitcnt lgkmcnt(2)
    v_mfma_f32_16x16x32_bf16 v[128:131], v[16:19], v[36:39], v[128:131]
    ds_read_b64_tr_b16 v[28:29], v120 offset:12768
    v_mfma_f32_16x16x32_bf16 v[144:147], v[20:23], v[36:39], v[144:147]
    ds_read_b64_tr_b16 v[30:31], v120 offset:13280
    s_add_u32 m0, s60, 8448
    v_mfma_f32_16x16x32_bf16 v[148:151], v[20:23], v[40:43], v[148:151]
    buffer_load_dwordx4 v100, s[40:43], s61 offen offset:0 lds
    v_mfma_f32_16x16x32_bf16 v[132:135], v[16:19], v[40:43], v[132:135]
    v_mfma_f32_16x16x32_bf16 v[136:139], v[16:19], v[44:47], v[136:139]
    buffer_load_dwordx4 v101, s[40:43], s61 offen offset:1056 lds
    v_mfma_f32_16x16x32_bf16 v[152:155], v[20:23], v[44:47], v[152:155]
    v_mfma_f32_16x16x32_bf16 v[156:159], v[20:23], v[48:51], v[156:159]
    s_waitcnt vmcnt(14)
    ds_read_b64_tr_b16 v[20:21], v120 offset:16928
    v_mfma_f32_16x16x32_bf16 v[140:143], v[16:19], v[48:51], v[140:143]
    ds_read_b64_tr_b16 v[22:23], v120 offset:17440
    s_waitcnt lgkmcnt(2)
    v_mfma_f32_16x16x32_bf16 v[188:191], v[28:31], v[48:51], v[188:191]
    ds_read_b64_tr_b16 v[16:17], v120 offset:16896
    v_mfma_f32_16x16x32_bf16 v[172:175], v[24:27], v[48:51], v[172:175]
    ds_read_b64_tr_b16 v[18:19], v120 offset:17408
    v_mfma_f32_16x16x32_bf16 v[168:171], v[24:27], v[44:47], v[168:171]
    buffer_load_dwordx4 v102, s[40:43], s61 offen offset:2112 lds
    v_mfma_f32_16x16x32_bf16 v[184:187], v[28:31], v[44:47], v[184:187]
    v_mfma_f32_16x16x32_bf16 v[180:183], v[28:31], v[40:43], v[180:183]
    buffer_load_dwordx4 v103, s[40:43], s61 offen offset:3168 lds
    v_mfma_f32_16x16x32_bf16 v[164:167], v[24:27], v[40:43], v[164:167]
    v_mfma_f32_16x16x32_bf16 v[160:163], v[24:27], v[36:39], v[160:163]
    ds_read_b64_tr_b16 v[24:25], v120 offset:16960
    v_mfma_f32_16x16x32_bf16 v[176:179], v[28:31], v[36:39], v[176:179]
    ds_read_b64_tr_b16 v[26:27], v120 offset:17472
    s_waitcnt lgkmcnt(2)
    v_mfma_f32_16x16x32_bf16 v[192:195], v[16:19], v[36:39], v[192:195]
    ds_read_b64_tr_b16 v[28:29], v120 offset:16992
    v_mfma_f32_16x16x32_bf16 v[208:211], v[20:23], v[36:39], v[208:211]
    ds_read_b64_tr_b16 v[30:31], v120 offset:17504
    s_mov_b32 s61, 1261568
    s_add_u32 m0, s60, 12672
    v_mfma_f32_16x16x32_bf16 v[212:215], v[20:23], v[40:43], v[212:215]
    buffer_load_dwordx4 v100, s[36:39], s61 offen offset:0 lds
    v_mfma_f32_16x16x32_bf16 v[196:199], v[16:19], v[40:43], v[196:199]
    ds_read_b128 v[52:55], v121 offset:36864
    v_mfma_f32_16x16x32_bf16 v[200:203], v[16:19], v[44:47], v[200:203]
    buffer_load_dwordx4 v101, s[36:39], s61 offen offset:1056 lds
    v_mfma_f32_16x16x32_bf16 v[216:219], v[20:23], v[44:47], v[216:219]
    ds_read_b128 v[56:59], v121 offset:37120
    v_mfma_f32_16x16x32_bf16 v[220:223], v[20:23], v[48:51], v[220:223]
    s_waitcnt vmcnt(14)
    ds_read_b64_tr_b16 v[20:21], v120 offset:21152
    v_mfma_f32_16x16x32_bf16 v[204:207], v[16:19], v[48:51], v[204:207]
    ds_read_b64_tr_b16 v[22:23], v120 offset:21664
    s_waitcnt lgkmcnt(4)
    v_mfma_f32_16x16x32_bf16 v[252:255], v[28:31], v[48:51], v[252:255]
    ds_read_b64_tr_b16 v[16:17], v120 offset:21120
    v_mfma_f32_16x16x32_bf16 v[236:239], v[24:27], v[48:51], v[236:239]
    ds_read_b64_tr_b16 v[18:19], v120 offset:21632
    v_mfma_f32_16x16x32_bf16 v[232:235], v[24:27], v[44:47], v[232:235]
    buffer_load_dwordx4 v102, s[36:39], s61 offen offset:2112 lds
    v_mfma_f32_16x16x32_bf16 v[248:251], v[28:31], v[44:47], v[248:251]
    ds_read_b128 v[60:63], v121 offset:37376
    v_mfma_f32_16x16x32_bf16 v[244:247], v[28:31], v[40:43], v[244:247]
    buffer_load_dwordx4 v103, s[36:39], s61 offen offset:3168 lds
    v_mfma_f32_16x16x32_bf16 v[228:231], v[24:27], v[40:43], v[228:231]
    ds_read_b128 v[64:67], v121 offset:37632
    v_mfma_f32_16x16x32_bf16 v[224:227], v[24:27], v[36:39], v[224:227]
    ds_read_b64_tr_b16 v[24:25], v120 offset:21184
    v_mfma_f32_16x16x32_bf16 v[240:243], v[28:31], v[36:39], v[240:243]
    ds_read_b64_tr_b16 v[26:27], v120 offset:21696
    s_waitcnt lgkmcnt(2)
    v_mfma_f32_16x16x32_bf16 v[128:131], v[16:19], v[52:55], v[128:131]
    ds_read_b64_tr_b16 v[28:29], v120 offset:21216
    v_mfma_f32_16x16x32_bf16 v[144:147], v[20:23], v[52:55], v[144:147]
    ds_read_b64_tr_b16 v[30:31], v120 offset:21728
    s_add_u32 m0, s60, 16896
    v_mfma_f32_16x16x32_bf16 v[148:151], v[20:23], v[56:59], v[148:151]
    buffer_load_dwordx4 v100, s[40:43], s61 offen offset:0 lds
    v_mfma_f32_16x16x32_bf16 v[132:135], v[16:19], v[56:59], v[132:135]
    v_mfma_f32_16x16x32_bf16 v[136:139], v[16:19], v[60:63], v[136:139]
    buffer_load_dwordx4 v101, s[40:43], s61 offen offset:1056 lds
    v_mfma_f32_16x16x32_bf16 v[152:155], v[20:23], v[60:63], v[152:155]
    v_mfma_f32_16x16x32_bf16 v[156:159], v[20:23], v[64:67], v[156:159]
    s_waitcnt vmcnt(14)
    ds_read_b64_tr_b16 v[20:21], v120 offset:32
    v_mfma_f32_16x16x32_bf16 v[140:143], v[16:19], v[64:67], v[140:143]
    ds_read_b64_tr_b16 v[22:23], v120 offset:544
    s_waitcnt lgkmcnt(2)
    v_mfma_f32_16x16x32_bf16 v[188:191], v[28:31], v[64:67], v[188:191]
    ds_read_b64_tr_b16 v[16:17], v120 offset:0
    v_mfma_f32_16x16x32_bf16 v[172:175], v[24:27], v[64:67], v[172:175]
    ds_read_b64_tr_b16 v[18:19], v120 offset:512
    v_mfma_f32_16x16x32_bf16 v[168:171], v[24:27], v[60:63], v[168:171]
    buffer_load_dwordx4 v102, s[40:43], s61 offen offset:2112 lds
    v_mfma_f32_16x16x32_bf16 v[184:187], v[28:31], v[60:63], v[184:187]
    v_mfma_f32_16x16x32_bf16 v[180:183], v[28:31], v[56:59], v[180:183]
    buffer_load_dwordx4 v103, s[40:43], s61 offen offset:3168 lds
    v_mfma_f32_16x16x32_bf16 v[164:167], v[24:27], v[56:59], v[164:167]
    v_mfma_f32_16x16x32_bf16 v[160:163], v[24:27], v[52:55], v[160:163]
    ds_read_b64_tr_b16 v[24:25], v120 offset:64
    v_mfma_f32_16x16x32_bf16 v[176:179], v[28:31], v[52:55], v[176:179]
    ds_read_b64_tr_b16 v[26:27], v120 offset:576
    s_waitcnt lgkmcnt(2)
    v_mfma_f32_16x16x32_bf16 v[192:195], v[16:19], v[52:55], v[192:195]
    ds_read_b64_tr_b16 v[28:29], v120 offset:96
    v_mfma_f32_16x16x32_bf16 v[208:211], v[20:23], v[52:55], v[208:211]
    ds_read_b64_tr_b16 v[30:31], v120 offset:608
    s_mov_b32 s61, 1376256
    s_add_u32 m0, s60, 21120
    v_mfma_f32_16x16x32_bf16 v[212:215], v[20:23], v[56:59], v[212:215]
    buffer_load_dwordx4 v100, s[36:39], s61 offen offset:0 lds
    v_mfma_f32_16x16x32_bf16 v[196:199], v[16:19], v[56:59], v[196:199]
    ds_read_b128 v[36:39], v121 offset:40960
    v_mfma_f32_16x16x32_bf16 v[200:203], v[16:19], v[60:63], v[200:203]
    buffer_load_dwordx4 v101, s[36:39], s61 offen offset:1056 lds
    v_mfma_f32_16x16x32_bf16 v[216:219], v[20:23], v[60:63], v[216:219]
    ds_read_b128 v[40:43], v121 offset:41216
    v_mfma_f32_16x16x32_bf16 v[220:223], v[20:23], v[64:67], v[220:223]
    s_waitcnt vmcnt(14)
    ds_read_b64_tr_b16 v[20:21], v120 offset:4256
    v_mfma_f32_16x16x32_bf16 v[204:207], v[16:19], v[64:67], v[204:207]
    ds_read_b64_tr_b16 v[22:23], v120 offset:4768
    s_waitcnt lgkmcnt(4)
    v_mfma_f32_16x16x32_bf16 v[252:255], v[28:31], v[64:67], v[252:255]
    ds_read_b64_tr_b16 v[16:17], v120 offset:4224
    v_mfma_f32_16x16x32_bf16 v[236:239], v[24:27], v[64:67], v[236:239]
    ds_read_b64_tr_b16 v[18:19], v120 offset:4736
    v_mfma_f32_16x16x32_bf16 v[232:235], v[24:27], v[60:63], v[232:235]
    buffer_load_dwordx4 v102, s[36:39], s61 offen offset:2112 lds
    v_mfma_f32_16x16x32_bf16 v[248:251], v[28:31], v[60:63], v[248:251]
    ds_read_b128 v[44:47], v121 offset:41472
    v_mfma_f32_16x16x32_bf16 v[244:247], v[28:31], v[56:59], v[244:247]
    buffer_load_dwordx4 v103, s[36:39], s61 offen offset:3168 lds
    v_mfma_f32_16x16x32_bf16 v[228:231], v[24:27], v[56:59], v[228:231]
    ds_read_b128 v[48:51], v121 offset:41728
    v_mfma_f32_16x16x32_bf16 v[224:227], v[24:27], v[52:55], v[224:227]
    ds_read_b64_tr_b16 v[24:25], v120 offset:4288
    v_mfma_f32_16x16x32_bf16 v[240:243], v[28:31], v[52:55], v[240:243]
    ds_read_b64_tr_b16 v[26:27], v120 offset:4800
    s_waitcnt lgkmcnt(2)
    v_mfma_f32_16x16x32_bf16 v[128:131], v[16:19], v[36:39], v[128:131]
    ds_read_b64_tr_b16 v[28:29], v120 offset:4320
    v_mfma_f32_16x16x32_bf16 v[144:147], v[20:23], v[36:39], v[144:147]
    ds_read_b64_tr_b16 v[30:31], v120 offset:4832
    s_add_u32 m0, s60, 0
    v_mfma_f32_16x16x32_bf16 v[148:151], v[20:23], v[40:43], v[148:151]
    buffer_load_dwordx4 v100, s[40:43], s61 offen offset:0 lds
    v_mfma_f32_16x16x32_bf16 v[132:135], v[16:19], v[40:43], v[132:135]
    v_mfma_f32_16x16x32_bf16 v[136:139], v[16:19], v[44:47], v[136:139]
    buffer_load_dwordx4 v101, s[40:43], s61 offen offset:1056 lds
    v_mfma_f32_16x16x32_bf16 v[152:155], v[20:23], v[44:47], v[152:155]
    v_mfma_f32_16x16x32_bf16 v[156:159], v[20:23], v[48:51], v[156:159]
    s_waitcnt vmcnt(14)
    ds_read_b64_tr_b16 v[20:21], v120 offset:8480
    v_mfma_f32_16x16x32_bf16 v[140:143], v[16:19], v[48:51], v[140:143]
    ds_read_b64_tr_b16 v[22:23], v120 offset:8992
    s_waitcnt lgkmcnt(2)
    v_mfma_f32_16x16x32_bf16 v[188:191], v[28:31], v[48:51], v[188:191]
    ds_read_b64_tr_b16 v[16:17], v120 offset:8448
    v_mfma_f32_16x16x32_bf16 v[172:175], v[24:27], v[48:51], v[172:175]
    ds_read_b64_tr_b16 v[18:19], v120 offset:8960
    v_mfma_f32_16x16x32_bf16 v[168:171], v[24:27], v[44:47], v[168:171]
    buffer_load_dwordx4 v102, s[40:43], s61 offen offset:2112 lds
    v_mfma_f32_16x16x32_bf16 v[184:187], v[28:31], v[44:47], v[184:187]
    v_mfma_f32_16x16x32_bf16 v[180:183], v[28:31], v[40:43], v[180:183]
    buffer_load_dwordx4 v103, s[40:43], s61 offen offset:3168 lds
    v_mfma_f32_16x16x32_bf16 v[164:167], v[24:27], v[40:43], v[164:167]
    v_mfma_f32_16x16x32_bf16 v[160:163], v[24:27], v[36:39], v[160:163]
    ds_read_b64_tr_b16 v[24:25], v120 offset:8512
    v_mfma_f32_16x16x32_bf16 v[176:179], v[28:31], v[36:39], v[176:179]
    ds_read_b64_tr_b16 v[26:27], v120 offset:9024
    s_waitcnt lgkmcnt(2)
    v_mfma_f32_16x16x32_bf16 v[192:195], v[16:19], v[36:39], v[192:195]
    ds_read_b64_tr_b16 v[28:29], v120 offset:8544
    v_mfma_f32_16x16x32_bf16 v[208:211], v[20:23], v[36:39], v[208:211]
    ds_read_b64_tr_b16 v[30:31], v120 offset:9056
    s_mov_b32 s61, 1490944
    s_add_u32 m0, s60, 4224
    v_mfma_f32_16x16x32_bf16 v[212:215], v[20:23], v[40:43], v[212:215]
    buffer_load_dwordx4 v100, s[36:39], s61 offen offset:0 lds
    v_mfma_f32_16x16x32_bf16 v[196:199], v[16:19], v[40:43], v[196:199]
    ds_read_b128 v[52:55], v121 offset:45056
    v_mfma_f32_16x16x32_bf16 v[200:203], v[16:19], v[44:47], v[200:203]
    buffer_load_dwordx4 v101, s[36:39], s61 offen offset:1056 lds
    v_mfma_f32_16x16x32_bf16 v[216:219], v[20:23], v[44:47], v[216:219]
    ds_read_b128 v[56:59], v121 offset:45312
    v_mfma_f32_16x16x32_bf16 v[220:223], v[20:23], v[48:51], v[220:223]
    s_waitcnt vmcnt(14)
    ds_read_b64_tr_b16 v[20:21], v120 offset:12704
    v_mfma_f32_16x16x32_bf16 v[204:207], v[16:19], v[48:51], v[204:207]
    ds_read_b64_tr_b16 v[22:23], v120 offset:13216
    s_waitcnt lgkmcnt(4)
    v_mfma_f32_16x16x32_bf16 v[252:255], v[28:31], v[48:51], v[252:255]
    ds_read_b64_tr_b16 v[16:17], v120 offset:12672
    v_mfma_f32_16x16x32_bf16 v[236:239], v[24:27], v[48:51], v[236:239]
    ds_read_b64_tr_b16 v[18:19], v120 offset:13184
    v_mfma_f32_16x16x32_bf16 v[232:235], v[24:27], v[44:47], v[232:235]
    buffer_load_dwordx4 v102, s[36:39], s61 offen offset:2112 lds
    v_mfma_f32_16x16x32_bf16 v[248:251], v[28:31], v[44:47], v[248:251]
    ds_read_b128 v[60:63], v121 offset:45568
    v_mfma_f32_16x16x32_bf16 v[244:247], v[28:31], v[40:43], v[244:247]
    buffer_load_dwordx4 v103, s[36:39], s61 offen offset:3168 lds
    v_mfma_f32_16x16x32_bf16 v[228:231], v[24:27], v[40:43], v[228:231]
    ds_read_b128 v[64:67], v121 offset:45824
    v_mfma_f32_16x16x32_bf16 v[224:227], v[24:27], v[36:39], v[224:227]
    ds_read_b64_tr_b16 v[24:25], v120 offset:12736
    v_mfma_f32_16x16x32_bf16 v[240:243], v[28:31], v[36:39], v[240:243]
    ds_read_b64_tr_b16 v[26:27], v120 offset:13248
    s_waitcnt lgkmcnt(2)
    v_mfma_f32_16x16x32_bf16 v[128:131], v[16:19], v[52:55], v[128:131]
    ds_read_b64_tr_b16 v[28:29], v120 offset:12768
    v_mfma_f32_16x16x32_bf16 v[144:147], v[20:23], v[52:55], v[144:147]
    ds_read_b64_tr_b16 v[30:31], v120 offset:13280
    s_add_u32 m0, s60, 8448
    v_mfma_f32_16x16x32_bf16 v[148:151], v[20:23], v[56:59], v[148:151]
    buffer_load_dwordx4 v100, s[40:43], s61 offen offset:0 lds
    v_mfma_f32_16x16x32_bf16 v[132:135], v[16:19], v[56:59], v[132:135]
    v_mfma_f32_16x16x32_bf16 v[136:139], v[16:19], v[60:63], v[136:139]
    buffer_load_dwordx4 v101, s[40:43], s61 offen offset:1056 lds
    v_mfma_f32_16x16x32_bf16 v[152:155], v[20:23], v[60:63], v[152:155]
    v_mfma_f32_16x16x32_bf16 v[156:159], v[20:23], v[64:67], v[156:159]
    s_waitcnt vmcnt(14)
    ds_read_b64_tr_b16 v[20:21], v120 offset:16928
    v_mfma_f32_16x16x32_bf16 v[140:143], v[16:19], v[64:67], v[140:143]
    ds_read_b64_tr_b16 v[22:23], v120 offset:17440
    s_waitcnt lgkmcnt(2)
    v_mfma_f32_16x16x32_bf16 v[188:191], v[28:31], v[64:67], v[188:191]
    ds_read_b64_tr_b16 v[16:17], v120 offset:16896
    v_mfma_f32_16x16x32_bf16 v[172:175], v[24:27], v[64:67], v[172:175]
    ds_read_b64_tr_b16 v[18:19], v120 offset:17408
    v_mfma_f32_16x16x32_bf16 v[168:171], v[24:27], v[60:63], v[168:171]
    buffer_load_dwordx4 v102, s[40:43], s61 offen offset:2112 lds
    v_mfma_f32_16x16x32_bf16 v[184:187], v[28:31], v[60:63], v[184:187]
    v_mfma_f32_16x16x32_bf16 v[180:183], v[28:31], v[56:59], v[180:183]
    buffer_load_dwordx4 v103, s[40:43], s61 offen offset:3168 lds
    v_mfma_f32_16x16x32_bf16 v[164:167], v[24:27], v[56:59], v[164:167]
    v_mfma_f32_16x16x32_bf16 v[160:163], v[24:27], v[52:55], v[160:163]
    ds_read_b64_tr_b16 v[24:25], v120 offset:16960
    v_mfma_f32_16x16x32_bf16 v[176:179], v[28:31], v[52:55], v[176:179]
    ds_read_b64_tr_b16 v[26:27], v120 offset:17472
    s_waitcnt lgkmcnt(2)
    v_mfma_f32_16x16x32_bf16 v[192:195], v[16:19], v[52:55], v[192:195]
    ds_read_b64_tr_b16 v[28:29], v120 offset:16992
    v_mfma_f32_16x16x32_bf16 v[208:211], v[20:23], v[52:55], v[208:211]
    ds_read_b64_tr_b16 v[30:31], v120 offset:17504
    s_mov_b32 s61, 0
    s_add_u32 m0, s60, 12672
    v_mfma_f32_16x16x32_bf16 v[212:215], v[20:23], v[56:59], v[212:215]
    buffer_load_dwordx4 v104, s[44:47], s61 offen offset:0 lds
    v_mfma_f32_16x16x32_bf16 v[196:199], v[16:19], v[56:59], v[196:199]
    ds_read_b128 v[36:39], v121 offset:49152
    v_mfma_f32_16x16x32_bf16 v[200:203], v[16:19], v[60:63], v[200:203]
    buffer_load_dwordx4 v105, s[44:47], s61 offen offset:1056 lds
    v_mfma_f32_16x16x32_bf16 v[216:219], v[20:23], v[60:63], v[216:219]
    ds_read_b128 v[40:43], v121 offset:49408
    v_mfma_f32_16x16x32_bf16 v[220:223], v[20:23], v[64:67], v[220:223]
    s_waitcnt vmcnt(14)
    ds_read_b64_tr_b16 v[20:21], v120 offset:21152
    v_mfma_f32_16x16x32_bf16 v[204:207], v[16:19], v[64:67], v[204:207]
    ds_read_b64_tr_b16 v[22:23], v120 offset:21664
    s_waitcnt lgkmcnt(4)
    v_mfma_f32_16x16x32_bf16 v[252:255], v[28:31], v[64:67], v[252:255]
    ds_read_b64_tr_b16 v[16:17], v120 offset:21120
    v_mfma_f32_16x16x32_bf16 v[236:239], v[24:27], v[64:67], v[236:239]
    ds_read_b64_tr_b16 v[18:19], v120 offset:21632
    v_mfma_f32_16x16x32_bf16 v[232:235], v[24:27], v[60:63], v[232:235]
    buffer_load_dwordx4 v106, s[44:47], s61 offen offset:2112 lds
    v_mfma_f32_16x16x32_bf16 v[248:251], v[28:31], v[60:63], v[248:251]
    ds_read_b128 v[44:47], v121 offset:49664
    v_mfma_f32_16x16x32_bf16 v[244:247], v[28:31], v[56:59], v[244:247]
    buffer_load_dwordx4 v107, s[44:47], s61 offen offset:3168 lds
    v_mfma_f32_16x16x32_bf16 v[228:231], v[24:27], v[56:59], v[228:231]
    ds_read_b128 v[48:51], v121 offset:49920
    v_mfma_f32_16x16x32_bf16 v[224:227], v[24:27], v[52:55], v[224:227]
    ds_read_b64_tr_b16 v[24:25], v120 offset:21184
    v_mfma_f32_16x16x32_bf16 v[240:243], v[28:31], v[52:55], v[240:243]
    ds_read_b64_tr_b16 v[26:27], v120 offset:21696
    s_waitcnt lgkmcnt(2)
    v_mfma_f32_16x16x32_bf16 v[128:131], v[16:19], v[36:39], v[128:131]
    ds_read_b64_tr_b16 v[28:29], v120 offset:21216
    v_mfma_f32_16x16x32_bf16 v[144:147], v[20:23], v[36:39], v[144:147]
    ds_read_b64_tr_b16 v[30:31], v120 offset:21728
    s_add_u32 m0, s60, 16896
    v_mfma_f32_16x16x32_bf16 v[148:151], v[20:23], v[40:43], v[148:151]
    buffer_load_dwordx4 v108, s[44:47], s61 offen offset:0 lds
    v_mfma_f32_16x16x32_bf16 v[132:135], v[16:19], v[40:43], v[132:135]
    v_mfma_f32_16x16x32_bf16 v[136:139], v[16:19], v[44:47], v[136:139]
    buffer_load_dwordx4 v109, s[44:47], s61 offen offset:1056 lds
    v_mfma_f32_16x16x32_bf16 v[152:155], v[20:23], v[44:47], v[152:155]
    v_mfma_f32_16x16x32_bf16 v[156:159], v[20:23], v[48:51], v[156:159]
    s_waitcnt vmcnt(14)
    ds_read_b64_tr_b16 v[20:21], v120 offset:32
    v_mfma_f32_16x16x32_bf16 v[140:143], v[16:19], v[48:51], v[140:143]
    ds_read_b64_tr_b16 v[22:23], v120 offset:544
    s_waitcnt lgkmcnt(2)
    v_mfma_f32_16x16x32_bf16 v[188:191], v[28:31], v[48:51], v[188:191]
    ds_read_b64_tr_b16 v[16:17], v120 offset:0
    v_mfma_f32_16x16x32_bf16 v[172:175], v[24:27], v[48:51], v[172:175]
    ds_read_b64_tr_b16 v[18:19], v120 offset:512
    v_mfma_f32_16x16x32_bf16 v[168:171], v[24:27], v[44:47], v[168:171]
    buffer_load_dwordx4 v110, s[44:47], s61 offen offset:2112 lds
    v_mfma_f32_16x16x32_bf16 v[184:187], v[28:31], v[44:47], v[184:187]
    v_mfma_f32_16x16x32_bf16 v[180:183], v[28:31], v[40:43], v[180:183]
    buffer_load_dwordx4 v111, s[44:47], s61 offen offset:3168 lds
    v_mfma_f32_16x16x32_bf16 v[164:167], v[24:27], v[40:43], v[164:167]
    v_mfma_f32_16x16x32_bf16 v[160:163], v[24:27], v[36:39], v[160:163]
    ds_read_b64_tr_b16 v[24:25], v120 offset:64
    v_mfma_f32_16x16x32_bf16 v[176:179], v[28:31], v[36:39], v[176:179]
    ds_read_b64_tr_b16 v[26:27], v120 offset:576
    s_waitcnt lgkmcnt(2)
    v_mfma_f32_16x16x32_bf16 v[192:195], v[16:19], v[36:39], v[192:195]
    ds_read_b64_tr_b16 v[28:29], v120 offset:96
    v_mfma_f32_16x16x32_bf16 v[208:211], v[20:23], v[36:39], v[208:211]
    ds_read_b64_tr_b16 v[30:31], v120 offset:608
    s_mov_b32 s61, 262144
    s_add_u32 m0, s60, 21120
    v_mfma_f32_16x16x32_bf16 v[212:215], v[20:23], v[40:43], v[212:215]
    buffer_load_dwordx4 v104, s[44:47], s61 offen offset:0 lds
    v_mfma_f32_16x16x32_bf16 v[196:199], v[16:19], v[40:43], v[196:199]
    ds_read_b128 v[52:55], v121 offset:53248
    v_mfma_f32_16x16x32_bf16 v[200:203], v[16:19], v[44:47], v[200:203]
    buffer_load_dwordx4 v105, s[44:47], s61 offen offset:1056 lds
    v_mfma_f32_16x16x32_bf16 v[216:219], v[20:23], v[44:47], v[216:219]
    ds_read_b128 v[56:59], v121 offset:53504
    v_mfma_f32_16x16x32_bf16 v[220:223], v[20:23], v[48:51], v[220:223]
    s_waitcnt vmcnt(14)
    ds_read_b64_tr_b16 v[20:21], v120 offset:4256
    v_mfma_f32_16x16x32_bf16 v[204:207], v[16:19], v[48:51], v[204:207]
    ds_read_b64_tr_b16 v[22:23], v120 offset:4768
    s_waitcnt lgkmcnt(4)
    v_mfma_f32_16x16x32_bf16 v[252:255], v[28:31], v[48:51], v[252:255]
    ds_read_b64_tr_b16 v[16:17], v120 offset:4224
    v_mfma_f32_16x16x32_bf16 v[236:239], v[24:27], v[48:51], v[236:239]
    ds_read_b64_tr_b16 v[18:19], v120 offset:4736
    v_mfma_f32_16x16x32_bf16 v[232:235], v[24:27], v[44:47], v[232:235]
    buffer_load_dwordx4 v106, s[44:47], s61 offen offset:2112 lds
    v_mfma_f32_16x16x32_bf16 v[248:251], v[28:31], v[44:47], v[248:251]
    ds_read_b128 v[60:63], v121 offset:53760
    v_mfma_f32_16x16x32_bf16 v[244:247], v[28:31], v[40:43], v[244:247]
    buffer_load_dwordx4 v107, s[44:47], s61 offen offset:3168 lds
    v_mfma_f32_16x16x32_bf16 v[228:231], v[24:27], v[40:43], v[228:231]
    ds_read_b128 v[64:67], v121 offset:54016
    v_mfma_f32_16x16x32_bf16 v[224:227], v[24:27], v[36:39], v[224:227]
    ds_read_b64_tr_b16 v[24:25], v120 offset:4288
    v_mfma_f32_16x16x32_bf16 v[240:243], v[28:31], v[36:39], v[240:243]
    ds_read_b64_tr_b16 v[26:27], v120 offset:4800
    s_waitcnt lgkmcnt(2)
    v_mfma_f32_16x16x32_bf16 v[128:131], v[16:19], v[52:55], v[128:131]
    ds_read_b64_tr_b16 v[28:29], v120 offset:4320
    v_mfma_f32_16x16x32_bf16 v[144:147], v[20:23], v[52:55], v[144:147]
    ds_read_b64_tr_b16 v[30:31], v120 offset:4832
    s_add_u32 m0, s60, 0
    v_mfma_f32_16x16x32_bf16 v[148:151], v[20:23], v[56:59], v[148:151]
    buffer_load_dwordx4 v108, s[44:47], s61 offen offset:0 lds
    v_mfma_f32_16x16x32_bf16 v[132:135], v[16:19], v[56:59], v[132:135]
    v_mfma_f32_16x16x32_bf16 v[136:139], v[16:19], v[60:63], v[136:139]
    buffer_load_dwordx4 v109, s[44:47], s61 offen offset:1056 lds
    v_mfma_f32_16x16x32_bf16 v[152:155], v[20:23], v[60:63], v[152:155]
    v_mfma_f32_16x16x32_bf16 v[156:159], v[20:23], v[64:67], v[156:159]
    s_waitcnt vmcnt(14)
    ds_read_b64_tr_b16 v[20:21], v120 offset:8480
    v_mfma_f32_16x16x32_bf16 v[140:143], v[16:19], v[64:67], v[140:143]
    ds_read_b64_tr_b16 v[22:23], v120 offset:8992
    s_waitcnt lgkmcnt(2)
    v_mfma_f32_16x16x32_bf16 v[188:191], v[28:31], v[64:67], v[188:191]
    ds_read_b64_tr_b16 v[16:17], v120 offset:8448
    v_mfma_f32_16x16x32_bf16 v[172:175], v[24:27], v[64:67], v[172:175]
    ds_read_b64_tr_b16 v[18:19], v120 offset:8960
    v_mfma_f32_16x16x32_bf16 v[168:171], v[24:27], v[60:63], v[168:171]
    buffer_load_dwordx4 v110, s[44:47], s61 offen offset:2112 lds
    v_mfma_f32_16x16x32_bf16 v[184:187], v[28:31], v[60:63], v[184:187]
    v_mfma_f32_16x16x32_bf16 v[180:183], v[28:31], v[56:59], v[180:183]
    buffer_load_dwordx4 v111, s[44:47], s61 offen offset:3168 lds
    v_mfma_f32_16x16x32_bf16 v[164:167], v[24:27], v[56:59], v[164:167]
    v_mfma_f32_16x16x32_bf16 v[160:163], v[24:27], v[52:55], v[160:163]
    ds_read_b64_tr_b16 v[24:25], v120 offset:8512
    v_mfma_f32_16x16x32_bf16 v[176:179], v[28:31], v[52:55], v[176:179]
    ds_read_b64_tr_b16 v[26:27], v120 offset:9024
    s_waitcnt lgkmcnt(2)
    v_mfma_f32_16x16x32_bf16 v[192:195], v[16:19], v[52:55], v[192:195]
    ds_read_b64_tr_b16 v[28:29], v120 offset:8544
    v_mfma_f32_16x16x32_bf16 v[208:211], v[20:23], v[52:55], v[208:211]
    ds_read_b64_tr_b16 v[30:31], v120 offset:9056
    s_mov_b32 s61, 524288
    s_add_u32 m0, s60, 4224
    v_mfma_f32_16x16x32_bf16 v[212:215], v[20:23], v[56:59], v[212:215]
    buffer_load_dwordx4 v104, s[44:47], s61 offen offset:0 lds
    v_mfma_f32_16x16x32_bf16 v[196:199], v[16:19], v[56:59], v[196:199]
    ds_read_b128 v[36:39], v121 offset:0
    v_mfma_f32_16x16x32_bf16 v[200:203], v[16:19], v[60:63], v[200:203]
    buffer_load_dwordx4 v105, s[44:47], s61 offen offset:1056 lds
    v_mfma_f32_16x16x32_bf16 v[216:219], v[20:23], v[60:63], v[216:219]
    ds_read_b128 v[40:43], v121 offset:256
    v_mfma_f32_16x16x32_bf16 v[220:223], v[20:23], v[64:67], v[220:223]
    s_waitcnt vmcnt(14)
    ds_read_b64_tr_b16 v[20:21], v120 offset:12704
    v_mfma_f32_16x16x32_bf16 v[204:207], v[16:19], v[64:67], v[204:207]
    ds_read_b64_tr_b16 v[22:23], v120 offset:13216
    s_waitcnt lgkmcnt(4)
    v_mfma_f32_16x16x32_bf16 v[252:255], v[28:31], v[64:67], v[252:255]
    ds_read_b64_tr_b16 v[16:17], v120 offset:12672
    v_mfma_f32_16x16x32_bf16 v[236:239], v[24:27], v[64:67], v[236:239]
    ds_read_b64_tr_b16 v[18:19], v120 offset:13184
    v_mfma_f32_16x16x32_bf16 v[232:235], v[24:27], v[60:63], v[232:235]
    buffer_load_dwordx4 v106, s[44:47], s61 offen offset:2112 lds
    v_mfma_f32_16x16x32_bf16 v[248:251], v[28:31], v[60:63], v[248:251]
    ds_read_b128 v[44:47], v121 offset:512
    v_mfma_f32_16x16x32_bf16 v[244:247], v[28:31], v[56:59], v[244:247]
    buffer_load_dwordx4 v107, s[44:47], s61 offen offset:3168 lds
    v_mfma_f32_16x16x32_bf16 v[228:231], v[24:27], v[56:59], v[228:231]
    ds_read_b128 v[48:51], v121 offset:768
    v_mfma_f32_16x16x32_bf16 v[224:227], v[24:27], v[52:55], v[224:227]
    ds_read_b64_tr_b16 v[24:25], v120 offset:12736
    v_mfma_f32_16x16x32_bf16 v[240:243], v[28:31], v[52:55], v[240:243]
    ds_read_b64_tr_b16 v[26:27], v120 offset:13248
    ds_read_b64_tr_b16 v[28:29], v120 offset:12768
    ds_read_b64_tr_b16 v[30:31], v120 offset:13280
    s_lshl_b32 s27, s20, 2
    s_add_u32 s27, s27, s16
    s_mul_i32 s28, s27, 1792
    v_lshlrev_b32 v13, 7, v0
    s_mov_b64 exec, 0x3fff
    buffer_load_dword v34, v13, s[48:51], s28 offen
    s_mov_b64 exec, -1
    s_nop 7
    v_pk_mul_f32 v[128:129], v[128:129], v[192:193]
    v_pk_mul_f32 v[130:131], v[130:131], v[194:195]
    v_cvt_pk_bf16_f32 v68, v128, v129
    v_cvt_pk_bf16_f32 v69, v130, v131
    v_pk_mul_f32 v[132:133], v[132:133], v[196:197]
    v_pk_mul_f32 v[134:135], v[134:135], v[198:199]
    v_cvt_pk_bf16_f32 v72, v132, v133
    v_cvt_pk_bf16_f32 v73, v134, v135
    v_pk_mul_f32 v[136:137], v[136:137], v[200:201]
    v_pk_mul_f32 v[138:139], v[138:139], v[202:203]
    v_cvt_pk_bf16_f32 v76, v136, v137
    v_cvt_pk_bf16_f32 v77, v138, v139
    v_pk_mul_f32 v[140:141], v[140:141], v[204:205]
    v_pk_mul_f32 v[142:143], v[142:143], v[206:207]
    v_cvt_pk_bf16_f32 v80, v140, v141
    v_cvt_pk_bf16_f32 v81, v142, v143
    v_pk_mul_f32 v[144:145], v[144:145], v[208:209]
    v_pk_mul_f32 v[146:147], v[146:147], v[210:211]
    v_cvt_pk_bf16_f32 v70, v144, v145
    v_cvt_pk_bf16_f32 v71, v146, v147
    v_pk_mul_f32 v[148:149], v[148:149], v[212:213]
    v_pk_mul_f32 v[150:151], v[150:151], v[214:215]
    v_cvt_pk_bf16_f32 v74, v148, v149
    v_cvt_pk_bf16_f32 v75, v150, v151
    v_pk_mul_f32 v[152:153], v[152:153], v[216:217]
    v_pk_mul_f32 v[154:155], v[154:155], v[218:219]
    v_cvt_pk_bf16_f32 v78, v152, v153
    v_cvt_pk_bf16_f32 v79, v154, v155
    v_pk_mul_f32 v[156:157], v[156:157], v[220:221]
    v_pk_mul_f32 v[158:159], v[158:159], v[222:223]
    v_cvt_pk_bf16_f32 v82, v156, v157
    v_cvt_pk_bf16_f32 v83, v158, v159
    v_pk_mul_f32 v[160:161], v[160:161], v[224:225]
    v_pk_mul_f32 v[162:163], v[162:163], v[226:227]
    v_cvt_pk_bf16_f32 v84, v160, v161
    v_cvt_pk_bf16_f32 v85, v162, v163
    v_pk_mul_f32 v[164:165], v[164:165], v[228:229]
    v_pk_mul_f32 v[166:167], v[166:167], v[230:231]
    v_cvt_pk_bf16_f32 v88, v164, v165
    v_cvt_pk_bf16_f32 v89, v166, v167
    v_pk_mul_f32 v[168:169], v[168:169], v[232:233]
    v_pk_mul_f32 v[170:171], v[170:171], v[234:235]
    v_cvt_pk_bf16_f32 v92, v168, v169
    v_cvt_pk_bf16_f32 v93, v170, v171
    v_pk_mul_f32 v[172:173], v[172:173], v[236:237]
    v_pk_mul_f32 v[174:175], v[174:175], v[238:239]
    v_cvt_pk_bf16_f32 v96, v172, v173
    v_cvt_pk_bf16_f32 v97, v174, v175
    v_pk_mul_f32 v[176:177], v[176:177], v[240:241]
    v_pk_mul_f32 v[178:179], v[178:179], v[242:243]
    v_cvt_pk_bf16_f32 v86, v176, v177
    v_cvt_pk_bf16_f32 v87, v178, v179
    v_pk_mul_f32 v[180:181], v[180:181], v[244:245]
    v_pk_mul_f32 v[182:183], v[182:183], v[246:247]
    v_cvt_pk_bf16_f32 v90, v180, v181
    v_cvt_pk_bf16_f32 v91, v182, v183
    v_pk_mul_f32 v[184:185], v[184:185], v[248:249]
    v_pk_mul_f32 v[186:187], v[186:187], v[250:251]
    v_cvt_pk_bf16_f32 v94, v184, v185
L_pg3:
    s_cbranch_execz L_pg7
    v_cvt_pk_bf16_f32 v95, v186, v187
    v_pk_mul_f32 v[188:189], v[188:189], v[252:253]
    v_pk_mul_f32 v[190:191], v[190:191], v[254:255]
    v_cvt_pk_bf16_f32 v98, v188, v189
    v_cvt_pk_bf16_f32 v99, v190, v191
    s_waitcnt lgkmcnt(4)
    v_mfma_f32_16x16x32_bf16 v[128:131], v[16:19], v[36:39], 0
    v_mfma_f32_16x16x32_bf16 v[144:147], v[20:23], v[36:39], 0
    s_add_u32 m0, s60, 8448
    v_mfma_f32_16x16x32_bf16 v[148:151], v[20:23], v[40:43], 0
    buffer_load_dwordx4 v108, s[44:47], s61 offen offset:0 lds
    v_mfma_f32_16x16x32_bf16 v[132:135], v[16:19], v[40:43], 0
    v_mfma_f32_16x16x32_bf16 v[136:139], v[16:19], v[44:47], 0
    buffer_load_dwordx4 v109, s[44:47], s61 offen offset:1056 lds
    v_mfma_f32_16x16x32_bf16 v[152:155], v[20:23], v[44:47], 0
    v_mfma_f32_16x16x32_bf16 v[156:159], v[20:23], v[48:51], 0
    s_waitcnt vmcnt(15)
    ds_read_b64_tr_b16 v[20:21], v120 offset:16928
    v_mfma_f32_16x16x32_bf16 v[140:143], v[16:19], v[48:51], 0
    ds_read_b64_tr_b16 v[22:23], v120 offset:17440
    s_waitcnt lgkmcnt(2)
    v_mfma_f32_16x16x32_bf16 v[188:191], v[28:31], v[48:51], 0
    ds_read_b64_tr_b16 v[16:17], v120 offset:16896
    v_mfma_f32_16x16x32_bf16 v[172:175], v[24:27], v[48:51], 0
    ds_read_b64_tr_b16 v[18:19], v120 offset:17408
    v_mfma_f32_16x16x32_bf16 v[168:171], v[24:27], v[44:47], 0
    buffer_load_dwordx4 v110, s[44:47], s61 offen offset:2112 lds
    v_mfma_f32_16x16x32_bf16 v[184:187], v[28:31], v[44:47], 0
    v_mfma_f32_16x16x32_bf16 v[180:183], v[28:31], v[40:43], 0
    buffer_load_dwordx4 v111, s[44:47], s61 offen offset:3168 lds
    v_mfma_f32_16x16x32_bf16 v[164:167], v[24:27], v[40:43], 0
    v_mfma_f32_16x16x32_bf16 v[160:163], v[24:27], v[36:39], 0
    ds_read_b64_tr_b16 v[24:25], v120 offset:16960
    v_mfma_f32_16x16x32_bf16 v[176:179], v[28:31], v[36:39], 0
    ds_read_b64_tr_b16 v[26:27], v120 offset:17472
    s_waitcnt lgkmcnt(2)
    v_mfma_f32_16x16x32_bf16 v[192:195], v[16:19], v[36:39], 0
    ds_read_b64_tr_b16 v[28:29], v120 offset:16992
    v_mfma_f32_16x16x32_bf16 v[208:211], v[20:23], v[36:39], 0
    ds_read_b64_tr_b16 v[30:31], v120 offset:17504
    s_mov_b32 s61, 786432
    s_add_u32 m0, s60, 12672
    v_mfma_f32_16x16x32_bf16 v[212:215], v[20:23], v[40:43], 0
    buffer_load_dwordx4 v104, s[44:47], s61 offen offset:0 lds
    v_mfma_f32_16x16x32_bf16 v[196:199], v[16:19], v[40:43], 0
    ds_read_b128 v[52:55], v121 offset:4096
    v_mfma_f32_16x16x32_bf16 v[200:203], v[16:19], v[44:47], 0
    buffer_load_dwordx4 v105, s[44:47], s61 offen offset:1056 lds
    v_mfma_f32_16x16x32_bf16 v[216:219], v[20:23], v[44:47], 0
    ds_read_b128 v[56:59], v121 offset:4352
    v_mfma_f32_16x16x32_bf16 v[220:223], v[20:23], v[48:51], 0
    s_waitcnt vmcnt(15)
    ds_read_b64_tr_b16 v[20:21], v120 offset:21152
    v_mfma_f32_16x16x32_bf16 v[204:207], v[16:19], v[48:51], 0
    ds_read_b64_tr_b16 v[22:23], v120 offset:21664
    s_waitcnt lgkmcnt(4)
    v_mfma_f32_16x16x32_bf16 v[252:255], v[28:31], v[48:51], 0
    ds_read_b64_tr_b16 v[16:17], v120 offset:21120
    v_mfma_f32_16x16x32_bf16 v[236:239], v[24:27], v[48:51], 0
    ds_read_b64_tr_b16 v[18:19], v120 offset:21632
    v_mfma_f32_16x16x32_bf16 v[232:235], v[24:27], v[44:47], 0
    buffer_load_dwordx4 v106, s[44:47], s61 offen offset:2112 lds
    v_mfma_f32_16x16x32_bf16 v[248:251], v[28:31], v[44:47], 0
    ds_read_b128 v[60:63], v121 offset:4608
    v_mfma_f32_16x16x32_bf16 v[244:247], v[28:31], v[40:43], 0
    buffer_load_dwordx4 v107, s[44:47], s61 offen offset:3168 lds
    v_mfma_f32_16x16x32_bf16 v[228:231], v[24:27], v[40:43], 0
    ds_read_b128 v[64:67], v121 offset:4864
    v_mfma_f32_16x16x32_bf16 v[224:227], v[24:27], v[36:39], 0
    ds_read_b64_tr_b16 v[24:25], v120 offset:21184
    v_mfma_f32_16x16x32_bf16 v[240:243], v[28:31], v[36:39], 0
    ds_read_b64_tr_b16 v[26:27], v120 offset:21696
    s_waitcnt lgkmcnt(2)
    v_mfma_f32_16x16x32_bf16 v[128:131], v[16:19], v[52:55], v[128:131]
    ds_read_b64_tr_b16 v[28:29], v120 offset:21216
    v_mfma_f32_16x16x32_bf16 v[144:147], v[20:23], v[52:55], v[144:147]
    ds_read_b64_tr_b16 v[30:31], v120 offset:21728
    s_add_u32 m0, s60, 16896
    v_mfma_f32_16x16x32_bf16 v[148:151], v[20:23], v[56:59], v[148:151]
    buffer_load_dwordx4 v108, s[44:47], s61 offen offset:0 lds
    v_mfma_f32_16x16x32_bf16 v[132:135], v[16:19], v[56:59], v[132:135]
    v_mfma_f32_16x16x32_bf16 v[136:139], v[16:19], v[60:63], v[136:139]
    buffer_load_dwordx4 v109, s[44:47], s61 offen offset:1056 lds
    v_mfma_f32_16x16x32_bf16 v[152:155], v[20:23], v[60:63], v[152:155]
    v_mfma_f32_16x16x32_bf16 v[156:159], v[20:23], v[64:67], v[156:159]
    s_waitcnt vmcnt(15)
    ds_read_b64_tr_b16 v[20:21], v120 offset:32
    v_mfma_f32_16x16x32_bf16 v[140:143], v[16:19], v[64:67], v[140:143]
    ds_read_b64_tr_b16 v[22:23], v120 offset:544
    s_waitcnt lgkmcnt(2)
    v_mfma_f32_16x16x32_bf16 v[188:191], v[28:31], v[64:67], v[188:191]
    ds_read_b64_tr_b16 v[16:17], v120 offset:0
    v_mfma_f32_16x16x32_bf16 v[172:175], v[24:27], v[64:67], v[172:175]
    ds_read_b64_tr_b16 v[18:19], v120 offset:512
    v_mfma_f32_16x16x32_bf16 v[168:171], v[24:27], v[60:63], v[168:171]
    buffer_load_dwordx4 v110, s[44:47], s61 offen offset:2112 lds
    v_mfma_f32_16x16x32_bf16 v[184:187], v[28:31], v[60:63], v[184:187]
    v_mfma_f32_16x16x32_bf16 v[180:183], v[28:31], v[56:59], v[180:183]
    buffer_load_dwordx4 v111, s[44:47], s61 offen offset:3168 lds
    v_mfma_f32_16x16x32_bf16 v[164:167], v[24:27], v[56:59], v[164:167]
    v_mfma_f32_16x16x32_bf16 v[160:163], v[24:27], v[52:55], v[160:163]
    ds_read_b64_tr_b16 v[24:25], v120 offset:64
    v_mfma_f32_16x16x32_bf16 v[176:179], v[28:31], v[52:55], v[176:179]
    ds_read_b64_tr_b16 v[26:27], v120 offset:576
    s_waitcnt lgkmcnt(2)
    v_mfma_f32_16x16x32_bf16 v[192:195], v[16:19], v[52:55], v[192:195]
    ds_read_b64_tr_b16 v[28:29], v120 offset:96
    v_mfma_f32_16x16x32_bf16 v[208:211], v[20:23], v[52:55], v[208:211]
    ds_read_b64_tr_b16 v[30:31], v120 offset:608
    s_mov_b32 s61, 1048576
    s_add_u32 m0, s60, 21120
    v_mfma_f32_16x16x32_bf16 v[212:215], v[20:23], v[56:59], v[212:215]
    buffer_load_dwordx4 v104, s[44:47], s61 offen offset:0 lds
    v_mfma_f32_16x16x32_bf16 v[196:199], v[16:19], v[56:59], v[196:199]
    ds_read_b128 v[36:39], v121 offset:8192
    v_mfma_f32_16x16x32_bf16 v[200:203], v[16:19], v[60:63], v[200:203]
    buffer_load_dwordx4 v105, s[44:47], s61 offen offset:1056 lds
    v_mfma_f32_16x16x32_bf16 v[216:219], v[20:23], v[60:63], v[216:219]
    ds_read_b128 v[40:43], v121 offset:8448
    v_mfma_f32_16x16x32_bf16 v[220:223], v[20:23], v[64:67], v[220:223]
    s_waitcnt vmcnt(15)
    ds_read_b64_tr_b16 v[20:21], v120 offset:4256
    v_mfma_f32_16x16x32_bf16 v[204:207], v[16:19], v[64:67], v[204:207]
    ds_read_b64_tr_b16 v[22:23], v120 offset:4768
    s_waitcnt lgkmcnt(4)
    v_mfma_f32_16x16x32_bf16 v[252:255], v[28:31], v[64:67], v[252:255]
    ds_read_b64_tr_b16 v[16:17], v120 offset:4224
    v_mfma_f32_16x16x32_bf16 v[236:239], v[24:27], v[64:67], v[236:239]
    ds_read_b64_tr_b16 v[18:19], v120 offset:4736
    v_mfma_f32_16x16x32_bf16 v[232:235], v[24:27], v[60:63], v[232:235]
    buffer_load_dwordx4 v106, s[44:47], s61 offen offset:2112 lds
    v_mfma_f32_16x16x32_bf16 v[248:251], v[28:31], v[60:63], v[248:251]
    ds_read_b128 v[44:47], v121 offset:8704
    v_mfma_f32_16x16x32_bf16 v[244:247], v[28:31], v[56:59], v[244:247]
    buffer_load_dwordx4 v107, s[44:47], s61 offen offset:3168 lds
    v_mfma_f32_16x16x32_bf16 v[228:231], v[24:27], v[56:59], v[228:231]
    ds_read_b128 v[48:51], v121 offset:8960
    v_mfma_f32_16x16x32_bf16 v[224:227], v[24:27], v[52:55], v[224:227]
    ds_read_b64_tr_b16 v[24:25], v120 offset:4288
    v_mfma_f32_16x16x32_bf16 v[240:243], v[28:31], v[52:55], v[240:243]
    ds_read_b64_tr_b16 v[26:27], v120 offset:4800
    s_waitcnt lgkmcnt(2)
    v_mfma_f32_16x16x32_bf16 v[128:131], v[16:19], v[36:39], v[128:131]
    ds_read_b64_tr_b16 v[28:29], v120 offset:4320
    v_mfma_f32_16x16x32_bf16 v[144:147], v[20:23], v[36:39], v[144:147]
    ds_read_b64_tr_b16 v[30:31], v120 offset:4832
    s_add_u32 m0, s60, 0
    v_mfma_f32_16x16x32_bf16 v[148:151], v[20:23], v[40:43], v[148:151]
    buffer_load_dwordx4 v108, s[44:47], s61 offen offset:0 lds
    v_mfma_f32_16x16x32_bf16 v[132:135], v[16:19], v[40:43], v[132:135]
    v_mfma_f32_16x16x32_bf16 v[136:139], v[16:19], v[44:47], v[136:139]
    buffer_load_dwordx4 v109, s[44:47], s61 offen offset:1056 lds
    v_mfma_f32_16x16x32_bf16 v[152:155], v[20:23], v[44:47], v[152:155]
    v_mfma_f32_16x16x32_bf16 v[156:159], v[20:23], v[48:51], v[156:159]
    s_waitcnt vmcnt(14)
    ds_read_b64_tr_b16 v[20:21], v120 offset:8480
    v_mfma_f32_16x16x32_bf16 v[140:143], v[16:19], v[48:51], v[140:143]
    ds_read_b64_tr_b16 v[22:23], v120 offset:8992
    s_waitcnt lgkmcnt(2)
    v_mfma_f32_16x16x32_bf16 v[188:191], v[28:31], v[48:51], v[188:191]
    ds_read_b64_tr_b16 v[16:17], v120 offset:8448
    v_mfma_f32_16x16x32_bf16 v[172:175], v[24:27], v[48:51], v[172:175]
    ds_read_b64_tr_b16 v[18:19], v120 offset:8960
    v_mfma_f32_16x16x32_bf16 v[168:171], v[24:27], v[44:47], v[168:171]
    buffer_load_dwordx4 v110, s[44:47], s61 offen offset:2112 lds
    v_mfma_f32_16x16x32_bf16 v[184:187], v[28:31], v[44:47], v[184:187]
    v_mfma_f32_16x16x32_bf16 v[180:183], v[28:31], v[40:43], v[180:183]
    buffer_load_dwordx4 v111, s[44:47], s61 offen offset:3168 lds
    v_mfma_f32_16x16x32_bf16 v[164:167], v[24:27], v[40:43], v[164:167]
    v_mfma_f32_16x16x32_bf16 v[160:163], v[24:27], v[36:39], v[160:163]
    ds_read_b64_tr_b16 v[24:25], v120 offset:8512
    v_mfma_f32_16x16x32_bf16 v[176:179], v[28:31], v[36:39], v[176:179]
    ds_read_b64_tr_b16 v[26:27], v120 offset:9024
    s_waitcnt lgkmcnt(2)
    v_mfma_f32_16x16x32_bf16 v[192:195], v[16:19], v[36:39], v[192:195]
    ds_read_b64_tr_b16 v[28:29], v120 offset:8544
    v_mfma_f32_16x16x32_bf16 v[208:211], v[20:23], v[36:39], v[208:211]
    ds_read_b64_tr_b16 v[30:31], v120 offset:9056
    s_mov_b32 s61, 1310720
    s_add_u32 m0, s60, 4224
    v_mfma_f32_16x16x32_bf16 v[212:215], v[20:23], v[40:43], v[212:215]
    buffer_load_dwordx4 v104, s[44:47], s61 offen offset:0 lds
    v_mfma_f32_16x16x32_bf16 v[196:199], v[16:19], v[40:43], v[196:199]
    ds_read_b128 v[52:55], v121 offset:12288
    v_mfma_f32_16x16x32_bf16 v[200:203], v[16:19], v[44:47], v[200:203]
    buffer_load_dwordx4 v105, s[44:47], s61 offen offset:1056 lds
    v_mfma_f32_16x16x32_bf16 v[216:219], v[20:23], v[44:47], v[216:219]
    ds_read_b128 v[56:59], v121 offset:12544
    v_mfma_f32_16x16x32_bf16 v[220:223], v[20:23], v[48:51], v[220:223]
    s_waitcnt vmcnt(14)
    ds_read_b64_tr_b16 v[20:21], v120 offset:12704
    v_mfma_f32_16x16x32_bf16 v[204:207], v[16:19], v[48:51], v[204:207]
    ds_read_b64_tr_b16 v[22:23], v120 offset:13216
    s_waitcnt lgkmcnt(4)
    v_mfma_f32_16x16x32_bf16 v[252:255], v[28:31], v[48:51], v[252:255]
    ds_read_b64_tr_b16 v[16:17], v120 offset:12672
    v_mfma_f32_16x16x32_bf16 v[236:239], v[24:27], v[48:51], v[236:239]
    ds_read_b64_tr_b16 v[18:19], v120 offset:13184
    v_mfma_f32_16x16x32_bf16 v[232:235], v[24:27], v[44:47], v[232:235]
    buffer_load_dwordx4 v106, s[44:47], s61 offen offset:2112 lds
    v_mfma_f32_16x16x32_bf16 v[248:251], v[28:31], v[44:47], v[248:251]
    ds_read_b128 v[60:63], v121 offset:12800
    v_mfma_f32_16x16x32_bf16 v[244:247], v[28:31], v[40:43], v[244:247]
    buffer_load_dwordx4 v107, s[44:47], s61 offen offset:3168 lds
    v_mfma_f32_16x16x32_bf16 v[228:231], v[24:27], v[40:43], v[228:231]
    ds_read_b128 v[64:67], v121 offset:13056
    v_mfma_f32_16x16x32_bf16 v[224:227], v[24:27], v[36:39], v[224:227]
    ds_read_b64_tr_b16 v[24:25], v120 offset:12736
    v_mfma_f32_16x16x32_bf16 v[240:243], v[28:31], v[36:39], v[240:243]
    ds_read_b64_tr_b16 v[26:27], v120 offset:13248
    s_waitcnt lgkmcnt(2)
    v_mfma_f32_16x16x32_bf16 v[128:131], v[16:19], v[52:55], v[128:131]
    ds_read_b64_tr_b16 v[28:29], v120 offset:12768
    v_mfma_f32_16x16x32_bf16 v[144:147], v[20:23], v[52:55], v[144:147]
    ds_read_b64_tr_b16 v[30:31], v120 offset:13280
    s_add_u32 m0, s60, 8448
    v_mfma_f32_16x16x32_bf16 v[148:151], v[20:23], v[56:59], v[148:151]
    buffer_load_dwordx4 v108, s[44:47], s61 offen offset:0 lds
    v_mfma_f32_16x16x32_bf16 v[132:135], v[16:19], v[56:59], v[132:135]
    v_mfma_f32_16x16x32_bf16 v[136:139], v[16:19], v[60:63], v[136:139]
    buffer_load_dwordx4 v109, s[44:47], s61 offen offset:1056 lds
    v_mfma_f32_16x16x32_bf16 v[152:155], v[20:23], v[60:63], v[152:155]
    v_mfma_f32_16x16x32_bf16 v[156:159], v[20:23], v[64:67], v[156:159]
    s_waitcnt vmcnt(14)
    ds_read_b64_tr_b16 v[20:21], v120 offset:16928
    v_mfma_f32_16x16x32_bf16 v[140:143], v[16:19], v[64:67], v[140:143]
    ds_read_b64_tr_b16 v[22:23], v120 offset:17440
    s_waitcnt lgkmcnt(2)
    v_mfma_f32_16x16x32_bf16 v[188:191], v[28:31], v[64:67], v[188:191]
    ds_read_b64_tr_b16 v[16:17], v120 offset:16896
    v_mfma_f32_16x16x32_bf16 v[172:175], v[24:27], v[64:67], v[172:175]
    ds_read_b64_tr_b16 v[18:19], v120 offset:17408
    v_mfma_f32_16x16x32_bf16 v[168:171], v[24:27], v[60:63], v[168:171]
    buffer_load_dwordx4 v110, s[44:47], s61 offen offset:2112 lds
    v_mfma_f32_16x16x32_bf16 v[184:187], v[28:31], v[60:63], v[184:187]
    v_mfma_f32_16x16x32_bf16 v[180:183], v[28:31], v[56:59], v[180:183]
    buffer_load_dwordx4 v111, s[44:47], s61 offen offset:3168 lds
    v_mfma_f32_16x16x32_bf16 v[164:167], v[24:27], v[56:59], v[164:167]
    v_mfma_f32_16x16x32_bf16 v[160:163], v[24:27], v[52:55], v[160:163]
    ds_read_b64_tr_b16 v[24:25], v120 offset:16960
    v_mfma_f32_16x16x32_bf16 v[176:179], v[28:31], v[52:55], v[176:179]
    ds_read_b64_tr_b16 v[26:27], v120 offset:17472
    s_waitcnt lgkmcnt(2)
    v_mfma_f32_16x16x32_bf16 v[192:195], v[16:19], v[52:55], v[192:195]
    ds_read_b64_tr_b16 v[28:29], v120 offset:16992
    v_mfma_f32_16x16x32_bf16 v[208:211], v[20:23], v[52:55], v[208:211]
    ds_read_b64_tr_b16 v[30:31], v120 offset:17504
    s_mov_b32 s61, 1572864
    s_add_u32 m0, s60, 12672
    v_mfma_f32_16x16x32_bf16 v[212:215], v[20:23], v[56:59], v[212:215]
    buffer_load_dwordx4 v104, s[44:47], s61 offen offset:0 lds
    v_mfma_f32_16x16x32_bf16 v[196:199], v[16:19], v[56:59], v[196:199]
    ds_read_b128 v[36:39], v121 offset:16384
    v_mfma_f32_16x16x32_bf16 v[200:203], v[16:19], v[60:63], v[200:203]
    buffer_load_dwordx4 v105, s[44:47], s61 offen offset:1056 lds
    v_mfma_f32_16x16x32_bf16 v[216:219], v[20:23], v[60:63], v[216:219]
    ds_read_b128 v[40:43], v121 offset:16640
    v_mfma_f32_16x16x32_bf16 v[220:223], v[20:23], v[64:67], v[220:223]
    s_waitcnt vmcnt(14)
    ds_read_b64_tr_b16 v[20:21], v120 offset:21152
    v_mfma_f32_16x16x32_bf16 v[204:207], v[16:19], v[64:67], v[204:207]
    ds_read_b64_tr_b16 v[22:23], v120 offset:21664
    s_waitcnt lgkmcnt(4)
    v_mfma_f32_16x16x32_bf16 v[252:255], v[28:31], v[64:67], v[252:255]
    ds_read_b64_tr_b16 v[16:17], v120 offset:21120
    v_mfma_f32_16x16x32_bf16 v[236:239], v[24:27], v[64:67], v[236:239]
    ds_read_b64_tr_b16 v[18:19], v120 offset:21632
    v_mfma_f32_16x16x32_bf16 v[232:235], v[24:27], v[60:63], v[232:235]
    buffer_load_dwordx4 v106, s[44:47], s61 offen offset:2112 lds
    v_mfma_f32_16x16x32_bf16 v[248:251], v[28:31], v[60:63], v[248:251]
    ds_read_b128 v[44:47], v121 offset:16896
    v_mfma_f32_16x16x32_bf16 v[244:247], v[28:31], v[56:59], v[244:247]
    buffer_load_dwordx4 v107, s[44:47], s61 offen offset:3168 lds
    v_mfma_f32_16x16x32_bf16 v[228:231], v[24:27], v[56:59], v[228:231]
    ds_read_b128 v[48:51], v121 offset:17152
    v_mfma_f32_16x16x32_bf16 v[224:227], v[24:27], v[52:55], v[224:227]
    ds_read_b64_tr_b16 v[24:25], v120 offset:21184
    v_mfma_f32_16x16x32_bf16 v[240:243], v[28:31], v[52:55], v[240:243]
    ds_read_b64_tr_b16 v[26:27], v120 offset:21696
    s_waitcnt lgkmcnt(2)
    v_mfma_f32_16x16x32_bf16 v[128:131], v[16:19], v[36:39], v[128:131]
    ds_read_b64_tr_b16 v[28:29], v120 offset:21216
    v_mfma_f32_16x16x32_bf16 v[144:147], v[20:23], v[36:39], v[144:147]
    ds_read_b64_tr_b16 v[30:31], v120 offset:21728
    s_add_u32 m0, s60, 16896
    v_mfma_f32_16x16x32_bf16 v[148:151], v[20:23], v[40:43], v[148:151]
    buffer_load_dwordx4 v108, s[44:47], s61 offen offset:0 lds
    v_mfma_f32_16x16x32_bf16 v[132:135], v[16:19], v[40:43], v[132:135]
    v_mfma_f32_16x16x32_bf16 v[136:139], v[16:19], v[44:47], v[136:139]
    buffer_load_dwordx4 v109, s[44:47], s61 offen offset:1056 lds
    v_mfma_f32_16x16x32_bf16 v[152:155], v[20:23], v[44:47], v[152:155]
    v_mfma_f32_16x16x32_bf16 v[156:159], v[20:23], v[48:51], v[156:159]
    s_waitcnt vmcnt(14)
    ds_read_b64_tr_b16 v[20:21], v120 offset:32
    v_mfma_f32_16x16x32_bf16 v[140:143], v[16:19], v[48:51], v[140:143]
    ds_read_b64_tr_b16 v[22:23], v120 offset:544
    s_waitcnt lgkmcnt(2)
    v_mfma_f32_16x16x32_bf16 v[188:191], v[28:31], v[48:51], v[188:191]
    ds_read_b64_tr_b16 v[16:17], v120 offset:0
    v_mfma_f32_16x16x32_bf16 v[172:175], v[24:27], v[48:51], v[172:175]
    ds_read_b64_tr_b16 v[18:19], v120 offset:512
    v_mfma_f32_16x16x32_bf16 v[168:171], v[24:27], v[44:47], v[168:171]
    buffer_load_dwordx4 v110, s[44:47], s61 offen offset:2112 lds
    v_mfma_f32_16x16x32_bf16 v[184:187], v[28:31], v[44:47], v[184:187]
    v_mfma_f32_16x16x32_bf16 v[180:183], v[28:31], v[40:43], v[180:183]
    buffer_load_dwordx4 v111, s[44:47], s61 offen offset:3168 lds
    v_mfma_f32_16x16x32_bf16 v[164:167], v[24:27], v[40:43], v[164:167]
    v_mfma_f32_16x16x32_bf16 v[160:163], v[24:27], v[36:39], v[160:163]
    ds_read_b64_tr_b16 v[24:25], v120 offset:64
    v_mfma_f32_16x16x32_bf16 v[176:179], v[28:31], v[36:39], v[176:179]
    ds_read_b64_tr_b16 v[26:27], v120 offset:576
    s_waitcnt lgkmcnt(2)
    v_mfma_f32_16x16x32_bf16 v[192:195], v[16:19], v[36:39], v[192:195]
    ds_read_b64_tr_b16 v[28:29], v120 offset:96
    v_mfma_f32_16x16x32_bf16 v[208:211], v[20:23], v[36:39], v[208:211]
    ds_read_b64_tr_b16 v[30:31], v120 offset:608
    s_mov_b32 s61, 1835008
    s_add_u32 m0, s60, 21120
    v_mfma_f32_16x16x32_bf16 v[212:215], v[20:23], v[40:43], v[212:215]
    buffer_load_dwordx4 v104, s[44:47], s61 offen offset:0 lds
    v_mfma_f32_16x16x32_bf16 v[196:199], v[16:19], v[40:43], v[196:199]
    ds_read_b128 v[52:55], v121 offset:20480
    v_mfma_f32_16x16x32_bf16 v[200:203], v[16:19], v[44:47], v[200:203]
    buffer_load_dwordx4 v105, s[44:47], s61 offen offset:1056 lds
    v_mfma_f32_16x16x32_bf16 v[216:219], v[20:23], v[44:47], v[216:219]
    ds_read_b128 v[56:59], v121 offset:20736
    v_mfma_f32_16x16x32_bf16 v[220:223], v[20:23], v[48:51], v[220:223]
    s_waitcnt vmcnt(14)
    ds_read_b64_tr_b16 v[20:21], v120 offset:4256
    v_mfma_f32_16x16x32_bf16 v[204:207], v[16:19], v[48:51], v[204:207]
    ds_read_b64_tr_b16 v[22:23], v120 offset:4768
    s_waitcnt lgkmcnt(4)
    v_mfma_f32_16x16x32_bf16 v[252:255], v[28:31], v[48:51], v[252:255]
    ds_read_b64_tr_b16 v[16:17], v120 offset:4224
    v_mfma_f32_16x16x32_bf16 v[236:239], v[24:27], v[48:51], v[236:239]
    ds_read_b64_tr_b16 v[18:19], v120 offset:4736
    v_mfma_f32_16x16x32_bf16 v[232:235], v[24:27], v[44:47], v[232:235]
    buffer_load_dwordx4 v106, s[44:47], s61 offen offset:2112 lds
    v_mfma_f32_16x16x32_bf16 v[248:251], v[28:31], v[44:47], v[248:251]
    ds_read_b128 v[60:63], v121 offset:20992
    v_mfma_f32_16x16x32_bf16 v[244:247], v[28:31], v[40:43], v[244:247]
    buffer_load_dwordx4 v107, s[44:47], s61 offen offset:3168 lds
    v_mfma_f32_16x16x32_bf16 v[228:231], v[24:27], v[40:43], v[228:231]
    ds_read_b128 v[64:67], v121 offset:21248
    v_mfma_f32_16x16x32_bf16 v[224:227], v[24:27], v[36:39], v[224:227]
    ds_read_b64_tr_b16 v[24:25], v120 offset:4288
    v_mfma_f32_16x16x32_bf16 v[240:243], v[28:31], v[36:39], v[240:243]
    ds_read_b64_tr_b16 v[26:27], v120 offset:4800
    s_waitcnt lgkmcnt(2)
    v_mfma_f32_16x16x32_bf16 v[128:131], v[16:19], v[52:55], v[128:131]
    ds_read_b64_tr_b16 v[28:29], v120 offset:4320
    v_mfma_f32_16x16x32_bf16 v[144:147], v[20:23], v[52:55], v[144:147]
    ds_read_b64_tr_b16 v[30:31], v120 offset:4832
    s_add_u32 m0, s60, 0
    v_mfma_f32_16x16x32_bf16 v[148:151], v[20:23], v[56:59], v[148:151]
    buffer_load_dwordx4 v108, s[44:47], s61 offen offset:0 lds
    v_mfma_f32_16x16x32_bf16 v[132:135], v[16:19], v[56:59], v[132:135]
    v_mfma_f32_16x16x32_bf16 v[136:139], v[16:19], v[60:63], v[136:139]
    buffer_load_dwordx4 v109, s[44:47], s61 offen offset:1056 lds
    v_mfma_f32_16x16x32_bf16 v[152:155], v[20:23], v[60:63], v[152:155]
    v_mfma_f32_16x16x32_bf16 v[156:159], v[20:23], v[64:67], v[156:159]
    s_waitcnt vmcnt(14)
    ds_read_b64_tr_b16 v[20:21], v120 offset:8480
    v_mfma_f32_16x16x32_bf16 v[140:143], v[16:19], v[64:67], v[140:143]
    ds_read_b64_tr_b16 v[22:23], v120 offset:8992
    s_waitcnt lgkmcnt(2)
    v_mfma_f32_16x16x32_bf16 v[188:191], v[28:31], v[64:67], v[188:191]
    ds_read_b64_tr_b16 v[16:17], v120 offset:8448
    v_mfma_f32_16x16x32_bf16 v[172:175], v[24:27], v[64:67], v[172:175]
    ds_read_b64_tr_b16 v[18:19], v120 offset:8960
    v_mfma_f32_16x16x32_bf16 v[168:171], v[24:27], v[60:63], v[168:171]
    buffer_load_dwordx4 v110, s[44:47], s61 offen offset:2112 lds
    v_mfma_f32_16x16x32_bf16 v[184:187], v[28:31], v[60:63], v[184:187]
    v_mfma_f32_16x16x32_bf16 v[180:183], v[28:31], v[56:59], v[180:183]
    buffer_load_dwordx4 v111, s[44:47], s61 offen offset:3168 lds
    v_mfma_f32_16x16x32_bf16 v[164:167], v[24:27], v[56:59], v[164:167]
    v_mfma_f32_16x16x32_bf16 v[160:163], v[24:27], v[52:55], v[160:163]
    ds_read_b64_tr_b16 v[24:25], v120 offset:8512
    v_mfma_f32_16x16x32_bf16 v[176:179], v[28:31], v[52:55], v[176:179]
    ds_read_b64_tr_b16 v[26:27], v120 offset:9024
    s_waitcnt lgkmcnt(2)
    v_mfma_f32_16x16x32_bf16 v[192:195], v[16:19], v[52:55], v[192:195]
    ds_read_b64_tr_b16 v[28:29], v120 offset:8544
    v_mfma_f32_16x16x32_bf16 v[208:211], v[20:23], v[52:55], v[208:211]
    ds_read_b64_tr_b16 v[30:31], v120 offset:9056
    s_mov_b32 s61, 2097152
    s_add_u32 m0, s60, 4224
    v_mfma_f32_16x16x32_bf16 v[212:215], v[20:23], v[56:59], v[212:215]
    buffer_load_dwordx4 v104, s[44:47], s61 offen offset:0 lds
    v_mfma_f32_16x16x32_bf16 v[196:199], v[16:19], v[56:59], v[196:199]
    ds_read_b128 v[36:39], v121 offset:24576
    v_mfma_f32_16x16x32_bf16 v[200:203], v[16:19], v[60:63], v[200:203]
    buffer_load_dwordx4 v105, s[44:47], s61 offen offset:1056 lds
    v_mfma_f32_16x16x32_bf16 v[216:219], v[20:23], v[60:63], v[216:219]
    ds_read_b128 v[40:43], v121 offset:24832
    v_mfma_f32_16x16x32_bf16 v[220:223], v[20:23], v[64:67], v[220:223]
    s_waitcnt vmcnt(14)
    ds_read_b64_tr_b16 v[20:21], v120 offset:12704
    v_mfma_f32_16x16x32_bf16 v[204:207], v[16:19], v[64:67], v[204:207]
    ds_read_b64_tr_b16 v[22:23], v120 offset:13216
    s_waitcnt lgkmcnt(4)
    v_mfma_f32_16x16x32_bf16 v[252:255], v[28:31], v[64:67], v[252:255]
    ds_read_b64_tr_b16 v[16:17], v120 offset:12672
    v_mfma_f32_16x16x32_bf16 v[236:239], v[24:27], v[64:67], v[236:239]
    ds_read_b64_tr_b16 v[18:19], v120 offset:13184
    v_mfma_f32_16x16x32_bf16 v[232:235], v[24:27], v[60:63], v[232:235]
    buffer_load_dwordx4 v106, s[44:47], s61 offen offset:2112 lds
    v_mfma_f32_16x16x32_bf16 v[248:251], v[28:31], v[60:63], v[248:251]
    ds_read_b128 v[44:47], v121 offset:25088
    v_mfma_f32_16x16x32_bf16 v[244:247], v[28:31], v[56:59], v[244:247]
    buffer_load_dwordx4 v107, s[44:47], s61 offen offset:3168 lds
    v_mfma_f32_16x16x32_bf16 v[228:231], v[24:27], v[56:59], v[228:231]
    ds_read_b128 v[48:51], v121 offset:25344
    v_mfma_f32_16x16x32_bf16 v[224:227], v[24:27], v[52:55], v[224:227]
    ds_read_b64_tr_b16 v[24:25], v120 offset:12736
    v_mfma_f32_16x16x32_bf16 v[240:243], v[28:31], v[52:55], v[240:243]
    ds_read_b64_tr_b16 v[26:27], v120 offset:13248
    s_waitcnt lgkmcnt(2)
    v_mfma_f32_16x16x32_bf16 v[128:131], v[16:19], v[36:39], v[128:131]
    ds_read_b64_tr_b16 v[28:29], v120 offset:12768
    v_mfma_f32_16x16x32_bf16 v[144:147], v[20:23], v[36:39], v[144:147]
    ds_read_b64_tr_b16 v[30:31], v120 offset:13280
    s_add_u32 m0, s60, 8448
    v_mfma_f32_16x16x32_bf16 v[148:151], v[20:23], v[40:43], v[148:151]
    buffer_load_dwordx4 v108, s[44:47], s61 offen offset:0 lds
    v_mfma_f32_16x16x32_bf16 v[132:135], v[16:19], v[40:43], v[132:135]
    v_mfma_f32_16x16x32_bf16 v[136:139], v[16:19], v[44:47], v[136:139]
    buffer_load_dwordx4 v109, s[44:47], s61 offen offset:1056 lds
    v_mfma_f32_16x16x32_bf16 v[152:155], v[20:23], v[44:47], v[152:155]
    v_mfma_f32_16x16x32_bf16 v[156:159], v[20:23], v[48:51], v[156:159]
    s_waitcnt vmcnt(14)
    ds_read_b64_tr_b16 v[20:21], v120 offset:16928
    v_mfma_f32_16x16x32_bf16 v[140:143], v[16:19], v[48:51], v[140:143]
    ds_read_b64_tr_b16 v[22:23], v120 offset:17440
    s_waitcnt lgkmcnt(2)
    v_mfma_f32_16x16x32_bf16 v[188:191], v[28:31], v[48:51], v[188:191]
    ds_read_b64_tr_b16 v[16:17], v120 offset:16896
    v_mfma_f32_16x16x32_bf16 v[172:175], v[24:27], v[48:51], v[172:175]
    ds_read_b64_tr_b16 v[18:19], v120 offset:17408
    v_mfma_f32_16x16x32_bf16 v[168:171], v[24:27], v[44:47], v[168:171]
    buffer_load_dwordx4 v110, s[44:47], s61 offen offset:2112 lds
    v_mfma_f32_16x16x32_bf16 v[184:187], v[28:31], v[44:47], v[184:187]
    v_mfma_f32_16x16x32_bf16 v[180:183], v[28:31], v[40:43], v[180:183]
    buffer_load_dwordx4 v111, s[44:47], s61 offen offset:3168 lds
    v_mfma_f32_16x16x32_bf16 v[164:167], v[24:27], v[40:43], v[164:167]
    v_mfma_f32_16x16x32_bf16 v[160:163], v[24:27], v[36:39], v[160:163]
    ds_read_b64_tr_b16 v[24:25], v120 offset:16960
    v_mfma_f32_16x16x32_bf16 v[176:179], v[28:31], v[36:39], v[176:179]
    ds_read_b64_tr_b16 v[26:27], v120 offset:17472
    s_waitcnt lgkmcnt(2)
    v_mfma_f32_16x16x32_bf16 v[192:195], v[16:19], v[36:39], v[192:195]
    ds_read_b64_tr_b16 v[28:29], v120 offset:16992
    v_mfma_f32_16x16x32_bf16 v[208:211], v[20:23], v[36:39], v[208:211]
    ds_read_b64_tr_b16 v[30:31], v120 offset:17504
    s_mov_b32 s61, 2359296
    s_add_u32 m0, s60, 12672
    v_mfma_f32_16x16x32_bf16 v[212:215], v[20:23], v[40:43], v[212:215]
    buffer_load_dwordx4 v104, s[44:47], s61 offen offset:0 lds
    v_mfma_f32_16x16x32_bf16 v[196:199], v[16:19], v[40:43], v[196:199]
    ds_read_b128 v[52:55], v121 offset:28672
    v_mfma_f32_16x16x32_bf16 v[200:203], v[16:19], v[44:47], v[200:203]
    buffer_load_dwordx4 v105, s[44:47], s61 offen offset:1056 lds
    v_mfma_f32_16x16x32_bf16 v[216:219], v[20:23], v[44:47], v[216:219]
    ds_read_b128 v[56:59], v121 offset:28928
    v_mfma_f32_16x16x32_bf16 v[220:223], v[20:23], v[48:51], v[220:223]
    s_waitcnt vmcnt(14)
    ds_read_b64_tr_b16 v[20:21], v120 offset:21152
    v_mfma_f32_16x16x32_bf16 v[204:207], v[16:19], v[48:51], v[204:207]
    ds_read_b64_tr_b16 v[22:23], v120 offset:21664
    s_waitcnt lgkmcnt(4)
    v_mfma_f32_16x16x32_bf16 v[252:255], v[28:31], v[48:51], v[252:255]
    ds_read_b64_tr_b16 v[16:17], v120 offset:21120
    v_mfma_f32_16x16x32_bf16 v[236:239], v[24:27], v[48:51], v[236:239]
    ds_read_b64_tr_b16 v[18:19], v120 offset:21632
    v_mfma_f32_16x16x32_bf16 v[232:235], v[24:27], v[44:47], v[232:235]
    buffer_load_dwordx4 v106, s[44:47], s61 offen offset:2112 lds
    v_mfma_f32_16x16x32_bf16 v[248:251], v[28:31], v[44:47], v[248:251]
    ds_read_b128 v[60:63], v121 offset:29184
    v_mfma_f32_16x16x32_bf16 v[244:247], v[28:31], v[40:43], v[244:247]
    buffer_load_dwordx4 v107, s[44:47], s61 offen offset:3168 lds
    v_mfma_f32_16x16x32_bf16 v[228:231], v[24:27], v[40:43], v[228:231]
    ds_read_b128 v[64:67], v121 offset:29440
    v_mfma_f32_16x16x32_bf16 v[224:227], v[24:27], v[36:39], v[224:227]
    ds_read_b64_tr_b16 v[24:25], v120 offset:21184
    v_mfma_f32_16x16x32_bf16 v[240:243], v[28:31], v[36:39], v[240:243]
    ds_read_b64_tr_b16 v[26:27], v120 offset:21696
    s_waitcnt lgkmcnt(2)
    v_mfma_f32_16x16x32_bf16 v[128:131], v[16:19], v[52:55], v[128:131]
    ds_read_b64_tr_b16 v[28:29], v120 offset:21216
    v_mfma_f32_16x16x32_bf16 v[144:147], v[20:23], v[52:55], v[144:147]
    ds_read_b64_tr_b16 v[30:31], v120 offset:21728
    s_add_u32 m0, s60, 16896
    v_mfma_f32_16x16x32_bf16 v[148:151], v[20:23], v[56:59], v[148:151]
    buffer_load_dwordx4 v108, s[44:47], s61 offen offset:0 lds
    v_mfma_f32_16x16x32_bf16 v[132:135], v[16:19], v[56:59], v[132:135]
    v_mfma_f32_16x16x32_bf16 v[136:139], v[16:19], v[60:63], v[136:139]
    buffer_load_dwordx4 v109, s[44:47], s61 offen offset:1056 lds
    v_mfma_f32_16x16x32_bf16 v[152:155], v[20:23], v[60:63], v[152:155]
    v_mfma_f32_16x16x32_bf16 v[156:159], v[20:23], v[64:67], v[156:159]
    s_waitcnt vmcnt(14)
    ds_read_b64_tr_b16 v[20:21], v120 offset:32
    v_mfma_f32_16x16x32_bf16 v[140:143], v[16:19], v[64:67], v[140:143]
    ds_read_b64_tr_b16 v[22:23], v120 offset:544
    s_waitcnt lgkmcnt(2)
    v_mfma_f32_16x16x32_bf16 v[188:191], v[28:31], v[64:67], v[188:191]
    ds_read_b64_tr_b16 v[16:17], v120 offset:0
    v_mfma_f32_16x16x32_bf16 v[172:175], v[24:27], v[64:67], v[172:175]
    ds_read_b64_tr_b16 v[18:19], v120 offset:512
    v_mfma_f32_16x16x32_bf16 v[168:171], v[24:27], v[60:63], v[168:171]
    buffer_load_dwordx4 v110, s[44:47], s61 offen offset:2112 lds
    v_mfma_f32_16x16x32_bf16 v[184:187], v[28:31], v[60:63], v[184:187]
    v_mfma_f32_16x16x32_bf16 v[180:183], v[28:31], v[56:59], v[180:183]
    buffer_load_dwordx4 v111, s[44:47], s61 offen offset:3168 lds
    v_mfma_f32_16x16x32_bf16 v[164:167], v[24:27], v[56:59], v[164:167]
    v_mfma_f32_16x16x32_bf16 v[160:163], v[24:27], v[52:55], v[160:163]
    ds_read_b64_tr_b16 v[24:25], v120 offset:64
    v_mfma_f32_16x16x32_bf16 v[176:179], v[28:31], v[52:55], v[176:179]
    ds_read_b64_tr_b16 v[26:27], v120 offset:576
    s_waitcnt lgkmcnt(2)
    v_mfma_f32_16x16x32_bf16 v[192:195], v[16:19], v[52:55], v[192:195]
    ds_read_b64_tr_b16 v[28:29], v120 offset:96
    v_mfma_f32_16x16x32_bf16 v[208:211], v[20:23], v[52:55], v[208:211]
    ds_read_b64_tr_b16 v[30:31], v120 offset:608
    s_mov_b32 s61, 2621440
    s_add_u32 m0, s60, 21120
    v_mfma_f32_16x16x32_bf16 v[212:215], v[20:23], v[56:59], v[212:215]
    buffer_load_dwordx4 v104, s[44:47], s61 offen offset:0 lds
    v_mfma_f32_16x16x32_bf16 v[196:199], v[16:19], v[56:59], v[196:199]
    ds_read_b128 v[36:39], v121 offset:32768
    v_mfma_f32_16x16x32_bf16 v[200:203], v[16:19], v[60:63], v[200:203]
    buffer_load_dwordx4 v105, s[44:47], s61 offen offset:1056 lds
    v_mfma_f32_16x16x32_bf16 v[216:219], v[20:23], v[60:63], v[216:219]
    ds_read_b128 v[40:43], v121 offset:33024
    v_mfma_f32_16x16x32_bf16 v[220:223], v[20:23], v[64:67], v[220:223]
    s_waitcnt vmcnt(14)
    ds_read_b64_tr_b16 v[20:21], v120 offset:4256
L_pg4:
    s_cbranch_execz L_pg8
    v_mfma_f32_16x16x32_bf16 v[204:207], v[16:19], v[64:67], v[204:207]
    ds_read_b64_tr_b16 v[22:23], v120 offset:4768
    s_waitcnt lgkmcnt(4)
    v_mfma_f32_16x16x32_bf16 v[252:255], v[28:31], v[64:67], v[252:255]
    ds_read_b64_tr_b16 v[16:17], v120 offset:4224
    v_mfma_f32_16x16x32_bf16 v[236:239], v[24:27], v[64:67], v[236:239]
    ds_read_b64_tr_b16 v[18:19], v120 offset:4736
    v_mfma_f32_16x16x32_bf16 v[232:235], v[24:27], v[60:63], v[232:235]
    buffer_load_dwordx4 v106, s[44:47], s61 offen offset:2112 lds
    v_mfma_f32_16x16x32_bf16 v[248:251], v[28:31], v[60:63], v[248:251]
    ds_read_b128 v[44:47], v121 offset:33280
    v_mfma_f32_16x16x32_bf16 v[244:247], v[28:31], v[56:59], v[244:247]
    buffer_load_dwordx4 v107, s[44:47], s61 offen offset:3168 lds
    v_mfma_f32_16x16x32_bf16 v[228:231], v[24:27], v[56:59], v[228:231]
    ds_read_b128 v[48:51], v121 offset:33536
    v_mfma_f32_16x16x32_bf16 v[224:227], v[24:27], v[52:55], v[224:227]
    ds_read_b64_tr_b16 v[24:25], v120 offset:4288
    v_mfma_f32_16x16x32_bf16 v[240:243], v[28:31], v[52:55], v[240:243]
    ds_read_b64_tr_b16 v[26:27], v120 offset:4800
    s_waitcnt lgkmcnt(2)
    v_mfma_f32_16x16x32_bf16 v[128:131], v[16:19], v[36:39], v[128:131]
    ds_read_b64_tr_b16 v[28:29], v120 offset:4320
    v_mfma_f32_16x16x32_bf16 v[144:147], v[20:23], v[36:39], v[144:147]
    ds_read_b64_tr_b16 v[30:31], v120 offset:4832
    s_add_u32 m0, s60, 0
    v_mfma_f32_16x16x32_bf16 v[148:151], v[20:23], v[40:43], v[148:151]
    buffer_load_dwordx4 v108, s[44:47], s61 offen offset:0 lds
    v_mfma_f32_16x16x32_bf16 v[132:135], v[16:19], v[40:43], v[132:135]
    v_mfma_f32_16x16x32_bf16 v[136:139], v[16:19], v[44:47], v[136:139]
    buffer_load_dwordx4 v109, s[44:47], s61 offen offset:1056 lds
    v_mfma_f32_16x16x32_bf16 v[152:155], v[20:23], v[44:47], v[152:155]
    v_mfma_f32_16x16x32_bf16 v[156:159], v[20:23], v[48:51], v[156:159]
    s_waitcnt vmcnt(14)
    ds_read_b64_tr_b16 v[20:21], v120 offset:8480
    v_mfma_f32_16x16x32_bf16 v[140:143], v[16:19], v[48:51], v[140:143]
    ds_read_b64_tr_b16 v[22:23], v120 offset:8992
    s_waitcnt lgkmcnt(2)
    v_mfma_f32_16x16x32_bf16 v[188:191], v[28:31], v[48:51], v[188:191]
    ds_read_b64_tr_b16 v[16:17], v120 offset:8448
    v_mfma_f32_16x16x32_bf16 v[172:175], v[24:27], v[48:51], v[172:175]
    ds_read_b64_tr_b16 v[18:19], v120 offset:8960
    v_mfma_f32_16x16x32_bf16 v[168:171], v[24:27], v[44:47], v[168:171]
    buffer_load_dwordx4 v110, s[44:47], s61 offen offset:2112 lds
    v_mfma_f32_16x16x32_bf16 v[184:187], v[28:31], v[44:47], v[184:187]
    v_mfma_f32_16x16x32_bf16 v[180:183], v[28:31], v[40:43], v[180:183]
    buffer_load_dwordx4 v111, s[44:47], s61 offen offset:3168 lds
    v_mfma_f32_16x16x32_bf16 v[164:167], v[24:27], v[40:43], v[164:167]
    v_mfma_f32_16x16x32_bf16 v[160:163], v[24:27], v[36:39], v[160:163]
    ds_read_b64_tr_b16 v[24:25], v120 offset:8512
    v_mfma_f32_16x16x32_bf16 v[176:179], v[28:31], v[36:39], v[176:179]
    ds_read_b64_tr_b16 v[26:27], v120 offset:9024
    s_waitcnt lgkmcnt(2)
    v_mfma_f32_16x16x32_bf16 v[192:195], v[16:19], v[36:39], v[192:195]
    ds_read_b64_tr_b16 v[28:29], v120 offset:8544
    v_mfma_f32_16x16x32_bf16 v[208:211], v[20:23], v[36:39], v[208:211]
    ds_read_b64_tr_b16 v[30:31], v120 offset:9056
    s_mov_b32 s61, 2883584
    s_add_u32 m0, s60, 4224
    v_mfma_f32_16x16x32_bf16 v[212:215], v[20:23], v[40:43], v[212:215]
    buffer_load_dwordx4 v104, s[44:47], s61 offen offset:0 lds
    v_mfma_f32_16x16x32_bf16 v[196:199], v[16:19], v[40:43], v[196:199]
    ds_read_b128 v[52:55], v121 offset:36864
    v_mfma_f32_16x16x32_bf16 v[200:203], v[16:19], v[44:47], v[200:203]
    buffer_load_dwordx4 v105, s[44:47], s61 offen offset:1056 lds
    v_mfma_f32_16x16x32_bf16 v[216:219], v[20:23], v[44:47], v[216:219]
    ds_read_b128 v[56:59], v121 offset:37120
    v_mfma_f32_16x16x32_bf16 v[220:223], v[20:23], v[48:51], v[220:223]
    s_waitcnt vmcnt(14)
    ds_read_b64_tr_b16 v[20:21], v120 offset:12704
    v_mfma_f32_16x16x32_bf16 v[204:207], v[16:19], v[48:51], v[204:207]
    ds_read_b64_tr_b16 v[22:23], v120 offset:13216
    s_waitcnt lgkmcnt(4)
    v_mfma_f32_16x16x32_bf16 v[252:255], v[28:31], v[48:51], v[252:255]
    ds_read_b64_tr_b16 v[16:17], v120 offset:12672
    v_mfma_f32_16x16x32_bf16 v[236:239], v[24:27], v[48:51], v[236:239]
    ds_read_b64_tr_b16 v[18:19], v120 offset:13184
    v_mfma_f32_16x16x32_bf16 v[232:235], v[24:27], v[44:47], v[232:235]
    buffer_load_dwordx4 v106, s[44:47], s61 offen offset:2112 lds
    v_mfma_f32_16x16x32_bf16 v[248:251], v[28:31], v[44:47], v[248:251]
    ds_read_b128 v[60:63], v121 offset:37376
    v_mfma_f32_16x16x32_bf16 v[244:247], v[28:31], v[40:43], v[244:247]
    buffer_load_dwordx4 v107, s[44:47], s61 offen offset:3168 lds
    v_mfma_f32_16x16x32_bf16 v[228:231], v[24:27], v[40:43], v[228:231]
    ds_read_b128 v[64:67], v121 offset:37632
    v_mfma_f32_16x16x32_bf16 v[224:227], v[24:27], v[36:39], v[224:227]
    ds_read_b64_tr_b16 v[24:25], v120 offset:12736
    v_mfma_f32_16x16x32_bf16 v[240:243], v[28:31], v[36:39], v[240:243]
    ds_read_b64_tr_b16 v[26:27], v120 offset:13248
    s_waitcnt lgkmcnt(2)
    v_mfma_f32_16x16x32_bf16 v[128:131], v[16:19], v[52:55], v[128:131]
    ds_read_b64_tr_b16 v[28:29], v120 offset:12768
    v_mfma_f32_16x16x32_bf16 v[144:147], v[20:23], v[52:55], v[144:147]
    ds_read_b64_tr_b16 v[30:31], v120 offset:13280
    s_add_u32 m0, s60, 8448
    v_mfma_f32_16x16x32_bf16 v[148:151], v[20:23], v[56:59], v[148:151]
    buffer_load_dwordx4 v108, s[44:47], s61 offen offset:0 lds
    v_mfma_f32_16x16x32_bf16 v[132:135], v[16:19], v[56:59], v[132:135]
    v_mfma_f32_16x16x32_bf16 v[136:139], v[16:19], v[60:63], v[136:139]
    buffer_load_dwordx4 v109, s[44:47], s61 offen offset:1056 lds
    v_mfma_f32_16x16x32_bf16 v[152:155], v[20:23], v[60:63], v[152:155]
    v_mfma_f32_16x16x32_bf16 v[156:159], v[20:23], v[64:67], v[156:159]
    s_waitcnt vmcnt(14)
    ds_read_b64_tr_b16 v[20:21], v120 offset:16928
    v_mfma_f32_16x16x32_bf16 v[140:143], v[16:19], v[64:67], v[140:143]
    ds_read_b64_tr_b16 v[22:23], v120 offset:17440
    s_waitcnt lgkmcnt(2)
    v_mfma_f32_16x16x32_bf16 v[188:191], v[28:31], v[64:67], v[188:191]
    ds_read_b64_tr_b16 v[16:17], v120 offset:16896
    v_mfma_f32_16x16x32_bf16 v[172:175], v[24:27], v[64:67], v[172:175]
    ds_read_b64_tr_b16 v[18:19], v120 offset:17408
    v_mfma_f32_16x16x32_bf16 v[168:171], v[24:27], v[60:63], v[168:171]
    buffer_load_dwordx4 v110, s[44:47], s61 offen offset:2112 lds
    v_mfma_f32_16x16x32_bf16 v[184:187], v[28:31], v[60:63], v[184:187]
    v_mfma_f32_16x16x32_bf16 v[180:183], v[28:31], v[56:59], v[180:183]
    buffer_load_dwordx4 v111, s[44:47], s61 offen offset:3168 lds
    v_mfma_f32_16x16x32_bf16 v[164:167], v[24:27], v[56:59], v[164:167]
    v_mfma_f32_16x16x32_bf16 v[160:163], v[24:27], v[52:55], v[160:163]
    ds_read_b64_tr_b16 v[24:25], v120 offset:16960
    v_mfma_f32_16x16x32_bf16 v[176:179], v[28:31], v[52:55], v[176:179]
    ds_read_b64_tr_b16 v[26:27], v120 offset:17472
    s_waitcnt lgkmcnt(2)
    v_mfma_f32_16x16x32_bf16 v[192:195], v[16:19], v[52:55], v[192:195]
    ds_read_b64_tr_b16 v[28:29], v120 offset:16992
    v_mfma_f32_16x16x32_bf16 v[208:211], v[20:23], v[52:55], v[208:211]
    ds_read_b64_tr_b16 v[30:31], v120 offset:17504
    s_mov_b32 s61, 3145728
    s_add_u32 m0, s60, 12672
    v_mfma_f32_16x16x32_bf16 v[212:215], v[20:23], v[56:59], v[212:215]
    buffer_load_dwordx4 v104, s[44:47], s61 offen offset:0 lds
    v_mfma_f32_16x16x32_bf16 v[196:199], v[16:19], v[56:59], v[196:199]
    ds_read_b128 v[36:39], v121 offset:40960
    v_mfma_f32_16x16x32_bf16 v[200:203], v[16:19], v[60:63], v[200:203]
    buffer_load_dwordx4 v105, s[44:47], s61 offen offset:1056 lds
    v_mfma_f32_16x16x32_bf16 v[216:219], v[20:23], v[60:63], v[216:219]
    ds_read_b128 v[40:43], v121 offset:41216
    v_mfma_f32_16x16x32_bf16 v[220:223], v[20:23], v[64:67], v[220:223]
    s_waitcnt vmcnt(14)
    ds_read_b64_tr_b16 v[20:21], v120 offset:21152
    v_mfma_f32_16x16x32_bf16 v[204:207], v[16:19], v[64:67], v[204:207]
    ds_read_b64_tr_b16 v[22:23], v120 offset:21664
    s_waitcnt lgkmcnt(4)
    v_mfma_f32_16x16x32_bf16 v[252:255], v[28:31], v[64:67], v[252:255]
    ds_read_b64_tr_b16 v[16:17], v120 offset:21120
    v_mfma_f32_16x16x32_bf16 v[236:239], v[24:27], v[64:67], v[236:239]
    ds_read_b64_tr_b16 v[18:19], v120 offset:21632
    v_mfma_f32_16x16x32_bf16 v[232:235], v[24:27], v[60:63], v[232:235]
    buffer_load_dwordx4 v106, s[44:47], s61 offen offset:2112 lds
    v_mfma_f32_16x16x32_bf16 v[248:251], v[28:31], v[60:63], v[248:251]
    ds_read_b128 v[44:47], v121 offset:41472
    v_mfma_f32_16x16x32_bf16 v[244:247], v[28:31], v[56:59], v[244:247]
    buffer_load_dwordx4 v107, s[44:47], s61 offen offset:3168 lds
    v_mfma_f32_16x16x32_bf16 v[228:231], v[24:27], v[56:59], v[228:231]
    ds_read_b128 v[48:51], v121 offset:41728
    v_mfma_f32_16x16x32_bf16 v[224:227], v[24:27], v[52:55], v[224:227]
    ds_read_b64_tr_b16 v[24:25], v120 offset:21184
    v_mfma_f32_16x16x32_bf16 v[240:243], v[28:31], v[52:55], v[240:243]
    ds_read_b64_tr_b16 v[26:27], v120 offset:21696
    s_waitcnt lgkmcnt(2)
    v_mfma_f32_16x16x32_bf16 v[128:131], v[16:19], v[36:39], v[128:131]
    ds_read_b64_tr_b16 v[28:29], v120 offset:21216
    v_mfma_f32_16x16x32_bf16 v[144:147], v[20:23], v[36:39], v[144:147]
    ds_read_b64_tr_b16 v[30:31], v120 offset:21728
    s_add_u32 m0, s60, 16896
    v_mfma_f32_16x16x32_bf16 v[148:151], v[20:23], v[40:43], v[148:151]
    buffer_load_dwordx4 v108, s[44:47], s61 offen offset:0 lds
    v_mfma_f32_16x16x32_bf16 v[132:135], v[16:19], v[40:43], v[132:135]
    v_mfma_f32_16x16x32_bf16 v[136:139], v[16:19], v[44:47], v[136:139]
    buffer_load_dwordx4 v109, s[44:47], s61 offen offset:1056 lds
    v_mfma_f32_16x16x32_bf16 v[152:155], v[20:23], v[44:47], v[152:155]
    v_mfma_f32_16x16x32_bf16 v[156:159], v[20:23], v[48:51], v[156:159]
    s_waitcnt vmcnt(14)
    ds_read_b64_tr_b16 v[20:21], v120 offset:32
    v_mfma_f32_16x16x32_bf16 v[140:143], v[16:19], v[48:51], v[140:143]
    ds_read_b64_tr_b16 v[22:23], v120 offset:544
    s_waitcnt lgkmcnt(2)
    v_mfma_f32_16x16x32_bf16 v[188:191], v[28:31], v[48:51], v[188:191]
    ds_read_b64_tr_b16 v[16:17], v120 offset:0
    v_mfma_f32_16x16x32_bf16 v[172:175], v[24:27], v[48:51], v[172:175]
    ds_read_b64_tr_b16 v[18:19], v120 offset:512
    v_mfma_f32_16x16x32_bf16 v[168:171], v[24:27], v[44:47], v[168:171]
    buffer_load_dwordx4 v110, s[44:47], s61 offen offset:2112 lds
    v_mfma_f32_16x16x32_bf16 v[184:187], v[28:31], v[44:47], v[184:187]
    v_mfma_f32_16x16x32_bf16 v[180:183], v[28:31], v[40:43], v[180:183]
    buffer_load_dwordx4 v111, s[44:47], s61 offen offset:3168 lds
    v_mfma_f32_16x16x32_bf16 v[164:167], v[24:27], v[40:43], v[164:167]
    v_mfma_f32_16x16x32_bf16 v[160:163], v[24:27], v[36:39], v[160:163]
    ds_read_b64_tr_b16 v[24:25], v120 offset:64
    v_mfma_f32_16x16x32_bf16 v[176:179], v[28:31], v[36:39], v[176:179]
    ds_read_b64_tr_b16 v[26:27], v120 offset:576
    s_waitcnt lgkmcnt(2)
    v_mfma_f32_16x16x32_bf16 v[192:195], v[16:19], v[36:39], v[192:195]
    ds_read_b64_tr_b16 v[28:29], v120 offset:96
    v_mfma_f32_16x16x32_bf16 v[208:211], v[20:23], v[36:39], v[208:211]
    ds_read_b64_tr_b16 v[30:31], v120 offset:608
    s_mov_b32 s61, 3407872
    s_add_u32 m0, s60, 21120
    v_mfma_f32_16x16x32_bf16 v[212:215], v[20:23], v[40:43], v[212:215]
    buffer_load_dwordx4 v104, s[44:47], s61 offen offset:0 lds
    v_mfma_f32_16x16x32_bf16 v[196:199], v[16:19], v[40:43], v[196:199]
    ds_read_b128 v[52:55], v121 offset:45056
    v_mfma_f32_16x16x32_bf16 v[200:203], v[16:19], v[44:47], v[200:203]
    buffer_load_dwordx4 v105, s[44:47], s61 offen offset:1056 lds
    v_mfma_f32_16x16x32_bf16 v[216:219], v[20:23], v[44:47], v[216:219]
    ds_read_b128 v[56:59], v121 offset:45312
    v_mfma_f32_16x16x32_bf16 v[220:223], v[20:23], v[48:51], v[220:223]
    s_waitcnt vmcnt(14)
    ds_read_b64_tr_b16 v[20:21], v120 offset:4256
    v_mfma_f32_16x16x32_bf16 v[204:207], v[16:19], v[48:51], v[204:207]
    ds_read_b64_tr_b16 v[22:23], v120 offset:4768
    s_waitcnt lgkmcnt(4)
    v_mfma_f32_16x16x32_bf16 v[252:255], v[28:31], v[48:51], v[252:255]
    ds_read_b64_tr_b16 v[16:17], v120 offset:4224
    v_mfma_f32_16x16x32_bf16 v[236:239], v[24:27], v[48:51], v[236:239]
    ds_read_b64_tr_b16 v[18:19], v120 offset:4736
    v_mfma_f32_16x16x32_bf16 v[232:235], v[24:27], v[44:47], v[232:235]
    buffer_load_dwordx4 v106, s[44:47], s61 offen offset:2112 lds
    v_mfma_f32_16x16x32_bf16 v[248:251], v[28:31], v[44:47], v[248:251]
    ds_read_b128 v[60:63], v121 offset:45568
    v_mfma_f32_16x16x32_bf16 v[244:247], v[28:31], v[40:43], v[244:247]
    buffer_load_dwordx4 v107, s[44:47], s61 offen offset:3168 lds
    v_mfma_f32_16x16x32_bf16 v[228:231], v[24:27], v[40:43], v[228:231]
    ds_read_b128 v[64:67], v121 offset:45824
    v_mfma_f32_16x16x32_bf16 v[224:227], v[24:27], v[36:39], v[224:227]
    ds_read_b64_tr_b16 v[24:25], v120 offset:4288
    v_mfma_f32_16x16x32_bf16 v[240:243], v[28:31], v[36:39], v[240:243]
    ds_read_b64_tr_b16 v[26:27], v120 offset:4800
    s_waitcnt lgkmcnt(2)
    v_mfma_f32_16x16x32_bf16 v[128:131], v[16:19], v[52:55], v[128:131]
    ds_read_b64_tr_b16 v[28:29], v120 offset:4320
    v_mfma_f32_16x16x32_bf16 v[144:147], v[20:23], v[52:55], v[144:147]
    ds_read_b64_tr_b16 v[30:31], v120 offset:4832
    s_add_u32 m0, s60, 0
    v_mfma_f32_16x16x32_bf16 v[148:151], v[20:23], v[56:59], v[148:151]
    buffer_load_dwordx4 v108, s[44:47], s61 offen offset:0 lds
    v_mfma_f32_16x16x32_bf16 v[132:135], v[16:19], v[56:59], v[132:135]
    v_mfma_f32_16x16x32_bf16 v[136:139], v[16:19], v[60:63], v[136:139]
    buffer_load_dwordx4 v109, s[44:47], s61 offen offset:1056 lds
    v_mfma_f32_16x16x32_bf16 v[152:155], v[20:23], v[60:63], v[152:155]
    v_mfma_f32_16x16x32_bf16 v[156:159], v[20:23], v[64:67], v[156:159]
    s_waitcnt vmcnt(14)
    ds_read_b64_tr_b16 v[20:21], v120 offset:8480
    v_mfma_f32_16x16x32_bf16 v[140:143], v[16:19], v[64:67], v[140:143]
    ds_read_b64_tr_b16 v[22:23], v120 offset:8992
    s_waitcnt lgkmcnt(2)
    v_mfma_f32_16x16x32_bf16 v[188:191], v[28:31], v[64:67], v[188:191]
    ds_read_b64_tr_b16 v[16:17], v120 offset:8448
    v_mfma_f32_16x16x32_bf16 v[172:175], v[24:27], v[64:67], v[172:175]
    ds_read_b64_tr_b16 v[18:19], v120 offset:8960
    v_mfma_f32_16x16x32_bf16 v[168:171], v[24:27], v[60:63], v[168:171]
    buffer_load_dwordx4 v110, s[44:47], s61 offen offset:2112 lds
    v_mfma_f32_16x16x32_bf16 v[184:187], v[28:31], v[60:63], v[184:187]
    v_mfma_f32_16x16x32_bf16 v[180:183], v[28:31], v[56:59], v[180:183]
    buffer_load_dwordx4 v111, s[44:47], s61 offen offset:3168 lds
    v_mfma_f32_16x16x32_bf16 v[164:167], v[24:27], v[56:59], v[164:167]
    v_mfma_f32_16x16x32_bf16 v[160:163], v[24:27], v[52:55], v[160:163]
    ds_read_b64_tr_b16 v[24:25], v120 offset:8512
    v_mfma_f32_16x16x32_bf16 v[176:179], v[28:31], v[52:55], v[176:179]
    ds_read_b64_tr_b16 v[26:27], v120 offset:9024
    s_waitcnt lgkmcnt(2)
    v_mfma_f32_16x16x32_bf16 v[192:195], v[16:19], v[52:55], v[192:195]
    ds_read_b64_tr_b16 v[28:29], v120 offset:8544
    v_mfma_f32_16x16x32_bf16 v[208:211], v[20:23], v[52:55], v[208:211]
    ds_read_b64_tr_b16 v[30:31], v120 offset:9056
    s_mov_b32 s61, 0
    s_add_u32 m0, s60, 4224
    v_mfma_f32_16x16x32_bf16 v[212:215], v[20:23], v[56:59], v[212:215]
    buffer_load_dwordx4 v112, s[48:51], s61 offen offset:0 lds
    v_mfma_f32_16x16x32_bf16 v[196:199], v[16:19], v[56:59], v[196:199]
    ds_read_b128 v[36:39], v121 offset:49152
    v_mfma_f32_16x16x32_bf16 v[200:203], v[16:19], v[60:63], v[200:203]
    buffer_load_dwordx4 v113, s[48:51], s61 offen offset:1056 lds
    v_mfma_f32_16x16x32_bf16 v[216:219], v[20:23], v[60:63], v[216:219]
    ds_read_b128 v[40:43], v121 offset:49408
    v_mfma_f32_16x16x32_bf16 v[220:223], v[20:23], v[64:67], v[220:223]
    s_waitcnt vmcnt(14)
    ds_read_b64_tr_b16 v[20:21], v120 offset:12704
    v_mfma_f32_16x16x32_bf16 v[204:207], v[16:19], v[64:67], v[204:207]
    ds_read_b64_tr_b16 v[22:23], v120 offset:13216
    s_waitcnt lgkmcnt(4)
    v_mfma_f32_16x16x32_bf16 v[252:255], v[28:31], v[64:67], v[252:255]
    ds_read_b64_tr_b16 v[16:17], v120 offset:12672
    v_mfma_f32_16x16x32_bf16 v[236:239], v[24:27], v[64:67], v[236:239]
    ds_read_b64_tr_b16 v[18:19], v120 offset:13184
    v_mfma_f32_16x16x32_bf16 v[232:235], v[24:27], v[60:63], v[232:235]
    buffer_load_dwordx4 v114, s[48:51], s61 offen offset:2112 lds
    v_mfma_f32_16x16x32_bf16 v[248:251], v[28:31], v[60:63], v[248:251]
    ds_read_b128 v[44:47], v121 offset:49664
    v_mfma_f32_16x16x32_bf16 v[244:247], v[28:31], v[56:59], v[244:247]
    buffer_load_dwordx4 v115, s[48:51], s61 offen offset:3168 lds
    v_mfma_f32_16x16x32_bf16 v[228:231], v[24:27], v[56:59], v[228:231]
    ds_read_b128 v[48:51], v121 offset:49920
    v_mfma_f32_16x16x32_bf16 v[224:227], v[24:27], v[52:55], v[224:227]
    ds_read_b64_tr_b16 v[24:25], v120 offset:12736
    v_mfma_f32_16x16x32_bf16 v[240:243], v[28:31], v[52:55], v[240:243]
    ds_read_b64_tr_b16 v[26:27], v120 offset:13248
    s_waitcnt lgkmcnt(2)
    v_mfma_f32_16x16x32_bf16 v[128:131], v[16:19], v[36:39], v[128:131]
    ds_read_b64_tr_b16 v[28:29], v120 offset:12768
    v_mfma_f32_16x16x32_bf16 v[144:147], v[20:23], v[36:39], v[144:147]
    ds_read_b64_tr_b16 v[30:31], v120 offset:13280
    s_add_u32 m0, s60, 8448
    v_mfma_f32_16x16x32_bf16 v[148:151], v[20:23], v[40:43], v[148:151]
    buffer_load_dwordx4 v116, s[48:51], s61 offen offset:0 lds
    v_mfma_f32_16x16x32_bf16 v[132:135], v[16:19], v[40:43], v[132:135]
    v_mfma_f32_16x16x32_bf16 v[136:139], v[16:19], v[44:47], v[136:139]
    buffer_load_dwordx4 v117, s[48:51], s61 offen offset:1056 lds
    v_mfma_f32_16x16x32_bf16 v[152:155], v[20:23], v[44:47], v[152:155]
    v_mfma_f32_16x16x32_bf16 v[156:159], v[20:23], v[48:51], v[156:159]
    s_waitcnt vmcnt(14)
    ds_read_b64_tr_b16 v[20:21], v120 offset:16928
    v_mfma_f32_16x16x32_bf16 v[140:143], v[16:19], v[48:51], v[140:143]
    ds_read_b64_tr_b16 v[22:23], v120 offset:17440
    s_waitcnt lgkmcnt(2)
    v_mfma_f32_16x16x32_bf16 v[188:191], v[28:31], v[48:51], v[188:191]
    ds_read_b64_tr_b16 v[16:17], v120 offset:16896
    v_mfma_f32_16x16x32_bf16 v[172:175], v[24:27], v[48:51], v[172:175]
    ds_read_b64_tr_b16 v[18:19], v120 offset:17408
    v_mfma_f32_16x16x32_bf16 v[168:171], v[24:27], v[44:47], v[168:171]
    buffer_load_dwordx4 v118, s[48:51], s61 offen offset:2112 lds
    v_mfma_f32_16x16x32_bf16 v[184:187], v[28:31], v[44:47], v[184:187]
    v_mfma_f32_16x16x32_bf16 v[180:183], v[28:31], v[40:43], v[180:183]
    buffer_load_dwordx4 v119, s[48:51], s61 offen offset:3168 lds
    v_mfma_f32_16x16x32_bf16 v[164:167], v[24:27], v[40:43], v[164:167]
    v_mfma_f32_16x16x32_bf16 v[160:163], v[24:27], v[36:39], v[160:163]
    ds_read_b64_tr_b16 v[24:25], v120 offset:16960
    v_mfma_f32_16x16x32_bf16 v[176:179], v[28:31], v[36:39], v[176:179]
    ds_read_b64_tr_b16 v[26:27], v120 offset:17472
    s_waitcnt lgkmcnt(2)
    v_mfma_f32_16x16x32_bf16 v[192:195], v[16:19], v[36:39], v[192:195]
    ds_read_b64_tr_b16 v[28:29], v120 offset:16992
    v_mfma_f32_16x16x32_bf16 v[208:211], v[20:23], v[36:39], v[208:211]
    ds_read_b64_tr_b16 v[30:31], v120 offset:17504
    s_mov_b32 s61, 28672
    s_add_u32 m0, s60, 12672
    v_mfma_f32_16x16x32_bf16 v[212:215], v[20:23], v[40:43], v[212:215]
    buffer_load_dwordx4 v112, s[48:51], s61 offen offset:0 lds
    v_mfma_f32_16x16x32_bf16 v[196:199], v[16:19], v[40:43], v[196:199]
    ds_read_b128 v[52:55], v121 offset:53248
    v_mfma_f32_16x16x32_bf16 v[200:203], v[16:19], v[44:47], v[200:203]
    buffer_load_dwordx4 v113, s[48:51], s61 offen offset:1056 lds
    v_mfma_f32_16x16x32_bf16 v[216:219], v[20:23], v[44:47], v[216:219]
    ds_read_b128 v[56:59], v121 offset:53504
    v_mfma_f32_16x16x32_bf16 v[220:223], v[20:23], v[48:51], v[220:223]
    s_waitcnt vmcnt(14)
    ds_read_b64_tr_b16 v[20:21], v120 offset:21152
    v_mfma_f32_16x16x32_bf16 v[204:207], v[16:19], v[48:51], v[204:207]
    ds_read_b64_tr_b16 v[22:23], v120 offset:21664
    s_waitcnt lgkmcnt(4)
    v_mfma_f32_16x16x32_bf16 v[252:255], v[28:31], v[48:51], v[252:255]
    ds_read_b64_tr_b16 v[16:17], v120 offset:21120
    v_mfma_f32_16x16x32_bf16 v[236:239], v[24:27], v[48:51], v[236:239]
    ds_read_b64_tr_b16 v[18:19], v120 offset:21632
    v_mfma_f32_16x16x32_bf16 v[232:235], v[24:27], v[44:47], v[232:235]
    buffer_load_dwordx4 v114, s[48:51], s61 offen offset:2112 lds
    v_mfma_f32_16x16x32_bf16 v[248:251], v[28:31], v[44:47], v[248:251]
    ds_read_b128 v[60:63], v121 offset:53760
    v_mfma_f32_16x16x32_bf16 v[244:247], v[28:31], v[40:43], v[244:247]
    buffer_load_dwordx4 v115, s[48:51], s61 offen offset:3168 lds
    v_mfma_f32_16x16x32_bf16 v[228:231], v[24:27], v[40:43], v[228:231]
    ds_read_b128 v[64:67], v121 offset:54016
    v_mfma_f32_16x16x32_bf16 v[224:227], v[24:27], v[36:39], v[224:227]
    ds_read_b64_tr_b16 v[24:25], v120 offset:21184
    v_mfma_f32_16x16x32_bf16 v[240:243], v[28:31], v[36:39], v[240:243]
    ds_read_b64_tr_b16 v[26:27], v120 offset:21696
    s_waitcnt lgkmcnt(2)
    v_mfma_f32_16x16x32_bf16 v[128:131], v[16:19], v[52:55], v[128:131]
    ds_read_b64_tr_b16 v[28:29], v120 offset:21216
    v_mfma_f32_16x16x32_bf16 v[144:147], v[20:23], v[52:55], v[144:147]
    ds_read_b64_tr_b16 v[30:31], v120 offset:21728
    s_add_u32 m0, s60, 16896
    v_mfma_f32_16x16x32_bf16 v[148:151], v[20:23], v[56:59], v[148:151]
    buffer_load_dwordx4 v116, s[48:51], s61 offen offset:0 lds
    v_mfma_f32_16x16x32_bf16 v[132:135], v[16:19], v[56:59], v[132:135]
    v_mfma_f32_16x16x32_bf16 v[136:139], v[16:19], v[60:63], v[136:139]
    buffer_load_dwordx4 v117, s[48:51], s61 offen offset:1056 lds
    v_mfma_f32_16x16x32_bf16 v[152:155], v[20:23], v[60:63], v[152:155]
    v_mfma_f32_16x16x32_bf16 v[156:159], v[20:23], v[64:67], v[156:159]
    s_waitcnt vmcnt(14)
    ds_read_b64_tr_b16 v[20:21], v120 offset:32
    v_mfma_f32_16x16x32_bf16 v[140:143], v[16:19], v[64:67], v[140:143]
    ds_read_b64_tr_b16 v[22:23], v120 offset:544
    s_waitcnt lgkmcnt(2)
    v_mfma_f32_16x16x32_bf16 v[188:191], v[28:31], v[64:67], v[188:191]
    ds_read_b64_tr_b16 v[16:17], v120 offset:0
    v_mfma_f32_16x16x32_bf16 v[172:175], v[24:27], v[64:67], v[172:175]
    ds_read_b64_tr_b16 v[18:19], v120 offset:512
    v_mfma_f32_16x16x32_bf16 v[168:171], v[24:27], v[60:63], v[168:171]
    buffer_load_dwordx4 v118, s[48:51], s61 offen offset:2112 lds
    v_mfma_f32_16x16x32_bf16 v[184:187], v[28:31], v[60:63], v[184:187]
    v_mfma_f32_16x16x32_bf16 v[180:183], v[28:31], v[56:59], v[180:183]
    buffer_load_dwordx4 v119, s[48:51], s61 offen offset:3168 lds
    v_mfma_f32_16x16x32_bf16 v[164:167], v[24:27], v[56:59], v[164:167]
    v_mfma_f32_16x16x32_bf16 v[160:163], v[24:27], v[52:55], v[160:163]
    ds_read_b64_tr_b16 v[24:25], v120 offset:64
    v_mfma_f32_16x16x32_bf16 v[176:179], v[28:31], v[52:55], v[176:179]
    ds_read_b64_tr_b16 v[26:27], v120 offset:576
    s_waitcnt lgkmcnt(2)
    v_mfma_f32_16x16x32_bf16 v[192:195], v[16:19], v[52:55], v[192:195]
    ds_read_b64_tr_b16 v[28:29], v120 offset:96
    v_mfma_f32_16x16x32_bf16 v[208:211], v[20:23], v[52:55], v[208:211]
    ds_read_b64_tr_b16 v[30:31], v120 offset:608
    s_mov_b32 s61, 57344
    s_add_u32 m0, s60, 21120
    v_mfma_f32_16x16x32_bf16 v[212:215], v[20:23], v[56:59], v[212:215]
    buffer_load_dwordx4 v112, s[48:51], s61 offen offset:0 lds
    v_mfma_f32_16x16x32_bf16 v[196:199], v[16:19], v[56:59], v[196:199]
    v_mfma_f32_16x16x32_bf16 v[200:203], v[16:19], v[60:63], v[200:203]
    buffer_load_dwordx4 v113, s[48:51], s61 offen offset:1056 lds
    v_mfma_f32_16x16x32_bf16 v[216:219], v[20:23], v[60:63], v[216:219]
    v_mfma_f32_16x16x32_bf16 v[220:223], v[20:23], v[64:67], v[220:223]
    s_waitcnt vmcnt(14)
    ds_read_b64_tr_b16 v[20:21], v120 offset:4256
    v_mfma_f32_16x16x32_bf16 v[204:207], v[16:19], v[64:67], v[204:207]
    ds_read_b64_tr_b16 v[22:23], v120 offset:4768
    s_waitcnt lgkmcnt(2)
    v_mfma_f32_16x16x32_bf16 v[252:255], v[28:31], v[64:67], v[252:255]
    ds_read_b64_tr_b16 v[16:17], v120 offset:4224
    v_mfma_f32_16x16x32_bf16 v[236:239], v[24:27], v[64:67], v[236:239]
    ds_read_b64_tr_b16 v[18:19], v120 offset:4736
    v_mfma_f32_16x16x32_bf16 v[232:235], v[24:27], v[60:63], v[232:235]
    buffer_load_dwordx4 v114, s[48:51], s61 offen offset:2112 lds
    v_mfma_f32_16x16x32_bf16 v[248:251], v[28:31], v[60:63], v[248:251]
    v_mfma_f32_16x16x32_bf16 v[244:247], v[28:31], v[56:59], v[244:247]
    buffer_load_dwordx4 v115, s[48:51], s61 offen offset:3168 lds
    v_mfma_f32_16x16x32_bf16 v[228:231], v[24:27], v[56:59], v[228:231]
    v_mfma_f32_16x16x32_bf16 v[224:227], v[24:27], v[52:55], v[224:227]
    ds_read_b64_tr_b16 v[24:25], v120 offset:4288
    v_mfma_f32_16x16x32_bf16 v[240:243], v[28:31], v[52:55], v[240:243]
    ds_read_b64_tr_b16 v[26:27], v120 offset:4800
    ds_read_b64_tr_b16 v[28:29], v120 offset:4320
    ds_read_b64_tr_b16 v[30:31], v120 offset:4832
    s_lshl_b32 s27, s20, 9
    v_lshrrev_b32 v13, 2, v0
    v_lshlrev_b32 v13, 14, v13
    v_and_b32 v14, 3, v0
    v_lshl_add_u32 v13, v14, 7, v13
    s_mov_b32 exec_hi, 0
    buffer_load_dword v34, v13, s[56:59], s27 offen
    s_mov_b64 exec, -1
    v_and_b32 v10, 15, v0
    v_lshlrev_b32 v10, 4, v10
    v_lshrrev_b32 v11, 5, v0
    v_lshl_add_u32 v10, v11, 10, v10
    v_bfe_u32 v11, v0, 4, 1
    v_lshl_add_u32 v10, v11, 11, v10
    s_lshl_b32 s27, s16, 14
    v_add_u32 v10, s27, v10
    v_cvt_pk_bf16_f32 v128, v128, v129
    v_cvt_pk_bf16_f32 v129, v130, v131
    v_cvt_pk_bf16_f32 v130, v144, v145
    v_cvt_pk_bf16_f32 v131, v146, v147
    s_load_dwordx2 s[36:37], s[0:1], 80
    s_load_dwordx2 s[40:41], s[0:1], 72
    s_load_dwordx2 s[44:45], s[0:1], 0
    s_waitcnt lgkmcnt(0)
    s_mov_b32 s38, 256
    s_mov_b32 s39, 0x20000
    s_mov_b32 s42, 1835008
    s_mov_b32 s43, 0x20000
    s_mov_b32 s46, 1835008
    s_mov_b32 s47, 0x20000
    s_barrier
    v_cvt_pk_bf16_f32 v132, v132, v133
    v_cvt_pk_bf16_f32 v133, v134, v135
    v_cvt_pk_bf16_f32 v134, v148, v149
    v_cvt_pk_bf16_f32 v135, v150, v151
    v_permlane16_swap_b32 v128, v130
    v_permlane16_swap_b32 v129, v131
    ds_write_b128 v10, v[128:131] offset:0
    v_cvt_pk_bf16_f32 v136, v136, v137
    v_cvt_pk_bf16_f32 v137, v138, v139
    v_cvt_pk_bf16_f32 v138, v152, v153
    v_cvt_pk_bf16_f32 v139, v154, v155
    v_permlane16_swap_b32 v132, v134
    v_permlane16_swap_b32 v133, v135
    ds_write_b128 v10, v[132:135] offset:256
    v_cvt_pk_bf16_f32 v140, v140, v141
    v_cvt_pk_bf16_f32 v141, v142, v143
    v_cvt_pk_bf16_f32 v142, v156, v157
    v_cvt_pk_bf16_f32 v143, v158, v159
    v_permlane16_swap_b32 v136, v138
    v_permlane16_swap_b32 v137, v139
    ds_write_b128 v10, v[136:139] offset:512
    v_cvt_pk_bf16_f32 v160, v160, v161
    v_cvt_pk_bf16_f32 v161, v162, v163
    v_cvt_pk_bf16_f32 v162, v176, v177
    v_cvt_pk_bf16_f32 v163, v178, v179
    v_permlane16_swap_b32 v140, v142
    v_permlane16_swap_b32 v141, v143
    ds_write_b128 v10, v[140:143] offset:768
    v_cvt_pk_bf16_f32 v164, v164, v165
    v_cvt_pk_bf16_f32 v165, v166, v167
    v_cvt_pk_bf16_f32 v166, v180, v181
    v_cvt_pk_bf16_f32 v167, v182, v183
    v_permlane16_swap_b32 v160, v162
    v_permlane16_swap_b32 v161, v163
    ds_write_b128 v10, v[160:163] offset:4096
    v_cvt_pk_bf16_f32 v168, v168, v169
    v_cvt_pk_bf16_f32 v169, v170, v171
    v_cvt_pk_bf16_f32 v170, v184, v185
    v_cvt_pk_bf16_f32 v171, v186, v187
    v_permlane16_swap_b32 v164, v166
    v_permlane16_swap_b32 v165, v167
    ds_write_b128 v10, v[164:167] offset:4352
    v_cvt_pk_bf16_f32 v172, v172, v173
    v_cvt_pk_bf16_f32 v173, v174, v175
    v_cvt_pk_bf16_f32 v174, v188, v189
    v_cvt_pk_bf16_f32 v175, v190, v191
    v_permlane16_swap_b32 v168, v170
    v_permlane16_swap_b32 v169, v171
    ds_write_b128 v10, v[168:171] offset:4608
    v_cvt_pk_bf16_f32 v192, v192, v193
    v_cvt_pk_bf16_f32 v193, v194, v195
    v_cvt_pk_bf16_f32 v194, v208, v209
    v_cvt_pk_bf16_f32 v195, v210, v211
    v_permlane16_swap_b32 v172, v174
    v_permlane16_swap_b32 v173, v175
    ds_write_b128 v10, v[172:175] offset:4864
    v_cvt_pk_bf16_f32 v196, v196, v197
    v_cvt_pk_bf16_f32 v197, v198, v199
    v_cvt_pk_bf16_f32 v198, v212, v213
    v_cvt_pk_bf16_f32 v199, v214, v215
    v_permlane16_swap_b32 v192, v194
    v_permlane16_swap_b32 v193, v195
    ds_write_b128 v10, v[192:195] offset:8192
    v_cvt_pk_bf16_f32 v200, v200, v201
    v_cvt_pk_bf16_f32 v201, v202, v203
    v_cvt_pk_bf16_f32 v202, v216, v217
    v_cvt_pk_bf16_f32 v203, v218, v219
    v_permlane16_swap_b32 v196, v198
    v_permlane16_swap_b32 v197, v199
    ds_write_b128 v10, v[196:199] offset:8448
    v_cvt_pk_bf16_f32 v204, v204, v205
    v_cvt_pk_bf16_f32 v205, v206, v207
    v_cvt_pk_bf16_f32 v206, v220, v221
    v_cvt_pk_bf16_f32 v207, v222, v223
    v_permlane16_swap_b32 v200, v202
    v_permlane16_swap_b32 v201, v203
    ds_write_b128 v10, v[200:203] offset:8704
    v_cvt_pk_bf16_f32 v224, v224, v225
    v_cvt_pk_bf16_f32 v225, v226, v227
    v_cvt_pk_bf16_f32 v226, v240, v241
    v_cvt_pk_bf16_f32 v227, v242, v243
    v_permlane16_swap_b32 v204, v206
    v_permlane16_swap_b32 v205, v207
    ds_write_b128 v10, v[204:207] offset:8960
    v_cvt_pk_bf16_f32 v228, v228, v229
    v_cvt_pk_bf16_f32 v229, v230, v231
    v_cvt_pk_bf16_f32 v230, v244, v245
    v_cvt_pk_bf16_f32 v231, v246, v247
L_pg5:
    s_cbranch_execz L_pg9
    v_permlane16_swap_b32 v224, v226
    v_permlane16_swap_b32 v225, v227
    ds_write_b128 v10, v[224:227] offset:12288
    v_cvt_pk_bf16_f32 v232, v232, v233
    v_cvt_pk_bf16_f32 v233, v234, v235
    v_cvt_pk_bf16_f32 v234, v248, v249
    v_cvt_pk_bf16_f32 v235, v250, v251
    v_permlane16_swap_b32 v228, v230
    v_permlane16_swap_b32 v229, v231
    ds_write_b128 v10, v[228:231] offset:12544
    v_cvt_pk_bf16_f32 v236, v236, v237
    v_cvt_pk_bf16_f32 v237, v238, v239
    v_cvt_pk_bf16_f32 v238, v252, v253
    v_cvt_pk_bf16_f32 v239, v254, v255
    v_permlane16_swap_b32 v232, v234
    v_permlane16_swap_b32 v233, v235
    ds_write_b128 v10, v[232:235] offset:12800
    s_nop 1
    v_permlane16_swap_b32 v236, v238
    v_permlane16_swap_b32 v237, v239
    ds_write_b128 v10, v[236:239] offset:13056
    s_lshl_b32 s27, s17, 15
    v_add_u32 v11, s27, v121
    s_waitcnt lgkmcnt(0)
    s_barrier
    ds_read_b128 a[0:3], v11 offset:0
    ds_read_b128 a[4:7], v11 offset:4096
    ds_read_b128 a[8:11], v11 offset:8192
    ds_read_b128 a[12:15], v11 offset:12288
    ds_read_b128 a[16:19], v11 offset:16384
    ds_read_b128 a[20:23], v11 offset:20480
    ds_read_b128 a[24:27], v11 offset:24576
    ds_read_b128 a[28:31], v11 offset:28672
    ds_read_b128 a[32:35], v11 offset:256
    ds_read_b128 a[36:39], v11 offset:4352
    ds_read_b128 a[40:43], v11 offset:8448
    ds_read_b128 a[44:47], v11 offset:12544
    ds_read_b128 a[48:51], v11 offset:16640
    ds_read_b128 a[52:55], v11 offset:20736
    ds_read_b128 a[56:59], v11 offset:24832
    ds_read_b128 a[60:63], v11 offset:28928
    ds_read_b128 a[64:67], v11 offset:512
    ds_read_b128 a[68:71], v11 offset:4608
    ds_read_b128 a[72:75], v11 offset:8704
    ds_read_b128 a[76:79], v11 offset:12800
    ds_read_b128 a[80:83], v11 offset:16896
    ds_read_b128 a[84:87], v11 offset:20992
    ds_read_b128 a[88:91], v11 offset:25088
    ds_read_b128 a[92:95], v11 offset:29184
    ds_read_b128 a[96:99], v11 offset:768
    ds_read_b128 a[100:103], v11 offset:4864
    ds_read_b128 a[104:107], v11 offset:8960
    ds_read_b128 a[108:111], v11 offset:13056
    ds_read_b128 a[112:115], v11 offset:17152
    ds_read_b128 a[116:119], v11 offset:21248
    ds_read_b128 a[120:123], v11 offset:25344
    ds_read_b128 a[124:127], v11 offset:29440
    s_lshl_b32 s27, s16, 13
    v_add_u32 v10, s27, v121
    s_waitcnt lgkmcnt(0)
    s_barrier
    ds_write_b128 v10, v[68:71] offset:0
    ds_write_b128 v10, v[72:75] offset:256
    ds_write_b128 v10, v[76:79] offset:512
    ds_write_b128 v10, v[80:83] offset:768
    ds_write_b128 v10, v[84:87] offset:4096
    ds_write_b128 v10, v[88:91] offset:4352
    ds_write_b128 v10, v[92:95] offset:4608
    ds_write_b128 v10, v[96:99] offset:4864
    s_waitcnt lgkmcnt(0)
    s_barrier
    ds_read_b128 v[36:39], v121 offset:0
    ds_read_b128 v[40:43], v121 offset:256
    ds_read_b128 v[44:47], v121 offset:512
    ds_read_b128 v[48:51], v121 offset:768
    s_waitcnt lgkmcnt(0)
    v_mfma_f32_16x16x32_bf16 v[128:131], v[16:19], v[36:39], 0
    v_mfma_f32_16x16x32_bf16 v[144:147], v[20:23], v[36:39], 0
    s_add_u32 m0, s60, 0
    v_mfma_f32_16x16x32_bf16 v[148:151], v[20:23], v[40:43], 0
    buffer_load_dwordx4 v116, s[48:51], s61 offen offset:0 lds
    v_mfma_f32_16x16x32_bf16 v[132:135], v[16:19], v[40:43], 0
    v_mfma_f32_16x16x32_bf16 v[136:139], v[16:19], v[44:47], 0
    buffer_load_dwordx4 v117, s[48:51], s61 offen offset:1056 lds
    v_mfma_f32_16x16x32_bf16 v[152:155], v[20:23], v[44:47], 0
    v_mfma_f32_16x16x32_bf16 v[156:159], v[20:23], v[48:51], 0
    s_waitcnt vmcnt(15)
    ds_read_b64_tr_b16 v[20:21], v120 offset:8480
    v_mfma_f32_16x16x32_bf16 v[140:143], v[16:19], v[48:51], 0
    ds_read_b64_tr_b16 v[22:23], v120 offset:8992
    v_mfma_f32_16x16x32_bf16 v[188:191], v[28:31], v[48:51], 0
    ds_read_b64_tr_b16 v[16:17], v120 offset:8448
    v_mfma_f32_16x16x32_bf16 v[172:175], v[24:27], v[48:51], 0
    ds_read_b64_tr_b16 v[18:19], v120 offset:8960
    v_mfma_f32_16x16x32_bf16 v[168:171], v[24:27], v[44:47], 0
    buffer_load_dwordx4 v118, s[48:51], s61 offen offset:2112 lds
    v_mfma_f32_16x16x32_bf16 v[184:187], v[28:31], v[44:47], 0
    v_mfma_f32_16x16x32_bf16 v[180:183], v[28:31], v[40:43], 0
    buffer_load_dwordx4 v119, s[48:51], s61 offen offset:3168 lds
    v_mfma_f32_16x16x32_bf16 v[164:167], v[24:27], v[40:43], 0
    v_mfma_f32_16x16x32_bf16 v[160:163], v[24:27], v[36:39], 0
    ds_read_b64_tr_b16 v[24:25], v120 offset:8512
    v_mfma_f32_16x16x32_bf16 v[176:179], v[28:31], v[36:39], 0
    ds_read_b64_tr_b16 v[26:27], v120 offset:9024
    s_waitcnt lgkmcnt(2)
    v_mfma_f32_16x16x32_bf16 v[192:195], v[16:19], v[36:39], 0
    ds_read_b64_tr_b16 v[28:29], v120 offset:8544
    v_mfma_f32_16x16x32_bf16 v[208:211], v[20:23], v[36:39], 0
    ds_read_b64_tr_b16 v[30:31], v120 offset:9056
    s_mov_b32 s61, 86016
    s_add_u32 m0, s60, 4224
    v_mfma_f32_16x16x32_bf16 v[212:215], v[20:23], v[40:43], 0
    buffer_load_dwordx4 v112, s[48:51], s61 offen offset:0 lds
    v_mfma_f32_16x16x32_bf16 v[196:199], v[16:19], v[40:43], 0
    ds_read_b128 v[52:55], v121 offset:4096
    v_mfma_f32_16x16x32_bf16 v[200:203], v[16:19], v[44:47], 0
    buffer_load_dwordx4 v113, s[48:51], s61 offen offset:1056 lds
    v_mfma_f32_16x16x32_bf16 v[216:219], v[20:23], v[44:47], 0
    ds_read_b128 v[56:59], v121 offset:4352
    v_mfma_f32_16x16x32_bf16 v[220:223], v[20:23], v[48:51], 0
    s_waitcnt vmcnt(15)
    ds_read_b64_tr_b16 v[20:21], v120 offset:12704
    v_mfma_f32_16x16x32_bf16 v[204:207], v[16:19], v[48:51], 0
    ds_read_b64_tr_b16 v[22:23], v120 offset:13216
    s_waitcnt lgkmcnt(4)
    v_mfma_f32_16x16x32_bf16 v[252:255], v[28:31], v[48:51], 0
    ds_read_b64_tr_b16 v[16:17], v120 offset:12672
    v_mfma_f32_16x16x32_bf16 v[236:239], v[24:27], v[48:51], 0
    ds_read_b64_tr_b16 v[18:19], v120 offset:13184
    v_mfma_f32_16x16x32_bf16 v[232:235], v[24:27], v[44:47], 0
    buffer_load_dwordx4 v114, s[48:51], s61 offen offset:2112 lds
    v_mfma_f32_16x16x32_bf16 v[248:251], v[28:31], v[44:47], 0
    ds_read_b128 v[60:63], v121 offset:4608
    v_mfma_f32_16x16x32_bf16 v[244:247], v[28:31], v[40:43], 0
    buffer_load_dwordx4 v115, s[48:51], s61 offen offset:3168 lds
    v_mfma_f32_16x16x32_bf16 v[228:231], v[24:27], v[40:43], 0
    ds_read_b128 v[64:67], v121 offset:4864
    v_mfma_f32_16x16x32_bf16 v[224:227], v[24:27], v[36:39], 0
    ds_read_b64_tr_b16 v[24:25], v120 offset:12736
    v_mfma_f32_16x16x32_bf16 v[240:243], v[28:31], v[36:39], 0
    ds_read_b64_tr_b16 v[26:27], v120 offset:13248
    s_waitcnt lgkmcnt(2)
    v_mfma_f32_16x16x32_bf16 v[128:131], v[16:19], v[52:55], v[128:131]
    ds_read_b64_tr_b16 v[28:29], v120 offset:12768
    v_mfma_f32_16x16x32_bf16 v[144:147], v[20:23], v[52:55], v[144:147]
    ds_read_b64_tr_b16 v[30:31], v120 offset:13280
    s_add_u32 m0, s60, 8448
    v_mfma_f32_16x16x32_bf16 v[148:151], v[20:23], v[56:59], v[148:151]
    buffer_load_dwordx4 v116, s[48:51], s61 offen offset:0 lds
    v_mfma_f32_16x16x32_bf16 v[132:135], v[16:19], v[56:59], v[132:135]
    v_mfma_f32_16x16x32_bf16 v[136:139], v[16:19], v[60:63], v[136:139]
    buffer_load_dwordx4 v117, s[48:51], s61 offen offset:1056 lds
    v_mfma_f32_16x16x32_bf16 v[152:155], v[20:23], v[60:63], v[152:155]
    v_mfma_f32_16x16x32_bf16 v[156:159], v[20:23], v[64:67], v[156:159]
    s_waitcnt vmcnt(15)
    ds_read_b64_tr_b16 v[20:21], v120 offset:16928
    v_mfma_f32_16x16x32_bf16 v[140:143], v[16:19], v[64:67], v[140:143]
    ds_read_b64_tr_b16 v[22:23], v120 offset:17440
    s_waitcnt lgkmcnt(2)
    v_mfma_f32_16x16x32_bf16 v[188:191], v[28:31], v[64:67], v[188:191]
    ds_read_b64_tr_b16 v[16:17], v120 offset:16896
    v_mfma_f32_16x16x32_bf16 v[172:175], v[24:27], v[64:67], v[172:175]
    ds_read_b64_tr_b16 v[18:19], v120 offset:17408
    v_mfma_f32_16x16x32_bf16 v[168:171], v[24:27], v[60:63], v[168:171]
    buffer_load_dwordx4 v118, s[48:51], s61 offen offset:2112 lds
    v_mfma_f32_16x16x32_bf16 v[184:187], v[28:31], v[60:63], v[184:187]
    v_mfma_f32_16x16x32_bf16 v[180:183], v[28:31], v[56:59], v[180:183]
    buffer_load_dwordx4 v119, s[48:51], s61 offen offset:3168 lds
    v_mfma_f32_16x16x32_bf16 v[164:167], v[24:27], v[56:59], v[164:167]
    v_mfma_f32_16x16x32_bf16 v[160:163], v[24:27], v[52:55], v[160:163]
    ds_read_b64_tr_b16 v[24:25], v120 offset:16960
    v_mfma_f32_16x16x32_bf16 v[176:179], v[28:31], v[52:55], v[176:179]
    ds_read_b64_tr_b16 v[26:27], v120 offset:17472
    s_waitcnt lgkmcnt(2)
    v_mfma_f32_16x16x32_bf16 v[192:195], v[16:19], v[52:55], v[192:195]
    ds_read_b64_tr_b16 v[28:29], v120 offset:16992
    v_mfma_f32_16x16x32_bf16 v[208:211], v[20:23], v[52:55], v[208:211]
    ds_read_b64_tr_b16 v[30:31], v120 offset:17504
    s_mov_b32 s61, 114688
    s_add_u32 m0, s60, 12672
    v_mfma_f32_16x16x32_bf16 v[212:215], v[20:23], v[56:59], v[212:215]
    buffer_load_dwordx4 v112, s[48:51], s61 offen offset:0 lds
    v_mfma_f32_16x16x32_bf16 v[196:199], v[16:19], v[56:59], v[196:199]
    ds_read_b128 v[36:39], v121 offset:8192
    v_mfma_f32_16x16x32_bf16 v[200:203], v[16:19], v[60:63], v[200:203]
    buffer_load_dwordx4 v113, s[48:51], s61 offen offset:1056 lds
    v_mfma_f32_16x16x32_bf16 v[216:219], v[20:23], v[60:63], v[216:219]
    ds_read_b128 v[40:43], v121 offset:8448
    v_mfma_f32_16x16x32_bf16 v[220:223], v[20:23], v[64:67], v[220:223]
    s_waitcnt vmcnt(15)
    ds_read_b64_tr_b16 v[20:21], v120 offset:21152
    v_mfma_f32_16x16x32_bf16 v[204:207], v[16:19], v[64:67], v[204:207]
    ds_read_b64_tr_b16 v[22:23], v120 offset:21664
    s_waitcnt lgkmcnt(4)
    v_mfma_f32_16x16x32_bf16 v[252:255], v[28:31], v[64:67], v[252:255]
    ds_read_b64_tr_b16 v[16:17], v120 offset:21120
    v_mfma_f32_16x16x32_bf16 v[236:239], v[24:27], v[64:67], v[236:239]
    ds_read_b64_tr_b16 v[18:19], v120 offset:21632
    v_mfma_f32_16x16x32_bf16 v[232:235], v[24:27], v[60:63], v[232:235]
    buffer_load_dwordx4 v114, s[48:51], s61 offen offset:2112 lds
    v_mfma_f32_16x16x32_bf16 v[248:251], v[28:31], v[60:63], v[248:251]
    ds_read_b128 v[44:47], v121 offset:8704
    v_mfma_f32_16x16x32_bf16 v[244:247], v[28:31], v[56:59], v[244:247]
    buffer_load_dwordx4 v115, s[48:51], s61 offen offset:3168 lds
    v_mfma_f32_16x16x32_bf16 v[228:231], v[24:27], v[56:59], v[228:231]
    ds_read_b128 v[48:51], v121 offset:8960
    v_mfma_f32_16x16x32_bf16 v[224:227], v[24:27], v[52:55], v[224:227]
    ds_read_b64_tr_b16 v[24:25], v120 offset:21184
    v_mfma_f32_16x16x32_bf16 v[240:243], v[28:31], v[52:55], v[240:243]
    ds_read_b64_tr_b16 v[26:27], v120 offset:21696
    s_waitcnt lgkmcnt(2)
    v_mfma_f32_16x16x32_bf16 v[128:131], v[16:19], v[36:39], v[128:131]
    ds_read_b64_tr_b16 v[28:29], v120 offset:21216
    v_mfma_f32_16x16x32_bf16 v[144:147], v[20:23], v[36:39], v[144:147]
    ds_read_b64_tr_b16 v[30:31], v120 offset:21728
    s_add_u32 m0, s60, 16896
    v_mfma_f32_16x16x32_bf16 v[148:151], v[20:23], v[40:43], v[148:151]
    buffer_load_dwordx4 v116, s[48:51], s61 offen offset:0 lds
    v_mfma_f32_16x16x32_bf16 v[132:135], v[16:19], v[40:43], v[132:135]
    v_mfma_f32_16x16x32_bf16 v[136:139], v[16:19], v[44:47], v[136:139]
    buffer_load_dwordx4 v117, s[48:51], s61 offen offset:1056 lds
    v_mfma_f32_16x16x32_bf16 v[152:155], v[20:23], v[44:47], v[152:155]
    v_mfma_f32_16x16x32_bf16 v[156:159], v[20:23], v[48:51], v[156:159]
    s_waitcnt vmcnt(14)
    ds_read_b64_tr_b16 v[20:21], v120 offset:32
    v_mfma_f32_16x16x32_bf16 v[140:143], v[16:19], v[48:51], v[140:143]
    ds_read_b64_tr_b16 v[22:23], v120 offset:544
    s_waitcnt lgkmcnt(2)
    v_mfma_f32_16x16x32_bf16 v[188:191], v[28:31], v[48:51], v[188:191]
    ds_read_b64_tr_b16 v[16:17], v120 offset:0
    v_mfma_f32_16x16x32_bf16 v[172:175], v[24:27], v[48:51], v[172:175]
    ds_read_b64_tr_b16 v[18:19], v120 offset:512
    v_mfma_f32_16x16x32_bf16 v[168:171], v[24:27], v[44:47], v[168:171]
    buffer_load_dwordx4 v118, s[48:51], s61 offen offset:2112 lds
    v_mfma_f32_16x16x32_bf16 v[184:187], v[28:31], v[44:47], v[184:187]
    v_mfma_f32_16x16x32_bf16 v[180:183], v[28:31], v[40:43], v[180:183]
    buffer_load_dwordx4 v119, s[48:51], s61 offen offset:3168 lds
    v_mfma_f32_16x16x32_bf16 v[164:167], v[24:27], v[40:43], v[164:167]
    v_mfma_f32_16x16x32_bf16 v[160:163], v[24:27], v[36:39], v[160:163]
    ds_read_b64_tr_b16 v[24:25], v120 offset:64
    v_mfma_f32_16x16x32_bf16 v[176:179], v[28:31], v[36:39], v[176:179]
    ds_read_b64_tr_b16 v[26:27], v120 offset:576
    s_waitcnt lgkmcnt(2)
    v_mfma_f32_16x16x32_bf16 v[192:195], v[16:19], v[36:39], v[192:195]
    ds_read_b64_tr_b16 v[28:29], v120 offset:96
    v_mfma_f32_16x16x32_bf16 v[208:211], v[20:23], v[36:39], v[208:211]
    ds_read_b64_tr_b16 v[30:31], v120 offset:608
    s_mov_b32 s61, 143360
    s_add_u32 m0, s60, 21120
    v_mfma_f32_16x16x32_bf16 v[212:215], v[20:23], v[40:43], v[212:215]
    buffer_load_dwordx4 v112, s[48:51], s61 offen offset:0 lds
    v_mfma_f32_16x16x32_bf16 v[196:199], v[16:19], v[40:43], v[196:199]
    ds_read_b128 v[52:55], v121 offset:12288
    v_mfma_f32_16x16x32_bf16 v[200:203], v[16:19], v[44:47], v[200:203]
    buffer_load_dwordx4 v113, s[48:51], s61 offen offset:1056 lds
    v_mfma_f32_16x16x32_bf16 v[216:219], v[20:23], v[44:47], v[216:219]
    ds_read_b128 v[56:59], v121 offset:12544
    v_mfma_f32_16x16x32_bf16 v[220:223], v[20:23], v[48:51], v[220:223]
    s_waitcnt vmcnt(14)
    ds_read_b64_tr_b16 v[20:21], v120 offset:4256
    v_mfma_f32_16x16x32_bf16 v[204:207], v[16:19], v[48:51], v[204:207]
    ds_read_b64_tr_b16 v[22:23], v120 offset:4768
    s_waitcnt lgkmcnt(4)
    v_mfma_f32_16x16x32_bf16 v[252:255], v[28:31], v[48:51], v[252:255]
    ds_read_b64_tr_b16 v[16:17], v120 offset:4224
    v_mfma_f32_16x16x32_bf16 v[236:239], v[24:27], v[48:51], v[236:239]
    ds_read_b64_tr_b16 v[18:19], v120 offset:4736
    v_mfma_f32_16x16x32_bf16 v[232:235], v[24:27], v[44:47], v[232:235]
    buffer_load_dwordx4 v114, s[48:51], s61 offen offset:2112 lds
    v_mfma_f32_16x16x32_bf16 v[248:251], v[28:31], v[44:47], v[248:251]
    ds_read_b128 v[60:63], v121 offset:12800
    v_mfma_f32_16x16x32_bf16 v[244:247], v[28:31], v[40:43], v[244:247]
    buffer_load_dwordx4 v115, s[48:51], s61 offen offset:3168 lds
    v_mfma_f32_16x16x32_bf16 v[228:231], v[24:27], v[40:43], v[228:231]
    ds_read_b128 v[64:67], v121 offset:13056
    v_mfma_f32_16x16x32_bf16 v[224:227], v[24:27], v[36:39], v[224:227]
    ds_read_b64_tr_b16 v[24:25], v120 offset:4288
    v_mfma_f32_16x16x32_bf16 v[240:243], v[28:31], v[36:39], v[240:243]
    ds_read_b64_tr_b16 v[26:27], v120 offset:4800
    s_waitcnt lgkmcnt(2)
    v_mfma_f32_16x16x32_bf16 v[128:131], v[16:19], v[52:55], v[128:131]
    ds_read_b64_tr_b16 v[28:29], v120 offset:4320
    v_mfma_f32_16x16x32_bf16 v[144:147], v[20:23], v[52:55], v[144:147]
    ds_read_b64_tr_b16 v[30:31], v120 offset:4832
    s_add_u32 m0, s60, 0
    v_mfma_f32_16x16x32_bf16 v[148:151], v[20:23], v[56:59], v[148:151]
    buffer_load_dwordx4 v116, s[48:51], s61 offen offset:0 lds
    v_mfma_f32_16x16x32_bf16 v[132:135], v[16:19], v[56:59], v[132:135]
    v_mfma_f32_16x16x32_bf16 v[136:139], v[16:19], v[60:63], v[136:139]
    buffer_load_dwordx4 v117, s[48:51], s61 offen offset:1056 lds
    v_mfma_f32_16x16x32_bf16 v[152:155], v[20:23], v[60:63], v[152:155]
    v_mfma_f32_16x16x32_bf16 v[156:159], v[20:23], v[64:67], v[156:159]
    s_waitcnt vmcnt(14)
    ds_read_b64_tr_b16 v[20:21], v120 offset:8480
    v_mfma_f32_16x16x32_bf16 v[140:143], v[16:19], v[64:67], v[140:143]
    ds_read_b64_tr_b16 v[22:23], v120 offset:8992
    s_waitcnt lgkmcnt(2)
    v_mfma_f32_16x16x32_bf16 v[188:191], v[28:31], v[64:67], v[188:191]
    ds_read_b64_tr_b16 v[16:17], v120 offset:8448
    v_mfma_f32_16x16x32_bf16 v[172:175], v[24:27], v[64:67], v[172:175]
    ds_read_b64_tr_b16 v[18:19], v120 offset:8960
    v_mfma_f32_16x16x32_bf16 v[168:171], v[24:27], v[60:63], v[168:171]
    buffer_load_dwordx4 v118, s[48:51], s61 offen offset:2112 lds
    v_mfma_f32_16x16x32_bf16 v[184:187], v[28:31], v[60:63], v[184:187]
    v_mfma_f32_16x16x32_bf16 v[180:183], v[28:31], v[56:59], v[180:183]
    buffer_load_dwordx4 v119, s[48:51], s61 offen offset:3168 lds
    v_mfma_f32_16x16x32_bf16 v[164:167], v[24:27], v[56:59], v[164:167]
    v_mfma_f32_16x16x32_bf16 v[160:163], v[24:27], v[52:55], v[160:163]
    ds_read_b64_tr_b16 v[24:25], v120 offset:8512
    v_mfma_f32_16x16x32_bf16 v[176:179], v[28:31], v[52:55], v[176:179]
    ds_read_b64_tr_b16 v[26:27], v120 offset:9024
    s_waitcnt lgkmcnt(2)
    v_mfma_f32_16x16x32_bf16 v[192:195], v[16:19], v[52:55], v[192:195]
    ds_read_b64_tr_b16 v[28:29], v120 offset:8544
    v_mfma_f32_16x16x32_bf16 v[208:211], v[20:23], v[52:55], v[208:211]
    ds_read_b64_tr_b16 v[30:31], v120 offset:9056
    s_mov_b32 s61, 172032
    s_add_u32 m0, s60, 4224
    v_mfma_f32_16x16x32_bf16 v[212:215], v[20:23], v[56:59], v[212:215]
    buffer_load_dwordx4 v112, s[48:51], s61 offen offset:0 lds
    v_mfma_f32_16x16x32_bf16 v[196:199], v[16:19], v[56:59], v[196:199]
    ds_read_b128 v[36:39], v121 offset:16384
    v_mfma_f32_16x16x32_bf16 v[200:203], v[16:19], v[60:63], v[200:203]
    buffer_load_dwordx4 v113, s[48:51], s61 offen offset:1056 lds
    v_mfma_f32_16x16x32_bf16 v[216:219], v[20:23], v[60:63], v[216:219]
    ds_read_b128 v[40:43], v121 offset:16640
    v_mfma_f32_16x16x32_bf16 v[220:223], v[20:23], v[64:67], v[220:223]
    s_waitcnt vmcnt(14)
    ds_read_b64_tr_b16 v[20:21], v120 offset:12704
    v_mfma_f32_16x16x32_bf16 v[204:207], v[16:19], v[64:67], v[204:207]
    ds_read_b64_tr_b16 v[22:23], v120 offset:13216
    s_waitcnt lgkmcnt(4)
    v_mfma_f32_16x16x32_bf16 v[252:255], v[28:31], v[64:67], v[252:255]
    ds_read_b64_tr_b16 v[16:17], v120 offset:12672
    v_mfma_f32_16x16x32_bf16 v[236:239], v[24:27], v[64:67], v[236:239]
    ds_read_b64_tr_b16 v[18:19], v120 offset:13184
    v_mfma_f32_16x16x32_bf16 v[232:235], v[24:27], v[60:63], v[232:235]
    buffer_load_dwordx4 v114, s[48:51], s61 offen offset:2112 lds
    v_mfma_f32_16x16x32_bf16 v[248:251], v[28:31], v[60:63], v[248:251]
    ds_read_b128 v[44:47], v121 offset:16896
    v_mfma_f32_16x16x32_bf16 v[244:247], v[28:31], v[56:59], v[244:247]
    buffer_load_dwordx4 v115, s[48:51], s61 offen offset:3168 lds
    v_mfma_f32_16x16x32_bf16 v[228:231], v[24:27], v[56:59], v[228:231]
    ds_read_b128 v[48:51], v121 offset:17152
    v_mfma_f32_16x16x32_bf16 v[224:227], v[24:27], v[52:55], v[224:227]
    ds_read_b64_tr_b16 v[24:25], v120 offset:12736
    v_mfma_f32_16x16x32_bf16 v[240:243], v[28:31], v[52:55], v[240:243]
    ds_read_b64_tr_b16 v[26:27], v120 offset:13248
    s_waitcnt lgkmcnt(2)
    v_mfma_f32_16x16x32_bf16 v[128:131], v[16:19], v[36:39], v[128:131]
    ds_read_b64_tr_b16 v[28:29], v120 offset:12768
    v_mfma_f32_16x16x32_bf16 v[144:147], v[20:23], v[36:39], v[144:147]
    ds_read_b64_tr_b16 v[30:31], v120 offset:13280
    s_add_u32 m0, s60, 8448
    v_mfma_f32_16x16x32_bf16 v[148:151], v[20:23], v[40:43], v[148:151]
    buffer_load_dwordx4 v116, s[48:51], s61 offen offset:0 lds
    v_mfma_f32_16x16x32_bf16 v[132:135], v[16:19], v[40:43], v[132:135]
    v_mfma_f32_16x16x32_bf16 v[136:139], v[16:19], v[44:47], v[136:139]
    buffer_load_dwordx4 v117, s[48:51], s61 offen offset:1056 lds
    v_mfma_f32_16x16x32_bf16 v[152:155], v[20:23], v[44:47], v[152:155]
    v_mfma_f32_16x16x32_bf16 v[156:159], v[20:23], v[48:51], v[156:159]
    s_waitcnt vmcnt(14)
    ds_read_b64_tr_b16 v[20:21], v120 offset:16928
    v_mfma_f32_16x16x32_bf16 v[140:143], v[16:19], v[48:51], v[140:143]
    ds_read_b64_tr_b16 v[22:23], v120 offset:17440
    s_waitcnt lgkmcnt(2)
    v_mfma_f32_16x16x32_bf16 v[188:191], v[28:31], v[48:51], v[188:191]
    ds_read_b64_tr_b16 v[16:17], v120 offset:16896
    v_mfma_f32_16x16x32_bf16 v[172:175], v[24:27], v[48:51], v[172:175]
    ds_read_b64_tr_b16 v[18:19], v120 offset:17408
    v_mfma_f32_16x16x32_bf16 v[168:171], v[24:27], v[44:47], v[168:171]
    buffer_load_dwordx4 v118, s[48:51], s61 offen offset:2112 lds
    v_mfma_f32_16x16x32_bf16 v[184:187], v[28:31], v[44:47], v[184:187]
    v_mfma_f32_16x16x32_bf16 v[180:183], v[28:31], v[40:43], v[180:183]
    buffer_load_dwordx4 v119, s[48:51], s61 offen offset:3168 lds
    v_mfma_f32_16x16x32_bf16 v[164:167], v[24:27], v[40:43], v[164:167]
    v_mfma_f32_16x16x32_bf16 v[160:163], v[24:27], v[36:39], v[160:163]
    ds_read_b64_tr_b16 v[24:25], v120 offset:16960
    v_mfma_f32_16x16x32_bf16 v[176:179], v[28:31], v[36:39], v[176:179]
    ds_read_b64_tr_b16 v[26:27], v120 offset:17472
    s_waitcnt lgkmcnt(2)
    v_mfma_f32_16x16x32_bf16 v[192:195], v[16:19], v[36:39], v[192:195]
    ds_read_b64_tr_b16 v[28:29], v120 offset:16992
    v_mfma_f32_16x16x32_bf16 v[208:211], v[20:23], v[36:39], v[208:211]
    ds_read_b64_tr_b16 v[30:31], v120 offset:17504
    s_mov_b32 s61, 200704
    s_add_u32 m0, s60, 12672
    v_mfma_f32_16x16x32_bf16 v[212:215], v[20:23], v[40:43], v[212:215]
    buffer_load_dwordx4 v112, s[48:51], s61 offen offset:0 lds
    v_mfma_f32_16x16x32_bf16 v[196:199], v[16:19], v[40:43], v[196:199]
    ds_read_b128 v[52:55], v121 offset:20480
    v_mfma_f32_16x16x32_bf16 v[200:203], v[16:19], v[44:47], v[200:203]
    buffer_load_dwordx4 v113, s[48:51], s61 offen offset:1056 lds
    v_mfma_f32_16x16x32_bf16 v[216:219], v[20:23], v[44:47], v[216:219]
    ds_read_b128 v[56:59], v121 offset:20736
    v_mfma_f32_16x16x32_bf16 v[220:223], v[20:23], v[48:51], v[220:223]
    s_waitcnt vmcnt(14)
    ds_read_b64_tr_b16 v[20:21], v120 offset:21152
    v_mfma_f32_16x16x32_bf16 v[204:207], v[16:19], v[48:51], v[204:207]
    ds_read_b64_tr_b16 v[22:23], v120 offset:21664
    s_waitcnt lgkmcnt(4)
    v_mfma_f32_16x16x32_bf16 v[252:255], v[28:31], v[48:51], v[252:255]
    ds_read_b64_tr_b16 v[16:17], v120 offset:21120
    v_mfma_f32_16x16x32_bf16 v[236:239], v[24:27], v[48:51], v[236:239]
    ds_read_b64_tr_b16 v[18:19], v120 offset:21632
    v_mfma_f32_16x16x32_bf16 v[232:235], v[24:27], v[44:47], v[232:235]
    buffer_load_dwordx4 v114, s[48:51], s61 offen offset:2112 lds
    v_mfma_f32_16x16x32_bf16 v[248:251], v[28:31], v[44:47], v[248:251]
    ds_read_b128 v[60:63], v121 offset:20992
    v_mfma_f32_16x16x32_bf16 v[244:247], v[28:31], v[40:43], v[244:247]
    buffer_load_dwordx4 v115, s[48:51], s61 offen offset:3168 lds
    v_mfma_f32_16x16x32_bf16 v[228:231], v[24:27], v[40:43], v[228:231]
    ds_read_b128 v[64:67], v121 offset:21248
    v_mfma_f32_16x16x32_bf16 v[224:227], v[24:27], v[36:39], v[224:227]
    ds_read_b64_tr_b16 v[24:25], v120 offset:21184
    v_mfma_f32_16x16x32_bf16 v[240:243], v[28:31], v[36:39], v[240:243]
    ds_read_b64_tr_b16 v[26:27], v120 offset:21696
    s_waitcnt lgkmcnt(2)
    v_mfma_f32_16x16x32_bf16 v[128:131], v[16:19], v[52:55], v[128:131]
    ds_read_b64_tr_b16 v[28:29], v120 offset:21216
    v_mfma_f32_16x16x32_bf16 v[144:147], v[20:23], v[52:55], v[144:147]
    ds_read_b64_tr_b16 v[30:31], v120 offset:21728
    s_add_u32 m0, s60, 16896
    v_mfma_f32_16x16x32_bf16 v[148:151], v[20:23], v[56:59], v[148:151]
    buffer_load_dwordx4 v116, s[48:51], s61 offen offset:0 lds
    v_mfma_f32_16x16x32_bf16 v[132:135], v[16:19], v[56:59], v[132:135]
    v_mfma_f32_16x16x32_bf16 v[136:139], v[16:19], v[60:63], v[136:139]
    buffer_load_dwordx4 v117, s[48:51], s61 offen offset:1056 lds
    v_mfma_f32_16x16x32_bf16 v[152:155], v[20:23], v[60:63], v[152:155]
    v_mfma_f32_16x16x32_bf16 v[156:159], v[20:23], v[64:67], v[156:159]
    s_waitcnt vmcnt(14)
    ds_read_b64_tr_b16 v[20:21], v120 offset:32
    v_mfma_f32_16x16x32_bf16 v[140:143], v[16:19], v[64:67], v[140:143]
    ds_read_b64_tr_b16 v[22:23], v120 offset:544
    s_waitcnt lgkmcnt(2)
    v_mfma_f32_16x16x32_bf16 v[188:191], v[28:31], v[64:67], v[188:191]
    ds_read_b64_tr_b16 v[16:17], v120 offset:0
    v_mfma_f32_16x16x32_bf16 v[172:175], v[24:27], v[64:67], v[172:175]
    ds_read_b64_tr_b16 v[18:19], v120 offset:512
    v_mfma_f32_16x16x32_bf16 v[168:171], v[24:27], v[60:63], v[168:171]
    buffer_load_dwordx4 v118, s[48:51], s61 offen offset:2112 lds
    v_mfma_f32_16x16x32_bf16 v[184:187], v[28:31], v[60:63], v[184:187]
    v_mfma_f32_16x16x32_bf16 v[180:183], v[28:31], v[56:59], v[180:183]
    buffer_load_dwordx4 v119, s[48:51], s61 offen offset:3168 lds
    v_mfma_f32_16x16x32_bf16 v[164:167], v[24:27], v[56:59], v[164:167]
    v_mfma_f32_16x16x32_bf16 v[160:163], v[24:27], v[52:55], v[160:163]
    ds_read_b64_tr_b16 v[24:25], v120 offset:64
    v_mfma_f32_16x16x32_bf16 v[176:179], v[28:31], v[52:55], v[176:179]
    ds_read_b64_tr_b16 v[26:27], v120 offset:576
    s_waitcnt lgkmcnt(2)
    v_mfma_f32_16x16x32_bf16 v[192:195], v[16:19], v[52:55], v[192:195]
    ds_read_b64_tr_b16 v[28:29], v120 offset:96
    v_mfma_f32_16x16x32_bf16 v[208:211], v[20:23], v[52:55], v[208:211]
    ds_read_b64_tr_b16 v[30:31], v120 offset:608
    v_mfma_f32_16x16x32_bf16 v[212:215], v[20:23], v[56:59], v[212:215]
    v_mfma_f32_16x16x32_bf16 v[196:199], v[16:19], v[56:59], v[196:199]
    ds_read_b128 v[36:39], v121 offset:24576
    v_mfma_f32_16x16x32_bf16 v[200:203], v[16:19], v[60:63], v[200:203]
    v_mfma_f32_16x16x32_bf16 v[216:219], v[20:23], v[60:63], v[216:219]
    ds_read_b128 v[40:43], v121 offset:24832
    v_mfma_f32_16x16x32_bf16 v[220:223], v[20:23], v[64:67], v[220:223]
    s_waitcnt vmcnt(12)
    ds_read_b64_tr_b16 v[20:21], v120 offset:4256
    v_mfma_f32_16x16x32_bf16 v[204:207], v[16:19], v[64:67], v[204:207]
    ds_read_b64_tr_b16 v[22:23], v120 offset:4768
    s_waitcnt lgkmcnt(4)
    v_mfma_f32_16x16x32_bf16 v[252:255], v[28:31], v[64:67], v[252:255]
    ds_read_b64_tr_b16 v[16:17], v120 offset:4224
    v_mfma_f32_16x16x32_bf16 v[236:239], v[24:27], v[64:67], v[236:239]
    ds_read_b64_tr_b16 v[18:19], v120 offset:4736
    v_mfma_f32_16x16x32_bf16 v[232:235], v[24:27], v[60:63], v[232:235]
    v_mfma_f32_16x16x32_bf16 v[248:251], v[28:31], v[60:63], v[248:251]
    ds_read_b128 v[44:47], v121 offset:25088
    v_mfma_f32_16x16x32_bf16 v[244:247], v[28:31], v[56:59], v[244:247]
    v_mfma_f32_16x16x32_bf16 v[228:231], v[24:27], v[56:59], v[228:231]
    ds_read_b128 v[48:51], v121 offset:25344
    v_mfma_f32_16x16x32_bf16 v[224:227], v[24:27], v[52:55], v[224:227]
    ds_read_b64_tr_b16 v[24:25], v120 offset:4288
    v_mfma_f32_16x16x32_bf16 v[240:243], v[28:31], v[52:55], v[240:243]
    ds_read_b64_tr_b16 v[26:27], v120 offset:4800
    s_waitcnt lgkmcnt(2)
    v_mfma_f32_16x16x32_bf16 v[128:131], v[16:19], v[36:39], v[128:131]
    ds_read_b64_tr_b16 v[28:29], v120 offset:4320
    v_mfma_f32_16x16x32_bf16 v[144:147], v[20:23], v[36:39], v[144:147]
    ds_read_b64_tr_b16 v[30:31], v120 offset:4832
    v_mfma_f32_16x16x32_bf16 v[148:151], v[20:23], v[40:43], v[148:151]
    v_mfma_f32_16x16x32_bf16 v[132:135], v[16:19], v[40:43], v[132:135]
    v_mfma_f32_16x16x32_bf16 v[136:139], v[16:19], v[44:47], v[136:139]
    v_mfma_f32_16x16x32_bf16 v[152:155], v[20:23], v[44:47], v[152:155]
    v_mfma_f32_16x16x32_bf16 v[156:159], v[20:23], v[48:51], v[156:159]
    s_waitcnt vmcnt(8)
    ds_read_b64_tr_b16 v[20:21], v120 offset:8480
    v_mfma_f32_16x16x32_bf16 v[140:143], v[16:19], v[48:51], v[140:143]
    ds_read_b64_tr_b16 v[22:23], v120 offset:8992
    s_waitcnt lgkmcnt(2)
    v_mfma_f32_16x16x32_bf16 v[188:191], v[28:31], v[48:51], v[188:191]
    ds_read_b64_tr_b16 v[16:17], v120 offset:8448
    v_mfma_f32_16x16x32_bf16 v[172:175], v[24:27], v[48:51], v[172:175]
    ds_read_b64_tr_b16 v[18:19], v120 offset:8960
    v_mfma_f32_16x16x32_bf16 v[168:171], v[24:27], v[44:47], v[168:171]
    v_mfma_f32_16x16x32_bf16 v[184:187], v[28:31], v[44:47], v[184:187]
    v_mfma_f32_16x16x32_bf16 v[180:183], v[28:31], v[40:43], v[180:183]
    v_mfma_f32_16x16x32_bf16 v[164:167], v[24:27], v[40:43], v[164:167]
    v_mfma_f32_16x16x32_bf16 v[160:163], v[24:27], v[36:39], v[160:163]
    ds_read_b64_tr_b16 v[24:25], v120 offset:8512
    v_mfma_f32_16x16x32_bf16 v[176:179], v[28:31], v[36:39], v[176:179]
    ds_read_b64_tr_b16 v[26:27], v120 offset:9024
    s_waitcnt lgkmcnt(2)
    v_mfma_f32_16x16x32_bf16 v[192:195], v[16:19], v[36:39], v[192:195]
    ds_read_b64_tr_b16 v[28:29], v120 offset:8544
    v_mfma_f32_16x16x32_bf16 v[208:211], v[20:23], v[36:39], v[208:211]
    ds_read_b64_tr_b16 v[30:31], v120 offset:9056
    v_mfma_f32_16x16x32_bf16 v[212:215], v[20:23], v[40:43], v[212:215]
    v_mfma_f32_16x16x32_bf16 v[196:199], v[16:19], v[40:43], v[196:199]
    ds_read_b128 v[52:55], v121 offset:28672
    v_mfma_f32_16x16x32_bf16 v[200:203], v[16:19], v[44:47], v[200:203]
    v_mfma_f32_16x16x32_bf16 v[216:219], v[20:23], v[44:47], v[216:219]
    s_waitcnt lgkmcnt(1)
    s_barrier
    ds_read_b128 v[56:59], v121 offset:28928
    v_subrev_u32 v6, 32, v3
    s_lshl_b32 s27, s19, 5
    s_add_u32 s27, s27, s20
    v_mfma_f32_16x16x32_bf16 v[220:223], v[20:23], v[48:51], v[220:223]
    s_waitcnt vmcnt(4)
    ds_read_b64_tr_b16 v[20:21], v120 offset:12704
    v_subrev_u32 v7, 64, v3
    s_mul_i32 s27, s27, 57344
    s_lshl_b32 s28, s16, 14
    v_mfma_f32_16x16x32_bf16 v[204:207], v[16:19], v[48:51], v[204:207]
    ds_read_b64_tr_b16 v[22:23], v120 offset:13216
    v_subrev_u32 v8, 96, v3
    s_add_u32 s27, s27, s28
    s_add_u32 s30, s27, 0
    v_mfma_f32_16x16x32_bf16 v[252:255], v[28:31], v[48:51], v[252:255]
    ds_read_b64_tr_b16 v[16:17], v120 offset:12672
    v_subrev_u32 v9, 32, v4
    v_mfma_f32_16x16x32_bf16 v[236:239], v[24:27], v[48:51], v[236:239]
    ds_read_b64_tr_b16 v[18:19], v120 offset:13184
    v_subrev_u32 v10, 64, v4
    v_mfma_f32_16x16x32_bf16 v[232:235], v[24:27], v[44:47], v[232:235]
    v_subrev_u32 v11, 96, v4
    s_mov_b32 m0, s74
    v_lshlrev_b32 v5, 4, v0
    s_movk_i32 s29, 0x1000
    s_cmp_eq_u32 s16, 3
    s_cselect_b32 s29, 0x40000000, s29
    v_mfma_f32_16x16x32_bf16 v[248:251], v[28:31], v[44:47], v[248:251]
    ds_read_b128 v[60:63], v121 offset:29184
    buffer_load_dwordx4 v3, s[64:67], 0 offen offset:0 lds
L_pg6:
    s_cbranch_execz L_pg10
    v_mfma_f32_16x16x32_bf16 v[244:247], v[28:31], v[40:43], v[244:247]
    v_mfma_f32_16x16x32_bf16 v[228:231], v[24:27], v[40:43], v[228:231]
    ds_read_b128 v[64:67], v121 offset:29440
    v_mfma_f32_16x16x32_bf16 v[224:227], v[24:27], v[36:39], v[224:227]
    ds_read_b64_tr_b16 v[24:25], v120 offset:12736
    buffer_load_dwordx4 v6, s[64:67], 0 offen offset:1056 lds
    v_mfma_f32_16x16x32_bf16 v[240:243], v[28:31], v[36:39], v[240:243]
    ds_read_b64_tr_b16 v[26:27], v120 offset:13248
    s_waitcnt lgkmcnt(2)
    v_mfma_f32_16x16x32_bf16 v[128:131], v[16:19], v[52:55], v[128:131]
    ds_read_b64_tr_b16 v[28:29], v120 offset:12768
    v_mfma_f32_16x16x32_bf16 v[144:147], v[20:23], v[52:55], v[144:147]
    ds_read_b64_tr_b16 v[30:31], v120 offset:13280
    buffer_load_dwordx4 v7, s[64:67], 0 offen offset:2112 lds
    v_mfma_f32_16x16x32_bf16 v[148:151], v[20:23], v[56:59], v[148:151]
    v_mfma_f32_16x16x32_bf16 v[132:135], v[16:19], v[56:59], v[132:135]
    v_mfma_f32_16x16x32_bf16 v[136:139], v[16:19], v[60:63], v[136:139]
    buffer_load_dwordx4 v8, s[64:67], 0 offen offset:3168 lds
    v_mfma_f32_16x16x32_bf16 v[152:155], v[20:23], v[60:63], v[152:155]
    v_mfma_f32_16x16x32_bf16 v[156:159], v[20:23], v[64:67], v[156:159]
    s_waitcnt vmcnt(4)
    ds_read_b64_tr_b16 v[20:21], v120 offset:16928
    s_mov_b32 m0, s75
    v_mfma_f32_16x16x32_bf16 v[140:143], v[16:19], v[64:67], v[140:143]
    ds_read_b64_tr_b16 v[22:23], v120 offset:17440
    buffer_load_dwordx4 v3, s[68:71], 0 offen offset:0 lds
    s_waitcnt lgkmcnt(2)
    v_mfma_f32_16x16x32_bf16 v[188:191], v[28:31], v[64:67], v[188:191]
    ds_read_b64_tr_b16 v[16:17], v120 offset:16896
    v_mfma_f32_16x16x32_bf16 v[172:175], v[24:27], v[64:67], v[172:175]
    ds_read_b64_tr_b16 v[18:19], v120 offset:17408
    v_mfma_f32_16x16x32_bf16 v[168:171], v[24:27], v[60:63], v[168:171]
    buffer_load_dwordx4 v6, s[68:71], 0 offen offset:1056 lds
    v_mfma_f32_16x16x32_bf16 v[184:187], v[28:31], v[60:63], v[184:187]
    v_mfma_f32_16x16x32_bf16 v[180:183], v[28:31], v[56:59], v[180:183]
    v_mfma_f32_16x16x32_bf16 v[164:167], v[24:27], v[56:59], v[164:167]
    buffer_load_dwordx4 v7, s[68:71], 0 offen offset:2112 lds
    v_mfma_f32_16x16x32_bf16 v[160:163], v[24:27], v[52:55], v[160:163]
    ds_read_b64_tr_b16 v[24:25], v120 offset:16960
    v_mfma_f32_16x16x32_bf16 v[176:179], v[28:31], v[52:55], v[176:179]
    ds_read_b64_tr_b16 v[26:27], v120 offset:17472
    s_waitcnt lgkmcnt(2)
    v_mfma_f32_16x16x32_bf16 v[192:195], v[16:19], v[52:55], v[192:195]
    ds_read_b64_tr_b16 v[28:29], v120 offset:16992
    buffer_load_dwordx4 v8, s[68:71], 0 offen offset:3168 lds
    v_mfma_f32_16x16x32_bf16 v[208:211], v[20:23], v[52:55], v[208:211]
    ds_read_b64_tr_b16 v[30:31], v120 offset:17504
    v_mfma_f32_16x16x32_bf16 v[212:215], v[20:23], v[56:59], v[212:215]
    v_mfma_f32_16x16x32_bf16 v[196:199], v[16:19], v[56:59], v[196:199]
    v_mfma_f32_16x16x32_bf16 v[200:203], v[16:19], v[60:63], v[200:203]
    v_mfma_f32_16x16x32_bf16 v[216:219], v[20:23], v[60:63], v[216:219]
    v_mfma_f32_16x16x32_bf16 v[220:223], v[20:23], v[64:67], v[220:223]
    v_mfma_f32_16x16x32_bf16 v[204:207], v[16:19], v[64:67], v[204:207]
    s_waitcnt lgkmcnt(0)
    v_mfma_f32_16x16x32_bf16 v[252:255], v[28:31], v[64:67], v[252:255]
    v_mfma_f32_16x16x32_bf16 v[236:239], v[24:27], v[64:67], v[236:239]
    v_mfma_f32_16x16x32_bf16 v[232:235], v[24:27], v[60:63], v[232:235]
    v_mfma_f32_16x16x32_bf16 v[248:251], v[28:31], v[60:63], v[248:251]
    v_mfma_f32_16x16x32_bf16 v[244:247], v[28:31], v[56:59], v[244:247]
    v_mfma_f32_16x16x32_bf16 v[228:231], v[24:27], v[56:59], v[228:231]
    v_mfma_f32_16x16x32_bf16 v[224:227], v[24:27], v[52:55], v[224:227]
    v_mfma_f32_16x16x32_bf16 v[240:243], v[28:31], v[52:55], v[240:243]
    s_waitcnt lgkmcnt(0) vmcnt(0)
    s_barrier
    ds_read_b128 v[16:19], v1 offset:33792
    ds_read_b128 v[20:23], v1 offset:33856
    ds_read_b128 v[24:27], v1 offset:42240
    ds_read_b128 v[28:31], v1 offset:42304
    s_waitcnt lgkmcnt(2)
    v_mfma_f32_16x16x32_bf16 v[64:67], v[16:19], a[0:3], 0
    s_mov_b32 m0, s72
    v_cvt_pk_bf16_f32 v128, v128, v129
    v_cvt_pk_bf16_f32 v129, v130, v131
    v_mfma_f32_16x16x32_bf16 v[64:67], v[20:23], a[4:7], v[64:67]
    buffer_load_dwordx4 v3, s[64:67], s63 offen offset:0 lds
    v_cvt_pk_bf16_f32 v130, v144, v145
    v_mfma_f32_16x16x32_bf16 v[72:75], v[16:19], a[32:35], 0
    v_cvt_pk_bf16_f32 v131, v146, v147
    v_cvt_pk_bf16_f32 v132, v132, v133
    v_mfma_f32_16x16x32_bf16 v[72:75], v[20:23], a[36:39], v[72:75]
    buffer_load_dwordx4 v6, s[64:67], s63 offen offset:1056 lds
    v_cvt_pk_bf16_f32 v133, v134, v135
    v_mfma_f32_16x16x32_bf16 v[80:83], v[16:19], a[64:67], 0
    v_cvt_pk_bf16_f32 v134, v148, v149
    v_cvt_pk_bf16_f32 v135, v150, v151
    v_mfma_f32_16x16x32_bf16 v[80:83], v[20:23], a[68:71], v[80:83]
    buffer_load_dwordx4 v7, s[64:67], s63 offen offset:2112 lds
    v_cvt_pk_bf16_f32 v136, v136, v137
    v_mfma_f32_16x16x32_bf16 v[88:91], v[16:19], a[96:99], 0
    ds_read_b128 v[16:19], v1 offset:33920
    v_cvt_pk_bf16_f32 v137, v138, v139
    v_mfma_f32_16x16x32_bf16 v[88:91], v[20:23], a[100:103], v[88:91]
    ds_read_b128 v[20:23], v1 offset:33984
    buffer_load_dwordx4 v8, s[64:67], s63 offen offset:3168 lds
    s_waitcnt lgkmcnt(2)
    v_mfma_f32_16x16x32_bf16 v[68:71], v[24:27], a[0:3], 0
    s_mov_b32 m0, s73
    v_cvt_pk_bf16_f32 v138, v152, v153
    v_cvt_pk_bf16_f32 v139, v154, v155
    v_mfma_f32_16x16x32_bf16 v[68:71], v[28:31], a[4:7], v[68:71]
    buffer_load_dwordx4 v3, s[68:71], s63 offen offset:0 lds
    v_cvt_pk_bf16_f32 v140, v140, v141
    v_mfma_f32_16x16x32_bf16 v[76:79], v[24:27], a[32:35], 0
    v_cvt_pk_bf16_f32 v141, v142, v143
    v_cvt_pk_bf16_f32 v142, v156, v157
    v_mfma_f32_16x16x32_bf16 v[76:79], v[28:31], a[36:39], v[76:79]
    buffer_load_dwordx4 v6, s[68:71], s63 offen offset:1056 lds
    v_cvt_pk_bf16_f32 v143, v158, v159
    v_mfma_f32_16x16x32_bf16 v[84:87], v[24:27], a[64:67], 0
    v_cvt_pk_bf16_f32 v160, v160, v161
    v_cvt_pk_bf16_f32 v161, v162, v163
    v_mfma_f32_16x16x32_bf16 v[84:87], v[28:31], a[68:71], v[84:87]
    buffer_load_dwordx4 v7, s[68:71], s63 offen offset:2112 lds
    v_cvt_pk_bf16_f32 v162, v176, v177
    v_mfma_f32_16x16x32_bf16 v[92:95], v[24:27], a[96:99], 0
    ds_read_b128 v[24:27], v1 offset:42368
    v_cvt_pk_bf16_f32 v163, v178, v179
    v_mfma_f32_16x16x32_bf16 v[92:95], v[28:31], a[100:103], v[92:95]
    ds_read_b128 v[28:31], v1 offset:42432
    buffer_load_dwordx4 v8, s[68:71], s63 offen offset:3168 lds
    s_waitcnt lgkmcnt(2)
    v_mfma_f32_16x16x32_bf16 v[64:67], v[16:19], a[8:11], v[64:67]
    v_cvt_pk_bf16_f32 v164, v164, v165
    v_cvt_pk_bf16_f32 v165, v166, v167
    v_mfma_f32_16x16x32_bf16 v[64:67], v[20:23], a[12:15], v[64:67]
    v_cvt_pk_bf16_f32 v166, v180, v181
    v_cvt_pk_bf16_f32 v167, v182, v183
    v_mfma_f32_16x16x32_bf16 v[72:75], v[16:19], a[40:43], v[72:75]
    v_cvt_pk_bf16_f32 v168, v168, v169
    v_cvt_pk_bf16_f32 v169, v170, v171
    v_mfma_f32_16x16x32_bf16 v[72:75], v[20:23], a[44:47], v[72:75]
    v_cvt_pk_bf16_f32 v170, v184, v185
    v_cvt_pk_bf16_f32 v171, v186, v187
    v_mfma_f32_16x16x32_bf16 v[80:83], v[16:19], a[72:75], v[80:83]
    v_cvt_pk_bf16_f32 v172, v172, v173
    v_cvt_pk_bf16_f32 v173, v174, v175
    v_mfma_f32_16x16x32_bf16 v[80:83], v[20:23], a[76:79], v[80:83]
    v_cvt_pk_bf16_f32 v174, v188, v189
    v_cvt_pk_bf16_f32 v175, v190, v191
    s_mov_b32 m0, s76
    v_mfma_f32_16x16x32_bf16 v[88:91], v[16:19], a[104:107], v[88:91]
    ds_read_b128 v[16:19], v1 offset:34048
    buffer_load_dwordx4 v4, s[8:11], 0 offen offset:0 lds
    v_mfma_f32_16x16x32_bf16 v[88:91], v[20:23], a[108:111], v[88:91]
    ds_read_b128 v[20:23], v1 offset:34112
    s_waitcnt lgkmcnt(2)
    v_mfma_f32_16x16x32_bf16 v[68:71], v[24:27], a[8:11], v[68:71]
    buffer_store_dwordx4 v[128:131], v5, s[32:35], s30 offen offset:0 sc1
    v_mfma_f32_16x16x32_bf16 v[68:71], v[28:31], a[12:15], v[68:71]
    v_mfma_f32_16x16x32_bf16 v[76:79], v[24:27], a[40:43], v[76:79]
    buffer_load_dwordx4 v9, s[8:11], 0 offen offset:1056 lds
    v_mfma_f32_16x16x32_bf16 v[76:79], v[28:31], a[44:47], v[76:79]
    v_mfma_f32_16x16x32_bf16 v[84:87], v[24:27], a[72:75], v[84:87]
    buffer_store_dwordx4 v[132:135], v5, s[32:35], s30 offen offset:1024 sc1
    v_mfma_f32_16x16x32_bf16 v[84:87], v[28:31], a[76:79], v[84:87]
    v_mfma_f32_16x16x32_bf16 v[92:95], v[24:27], a[104:107], v[92:95]
    ds_read_b128 v[24:27], v1 offset:42496
    buffer_load_dwordx4 v10, s[8:11], 0 offen offset:2112 lds
    v_mfma_f32_16x16x32_bf16 v[92:95], v[28:31], a[108:111], v[92:95]
    ds_read_b128 v[28:31], v1 offset:42560
    s_waitcnt lgkmcnt(2)
    v_mfma_f32_16x16x32_bf16 v[64:67], v[16:19], a[16:19], v[64:67]
    buffer_store_dwordx4 v[136:139], v5, s[32:35], s30 offen offset:2048 sc1
    v_mfma_f32_16x16x32_bf16 v[64:67], v[20:23], a[20:23], v[64:67]
    v_mfma_f32_16x16x32_bf16 v[72:75], v[16:19], a[48:51], v[72:75]
    buffer_load_dwordx4 v11, s[8:11], 0 offen offset:3168 lds
    v_mfma_f32_16x16x32_bf16 v[72:75], v[20:23], a[52:55], v[72:75]
    v_mfma_f32_16x16x32_bf16 v[80:83], v[16:19], a[80:83], v[80:83]
    buffer_store_dwordx4 v[140:143], v5, s[32:35], s30 offen offset:3072 sc1
    v_mfma_f32_16x16x32_bf16 v[80:83], v[20:23], a[84:87], v[80:83]
    s_mov_b32 m0, s77
    v_mfma_f32_16x16x32_bf16 v[88:91], v[16:19], a[112:115], v[88:91]
    ds_read_b128 v[16:19], v1 offset:34176
    buffer_load_dwordx4 v4, s[80:83], 0 offen offset:0 lds
    s_add_u32 s30, s30, 0x1000
    v_mfma_f32_16x16x32_bf16 v[88:91], v[20:23], a[116:119], v[88:91]
    ds_read_b128 v[20:23], v1 offset:34240
    v_cvt_pk_bf16_f32 v192, v192, v193
    s_waitcnt lgkmcnt(2)
    v_mfma_f32_16x16x32_bf16 v[68:71], v[24:27], a[16:19], v[68:71]
    buffer_store_dwordx4 v[160:163], v5, s[32:35], s30 offen offset:0 sc1
    v_cvt_pk_bf16_f32 v193, v194, v195
    v_mfma_f32_16x16x32_bf16 v[68:71], v[28:31], a[20:23], v[68:71]
    v_cvt_pk_bf16_f32 v194, v208, v209
    v_cvt_pk_bf16_f32 v195, v210, v211
    v_mfma_f32_16x16x32_bf16 v[76:79], v[24:27], a[48:51], v[76:79]
    buffer_load_dwordx4 v9, s[80:83], 0 offen offset:1056 lds
    v_cvt_pk_bf16_f32 v196, v196, v197
    v_mfma_f32_16x16x32_bf16 v[76:79], v[28:31], a[52:55], v[76:79]
    v_cvt_pk_bf16_f32 v197, v198, v199
    v_cvt_pk_bf16_f32 v198, v212, v213
    v_mfma_f32_16x16x32_bf16 v[84:87], v[24:27], a[80:83], v[84:87]
    buffer_store_dwordx4 v[164:167], v5, s[32:35], s30 offen offset:1024 sc1
    v_cvt_pk_bf16_f32 v199, v214, v215
    v_mfma_f32_16x16x32_bf16 v[84:87], v[28:31], a[84:87], v[84:87]
    v_cvt_pk_bf16_f32 v200, v200, v201
    v_cvt_pk_bf16_f32 v201, v202, v203
    v_mfma_f32_16x16x32_bf16 v[92:95], v[24:27], a[112:115], v[92:95]
    ds_read_b128 v[24:27], v1 offset:42624
    buffer_load_dwordx4 v10, s[80:83], 0 offen offset:2112 lds
    v_mfma_f32_16x16x32_bf16 v[92:95], v[28:31], a[116:119], v[92:95]
    ds_read_b128 v[28:31], v1 offset:42688
    v_cvt_pk_bf16_f32 v202, v216, v217
    s_waitcnt lgkmcnt(2)
    v_mfma_f32_16x16x32_bf16 v[64:67], v[16:19], a[24:27], v[64:67]
    buffer_store_dwordx4 v[168:171], v5, s[32:35], s30 offen offset:2048 sc1
    v_cvt_pk_bf16_f32 v203, v218, v219
    v_mfma_f32_16x16x32_bf16 v[64:67], v[20:23], a[28:31], v[64:67]
    v_cvt_pk_bf16_f32 v204, v204, v205
    v_cvt_pk_bf16_f32 v205, v206, v207
    v_mfma_f32_16x16x32_bf16 v[72:75], v[16:19], a[56:59], v[72:75]
    buffer_load_dwordx4 v11, s[80:83], 0 offen offset:3168 lds
    v_cvt_pk_bf16_f32 v206, v220, v221
    v_mfma_f32_16x16x32_bf16 v[72:75], v[20:23], a[60:63], v[72:75]
    v_cvt_pk_bf16_f32 v207, v222, v223
    v_cvt_pk_bf16_f32 v224, v224, v225
    v_mfma_f32_16x16x32_bf16 v[80:83], v[16:19], a[88:91], v[80:83]
    buffer_store_dwordx4 v[172:175], v5, s[32:35], s30 offen offset:3072 sc1
    v_cvt_pk_bf16_f32 v225, v226, v227
    v_mfma_f32_16x16x32_bf16 v[80:83], v[20:23], a[92:95], v[80:83]
    v_cvt_pk_bf16_f32 v226, v240, v241
    v_cvt_pk_bf16_f32 v227, v242, v243
    v_mfma_f32_16x16x32_bf16 v[88:91], v[16:19], a[120:123], v[88:91]
    v_cvt_pk_bf16_f32 v228, v228, v229
    v_cvt_pk_bf16_f32 v229, v230, v231
    v_mfma_f32_16x16x32_bf16 v[88:91], v[20:23], a[124:127], v[88:91]
    s_waitcnt lgkmcnt(0) vmcnt(16)
    s_barrier
    v_cvt_pk_bf16_f32 v230, v244, v245
    v_cvt_pk_bf16_f32 v231, v246, v247
    v_mfma_f32_16x16x32_bf16 v[68:71], v[24:27], a[24:27], v[68:71]
    v_cvt_pk_bf16_f32 v232, v232, v233
    v_cvt_pk_bf16_f32 v233, v234, v235
    v_mfma_f32_16x16x32_bf16 v[68:71], v[28:31], a[28:31], v[68:71]
    v_cvt_pk_bf16_f32 v234, v248, v249
    v_cvt_pk_bf16_f32 v235, v250, v251
    v_mfma_f32_16x16x32_bf16 v[76:79], v[24:27], a[56:59], v[76:79]
    v_cvt_pk_bf16_f32 v236, v236, v237
    v_cvt_pk_bf16_f32 v237, v238, v239
    v_mfma_f32_16x16x32_bf16 v[76:79], v[28:31], a[60:63], v[76:79]
    v_cvt_pk_bf16_f32 v238, v252, v253
    v_cvt_pk_bf16_f32 v239, v254, v255
    v_mfma_f32_16x16x32_bf16 v[84:87], v[24:27], a[88:91], v[84:87]
    v_mfma_f32_16x16x32_bf16 v[84:87], v[28:31], a[92:95], v[84:87]
    v_mfma_f32_16x16x32_bf16 v[92:95], v[24:27], a[120:123], v[92:95]
    v_mfma_f32_16x16x32_bf16 v[92:95], v[28:31], a[124:127], v[92:95]
    ds_read_b128 v[16:19], v1 offset:0
    ds_read_b128 v[20:23], v1 offset:64
    ds_read_b128 v[24:27], v1 offset:8448
    ds_read_b128 v[28:31], v1 offset:8512
    s_nop 3
    v_max3_f32 v36, v64, v65, v66
    v_max3_f32 v37, v72, v73, v74
    v_max3_f32 v38, v80, v81, v82
    s_add_u32 s64, s64, 32768
    s_addc_u32 s65, s65, 0
    s_sub_u32 s66, s66, 32768
    v_max3_f32 v39, v88, v89, v90
    v_max3_f32 v36, v36, v67, v68
    v_max3_f32 v37, v37, v75, v76
    v_max3_f32 v38, v38, v83, v84
    s_add_u32 s68, s68, 32768
    s_addc_u32 s69, s69, 0
    s_sub_u32 s70, s70, 32768
    s_mov_b32 m0, s74
    v_max3_f32 v39, v39, v91, v92
    v_max3_f32 v36, v36, v69, v70
    v_max3_f32 v37, v37, v77, v78
    v_max3_f32 v38, v38, v85, v86
    buffer_load_dwordx4 v3, s[64:67], 0 offen offset:0 lds
    v_max3_f32 v39, v39, v93, v94
    v_max_f32 v36, v36, v71
    v_max_f32 v37, v37, v79
    v_max_f32 v38, v38, v87
    buffer_load_dwordx4 v6, s[64:67], 0 offen offset:1056 lds
    v_max_f32 v39, v39, v95
    v_mov_b32 v40, v36
    v_mov_b32 v41, v37
    v_mov_b32 v42, v38
    buffer_load_dwordx4 v7, s[64:67], 0 offen offset:2112 lds
    v_mov_b32 v43, v39
    s_nop 0
    v_permlane16_swap_b32 v40, v36
    v_permlane16_swap_b32 v41, v37
    buffer_load_dwordx4 v8, s[64:67], 0 offen offset:3168 lds
    s_mov_b32 m0, s75
    v_permlane16_swap_b32 v42, v38
    v_permlane16_swap_b32 v43, v39
    v_max_f32 v36, v36, v40
    v_max_f32 v37, v37, v41
    buffer_load_dwordx4 v3, s[68:71], 0 offen offset:0 lds
    v_max_f32 v38, v38, v42
    v_max_f32 v39, v39, v43
    v_mov_b32 v40, v36
    v_mov_b32 v41, v37
    buffer_load_dwordx4 v6, s[68:71], 0 offen offset:1056 lds
    v_mov_b32 v42, v38
    v_mov_b32 v43, v39
    s_nop 0
    v_permlane32_swap_b32 v40, v36
    buffer_load_dwordx4 v7, s[68:71], 0 offen offset:2112 lds
    v_permlane32_swap_b32 v41, v37
    v_permlane32_swap_b32 v42, v38
    v_permlane32_swap_b32 v43, v39
    v_max_f32 v36, v36, v40
    buffer_load_dwordx4 v8, s[68:71], 0 offen offset:3168 lds
    s_add_u32 s30, s30, s29
    v_max_f32 v37, v37, v41
    v_max_f32 v38, v38, v42
    v_max_f32 v39, v39, v43
    v_pk_add_f32 v[64:65], v[64:65], v[36:37] op_sel:[0,0] op_sel_hi:[1,0] neg_lo:[0,1] neg_hi:[0,1]
    buffer_store_dwordx4 v[192:195], v5, s[32:35], s30 offen offset:0 sc1
    v_pk_add_f32 v[66:67], v[66:67], v[36:37] op_sel:[0,0] op_sel_hi:[1,0] neg_lo:[0,1] neg_hi:[0,1]
    v_pk_add_f32 v[68:69], v[68:69], v[36:37] op_sel:[0,0] op_sel_hi:[1,0] neg_lo:[0,1] neg_hi:[0,1]
    v_pk_add_f32 v[70:71], v[70:71], v[36:37] op_sel:[0,0] op_sel_hi:[1,0] neg_lo:[0,1] neg_hi:[0,1]
    v_sub_f32 v48, 0, v36
    buffer_store_dwordx4 v[196:199], v5, s[32:35], s30 offen offset:1024 sc1
    v_sub_f32 v49, 0, v36
    v_sub_f32 v50, 0, v36
    v_sub_f32 v51, 0, v36
    v_mov_b32 v44, 0
    v_pk_add_f32 v[72:73], v[72:73], v[36:37] op_sel:[0,1] op_sel_hi:[1,1] neg_lo:[0,1] neg_hi:[0,1]
    v_pk_add_f32 v[74:75], v[74:75], v[36:37] op_sel:[0,1] op_sel_hi:[1,1] neg_lo:[0,1] neg_hi:[0,1]
    v_pk_add_f32 v[76:77], v[76:77], v[36:37] op_sel:[0,1] op_sel_hi:[1,1] neg_lo:[0,1] neg_hi:[0,1]
    v_pk_add_f32 v[78:79], v[78:79], v[36:37] op_sel:[0,1] op_sel_hi:[1,1] neg_lo:[0,1] neg_hi:[0,1]
    v_sub_f32 v52, 0, v37
    v_sub_f32 v53, 0, v37
    v_sub_f32 v54, 0, v37
    v_sub_f32 v55, 0, v37
    v_mov_b32 v45, 0
    v_pk_add_f32 v[80:81], v[80:81], v[38:39] op_sel:[0,0] op_sel_hi:[1,0] neg_lo:[0,1] neg_hi:[0,1]
    v_pk_add_f32 v[82:83], v[82:83], v[38:39] op_sel:[0,0] op_sel_hi:[1,0] neg_lo:[0,1] neg_hi:[0,1]
    v_pk_add_f32 v[84:85], v[84:85], v[38:39] op_sel:[0,0] op_sel_hi:[1,0] neg_lo:[0,1] neg_hi:[0,1]
    v_pk_add_f32 v[86:87], v[86:87], v[38:39] op_sel:[0,0] op_sel_hi:[1,0] neg_lo:[0,1] neg_hi:[0,1]
    v_sub_f32 v56, 0, v38
    v_sub_f32 v57, 0, v38
    v_sub_f32 v58, 0, v38
    v_sub_f32 v59, 0, v38
    v_mov_b32 v46, 0
    v_pk_add_f32 v[88:89], v[88:89], v[38:39] op_sel:[0,1] op_sel_hi:[1,1] neg_lo:[0,1] neg_hi:[0,1]
    v_pk_add_f32 v[90:91], v[90:91], v[38:39] op_sel:[0,1] op_sel_hi:[1,1] neg_lo:[0,1] neg_hi:[0,1]
    v_pk_add_f32 v[92:93], v[92:93], v[38:39] op_sel:[0,1] op_sel_hi:[1,1] neg_lo:[0,1] neg_hi:[0,1]
    v_pk_add_f32 v[94:95], v[94:95], v[38:39] op_sel:[0,1] op_sel_hi:[1,1] neg_lo:[0,1] neg_hi:[0,1]
    v_sub_f32 v60, 0, v39
    v_sub_f32 v61, 0, v39
    v_sub_f32 v62, 0, v39
    v_sub_f32 v63, 0, v39
    v_mov_b32 v47, 0
    v_exp_f32 v64, v64
    v_exp_f32 v65, v65
    v_add_f32 v12, v44, v64
    v_exp_f32 v66, v66
    v_add_f32 v12, v12, v65
    v_cvt_pk_bf16_f32 v64, v64, v65
    v_exp_f32 v67, v67
    v_add_f32 v12, v12, v66
    v_exp_f32 v68, v68
    v_add_f32 v12, v12, v67
    v_cvt_pk_bf16_f32 v65, v66, v67
    v_exp_f32 v69, v69
    v_add_f32 v12, v12, v68
    v_exp_f32 v70, v70
    v_add_f32 v12, v12, v69
    v_cvt_pk_bf16_f32 v66, v68, v69
    v_exp_f32 v71, v71
    v_add_f32 v12, v12, v70
    v_exp_f32 v72, v72
    v_add_f32 v12, v12, v71
    v_cvt_pk_bf16_f32 v67, v70, v71
    v_exp_f32 v73, v73
    v_add_f32 v13, v45, v72
    s_nop 0
    v_add_f32 v13, v13, v73
    v_cvt_pk_bf16_f32 v72, v72, v73
    s_waitcnt lgkmcnt(2)
    v_mfma_f32_16x16x32_bf16 v[96:99], v[16:19], a[0:3], v[48:51]
    v_exp_f32 v74, v74
    v_mfma_f32_16x16x32_bf16 v[96:99], v[20:23], a[4:7], v[96:99]
    buffer_store_dwordx4 v[200:203], v5, s[32:35], s30 offen offset:2048 sc1
    v_add_f32 v13, v13, v74
    v_mfma_f32_16x16x32_bf16 v[104:107], v[16:19], a[32:35], v[52:55]
    v_mfma_f32_16x16x32_bf16 v[104:107], v[20:23], a[36:39], v[104:107]
    v_exp_f32 v75, v75
    v_mfma_f32_16x16x32_bf16 v[112:115], v[16:19], a[64:67], v[56:59]
    v_add_f32 v13, v13, v75
    v_cvt_pk_bf16_f32 v73, v74, v75
    v_mfma_f32_16x16x32_bf16 v[112:115], v[20:23], a[68:71], v[112:115]
    v_exp_f32 v76, v76
    v_mfma_f32_16x16x32_bf16 v[120:123], v[16:19], a[96:99], v[60:63]
    ds_read_b128 v[16:19], v1 offset:128
    buffer_store_dwordx4 v[204:207], v5, s[32:35], s30 offen offset:3072 sc1
    s_add_u32 s30, s30, 0x1000
    v_mfma_f32_16x16x32_bf16 v[120:123], v[20:23], a[100:103], v[120:123]
    ds_read_b128 v[20:23], v1 offset:192
    s_waitcnt lgkmcnt(2)
    v_mfma_f32_16x16x32_bf16 v[100:103], v[24:27], a[0:3], v[48:51]
    v_exp_f32 v77, v77
    v_mfma_f32_16x16x32_bf16 v[100:103], v[28:31], a[4:7], v[100:103]
    v_add_f32 v13, v13, v76
    v_add_f32 v13, v13, v77
    v_mfma_f32_16x16x32_bf16 v[108:111], v[24:27], a[32:35], v[52:55]
    v_exp_f32 v78, v78
    v_mfma_f32_16x16x32_bf16 v[108:111], v[28:31], a[36:39], v[108:111]
    buffer_store_dwordx4 v[224:227], v5, s[32:35], s30 offen offset:0 sc1
    v_cvt_pk_bf16_f32 v74, v76, v77
    v_mfma_f32_16x16x32_bf16 v[116:119], v[24:27], a[64:67], v[56:59]
    v_add_f32 v13, v13, v78
    v_mfma_f32_16x16x32_bf16 v[116:119], v[28:31], a[68:71], v[116:119]
    v_exp_f32 v79, v79
    v_mfma_f32_16x16x32_bf16 v[124:127], v[24:27], a[96:99], v[60:63]
    ds_read_b128 v[24:27], v1 offset:8576
    v_add_f32 v13, v13, v79
    v_mfma_f32_16x16x32_bf16 v[124:127], v[28:31], a[100:103], v[124:127]
    ds_read_b128 v[28:31], v1 offset:8640
    s_waitcnt lgkmcnt(2)
    v_mfma_f32_16x16x32_bf16 v[96:99], v[16:19], a[8:11], v[96:99]
    v_exp_f32 v80, v80
    v_mfma_f32_16x16x32_bf16 v[96:99], v[20:23], a[12:15], v[96:99]
    buffer_store_dwordx4 v[228:231], v5, s[32:35], s30 offen offset:1024 sc1
    v_cvt_pk_bf16_f32 v75, v78, v79
    v_mfma_f32_16x16x32_bf16 v[104:107], v[16:19], a[40:43], v[104:107]
    v_exp_f32 v81, v81
    v_mfma_f32_16x16x32_bf16 v[104:107], v[20:23], a[44:47], v[104:107]
    v_add_f32 v14, v46, v80
    v_add_f32 v14, v14, v81
    v_mfma_f32_16x16x32_bf16 v[112:115], v[16:19], a[72:75], v[112:115]
    v_exp_f32 v82, v82
    v_mfma_f32_16x16x32_bf16 v[112:115], v[20:23], a[76:79], v[112:115]
    buffer_store_dwordx4 v[232:235], v5, s[32:35], s30 offen offset:2048 sc1
    v_cvt_pk_bf16_f32 v80, v80, v81
    v_mfma_f32_16x16x32_bf16 v[120:123], v[16:19], a[104:107], v[120:123]
    ds_read_b128 v[16:19], v1 offset:256
    v_add_f32 v14, v14, v82
    v_mfma_f32_16x16x32_bf16 v[120:123], v[20:23], a[108:111], v[120:123]
    ds_read_b128 v[20:23], v1 offset:320
    s_waitcnt lgkmcnt(2)
    v_mfma_f32_16x16x32_bf16 v[100:103], v[24:27], a[8:11], v[100:103]
    v_exp_f32 v83, v83
    v_mfma_f32_16x16x32_bf16 v[100:103], v[28:31], a[12:15], v[100:103]
    v_exp_f32 v84, v84
    v_mfma_f32_16x16x32_bf16 v[108:111], v[24:27], a[40:43], v[108:111]
    buffer_store_dwordx4 v[236:239], v5, s[32:35], s30 offen offset:3072 sc1
    v_add_f32 v14, v14, v83
    v_mfma_f32_16x16x32_bf16 v[108:111], v[28:31], a[44:47], v[108:111]
    v_exp_f32 v85, v85
    v_mfma_f32_16x16x32_bf16 v[116:119], v[24:27], a[72:75], v[116:119]
    v_cvt_pk_bf16_f32 v81, v82, v83
    v_add_f32 v14, v14, v84
    v_mfma_f32_16x16x32_bf16 v[116:119], v[28:31], a[76:79], v[116:119]
    v_add_f32 v14, v14, v85
    v_cvt_pk_bf16_f32 v82, v84, v85
    v_mfma_f32_16x16x32_bf16 v[124:127], v[24:27], a[104:107], v[124:127]
    ds_read_b128 v[24:27], v1 offset:8704
    v_mfma_f32_16x16x32_bf16 v[124:127], v[28:31], a[108:111], v[124:127]
    ds_read_b128 v[28:31], v1 offset:8768
    s_waitcnt lgkmcnt(2)
    v_mfma_f32_16x16x32_bf16 v[96:99], v[16:19], a[16:19], v[96:99]
    v_exp_f32 v86, v86
    v_mfma_f32_16x16x32_bf16 v[96:99], v[20:23], a[20:23], v[96:99]
    v_exp_f32 v87, v87
    v_mfma_f32_16x16x32_bf16 v[104:107], v[16:19], a[48:51], v[104:107]
    v_add_f32 v14, v14, v86
    v_add_f32 v14, v14, v87
    v_mfma_f32_16x16x32_bf16 v[104:107], v[20:23], a[52:55], v[104:107]
    v_exp_f32 v88, v88
    v_mfma_f32_16x16x32_bf16 v[112:115], v[16:19], a[80:83], v[112:115]
    v_cvt_pk_bf16_f32 v83, v86, v87
    v_add_f32 v15, v47, v88
    v_mfma_f32_16x16x32_bf16 v[112:115], v[20:23], a[84:87], v[112:115]
    v_exp_f32 v89, v89
    v_mfma_f32_16x16x32_bf16 v[120:123], v[16:19], a[112:115], v[120:123]
    ds_read_b128 v[16:19], v1 offset:384
    v_add_f32 v15, v15, v89
    v_mfma_f32_16x16x32_bf16 v[120:123], v[20:23], a[116:119], v[120:123]
    ds_read_b128 v[20:23], v1 offset:448
    s_waitcnt lgkmcnt(2)
    v_mfma_f32_16x16x32_bf16 v[100:103], v[24:27], a[16:19], v[100:103]
    v_exp_f32 v90, v90
    v_mfma_f32_16x16x32_bf16 v[100:103], v[28:31], a[20:23], v[100:103]
    v_cvt_pk_bf16_f32 v88, v88, v89
    v_add_f32 v15, v15, v90
    v_mfma_f32_16x16x32_bf16 v[108:111], v[24:27], a[48:51], v[108:111]
    v_exp_f32 v91, v91
    v_mfma_f32_16x16x32_bf16 v[108:111], v[28:31], a[52:55], v[108:111]
    v_add_f32 v15, v15, v91
    v_cvt_pk_bf16_f32 v89, v90, v91
    v_mfma_f32_16x16x32_bf16 v[116:119], v[24:27], a[80:83], v[116:119]
    v_mfma_f32_16x16x32_bf16 v[116:119], v[28:31], a[84:87], v[116:119]
    v_exp_f32 v92, v92
    v_mfma_f32_16x16x32_bf16 v[124:127], v[24:27], a[112:115], v[124:127]
    ds_read_b128 v[24:27], v1 offset:8832
    v_add_f32 v15, v15, v92
    v_mfma_f32_16x16x32_bf16 v[124:127], v[28:31], a[116:119], v[124:127]
    ds_read_b128 v[28:31], v1 offset:8896
    s_waitcnt lgkmcnt(2)
    v_mfma_f32_16x16x32_bf16 v[96:99], v[16:19], a[24:27], v[96:99]
    v_exp_f32 v93, v93
    v_mfma_f32_16x16x32_bf16 v[96:99], v[20:23], a[28:31], v[96:99]
    v_add_f32 v15, v15, v93
    v_cvt_pk_bf16_f32 v90, v92, v93
    v_mfma_f32_16x16x32_bf16 v[104:107], v[16:19], a[56:59], v[104:107]
    v_exp_f32 v94, v94
    v_mfma_f32_16x16x32_bf16 v[104:107], v[20:23], a[60:63], v[104:107]
    v_add_f32 v15, v15, v94
    v_mfma_f32_16x16x32_bf16 v[112:115], v[16:19], a[88:91], v[112:115]
    v_exp_f32 v95, v95
    v_mfma_f32_16x16x32_bf16 v[112:115], v[20:23], a[92:95], v[112:115]
    v_add_f32 v15, v15, v95
    v_cvt_pk_bf16_f32 v91, v94, v95
    v_mfma_f32_16x16x32_bf16 v[120:123], v[16:19], a[120:123], v[120:123]
    v_mfma_f32_16x16x32_bf16 v[120:123], v[20:23], a[124:127], v[120:123]
    s_waitcnt lgkmcnt(0) vmcnt(8)
    s_barrier
    ds_read_b64_tr_b16 v[16:17], v2 offset:0
    v_mfma_f32_16x16x32_bf16 v[100:103], v[24:27], a[24:27], v[100:103]
    ds_read_b64_tr_b16 v[18:19], v2 offset:512
    v_mfma_f32_16x16x32_bf16 v[100:103], v[28:31], a[28:31], v[100:103]
    ds_read_b64_tr_b16 v[20:21], v2 offset:32
    v_mfma_f32_16x16x32_bf16 v[108:111], v[24:27], a[56:59], v[108:111]
    ds_read_b64_tr_b16 v[22:23], v2 offset:544
    v_mfma_f32_16x16x32_bf16 v[108:111], v[28:31], a[60:63], v[108:111]
    v_mfma_f32_16x16x32_bf16 v[116:119], v[24:27], a[88:91], v[116:119]
    v_mfma_f32_16x16x32_bf16 v[116:119], v[28:31], a[92:95], v[116:119]
    v_mfma_f32_16x16x32_bf16 v[124:127], v[24:27], a[120:123], v[124:127]
    ds_read_b64_tr_b16 v[24:25], v2 offset:64
    v_mfma_f32_16x16x32_bf16 v[124:127], v[28:31], a[124:127], v[124:127]
    ds_read_b64_tr_b16 v[26:27], v2 offset:576
    s_waitcnt lgkmcnt(2)
    v_mfma_f32_16x16x32_bf16 v[128:131], v[16:19], v[64:67], 0
    ds_read_b64_tr_b16 v[28:29], v2 offset:96
    v_mfma_f32_16x16x32_bf16 v[132:135], v[20:23], v[64:67], 0
    s_mov_b32 m0, s78
    ds_read_b64_tr_b16 v[30:31], v2 offset:608
    v_mfma_f32_16x16x32_bf16 v[164:167], v[20:23], v[72:75], 0
    buffer_load_dwordx4 v4, s[8:11], s21 offen offset:0 lds
    v_mfma_f32_16x16x32_bf16 v[160:163], v[16:19], v[72:75], 0
    v_mfma_f32_16x16x32_bf16 v[192:195], v[16:19], v[80:83], 0
    v_mfma_f32_16x16x32_bf16 v[196:199], v[20:23], v[80:83], 0
    buffer_load_dwordx4 v9, s[8:11], s21 offen offset:1056 lds
    v_mfma_f32_16x16x32_bf16 v[228:231], v[20:23], v[88:91], 0
    ds_read_b64_tr_b16 v[20:21], v2 offset:4256
    v_mfma_f32_16x16x32_bf16 v[224:227], v[16:19], v[88:91], 0
    ds_read_b64_tr_b16 v[22:23], v2 offset:4768
    s_waitcnt lgkmcnt(2)
    v_mfma_f32_16x16x32_bf16 v[236:239], v[28:31], v[88:91], 0
    ds_read_b64_tr_b16 v[16:17], v2 offset:4224
    v_mfma_f32_16x16x32_bf16 v[232:235], v[24:27], v[88:91], 0
    ds_read_b64_tr_b16 v[18:19], v2 offset:4736
    v_mfma_f32_16x16x32_bf16 v[200:203], v[24:27], v[80:83], 0
    v_exp_f32 v96, v96
    v_mfma_f32_16x16x32_bf16 v[204:207], v[28:31], v[80:83], 0
    buffer_load_dwordx4 v10, s[8:11], s21 offen offset:2112 lds
    v_mfma_f32_16x16x32_bf16 v[172:175], v[28:31], v[72:75], 0
    v_exp_f32 v97, v97
    v_mfma_f32_16x16x32_bf16 v[168:171], v[24:27], v[72:75], 0
    v_add_f32 v44, v12, v96
    v_add_f32 v44, v44, v97
    v_mfma_f32_16x16x32_bf16 v[136:139], v[24:27], v[64:67], 0
    ds_read_b64_tr_b16 v[24:25], v2 offset:4288
    v_cvt_pk_bf16_f32 v96, v96, v97
    v_mfma_f32_16x16x32_bf16 v[140:143], v[28:31], v[64:67], 0
    ds_read_b64_tr_b16 v[26:27], v2 offset:4800
    s_waitcnt lgkmcnt(2)
    v_mfma_f32_16x16x32_bf16 v[144:147], v[16:19], v[64:67], 0
    ds_read_b64_tr_b16 v[28:29], v2 offset:4320
    v_mfma_f32_16x16x32_bf16 v[148:151], v[20:23], v[64:67], 0
    ds_read_b64_tr_b16 v[30:31], v2 offset:4832
    v_mfma_f32_16x16x32_bf16 v[180:183], v[20:23], v[72:75], 0
    buffer_load_dwordx4 v11, s[8:11], s21 offen offset:3168 lds
    v_mfma_f32_16x16x32_bf16 v[176:179], v[16:19], v[72:75], 0
    v_exp_f32 v98, v98
    v_mfma_f32_16x16x32_bf16 v[208:211], v[16:19], v[80:83], 0
    s_mov_b32 m0, s79
    v_exp_f32 v99, v99
    v_mfma_f32_16x16x32_bf16 v[212:215], v[20:23], v[80:83], 0
    buffer_load_dwordx4 v4, s[80:83], s21 offen offset:0 lds
    v_mfma_f32_16x16x32_bf16 v[244:247], v[20:23], v[88:91], 0
    ds_read_b64_tr_b16 v[20:21], v32 offset:32
    v_add_f32 v44, v44, v98
    v_mfma_f32_16x16x32_bf16 v[240:243], v[16:19], v[88:91], 0
    ds_read_b64_tr_b16 v[22:23], v32 offset:544
    s_waitcnt lgkmcnt(2)
    v_mfma_f32_16x16x32_bf16 v[252:255], v[28:31], v[88:91], 0
    ds_read_b64_tr_b16 v[16:17], v32 offset:0
    v_add_f32 v44, v44, v99
    v_mfma_f32_16x16x32_bf16 v[248:251], v[24:27], v[88:91], 0
    ds_read_b64_tr_b16 v[18:19], v32 offset:512
    v_cvt_pk_bf16_f32 v97, v98, v99
    v_mfma_f32_16x16x32_bf16 v[216:219], v[24:27], v[80:83], 0
    buffer_load_dwordx4 v9, s[80:83], s21 offen offset:1056 lds
    v_mfma_f32_16x16x32_bf16 v[220:223], v[28:31], v[80:83], 0
    v_exp_f32 v100, v100
    v_mfma_f32_16x16x32_bf16 v[188:191], v[28:31], v[72:75], 0
    v_exp_f32 v101, v101
    v_mfma_f32_16x16x32_bf16 v[184:187], v[24:27], v[72:75], 0
L_pg7:
    s_cbranch_execz L_pg11
    buffer_load_dwordx4 v10, s[80:83], s21 offen offset:2112 lds
    v_mfma_f32_16x16x32_bf16 v[152:155], v[24:27], v[64:67], 0
    ds_read_b64_tr_b16 v[24:25], v32 offset:64
    v_add_f32 v44, v44, v100
    v_mfma_f32_16x16x32_bf16 v[156:159], v[28:31], v[64:67], 0
    ds_read_b64_tr_b16 v[26:27], v32 offset:576
    s_waitcnt lgkmcnt(2)
    v_mfma_f32_16x16x32_bf16 a[128:131], v[16:19], v[64:67], 0
    ds_read_b64_tr_b16 v[28:29], v32 offset:96
    v_add_f32 v44, v44, v101
    v_mfma_f32_16x16x32_bf16 a[132:135], v[20:23], v[64:67], 0
    ds_read_b64_tr_b16 v[30:31], v32 offset:608
    v_cvt_pk_bf16_f32 v98, v100, v101
    v_mfma_f32_16x16x32_bf16 a[164:167], v[20:23], v[72:75], 0
    v_exp_f32 v102, v102
    v_mfma_f32_16x16x32_bf16 a[160:163], v[16:19], v[72:75], 0
    v_exp_f32 v103, v103
    v_mfma_f32_16x16x32_bf16 a[192:195], v[16:19], v[80:83], 0
    buffer_load_dwordx4 v11, s[80:83], s21 offen offset:3168 lds
    v_mfma_f32_16x16x32_bf16 a[196:199], v[20:23], v[80:83], 0
    v_add_f32 v44, v44, v102
    v_add_f32 v44, v44, v103
    v_mfma_f32_16x16x32_bf16 a[228:231], v[20:23], v[88:91], 0
    ds_read_b64_tr_b16 v[20:21], v32 offset:4256
    v_cvt_pk_bf16_f32 v99, v102, v103
    v_mfma_f32_16x16x32_bf16 a[224:227], v[16:19], v[88:91], 0
    ds_read_b64_tr_b16 v[22:23], v32 offset:4768
    s_waitcnt lgkmcnt(2)
    v_mfma_f32_16x16x32_bf16 a[236:239], v[28:31], v[88:91], 0
    ds_read_b64_tr_b16 v[16:17], v32 offset:4224
    v_mfma_f32_16x16x32_bf16 a[232:235], v[24:27], v[88:91], 0
    s_mov_b32 m0, s72
    ds_read_b64_tr_b16 v[18:19], v32 offset:4736
    v_mfma_f32_16x16x32_bf16 a[200:203], v[24:27], v[80:83], 0
    buffer_load_dwordx4 v3, s[64:67], s21 offen offset:0 lds
    v_mfma_f32_16x16x32_bf16 a[204:207], v[28:31], v[80:83], 0
    v_exp_f32 v104, v104
    v_mfma_f32_16x16x32_bf16 a[172:175], v[28:31], v[72:75], 0
    v_exp_f32 v105, v105
    v_mfma_f32_16x16x32_bf16 a[168:171], v[24:27], v[72:75], 0
    buffer_load_dwordx4 v6, s[64:67], s21 offen offset:1056 lds
    v_mfma_f32_16x16x32_bf16 a[136:139], v[24:27], v[64:67], 0
    ds_read_b64_tr_b16 v[24:25], v32 offset:4288
    v_add_f32 v45, v13, v104
    v_mfma_f32_16x16x32_bf16 a[140:143], v[28:31], v[64:67], 0
    ds_read_b64_tr_b16 v[26:27], v32 offset:4800
    s_waitcnt lgkmcnt(2)
    v_mfma_f32_16x16x32_bf16 a[144:147], v[16:19], v[64:67], 0
    ds_read_b64_tr_b16 v[28:29], v32 offset:4320
    v_add_f32 v45, v45, v105
    v_mfma_f32_16x16x32_bf16 a[148:151], v[20:23], v[64:67], 0
    ds_read_b64_tr_b16 v[30:31], v32 offset:4832
    v_cvt_pk_bf16_f32 v104, v104, v105
    v_mfma_f32_16x16x32_bf16 a[180:183], v[20:23], v[72:75], 0
    v_exp_f32 v106, v106
    v_mfma_f32_16x16x32_bf16 a[176:179], v[16:19], v[72:75], 0
    buffer_load_dwordx4 v7, s[64:67], s21 offen offset:2112 lds
    v_mfma_f32_16x16x32_bf16 a[208:211], v[16:19], v[80:83], 0
    v_exp_f32 v107, v107
    v_mfma_f32_16x16x32_bf16 a[212:215], v[20:23], v[80:83], 0
    v_add_f32 v45, v45, v106
    v_add_f32 v45, v45, v107
    v_mfma_f32_16x16x32_bf16 a[244:247], v[20:23], v[88:91], 0
    ds_read_b128 v[20:23], v1 offset:33856
    v_cvt_pk_bf16_f32 v105, v106, v107
    v_mfma_f32_16x16x32_bf16 a[240:243], v[16:19], v[88:91], 0
    ds_read_b128 v[16:19], v1 offset:33792
    s_waitcnt lgkmcnt(2)
    v_mfma_f32_16x16x32_bf16 a[252:255], v[28:31], v[88:91], 0
    v_exp_f32 v108, v108
    v_mfma_f32_16x16x32_bf16 a[248:251], v[24:27], v[88:91], 0
    v_add_f32 v45, v45, v108
    v_mfma_f32_16x16x32_bf16 a[216:219], v[24:27], v[80:83], 0
    buffer_load_dwordx4 v8, s[64:67], s21 offen offset:3168 lds
    v_mfma_f32_16x16x32_bf16 a[220:223], v[28:31], v[80:83], 0
    v_exp_f32 v109, v109
    v_mfma_f32_16x16x32_bf16 a[188:191], v[28:31], v[72:75], 0
    v_add_f32 v45, v45, v109
    v_cvt_pk_bf16_f32 v106, v108, v109
    v_mfma_f32_16x16x32_bf16 a[184:187], v[24:27], v[72:75], 0
    v_mfma_f32_16x16x32_bf16 a[152:155], v[24:27], v[64:67], 0
    ds_read_b128 v[24:27], v1 offset:42240
    s_mov_b32 s26, 0
    v_mfma_f32_16x16x32_bf16 a[156:159], v[28:31], v[64:67], 0
    ds_read_b128 v[28:31], v1 offset:42304
.p2align 3
L_att_loop:
    s_waitcnt lgkmcnt(2)
    v_mfma_f32_16x16x32_bf16 v[64:67], v[16:19], a[0:3], v[48:51]
    s_mov_b32 m0, s73
    v_exp_f32 v110, v110
    v_mfma_f32_16x16x32_bf16 v[64:67], v[20:23], a[4:7], v[64:67]
    buffer_load_dwordx4 v3, s[68:71], s21 offen offset:0 lds
    v_mfma_f32_16x16x32_bf16 v[72:75], v[16:19], a[32:35], v[52:55]
    v_add_f32 v45, v45, v110
    v_mfma_f32_16x16x32_bf16 v[72:75], v[20:23], a[36:39], v[72:75]
    v_exp_f32 v111, v111
    v_mfma_f32_16x16x32_bf16 v[80:83], v[16:19], a[64:67], v[56:59]
    v_add_f32 v45, v45, v111
    v_cvt_pk_bf16_f32 v107, v110, v111
    v_mfma_f32_16x16x32_bf16 v[80:83], v[20:23], a[68:71], v[80:83]
    buffer_load_dwordx4 v6, s[68:71], s21 offen offset:1056 lds
    v_mfma_f32_16x16x32_bf16 v[88:91], v[16:19], a[96:99], v[60:63]
    ds_read_b128 v[16:19], v1 offset:33920
    v_mfma_f32_16x16x32_bf16 v[88:91], v[20:23], a[100:103], v[88:91]
    ds_read_b128 v[20:23], v1 offset:33984
    s_waitcnt lgkmcnt(2)
    v_mfma_f32_16x16x32_bf16 v[68:71], v[24:27], a[0:3], v[48:51]
    v_exp_f32 v112, v112
    v_mfma_f32_16x16x32_bf16 v[68:71], v[28:31], a[4:7], v[68:71]
    buffer_load_dwordx4 v7, s[68:71], s21 offen offset:2112 lds
    v_mfma_f32_16x16x32_bf16 v[76:79], v[24:27], a[32:35], v[52:55]
    v_exp_f32 v113, v113
    v_mfma_f32_16x16x32_bf16 v[76:79], v[28:31], a[36:39], v[76:79]
    v_add_f32 v46, v14, v112
    v_add_f32 v46, v46, v113
    v_mfma_f32_16x16x32_bf16 v[84:87], v[24:27], a[64:67], v[56:59]
    v_exp_f32 v114, v114
    v_mfma_f32_16x16x32_bf16 v[84:87], v[28:31], a[68:71], v[84:87]
    buffer_load_dwordx4 v8, s[68:71], s21 offen offset:3168 lds
    v_mfma_f32_16x16x32_bf16 v[92:95], v[24:27], a[96:99], v[60:63]
    ds_read_b128 v[24:27], v1 offset:42368
    v_cvt_pk_bf16_f32 v112, v112, v113
    v_mfma_f32_16x16x32_bf16 v[92:95], v[28:31], a[100:103], v[92:95]
    ds_read_b128 v[28:31], v1 offset:42432
    s_waitcnt lgkmcnt(2)
    v_mfma_f32_16x16x32_bf16 v[64:67], v[16:19], a[8:11], v[64:67]
    v_exp_f32 v115, v115
    v_mfma_f32_16x16x32_bf16 v[64:67], v[20:23], a[12:15], v[64:67]
    buffer_load_dword v34, v33, s[56:59], s21 offen
    s_add_u32 s21, s21, s63
    v_mfma_f32_16x16x32_bf16 v[72:75], v[16:19], a[40:43], v[72:75]
    v_exp_f32 v116, v116
    v_mfma_f32_16x16x32_bf16 v[72:75], v[20:23], a[44:47], v[72:75]
    v_add_f32 v46, v46, v114
    v_add_f32 v46, v46, v115
    v_mfma_f32_16x16x32_bf16 v[80:83], v[16:19], a[72:75], v[80:83]
    v_exp_f32 v117, v117
    v_mfma_f32_16x16x32_bf16 v[80:83], v[20:23], a[76:79], v[80:83]
    v_cvt_pk_bf16_f32 v113, v114, v115
    v_add_f32 v46, v46, v116
    v_mfma_f32_16x16x32_bf16 v[88:91], v[16:19], a[104:107], v[88:91]
    ds_read_b128 v[16:19], v1 offset:34048
    v_add_f32 v46, v46, v117
    v_mfma_f32_16x16x32_bf16 v[88:91], v[20:23], a[108:111], v[88:91]
    ds_read_b128 v[20:23], v1 offset:34112
    s_waitcnt lgkmcnt(2)
    v_mfma_f32_16x16x32_bf16 v[68:71], v[24:27], a[8:11], v[68:71]
    v_exp_f32 v118, v118
    v_mfma_f32_16x16x32_bf16 v[68:71], v[28:31], a[12:15], v[68:71]
    v_exp_f32 v119, v119
    v_mfma_f32_16x16x32_bf16 v[76:79], v[24:27], a[40:43], v[76:79]
    v_cvt_pk_bf16_f32 v114, v116, v117
    v_add_f32 v46, v46, v118
    v_mfma_f32_16x16x32_bf16 v[76:79], v[28:31], a[44:47], v[76:79]
    v_add_f32 v46, v46, v119
    v_cvt_pk_bf16_f32 v115, v118, v119
    v_mfma_f32_16x16x32_bf16 v[84:87], v[24:27], a[72:75], v[84:87]
    v_exp_f32 v120, v120
    v_mfma_f32_16x16x32_bf16 v[84:87], v[28:31], a[76:79], v[84:87]
    v_add_f32 v47, v15, v120
    v_mfma_f32_16x16x32_bf16 v[92:95], v[24:27], a[104:107], v[92:95]
    ds_read_b128 v[24:27], v1 offset:42496
    v_mfma_f32_16x16x32_bf16 v[92:95], v[28:31], a[108:111], v[92:95]
    ds_read_b128 v[28:31], v1 offset:42560
    s_waitcnt lgkmcnt(2)
    v_mfma_f32_16x16x32_bf16 v[64:67], v[16:19], a[16:19], v[64:67]
    v_exp_f32 v121, v121
    v_mfma_f32_16x16x32_bf16 v[64:67], v[20:23], a[20:23], v[64:67]
    v_add_f32 v47, v47, v121
    v_cvt_pk_bf16_f32 v120, v120, v121
    v_mfma_f32_16x16x32_bf16 v[72:75], v[16:19], a[48:51], v[72:75]
    v_exp_f32 v122, v122
    v_mfma_f32_16x16x32_bf16 v[72:75], v[20:23], a[52:55], v[72:75]
    v_add_f32 v47, v47, v122
    v_mfma_f32_16x16x32_bf16 v[80:83], v[16:19], a[80:83], v[80:83]
    v_mfma_f32_16x16x32_bf16 v[80:83], v[20:23], a[84:87], v[80:83]
    v_exp_f32 v123, v123
    v_mfma_f32_16x16x32_bf16 v[88:91], v[16:19], a[112:115], v[88:91]
    ds_read_b128 v[16:19], v1 offset:34176
    v_add_f32 v47, v47, v123
    v_mfma_f32_16x16x32_bf16 v[88:91], v[20:23], a[116:119], v[88:91]
    ds_read_b128 v[20:23], v1 offset:34240
    s_waitcnt lgkmcnt(2)
    v_mfma_f32_16x16x32_bf16 v[68:71], v[24:27], a[16:19], v[68:71]
    v_exp_f32 v124, v124
    v_mfma_f32_16x16x32_bf16 v[68:71], v[28:31], a[20:23], v[68:71]
    v_cvt_pk_bf16_f32 v121, v122, v123
    v_add_f32 v47, v47, v124
    v_mfma_f32_16x16x32_bf16 v[76:79], v[24:27], a[48:51], v[76:79]
    v_exp_f32 v125, v125
    v_mfma_f32_16x16x32_bf16 v[76:79], v[28:31], a[52:55], v[76:79]
    v_add_f32 v47, v47, v125
    v_cvt_pk_bf16_f32 v122, v124, v125
    v_mfma_f32_16x16x32_bf16 v[84:87], v[24:27], a[80:83], v[84:87]
    v_mfma_f32_16x16x32_bf16 v[84:87], v[28:31], a[84:87], v[84:87]
    v_exp_f32 v126, v126
    v_mfma_f32_16x16x32_bf16 v[92:95], v[24:27], a[112:115], v[92:95]
    ds_read_b128 v[24:27], v1 offset:42624
    v_add_f32 v47, v47, v126
    v_mfma_f32_16x16x32_bf16 v[92:95], v[28:31], a[116:119], v[92:95]
    ds_read_b128 v[28:31], v1 offset:42688
    s_waitcnt lgkmcnt(2)
    v_mfma_f32_16x16x32_bf16 v[64:67], v[16:19], a[24:27], v[64:67]
    v_exp_f32 v127, v127
    v_mfma_f32_16x16x32_bf16 v[64:67], v[20:23], a[28:31], v[64:67]
    v_add_f32 v47, v47, v127
    v_cvt_pk_bf16_f32 v123, v126, v127
    v_mfma_f32_16x16x32_bf16 v[72:75], v[16:19], a[56:59], v[72:75]
    v_mfma_f32_16x16x32_bf16 v[72:75], v[20:23], a[60:63], v[72:75]
    v_mfma_f32_16x16x32_bf16 v[80:83], v[16:19], a[88:91], v[80:83]
    v_mfma_f32_16x16x32_bf16 v[80:83], v[20:23], a[92:95], v[80:83]
    v_mfma_f32_16x16x32_bf16 v[88:91], v[16:19], a[120:123], v[88:91]
    v_mfma_f32_16x16x32_bf16 v[88:91], v[20:23], a[124:127], v[88:91]
    s_waitcnt lgkmcnt(0) vmcnt(1)
    s_barrier
    ds_read_b64_tr_b16 v[16:17], v2 offset:33792
    v_mfma_f32_16x16x32_bf16 v[68:71], v[24:27], a[24:27], v[68:71]
    ds_read_b64_tr_b16 v[18:19], v2 offset:34304
    v_mfma_f32_16x16x32_bf16 v[68:71], v[28:31], a[28:31], v[68:71]
    ds_read_b64_tr_b16 v[20:21], v2 offset:33824
    v_max3_f32 v43, v44, v45, v46
    v_mfma_f32_16x16x32_bf16 v[76:79], v[24:27], a[56:59], v[76:79]
    ds_read_b64_tr_b16 v[22:23], v2 offset:34336
    v_max_f32 v43, v43, v47
    v_mfma_f32_16x16x32_bf16 v[76:79], v[28:31], a[60:63], v[76:79]
    v_cmp_ngt_f32 vcc, 0x57800000, v43
    v_mfma_f32_16x16x32_bf16 v[84:87], v[24:27], a[88:91], v[84:87]
    v_mfma_f32_16x16x32_bf16 v[84:87], v[28:31], a[92:95], v[84:87]
    s_cbranch_vccnz L_rare1
L_back1:
    v_mfma_f32_16x16x32_bf16 v[92:95], v[24:27], a[120:123], v[92:95]
    ds_read_b64_tr_b16 v[24:25], v2 offset:33856
    v_mfma_f32_16x16x32_bf16 v[92:95], v[28:31], a[124:127], v[92:95]
    ds_read_b64_tr_b16 v[26:27], v2 offset:34368
    s_waitcnt lgkmcnt(2)
    v_mfma_f32_16x16x32_bf16 v[128:131], v[16:19], v[96:99], v[128:131]
    ds_read_b64_tr_b16 v[28:29], v2 offset:33888
    v_mfma_f32_16x16x32_bf16 v[132:135], v[20:23], v[96:99], v[132:135]
    s_mov_b32 m0, s76
    ds_read_b64_tr_b16 v[30:31], v2 offset:34400
    v_mfma_f32_16x16x32_bf16 v[164:167], v[20:23], v[104:107], v[164:167]
    buffer_load_dwordx4 v4, s[8:11], s21 offen offset:0 lds
    v_mfma_f32_16x16x32_bf16 v[160:163], v[16:19], v[104:107], v[160:163]
    v_mfma_f32_16x16x32_bf16 v[192:195], v[16:19], v[112:115], v[192:195]
    v_mfma_f32_16x16x32_bf16 v[196:199], v[20:23], v[112:115], v[196:199]
    buffer_load_dwordx4 v9, s[8:11], s21 offen offset:1056 lds
    v_mfma_f32_16x16x32_bf16 v[228:231], v[20:23], v[120:123], v[228:231]
    ds_read_b64_tr_b16 v[20:21], v2 offset:38048
    v_mfma_f32_16x16x32_bf16 v[224:227], v[16:19], v[120:123], v[224:227]
    ds_read_b64_tr_b16 v[22:23], v2 offset:38560
    s_waitcnt lgkmcnt(2)
    v_mfma_f32_16x16x32_bf16 v[236:239], v[28:31], v[120:123], v[236:239]
    ds_read_b64_tr_b16 v[16:17], v2 offset:38016
    v_mfma_f32_16x16x32_bf16 v[232:235], v[24:27], v[120:123], v[232:235]
    ds_read_b64_tr_b16 v[18:19], v2 offset:38528
    v_mfma_f32_16x16x32_bf16 v[200:203], v[24:27], v[112:115], v[200:203]
    v_exp_f32 v64, v64
    v_mfma_f32_16x16x32_bf16 v[204:207], v[28:31], v[112:115], v[204:207]
    buffer_load_dwordx4 v10, s[8:11], s21 offen offset:2112 lds
    v_mfma_f32_16x16x32_bf16 v[172:175], v[28:31], v[104:107], v[172:175]
    v_exp_f32 v65, v65
    v_mfma_f32_16x16x32_bf16 v[168:171], v[24:27], v[104:107], v[168:171]
    v_add_f32 v12, v44, v64
    v_add_f32 v12, v12, v65
    v_mfma_f32_16x16x32_bf16 v[136:139], v[24:27], v[96:99], v[136:139]
    ds_read_b64_tr_b16 v[24:25], v2 offset:38080
    v_cvt_pk_bf16_f32 v64, v64, v65
    v_mfma_f32_16x16x32_bf16 v[140:143], v[28:31], v[96:99], v[140:143]
    ds_read_b64_tr_b16 v[26:27], v2 offset:38592
    s_waitcnt lgkmcnt(2)
    v_mfma_f32_16x16x32_bf16 v[144:147], v[16:19], v[96:99], v[144:147]
    ds_read_b64_tr_b16 v[28:29], v2 offset:38112
    v_mfma_f32_16x16x32_bf16 v[148:151], v[20:23], v[96:99], v[148:151]
    ds_read_b64_tr_b16 v[30:31], v2 offset:38624
    v_mfma_f32_16x16x32_bf16 v[180:183], v[20:23], v[104:107], v[180:183]
    buffer_load_dwordx4 v11, s[8:11], s21 offen offset:3168 lds
    v_mfma_f32_16x16x32_bf16 v[176:179], v[16:19], v[104:107], v[176:179]
    v_exp_f32 v66, v66
    v_mfma_f32_16x16x32_bf16 v[208:211], v[16:19], v[112:115], v[208:211]
    s_mov_b32 m0, s77
    v_exp_f32 v67, v67
    v_mfma_f32_16x16x32_bf16 v[212:215], v[20:23], v[112:115], v[212:215]
    buffer_load_dwordx4 v4, s[80:83], s21 offen offset:0 lds
    v_mfma_f32_16x16x32_bf16 v[244:247], v[20:23], v[120:123], v[244:247]
    ds_read_b64_tr_b16 v[20:21], v32 offset:33824
    v_add_f32 v12, v12, v66
    v_mfma_f32_16x16x32_bf16 v[240:243], v[16:19], v[120:123], v[240:243]
    ds_read_b64_tr_b16 v[22:23], v32 offset:34336
    s_waitcnt lgkmcnt(2)
    v_mfma_f32_16x16x32_bf16 v[252:255], v[28:31], v[120:123], v[252:255]
    ds_read_b64_tr_b16 v[16:17], v32 offset:33792
    v_add_f32 v12, v12, v67
    v_mfma_f32_16x16x32_bf16 v[248:251], v[24:27], v[120:123], v[248:251]
    ds_read_b64_tr_b16 v[18:19], v32 offset:34304
    v_cvt_pk_bf16_f32 v65, v66, v67
    v_mfma_f32_16x16x32_bf16 v[216:219], v[24:27], v[112:115], v[216:219]
    buffer_load_dwordx4 v9, s[80:83], s21 offen offset:1056 lds
    v_mfma_f32_16x16x32_bf16 v[220:223], v[28:31], v[112:115], v[220:223]
    v_exp_f32 v68, v68
    v_mfma_f32_16x16x32_bf16 v[188:191], v[28:31], v[104:107], v[188:191]
    v_exp_f32 v69, v69
    v_mfma_f32_16x16x32_bf16 v[184:187], v[24:27], v[104:107], v[184:187]
    buffer_load_dwordx4 v10, s[80:83], s21 offen offset:2112 lds
    v_mfma_f32_16x16x32_bf16 v[152:155], v[24:27], v[96:99], v[152:155]
    ds_read_b64_tr_b16 v[24:25], v32 offset:33856
    v_add_f32 v12, v12, v68
    v_mfma_f32_16x16x32_bf16 v[156:159], v[28:31], v[96:99], v[156:159]
    ds_read_b64_tr_b16 v[26:27], v32 offset:34368
    s_waitcnt lgkmcnt(2)
    v_mfma_f32_16x16x32_bf16 a[128:131], v[16:19], v[96:99], a[128:131]
    ds_read_b64_tr_b16 v[28:29], v32 offset:33888
    v_add_f32 v12, v12, v69
    v_mfma_f32_16x16x32_bf16 a[132:135], v[20:23], v[96:99], a[132:135]
    ds_read_b64_tr_b16 v[30:31], v32 offset:34400
    v_cvt_pk_bf16_f32 v66, v68, v69
    v_mfma_f32_16x16x32_bf16 a[164:167], v[20:23], v[104:107], a[164:167]
    v_exp_f32 v70, v70
    v_mfma_f32_16x16x32_bf16 a[160:163], v[16:19], v[104:107], a[160:163]
    v_exp_f32 v71, v71
    v_mfma_f32_16x16x32_bf16 a[192:195], v[16:19], v[112:115], a[192:195]
    buffer_load_dwordx4 v11, s[80:83], s21 offen offset:3168 lds
    v_mfma_f32_16x16x32_bf16 a[196:199], v[20:23], v[112:115], a[196:199]
    v_add_f32 v12, v12, v70
    v_add_f32 v12, v12, v71
    v_mfma_f32_16x16x32_bf16 a[228:231], v[20:23], v[120:123], a[228:231]
    ds_read_b64_tr_b16 v[20:21], v32 offset:38048
    v_cvt_pk_bf16_f32 v67, v70, v71
    v_mfma_f32_16x16x32_bf16 a[224:227], v[16:19], v[120:123], a[224:227]
    ds_read_b64_tr_b16 v[22:23], v32 offset:38560
    s_waitcnt lgkmcnt(2)
    v_mfma_f32_16x16x32_bf16 a[236:239], v[28:31], v[120:123], a[236:239]
    ds_read_b64_tr_b16 v[16:17], v32 offset:38016
    v_mfma_f32_16x16x32_bf16 a[232:235], v[24:27], v[120:123], a[232:235]
    s_mov_b32 m0, s74
    ds_read_b64_tr_b16 v[18:19], v32 offset:38528
    v_mfma_f32_16x16x32_bf16 a[200:203], v[24:27], v[112:115], a[200:203]
    buffer_load_dwordx4 v3, s[64:67], s21 offen offset:0 lds
    v_mfma_f32_16x16x32_bf16 a[204:207], v[28:31], v[112:115], a[204:207]
    v_exp_f32 v72, v72
    v_mfma_f32_16x16x32_bf16 a[172:175], v[28:31], v[104:107], a[172:175]
    v_exp_f32 v73, v73
    v_mfma_f32_16x16x32_bf16 a[168:171], v[24:27], v[104:107], a[168:171]
    buffer_load_dwordx4 v6, s[64:67], s21 offen offset:1056 lds
    v_mfma_f32_16x16x32_bf16 a[136:139], v[24:27], v[96:99], a[136:139]
    ds_read_b64_tr_b16 v[24:25], v32 offset:38080
    v_add_f32 v13, v45, v72
    v_mfma_f32_16x16x32_bf16 a[140:143], v[28:31], v[96:99], a[140:143]
    ds_read_b64_tr_b16 v[26:27], v32 offset:38592
    s_waitcnt lgkmcnt(2)
    v_mfma_f32_16x16x32_bf16 a[144:147], v[16:19], v[96:99], a[144:147]
    ds_read_b64_tr_b16 v[28:29], v32 offset:38112
    v_add_f32 v13, v13, v73
    v_mfma_f32_16x16x32_bf16 a[148:151], v[20:23], v[96:99], a[148:151]
    ds_read_b64_tr_b16 v[30:31], v32 offset:38624
    v_cvt_pk_bf16_f32 v72, v72, v73
    v_mfma_f32_16x16x32_bf16 a[180:183], v[20:23], v[104:107], a[180:183]
    v_exp_f32 v74, v74
    v_mfma_f32_16x16x32_bf16 a[176:179], v[16:19], v[104:107], a[176:179]
    buffer_load_dwordx4 v7, s[64:67], s21 offen offset:2112 lds
    v_mfma_f32_16x16x32_bf16 a[208:211], v[16:19], v[112:115], a[208:211]
    v_exp_f32 v75, v75
    v_mfma_f32_16x16x32_bf16 a[212:215], v[20:23], v[112:115], a[212:215]
    v_add_f32 v13, v13, v74
    v_add_f32 v13, v13, v75
    v_mfma_f32_16x16x32_bf16 a[244:247], v[20:23], v[120:123], a[244:247]
    ds_read_b128 v[20:23], v1 offset:64
    v_cvt_pk_bf16_f32 v73, v74, v75
    v_mfma_f32_16x16x32_bf16 a[240:243], v[16:19], v[120:123], a[240:243]
    ds_read_b128 v[16:19], v1 offset:0
    s_waitcnt lgkmcnt(2)
    v_mfma_f32_16x16x32_bf16 a[252:255], v[28:31], v[120:123], a[252:255]
    v_exp_f32 v76, v76
    v_mfma_f32_16x16x32_bf16 a[248:251], v[24:27], v[120:123], a[248:251]
    v_add_f32 v13, v13, v76
    v_mfma_f32_16x16x32_bf16 a[216:219], v[24:27], v[112:115], a[216:219]
    buffer_load_dwordx4 v8, s[64:67], s21 offen offset:3168 lds
    v_mfma_f32_16x16x32_bf16 a[220:223], v[28:31], v[112:115], a[220:223]
    v_exp_f32 v77, v77
    v_mfma_f32_16x16x32_bf16 a[188:191], v[28:31], v[104:107], a[188:191]
    v_add_f32 v13, v13, v77
    v_cvt_pk_bf16_f32 v74, v76, v77
    v_mfma_f32_16x16x32_bf16 a[184:187], v[24:27], v[104:107], a[184:187]
    v_mfma_f32_16x16x32_bf16 a[152:155], v[24:27], v[96:99], a[152:155]
    ds_read_b128 v[24:27], v1 offset:8448
    s_and_b32 s27, s26, 7
    s_cbranch_scc0 L_sig
L_sigback:
    v_mfma_f32_16x16x32_bf16 a[156:159], v[28:31], v[96:99], a[156:159]
    ds_read_b128 v[28:31], v1 offset:8512
    s_waitcnt lgkmcnt(2)
    v_mfma_f32_16x16x32_bf16 v[96:99], v[16:19], a[0:3], v[48:51]
    s_mov_b32 m0, s75
    v_exp_f32 v78, v78
    v_mfma_f32_16x16x32_bf16 v[96:99], v[20:23], a[4:7], v[96:99]
    buffer_load_dwordx4 v3, s[68:71], s21 offen offset:0 lds
    v_mfma_f32_16x16x32_bf16 v[104:107], v[16:19], a[32:35], v[52:55]
    v_add_f32 v13, v13, v78
    v_mfma_f32_16x16x32_bf16 v[104:107], v[20:23], a[36:39], v[104:107]
    v_exp_f32 v79, v79
    v_mfma_f32_16x16x32_bf16 v[112:115], v[16:19], a[64:67], v[56:59]
    v_add_f32 v13, v13, v79
    v_cvt_pk_bf16_f32 v75, v78, v79
    v_mfma_f32_16x16x32_bf16 v[112:115], v[20:23], a[68:71], v[112:115]
    buffer_load_dwordx4 v6, s[68:71], s21 offen offset:1056 lds
    v_mfma_f32_16x16x32_bf16 v[120:123], v[16:19], a[96:99], v[60:63]
    ds_read_b128 v[16:19], v1 offset:128
    v_mfma_f32_16x16x32_bf16 v[120:123], v[20:23], a[100:103], v[120:123]
    ds_read_b128 v[20:23], v1 offset:192
    s_waitcnt lgkmcnt(2)
    v_mfma_f32_16x16x32_bf16 v[100:103], v[24:27], a[0:3], v[48:51]
    v_exp_f32 v80, v80
    v_mfma_f32_16x16x32_bf16 v[100:103], v[28:31], a[4:7], v[100:103]
    buffer_load_dwordx4 v7, s[68:71], s21 offen offset:2112 lds
    v_mfma_f32_16x16x32_bf16 v[108:111], v[24:27], a[32:35], v[52:55]
    v_exp_f32 v81, v81
    v_mfma_f32_16x16x32_bf16 v[108:111], v[28:31], a[36:39], v[108:111]
    v_add_f32 v14, v46, v80
    v_add_f32 v14, v14, v81
    v_mfma_f32_16x16x32_bf16 v[116:119], v[24:27], a[64:67], v[56:59]
    v_exp_f32 v82, v82
    v_mfma_f32_16x16x32_bf16 v[116:119], v[28:31], a[68:71], v[116:119]
    buffer_load_dwordx4 v8, s[68:71], s21 offen offset:3168 lds
    v_mfma_f32_16x16x32_bf16 v[124:127], v[24:27], a[96:99], v[60:63]
    ds_read_b128 v[24:27], v1 offset:8576
    v_cvt_pk_bf16_f32 v80, v80, v81
    v_mfma_f32_16x16x32_bf16 v[124:127], v[28:31], a[100:103], v[124:127]
    ds_read_b128 v[28:31], v1 offset:8640
    s_waitcnt lgkmcnt(2)
    v_mfma_f32_16x16x32_bf16 v[96:99], v[16:19], a[8:11], v[96:99]
    v_exp_f32 v83, v83
    v_mfma_f32_16x16x32_bf16 v[96:99], v[20:23], a[12:15], v[96:99]
    buffer_load_dword v34, v33, s[56:59], s21 offen
    s_add_u32 s21, s21, s63
    v_mfma_f32_16x16x32_bf16 v[104:107], v[16:19], a[40:43], v[104:107]
    v_exp_f32 v84, v84
    v_mfma_f32_16x16x32_bf16 v[104:107], v[20:23], a[44:47], v[104:107]
    v_add_f32 v14, v14, v82
    v_add_f32 v14, v14, v83
    v_mfma_f32_16x16x32_bf16 v[112:115], v[16:19], a[72:75], v[112:115]
    v_exp_f32 v85, v85
    v_mfma_f32_16x16x32_bf16 v[112:115], v[20:23], a[76:79], v[112:115]
    v_cvt_pk_bf16_f32 v81, v82, v83
    v_add_f32 v14, v14, v84
    v_mfma_f32_16x16x32_bf16 v[120:123], v[16:19], a[104:107], v[120:123]
    ds_read_b128 v[16:19], v1 offset:256
    v_add_f32 v14, v14, v85
    v_mfma_f32_16x16x32_bf16 v[120:123], v[20:23], a[108:111], v[120:123]
    ds_read_b128 v[20:23], v1 offset:320
    s_waitcnt lgkmcnt(2)
    v_mfma_f32_16x16x32_bf16 v[100:103], v[24:27], a[8:11], v[100:103]
    v_exp_f32 v86, v86
    v_mfma_f32_16x16x32_bf16 v[100:103], v[28:31], a[12:15], v[100:103]
    v_exp_f32 v87, v87
    v_mfma_f32_16x16x32_bf16 v[108:111], v[24:27], a[40:43], v[108:111]
    v_cvt_pk_bf16_f32 v82, v84, v85
    v_add_f32 v14, v14, v86
    v_mfma_f32_16x16x32_bf16 v[108:111], v[28:31], a[44:47], v[108:111]
    v_add_f32 v14, v14, v87
    v_cvt_pk_bf16_f32 v83, v86, v87
    v_mfma_f32_16x16x32_bf16 v[116:119], v[24:27], a[72:75], v[116:119]
    v_exp_f32 v88, v88
    v_mfma_f32_16x16x32_bf16 v[116:119], v[28:31], a[76:79], v[116:119]
    v_add_f32 v15, v47, v88
    v_mfma_f32_16x16x32_bf16 v[124:127], v[24:27], a[104:107], v[124:127]
    ds_read_b128 v[24:27], v1 offset:8704
    v_mfma_f32_16x16x32_bf16 v[124:127], v[28:31], a[108:111], v[124:127]
    ds_read_b128 v[28:31], v1 offset:8768
    s_waitcnt lgkmcnt(2)
    v_mfma_f32_16x16x32_bf16 v[96:99], v[16:19], a[16:19], v[96:99]
    v_exp_f32 v89, v89
    v_mfma_f32_16x16x32_bf16 v[96:99], v[20:23], a[20:23], v[96:99]
    v_add_f32 v15, v15, v89
    v_cvt_pk_bf16_f32 v88, v88, v89
    v_mfma_f32_16x16x32_bf16 v[104:107], v[16:19], a[48:51], v[104:107]
    v_exp_f32 v90, v90
    v_mfma_f32_16x16x32_bf16 v[104:107], v[20:23], a[52:55], v[104:107]
    v_add_f32 v15, v15, v90
    v_mfma_f32_16x16x32_bf16 v[112:115], v[16:19], a[80:83], v[112:115]
    v_mfma_f32_16x16x32_bf16 v[112:115], v[20:23], a[84:87], v[112:115]
    v_exp_f32 v91, v91
    v_mfma_f32_16x16x32_bf16 v[120:123], v[16:19], a[112:115], v[120:123]
    ds_read_b128 v[16:19], v1 offset:384
    v_add_f32 v15, v15, v91
    v_mfma_f32_16x16x32_bf16 v[120:123], v[20:23], a[116:119], v[120:123]
    ds_read_b128 v[20:23], v1 offset:448
    s_waitcnt lgkmcnt(2)
    v_mfma_f32_16x16x32_bf16 v[100:103], v[24:27], a[16:19], v[100:103]
    v_exp_f32 v92, v92
    v_mfma_f32_16x16x32_bf16 v[100:103], v[28:31], a[20:23], v[100:103]
    v_cvt_pk_bf16_f32 v89, v90, v91
    v_add_f32 v15, v15, v92
    v_mfma_f32_16x16x32_bf16 v[108:111], v[24:27], a[48:51], v[108:111]
    v_exp_f32 v93, v93
    v_mfma_f32_16x16x32_bf16 v[108:111], v[28:31], a[52:55], v[108:111]
    v_add_f32 v15, v15, v93
    v_cvt_pk_bf16_f32 v90, v92, v93
    v_mfma_f32_16x16x32_bf16 v[116:119], v[24:27], a[80:83], v[116:119]
    v_mfma_f32_16x16x32_bf16 v[116:119], v[28:31], a[84:87], v[116:119]
    v_exp_f32 v94, v94
    v_mfma_f32_16x16x32_bf16 v[124:127], v[24:27], a[112:115], v[124:127]
    ds_read_b128 v[24:27], v1 offset:8832
    v_add_f32 v15, v15, v94
    v_mfma_f32_16x16x32_bf16 v[124:127], v[28:31], a[116:119], v[124:127]
    ds_read_b128 v[28:31], v1 offset:8896
    s_waitcnt lgkmcnt(2)
    v_mfma_f32_16x16x32_bf16 v[96:99], v[16:19], a[24:27], v[96:99]
    v_exp_f32 v95, v95
    v_mfma_f32_16x16x32_bf16 v[96:99], v[20:23], a[28:31], v[96:99]
    v_add_f32 v15, v15, v95
    v_cvt_pk_bf16_f32 v91, v94, v95
    v_mfma_f32_16x16x32_bf16 v[104:107], v[16:19], a[56:59], v[104:107]
    v_mfma_f32_16x16x32_bf16 v[104:107], v[20:23], a[60:63], v[104:107]
    v_mfma_f32_16x16x32_bf16 v[112:115], v[16:19], a[88:91], v[112:115]
    v_mfma_f32_16x16x32_bf16 v[112:115], v[20:23], a[92:95], v[112:115]
    v_mfma_f32_16x16x32_bf16 v[120:123], v[16:19], a[120:123], v[120:123]
    v_mfma_f32_16x16x32_bf16 v[120:123], v[20:23], a[124:127], v[120:123]
    s_waitcnt lgkmcnt(0) vmcnt(1)
    s_barrier
    ds_read_b64_tr_b16 v[16:17], v2 offset:0
    v_mfma_f32_16x16x32_bf16 v[100:103], v[24:27], a[24:27], v[100:103]
    ds_read_b64_tr_b16 v[18:19], v2 offset:512
    v_mfma_f32_16x16x32_bf16 v[100:103], v[28:31], a[28:31], v[100:103]
    ds_read_b64_tr_b16 v[20:21], v2 offset:32
    v_max3_f32 v43, v12, v13, v14
    v_mfma_f32_16x16x32_bf16 v[108:111], v[24:27], a[56:59], v[108:111]
    ds_read_b64_tr_b16 v[22:23], v2 offset:544
    v_max_f32 v43, v43, v15
    v_mfma_f32_16x16x32_bf16 v[108:111], v[28:31], a[60:63], v[108:111]
    v_cmp_ngt_f32 vcc, 0x57800000, v43
    v_mfma_f32_16x16x32_bf16 v[116:119], v[24:27], a[88:91], v[116:119]
    v_mfma_f32_16x16x32_bf16 v[116:119], v[28:31], a[92:95], v[116:119]
    s_cbranch_vccnz L_rare2
L_back2:
    v_mfma_f32_16x16x32_bf16 v[124:127], v[24:27], a[120:123], v[124:127]
    ds_read_b64_tr_b16 v[24:25], v2 offset:64
    v_mfma_f32_16x16x32_bf16 v[124:127], v[28:31], a[124:127], v[124:127]
    ds_read_b64_tr_b16 v[26:27], v2 offset:576
    s_waitcnt lgkmcnt(2)
    v_mfma_f32_16x16x32_bf16 v[128:131], v[16:19], v[64:67], v[128:131]
    ds_read_b64_tr_b16 v[28:29], v2 offset:96
    v_mfma_f32_16x16x32_bf16 v[132:135], v[20:23], v[64:67], v[132:135]
    s_mov_b32 m0, s78
    ds_read_b64_tr_b16 v[30:31], v2 offset:608
    v_mfma_f32_16x16x32_bf16 v[164:167], v[20:23], v[72:75], v[164:167]
    buffer_load_dwordx4 v4, s[8:11], s21 offen offset:0 lds
    v_mfma_f32_16x16x32_bf16 v[160:163], v[16:19], v[72:75], v[160:163]
    v_mfma_f32_16x16x32_bf16 v[192:195], v[16:19], v[80:83], v[192:195]
    v_mfma_f32_16x16x32_bf16 v[196:199], v[20:23], v[80:83], v[196:199]
    buffer_load_dwordx4 v9, s[8:11], s21 offen offset:1056 lds
    v_mfma_f32_16x16x32_bf16 v[228:231], v[20:23], v[88:91], v[228:231]
    ds_read_b64_tr_b16 v[20:21], v2 offset:4256
    v_mfma_f32_16x16x32_bf16 v[224:227], v[16:19], v[88:91], v[224:227]
    ds_read_b64_tr_b16 v[22:23], v2 offset:4768
    s_waitcnt lgkmcnt(2)
    v_mfma_f32_16x16x32_bf16 v[236:239], v[28:31], v[88:91], v[236:239]
    ds_read_b64_tr_b16 v[16:17], v2 offset:4224
    v_mfma_f32_16x16x32_bf16 v[232:235], v[24:27], v[88:91], v[232:235]
    ds_read_b64_tr_b16 v[18:19], v2 offset:4736
    v_mfma_f32_16x16x32_bf16 v[200:203], v[24:27], v[80:83], v[200:203]
    v_exp_f32 v96, v96
    v_mfma_f32_16x16x32_bf16 v[204:207], v[28:31], v[80:83], v[204:207]
    buffer_load_dwordx4 v10, s[8:11], s21 offen offset:2112 lds
    v_mfma_f32_16x16x32_bf16 v[172:175], v[28:31], v[72:75], v[172:175]
    v_exp_f32 v97, v97
    v_mfma_f32_16x16x32_bf16 v[168:171], v[24:27], v[72:75], v[168:171]
    v_add_f32 v44, v12, v96
    v_add_f32 v44, v44, v97
    v_mfma_f32_16x16x32_bf16 v[136:139], v[24:27], v[64:67], v[136:139]
    ds_read_b64_tr_b16 v[24:25], v2 offset:4288
    v_cvt_pk_bf16_f32 v96, v96, v97
    v_mfma_f32_16x16x32_bf16 v[140:143], v[28:31], v[64:67], v[140:143]
    ds_read_b64_tr_b16 v[26:27], v2 offset:4800
    s_waitcnt lgkmcnt(2)
    v_mfma_f32_16x16x32_bf16 v[144:147], v[16:19], v[64:67], v[144:147]
    ds_read_b64_tr_b16 v[28:29], v2 offset:4320
    v_mfma_f32_16x16x32_bf16 v[148:151], v[20:23], v[64:67], v[148:151]
    ds_read_b64_tr_b16 v[30:31], v2 offset:4832
    v_mfma_f32_16x16x32_bf16 v[180:183], v[20:23], v[72:75], v[180:183]
    buffer_load_dwordx4 v11, s[8:11], s21 offen offset:3168 lds
    v_mfma_f32_16x16x32_bf16 v[176:179], v[16:19], v[72:75], v[176:179]
    v_exp_f32 v98, v98
    v_mfma_f32_16x16x32_bf16 v[208:211], v[16:19], v[80:83], v[208:211]
    s_mov_b32 m0, s79
    v_exp_f32 v99, v99
    v_mfma_f32_16x16x32_bf16 v[212:215], v[20:23], v[80:83], v[212:215]
    buffer_load_dwordx4 v4, s[80:83], s21 offen offset:0 lds
    v_mfma_f32_16x16x32_bf16 v[244:247], v[20:23], v[88:91], v[244:247]
    ds_read_b64_tr_b16 v[20:21], v32 offset:32
    v_add_f32 v44, v44, v98
    v_mfma_f32_16x16x32_bf16 v[240:243], v[16:19], v[88:91], v[240:243]
    ds_read_b64_tr_b16 v[22:23], v32 offset:544
    s_waitcnt lgkmcnt(2)
    v_mfma_f32_16x16x32_bf16 v[252:255], v[28:31], v[88:91], v[252:255]
    ds_read_b64_tr_b16 v[16:17], v32 offset:0
    v_add_f32 v44, v44, v99
    v_mfma_f32_16x16x32_bf16 v[248:251], v[24:27], v[88:91], v[248:251]
    ds_read_b64_tr_b16 v[18:19], v32 offset:512
    v_cvt_pk_bf16_f32 v97, v98, v99
    v_mfma_f32_16x16x32_bf16 v[216:219], v[24:27], v[80:83], v[216:219]
    buffer_load_dwordx4 v9, s[80:83], s21 offen offset:1056 lds
    v_mfma_f32_16x16x32_bf16 v[220:223], v[28:31], v[80:83], v[220:223]
    v_exp_f32 v100, v100
    v_mfma_f32_16x16x32_bf16 v[188:191], v[28:31], v[72:75], v[188:191]
    v_exp_f32 v101, v101
    v_mfma_f32_16x16x32_bf16 v[184:187], v[24:27], v[72:75], v[184:187]
L_pg8:
    s_cbranch_execz L_pg12
    buffer_load_dwordx4 v10, s[80:83], s21 offen offset:2112 lds
    v_mfma_f32_16x16x32_bf16 v[152:155], v[24:27], v[64:67], v[152:155]
    ds_read_b64_tr_b16 v[24:25], v32 offset:64
    v_add_f32 v44, v44, v100
    v_mfma_f32_16x16x32_bf16 v[156:159], v[28:31], v[64:67], v[156:159]
    ds_read_b64_tr_b16 v[26:27], v32 offset:576
    s_waitcnt lgkmcnt(2)
    v_mfma_f32_16x16x32_bf16 a[128:131], v[16:19], v[64:67], a[128:131]
    ds_read_b64_tr_b16 v[28:29], v32 offset:96
    v_add_f32 v44, v44, v101
    v_mfma_f32_16x16x32_bf16 a[132:135], v[20:23], v[64:67], a[132:135]
    ds_read_b64_tr_b16 v[30:31], v32 offset:608
    v_cvt_pk_bf16_f32 v98, v100, v101
    v_mfma_f32_16x16x32_bf16 a[164:167], v[20:23], v[72:75], a[164:167]
    v_exp_f32 v102, v102
    v_mfma_f32_16x16x32_bf16 a[160:163], v[16:19], v[72:75], a[160:163]
    v_exp_f32 v103, v103
    v_mfma_f32_16x16x32_bf16 a[192:195], v[16:19], v[80:83], a[192:195]
    buffer_load_dwordx4 v11, s[80:83], s21 offen offset:3168 lds
    v_mfma_f32_16x16x32_bf16 a[196:199], v[20:23], v[80:83], a[196:199]
    v_add_f32 v44, v44, v102
    v_add_f32 v44, v44, v103
    v_mfma_f32_16x16x32_bf16 a[228:231], v[20:23], v[88:91], a[228:231]
    ds_read_b64_tr_b16 v[20:21], v32 offset:4256
    v_cvt_pk_bf16_f32 v99, v102, v103
    v_mfma_f32_16x16x32_bf16 a[224:227], v[16:19], v[88:91], a[224:227]
    ds_read_b64_tr_b16 v[22:23], v32 offset:4768
    s_waitcnt lgkmcnt(2)
    v_mfma_f32_16x16x32_bf16 a[236:239], v[28:31], v[88:91], a[236:239]
    ds_read_b64_tr_b16 v[16:17], v32 offset:4224
    v_mfma_f32_16x16x32_bf16 a[232:235], v[24:27], v[88:91], a[232:235]
    s_mov_b32 m0, s72
    ds_read_b64_tr_b16 v[18:19], v32 offset:4736
    v_mfma_f32_16x16x32_bf16 a[200:203], v[24:27], v[80:83], a[200:203]
    buffer_load_dwordx4 v3, s[64:67], s21 offen offset:0 lds
    v_mfma_f32_16x16x32_bf16 a[204:207], v[28:31], v[80:83], a[204:207]
    v_exp_f32 v104, v104
    v_mfma_f32_16x16x32_bf16 a[172:175], v[28:31], v[72:75], a[172:175]
    v_exp_f32 v105, v105
    v_mfma_f32_16x16x32_bf16 a[168:171], v[24:27], v[72:75], a[168:171]
    buffer_load_dwordx4 v6, s[64:67], s21 offen offset:1056 lds
    v_mfma_f32_16x16x32_bf16 a[136:139], v[24:27], v[64:67], a[136:139]
    ds_read_b64_tr_b16 v[24:25], v32 offset:4288
    v_add_f32 v45, v13, v104
    v_mfma_f32_16x16x32_bf16 a[140:143], v[28:31], v[64:67], a[140:143]
    ds_read_b64_tr_b16 v[26:27], v32 offset:4800
    s_waitcnt lgkmcnt(2)
    v_mfma_f32_16x16x32_bf16 a[144:147], v[16:19], v[64:67], a[144:147]
    ds_read_b64_tr_b16 v[28:29], v32 offset:4320
    v_add_f32 v45, v45, v105
    v_mfma_f32_16x16x32_bf16 a[148:151], v[20:23], v[64:67], a[148:151]
    ds_read_b64_tr_b16 v[30:31], v32 offset:4832
    v_cvt_pk_bf16_f32 v104, v104, v105
    v_mfma_f32_16x16x32_bf16 a[180:183], v[20:23], v[72:75], a[180:183]
    v_exp_f32 v106, v106
    v_mfma_f32_16x16x32_bf16 a[176:179], v[16:19], v[72:75], a[176:179]
    buffer_load_dwordx4 v7, s[64:67], s21 offen offset:2112 lds
    v_mfma_f32_16x16x32_bf16 a[208:211], v[16:19], v[80:83], a[208:211]
    v_exp_f32 v107, v107
    v_mfma_f32_16x16x32_bf16 a[212:215], v[20:23], v[80:83], a[212:215]
    v_add_f32 v45, v45, v106
    v_add_f32 v45, v45, v107
    v_mfma_f32_16x16x32_bf16 a[244:247], v[20:23], v[88:91], a[244:247]
    ds_read_b128 v[20:23], v1 offset:33856
    v_cvt_pk_bf16_f32 v105, v106, v107
    v_mfma_f32_16x16x32_bf16 a[240:243], v[16:19], v[88:91], a[240:243]
    ds_read_b128 v[16:19], v1 offset:33792
    s_waitcnt lgkmcnt(2)
    v_mfma_f32_16x16x32_bf16 a[252:255], v[28:31], v[88:91], a[252:255]
    v_exp_f32 v108, v108
    v_mfma_f32_16x16x32_bf16 a[248:251], v[24:27], v[88:91], a[248:251]
    v_add_f32 v45, v45, v108
    v_mfma_f32_16x16x32_bf16 a[216:219], v[24:27], v[80:83], a[216:219]
    buffer_load_dwordx4 v8, s[64:67], s21 offen offset:3168 lds
    v_mfma_f32_16x16x32_bf16 a[220:223], v[28:31], v[80:83], a[220:223]
    v_exp_f32 v109, v109
    v_mfma_f32_16x16x32_bf16 a[188:191], v[28:31], v[72:75], a[188:191]
    v_add_f32 v45, v45, v109
    v_cvt_pk_bf16_f32 v106, v108, v109
    v_mfma_f32_16x16x32_bf16 a[184:187], v[24:27], v[72:75], a[184:187]
    v_mfma_f32_16x16x32_bf16 a[152:155], v[24:27], v[64:67], a[152:155]
    ds_read_b128 v[24:27], v1 offset:42240
    s_add_u32 s26, s26, 1
    s_cmp_lt_u32 s26, 15
    v_mfma_f32_16x16x32_bf16 a[156:159], v[28:31], v[64:67], a[156:159]
    ds_read_b128 v[28:31], v1 offset:42304
    s_cbranch_scc1 L_att_loop
    s_mul_i32 s26, s19, 7
    s_add_u32 s26, s26, s16
    v_lshlrev_b32 v6, 4, v0
    v_and_b32 v7, 15, v0
    v_mul_u32_u24 v7, 896, v7
    v_lshrrev_b32 v8, 4, v0
    v_lshl_add_u32 v7, v8, 3, v7
    s_lshl_b32 s27, s26, 10
    s_and_b32 s28, s26, 3
    s_mul_i32 s28, s28, 14336
    s_lshr_b32 s29, s26, 2
    s_lshl_b32 s29, s29, 6
    s_add_u32 s28, s28, s29
    v_add_u32 v1, s27, v6
    v_add_u32 v4, s28, v7
    s_add_u32 s26, s26, 4
    s_lshl_b32 s27, s26, 10
    s_and_b32 s28, s26, 3
    s_mul_i32 s28, s28, 14336
    s_lshr_b32 s29, s26, 2
    s_lshl_b32 s29, s29, 6
    s_add_u32 s28, s28, s29
    s_cmp_eq_u32 s16, 3
    s_cselect_b32 s27, 0x40000000, s27
    s_cselect_b32 s28, 0x40000000, s28
    v_add_u32 v3, s27, v6
    v_add_u32 v33, s28, v7
    s_mul_i32 s24, s20, 57344
    s_mul_i32 s25, s20, 57344
    v_readfirstlane_b32 s29, v5
    s_cmp_ge_u32 s29, 8
    s_cbranch_scc0 L_spinD
L_okD:
    s_waitcnt lgkmcnt(0) vmcnt(0)
    s_barrier
    ds_read_b64_tr_b16 v[16:17], v32 offset:33792
    ds_read_b64_tr_b16 v[18:19], v32 offset:34304
    ds_read_b64_tr_b16 v[20:21], v32 offset:33824
    ds_read_b64_tr_b16 v[22:23], v32 offset:34336
    ds_read_b64_tr_b16 v[24:25], v32 offset:33856
    ds_read_b64_tr_b16 v[26:27], v32 offset:34368
    ds_read_b64_tr_b16 v[28:29], v32 offset:33888
    ds_read_b64_tr_b16 v[30:31], v32 offset:34400
    v_exp_f32 v110, v110
    v_exp_f32 v111, v111
    v_add_f32 v45, v45, v110
    v_exp_f32 v112, v112
    v_add_f32 v45, v45, v111
    v_cvt_pk_bf16_f32 v107, v110, v111
    v_exp_f32 v113, v113
    v_add_f32 v46, v14, v112
    v_exp_f32 v114, v114
    v_add_f32 v46, v46, v113
    v_cvt_pk_bf16_f32 v112, v112, v113
    v_exp_f32 v115, v115
    v_add_f32 v46, v46, v114
    v_exp_f32 v116, v116
    v_add_f32 v46, v46, v115
    v_cvt_pk_bf16_f32 v113, v114, v115
    v_exp_f32 v117, v117
    v_add_f32 v46, v46, v116
    v_exp_f32 v118, v118
    v_add_f32 v46, v46, v117
    v_cvt_pk_bf16_f32 v114, v116, v117
    v_exp_f32 v119, v119
    v_add_f32 v46, v46, v118
    v_exp_f32 v120, v120
    v_add_f32 v46, v46, v119
    v_cvt_pk_bf16_f32 v115, v118, v119
    v_exp_f32 v121, v121
    v_add_f32 v47, v15, v120
    v_exp_f32 v122, v122
    v_add_f32 v47, v47, v121
    v_cvt_pk_bf16_f32 v120, v120, v121
    v_exp_f32 v123, v123
    v_add_f32 v47, v47, v122
    v_exp_f32 v124, v124
    v_add_f32 v47, v47, v123
    v_cvt_pk_bf16_f32 v121, v122, v123
    v_exp_f32 v125, v125
    v_add_f32 v47, v47, v124
    v_exp_f32 v126, v126
    v_add_f32 v47, v47, v125
    v_cvt_pk_bf16_f32 v122, v124, v125
    v_exp_f32 v127, v127
    v_add_f32 v47, v47, v126
    s_nop 0
    v_add_f32 v47, v47, v127
    v_cvt_pk_bf16_f32 v123, v126, v127
    v_max3_f32 v43, v44, v45, v46
    v_max_f32 v43, v43, v47
    v_cmp_ngt_f32 vcc, 0x57800000, v43
    s_cbranch_vccnz L_rare3
L_back3:
    s_waitcnt lgkmcnt(4)
    v_mfma_f32_16x16x32_bf16 a[128:131], v[16:19], v[96:99], a[128:131]
    s_add_u32 s29, s16, 1
    s_lshr_b32 s29, s29, 2
    v_mov_b32 v36, v44
    v_mov_b32 v37, v45
    s_add_u32 s26, s24, 0
    v_mfma_f32_16x16x32_bf16 a[132:135], v[20:23], v[96:99], a[132:135]
    s_add_u32 s29, s29, s16
    s_lshl_b32 s29, s29, 15
    v_lshlrev_b32 v6, 4, v0
    v_add_u32 v6, s29, v6
    v_mfma_f32_16x16x32_bf16 a[164:167], v[20:23], v[104:107], a[164:167]
    v_mov_b32 v38, v46
    v_mov_b32 v39, v47
    v_mfma_f32_16x16x32_bf16 a[160:163], v[16:19], v[104:107], a[160:163]
    v_permlane16_swap_b32 v36, v44
    v_permlane16_swap_b32 v37, v45
    v_mfma_f32_16x16x32_bf16 a[192:195], v[16:19], v[112:115], a[192:195]
    v_permlane16_swap_b32 v38, v46
    v_permlane16_swap_b32 v39, v47
    v_mfma_f32_16x16x32_bf16 a[196:199], v[20:23], v[112:115], a[196:199]
    v_add_f32 v44, v44, v36
    v_add_f32 v45, v45, v37
    v_mfma_f32_16x16x32_bf16 a[228:231], v[20:23], v[120:123], a[228:231]
    ds_read_b64_tr_b16 v[20:21], v32 offset:38048
    v_add_f32 v46, v46, v38
    v_mfma_f32_16x16x32_bf16 a[224:227], v[16:19], v[120:123], a[224:227]
    ds_read_b64_tr_b16 v[22:23], v32 offset:38560
    s_waitcnt lgkmcnt(2)
    v_mfma_f32_16x16x32_bf16 a[236:239], v[28:31], v[120:123], a[236:239]
    ds_read_b64_tr_b16 v[16:17], v32 offset:38016
    v_add_f32 v47, v47, v39
    v_mfma_f32_16x16x32_bf16 a[232:235], v[24:27], v[120:123], a[232:235]
    ds_read_b64_tr_b16 v[18:19], v32 offset:38528
    v_mov_b32 v36, v44
    v_mfma_f32_16x16x32_bf16 a[200:203], v[24:27], v[112:115], a[200:203]
    v_mov_b32 v37, v45
    v_mov_b32 v38, v46
    v_mfma_f32_16x16x32_bf16 a[204:207], v[28:31], v[112:115], a[204:207]
    v_mov_b32 v39, v47
    v_permlane32_swap_b32 v36, v44
    v_mfma_f32_16x16x32_bf16 a[172:175], v[28:31], v[104:107], a[172:175]
    v_permlane32_swap_b32 v37, v45
    v_permlane32_swap_b32 v38, v46
    v_mfma_f32_16x16x32_bf16 a[168:171], v[24:27], v[104:107], a[168:171]
    v_permlane32_swap_b32 v39, v47
    v_add_f32 v44, v44, v36
    v_mfma_f32_16x16x32_bf16 a[136:139], v[24:27], v[96:99], a[136:139]
    ds_read_b64_tr_b16 v[24:25], v32 offset:38080
    ds_write_b128 v6, a[128:131] offset:4096
    v_mfma_f32_16x16x32_bf16 a[140:143], v[28:31], v[96:99], a[140:143]
    ds_read_b64_tr_b16 v[26:27], v32 offset:38592
    s_waitcnt lgkmcnt(3)
    v_mfma_f32_16x16x32_bf16 a[144:147], v[16:19], v[96:99], a[144:147]
    ds_read_b64_tr_b16 v[28:29], v32 offset:38112
    v_add_f32 v45, v45, v37
    v_mfma_f32_16x16x32_bf16 a[148:151], v[20:23], v[96:99], a[148:151]
    ds_read_b64_tr_b16 v[30:31], v32 offset:38624
    v_add_f32 v46, v46, v38
    v_mfma_f32_16x16x32_bf16 a[180:183], v[20:23], v[104:107], a[180:183]
    ds_write_b128 v6, a[160:163] offset:12288
    v_add_f32 v47, v47, v39
    v_mfma_f32_16x16x32_bf16 a[176:179], v[16:19], v[104:107], a[176:179]
    v_mov_b32 v40, v48
    v_mov_b32 v41, v52
    v_mfma_f32_16x16x32_bf16 a[208:211], v[16:19], v[112:115], a[208:211]
    v_mov_b32 v42, v56
    v_mov_b32 v43, v60
    v_mfma_f32_16x16x32_bf16 a[212:215], v[20:23], v[112:115], a[212:215]
    v_lshlrev_b32 v11, 4, v0
    s_xor_b32 s28, s16, 2
    s_add_u32 s27, s28, 1
    buffer_load_dwordx4 a[0:3], v1, s[12:15], s26 offen sc1
    s_add_u32 s26, s26, 1835008
    v_mfma_f32_16x16x32_bf16 a[244:247], v[20:23], v[120:123], a[244:247]
    ds_read_b64_tr_b16 v[20:21], v2 offset:33824
    ds_write_b128 v6, a[192:195] offset:20480
    s_lshr_b32 s27, s27, 2
    s_add_u32 s27, s27, s28
    v_mfma_f32_16x16x32_bf16 a[240:243], v[16:19], v[120:123], a[240:243]
    ds_read_b64_tr_b16 v[22:23], v2 offset:34336
    s_lshl_b32 s27, s27, 15
    s_waitcnt lgkmcnt(4)
    v_mfma_f32_16x16x32_bf16 a[252:255], v[28:31], v[120:123], a[252:255]
    ds_read_b64_tr_b16 v[16:17], v2 offset:33792
    v_add_u32 v7, s27, v11
    v_mfma_f32_16x16x32_bf16 a[248:251], v[24:27], v[120:123], a[248:251]
    ds_read_b64_tr_b16 v[18:19], v2 offset:34304
    v_and_b32 v11, 15, v0
    v_mfma_f32_16x16x32_bf16 a[216:219], v[24:27], v[112:115], a[216:219]
    ds_write_b128 v6, a[224:227] offset:28672
    v_lshlrev_b32 v11, 4, v11
    s_lshl_b32 s27, s16, 9
    s_add_u32 s27, s27, 98304
    v_mfma_f32_16x16x32_bf16 a[220:223], v[28:31], v[112:115], a[220:223]
    v_add_u32 v8, s27, v11
    s_xor_b32 s28, s27, 0x400
    v_add_u32 v9, s28, v11
    v_mfma_f32_16x16x32_bf16 a[188:191], v[28:31], v[104:107], a[188:191]
    ds_write_b128 v8, v[40:43]
    buffer_load_dwordx4 a[4:7], v1, s[12:15], s26 offen sc1
    s_add_u32 s26, s26, 1835008
    v_mfma_f32_16x16x32_bf16 a[184:187], v[24:27], v[104:107], a[184:187]
    v_mfma_f32_16x16x32_bf16 a[152:155], v[24:27], v[96:99], a[152:155]
    ds_read_b64_tr_b16 v[24:25], v2 offset:33856
    ds_write_b128 v6, a[132:135] offset:5120
    v_mfma_f32_16x16x32_bf16 a[156:159], v[28:31], v[96:99], a[156:159]
    ds_read_b64_tr_b16 v[26:27], v2 offset:34368
    s_waitcnt lgkmcnt(5)
    v_mfma_f32_16x16x32_bf16 v[128:131], v[16:19], v[96:99], v[128:131]
    ds_read_b64_tr_b16 v[28:29], v2 offset:33888
    ds_write_b128 v8, v[44:47] offset:256
    v_mfma_f32_16x16x32_bf16 v[132:135], v[20:23], v[96:99], v[132:135]
    ds_read_b64_tr_b16 v[30:31], v2 offset:34400
    buffer_load_dwordx4 a[8:11], v1, s[12:15], s26 offen sc1
    s_add_u32 s26, s26, 1835008
    v_mfma_f32_16x16x32_bf16 v[164:167], v[20:23], v[104:107], v[164:167]
    ds_write_b128 v6, a[164:167] offset:13312
    v_mfma_f32_16x16x32_bf16 v[160:163], v[16:19], v[104:107], v[160:163]
    v_mfma_f32_16x16x32_bf16 v[192:195], v[16:19], v[112:115], v[192:195]
    buffer_load_dwordx4 a[12:15], v1, s[12:15], s26 offen sc1
    s_add_u32 s26, s26, 1835008
    v_mfma_f32_16x16x32_bf16 v[196:199], v[20:23], v[112:115], v[196:199]
    v_mfma_f32_16x16x32_bf16 v[228:231], v[20:23], v[120:123], v[228:231]
    ds_read_b64_tr_b16 v[20:21], v2 offset:38048
    ds_write_b128 v6, a[196:199] offset:21504
    v_mfma_f32_16x16x32_bf16 v[224:227], v[16:19], v[120:123], v[224:227]
    ds_read_b64_tr_b16 v[22:23], v2 offset:38560
    s_waitcnt lgkmcnt(4)
    v_mfma_f32_16x16x32_bf16 v[236:239], v[28:31], v[120:123], v[236:239]
    ds_read_b64_tr_b16 v[16:17], v2 offset:38016
    buffer_load_dwordx4 a[16:19], v1, s[12:15], s26 offen sc1
    s_add_u32 s26, s26, 1835008
    v_mfma_f32_16x16x32_bf16 v[232:235], v[24:27], v[120:123], v[232:235]
    ds_read_b64_tr_b16 v[18:19], v2 offset:38528
    v_mfma_f32_16x16x32_bf16 v[200:203], v[24:27], v[112:115], v[200:203]
    ds_write_b128 v6, a[228:231] offset:29696
    v_mfma_f32_16x16x32_bf16 v[204:207], v[28:31], v[112:115], v[204:207]
    buffer_load_dwordx4 a[20:23], v1, s[12:15], s26 offen sc1
    s_add_u32 s26, s26, 1835008
    v_mfma_f32_16x16x32_bf16 v[172:175], v[28:31], v[104:107], v[172:175]
    v_mfma_f32_16x16x32_bf16 v[168:171], v[24:27], v[104:107], v[168:171]
    v_mfma_f32_16x16x32_bf16 v[136:139], v[24:27], v[96:99], v[136:139]
    ds_read_b64_tr_b16 v[24:25], v2 offset:38080
    ds_write_b128 v6, a[136:139] offset:6144
    v_mfma_f32_16x16x32_bf16 v[140:143], v[28:31], v[96:99], v[140:143]
    ds_read_b64_tr_b16 v[26:27], v2 offset:38592
    s_waitcnt lgkmcnt(4)
    v_mfma_f32_16x16x32_bf16 v[144:147], v[16:19], v[96:99], v[144:147]
    ds_read_b64_tr_b16 v[28:29], v2 offset:38112
    buffer_load_dwordx4 a[24:27], v1, s[12:15], s26 offen sc1
    v_mfma_f32_16x16x32_bf16 v[148:151], v[20:23], v[96:99], v[148:151]
    ds_read_b64_tr_b16 v[30:31], v2 offset:38624
    v_mfma_f32_16x16x32_bf16 v[180:183], v[20:23], v[104:107], v[180:183]
    ds_write_b128 v6, a[168:171] offset:14336
    v_mfma_f32_16x16x32_bf16 v[176:179], v[16:19], v[104:107], v[176:179]
    buffer_load_dwordx2 a[28:29], v4, s[44:47], s25 offen offset:0
    v_mfma_f32_16x16x32_bf16 v[208:211], v[16:19], v[112:115], v[208:211]
    v_mfma_f32_16x16x32_bf16 v[212:215], v[20:23], v[112:115], v[212:215]
    v_mfma_f32_16x16x32_bf16 v[244:247], v[20:23], v[120:123], v[244:247]
    ds_write_b128 v6, a[200:203] offset:22528
    buffer_load_dwordx2 a[30:31], v4, s[44:47], s25 offen offset:32
    s_add_u32 s26, s24, 0
    v_mfma_f32_16x16x32_bf16 v[240:243], v[16:19], v[120:123], v[240:243]
    s_waitcnt lgkmcnt(2)
    v_mfma_f32_16x16x32_bf16 v[252:255], v[28:31], v[120:123], v[252:255]
    v_mfma_f32_16x16x32_bf16 v[248:251], v[24:27], v[120:123], v[248:251]
    buffer_load_dwordx4 a[32:35], v3, s[12:15], s26 offen sc1
    s_add_u32 s26, s26, 1835008
    v_mfma_f32_16x16x32_bf16 v[216:219], v[24:27], v[112:115], v[216:219]
    ds_write_b128 v6, a[232:235] offset:30720
    v_mfma_f32_16x16x32_bf16 v[220:223], v[28:31], v[112:115], v[220:223]
    v_mfma_f32_16x16x32_bf16 v[188:191], v[28:31], v[104:107], v[188:191]
    buffer_load_dwordx4 a[36:39], v3, s[12:15], s26 offen sc1
    s_add_u32 s26, s26, 1835008
    v_mfma_f32_16x16x32_bf16 v[184:187], v[24:27], v[104:107], v[184:187]
    v_mfma_f32_16x16x32_bf16 v[152:155], v[24:27], v[96:99], v[152:155]
    ds_write_b128 v6, a[140:143] offset:7168
    v_mfma_f32_16x16x32_bf16 v[156:159], v[28:31], v[96:99], v[156:159]
    buffer_load_dwordx4 a[40:43], v3, s[12:15], s26 offen sc1
    s_add_u32 s26, s26, 1835008
    s_barrier
    ds_read_b128 v[24:27], v9
    ds_read_b128 v[28:31], v9 offset:256
    buffer_load_dwordx4 a[44:47], v3, s[12:15], s26 offen sc1
    s_add_u32 s26, s26, 1835008
    buffer_load_dwordx4 a[48:51], v3, s[12:15], s26 offen sc1
    s_add_u32 s26, s26, 1835008
    buffer_load_dwordx4 a[52:55], v3, s[12:15], s26 offen sc1
    s_add_u32 s26, s26, 1835008
    buffer_load_dwordx4 a[56:59], v3, s[12:15], s26 offen sc1
    buffer_load_dwordx2 a[60:61], v33, s[44:47], s25 offen offset:0
    buffer_load_dwordx2 a[62:63], v33, s[44:47], s25 offen offset:32
    ds_write_b128 v6, a[172:175] offset:15360
    v_bfe_u32 v36, v0, 3, 1
    v_bfe_u32 v37, v0, 4, 1
    v_lshl_add_u32 v36, v37, 3, v36
    v_lshrrev_b32 v37, 5, v0
    v_lshl_add_u32 v36, v37, 4, v36
    v_mul_u32_u24 v36, 896, v36
    v_and_b32 v37, 7, v0
    ds_write_b128 v6, a[204:207] offset:23552
    v_lshl_add_u32 v36, v37, 4, v36
    s_lshl_b32 s27, s16, 8
    v_add_u32 v104, s27, v36
    v_add_u32 v105, 736, v104
    v_add_u32 v106, 1472, v104
    v_add_u32 v107, 2208, v104
    s_cmp_eq_u32 s16, 3
    ds_write_b128 v6, a[236:239] offset:31744
    s_cselect_b32 s27, 0x40000000, 128
    v_add_u32 v108, s27, v104
    v_add_u32 v109, s27, v105
    v_add_u32 v110, s27, v106
    v_add_u32 v111, s27, v107
    s_mul_i32 s60, s16, 21120
    s_add_u32 s60, s60, 65536
    ds_write_b128 v6, a[144:147] offset:8192
    v_bfe_u32 v36, v0, 3, 2
    v_mul_u32_u24 v120, 1056, v36
    v_bfe_u32 v36, v0, 2, 1
    v_lshl_add_u32 v120, v36, 7, v120
    v_lshrrev_b32 v36, 5, v0
    v_lshl_add_u32 v120, v36, 8, v120
    v_and_b32 v36, 3, v0
    ds_write_b128 v6, a[176:179] offset:16384
    v_lshl_add_u32 v120, v36, 3, v120
    v_add_u32 v120, s60, v120
    v_and_b32 v36, 15, v0
    v_lshrrev_b32 v37, 4, v0
    v_lshlrev_b32 v121, 4, v36
    v_lshl_add_u32 v121, v37, 10, v121
    s_lshl_b32 s27, s17, 1
    ds_write_b128 v6, a[208:211] offset:24576
    s_add_u32 s27, s27, s18
    s_lshl_b32 s27, s27, 14
    v_add_u32 v10, s27, v121
    s_waitcnt lgkmcnt(6)
    v_min_f32 v16, v40, v24
    v_min_f32 v17, v41, v25
    v_min_f32 v18, v42, v26
    ds_write_b128 v6, a[148:151] offset:9216
    v_min_f32 v19, v43, v27
    v_sub_f32 v20, v16, v40
    v_sub_f32 v21, v17, v41
    v_sub_f32 v22, v18, v42
    v_sub_f32 v23, v19, v43
    v_sub_f32 v24, v16, v24
    v_sub_f32 v25, v17, v25
    ds_write_b128 v6, a[180:183] offset:17408
    v_sub_f32 v26, v18, v26
    v_sub_f32 v27, v19, v27
    v_exp_f32 v20, v20
    v_exp_f32 v21, v21
    v_exp_f32 v22, v22
    v_exp_f32 v23, v23
    v_exp_f32 v24, v24
    ds_write_b128 v6, a[212:215] offset:25600
    v_exp_f32 v25, v25
    v_exp_f32 v26, v26
    v_exp_f32 v27, v27
    v_mul_f32 v44, v44, v20
    v_mul_f32 v45, v45, v21
    v_mul_f32 v46, v46, v22
    v_mul_f32 v47, v47, v23
    ds_write_b128 v6, a[152:155] offset:10240
    v_fma_f32 v44, v28, v24, v44
    v_fma_f32 v45, v29, v25, v45
    v_fma_f32 v46, v30, v26, v46
    v_fma_f32 v47, v31, v27, v47
    v_rcp_f32 v44, v44
    v_rcp_f32 v45, v45
    v_rcp_f32 v46, v46
    ds_write_b128 v6, a[184:187] offset:18432
    v_rcp_f32 v47, v47
    v_mul_f32 v20, v20, v44
    v_mul_f32 v21, v21, v45
    v_mul_f32 v22, v22, v46
    v_mul_f32 v23, v23, v47
    v_mul_f32 v24, v24, v44
    v_mul_f32 v25, v25, v45
    ds_write_b128 v6, a[216:219] offset:26624
    v_mul_f32 v26, v26, v46
    v_mul_f32 v27, v27, v47
    v_pk_mul_f32 v[128:129], v[128:129], v[20:21] op_sel:[0,0] op_sel_hi:[1,0]
    v_pk_mul_f32 v[130:131], v[130:131], v[20:21] op_sel:[0,0] op_sel_hi:[1,0]
    v_pk_mul_f32 v[132:133], v[132:133], v[20:21] op_sel:[0,0] op_sel_hi:[1,0]
    v_pk_mul_f32 v[134:135], v[134:135], v[20:21] op_sel:[0,0] op_sel_hi:[1,0]
    v_pk_mul_f32 v[136:137], v[136:137], v[20:21] op_sel:[0,0] op_sel_hi:[1,0]
    ds_write_b128 v6, a[156:159] offset:11264
    v_pk_mul_f32 v[138:139], v[138:139], v[20:21] op_sel:[0,0] op_sel_hi:[1,0]
    v_pk_mul_f32 v[140:141], v[140:141], v[20:21] op_sel:[0,0] op_sel_hi:[1,0]
    v_pk_mul_f32 v[142:143], v[142:143], v[20:21] op_sel:[0,0] op_sel_hi:[1,0]
    v_pk_mul_f32 v[144:145], v[144:145], v[20:21] op_sel:[0,0] op_sel_hi:[1,0]
    v_pk_mul_f32 v[146:147], v[146:147], v[20:21] op_sel:[0,0] op_sel_hi:[1,0]
    v_pk_mul_f32 v[148:149], v[148:149], v[20:21] op_sel:[0,0] op_sel_hi:[1,0]
    v_pk_mul_f32 v[150:151], v[150:151], v[20:21] op_sel:[0,0] op_sel_hi:[1,0]
    ds_write_b128 v6, a[188:191] offset:19456
    v_pk_mul_f32 v[152:153], v[152:153], v[20:21] op_sel:[0,0] op_sel_hi:[1,0]
    v_pk_mul_f32 v[154:155], v[154:155], v[20:21] op_sel:[0,0] op_sel_hi:[1,0]
    v_pk_mul_f32 v[156:157], v[156:157], v[20:21] op_sel:[0,0] op_sel_hi:[1,0]
    v_pk_mul_f32 v[158:159], v[158:159], v[20:21] op_sel:[0,0] op_sel_hi:[1,0]
    v_pk_mul_f32 v[160:161], v[160:161], v[20:21] op_sel:[0,1] op_sel_hi:[1,1]
    v_pk_mul_f32 v[162:163], v[162:163], v[20:21] op_sel:[0,1] op_sel_hi:[1,1]
    v_pk_mul_f32 v[164:165], v[164:165], v[20:21] op_sel:[0,1] op_sel_hi:[1,1]
    ds_write_b128 v6, a[220:223] offset:27648
    v_pk_mul_f32 v[166:167], v[166:167], v[20:21] op_sel:[0,1] op_sel_hi:[1,1]
    v_pk_mul_f32 v[168:169], v[168:169], v[20:21] op_sel:[0,1] op_sel_hi:[1,1]
    v_pk_mul_f32 v[170:171], v[170:171], v[20:21] op_sel:[0,1] op_sel_hi:[1,1]
    v_pk_mul_f32 v[172:173], v[172:173], v[20:21] op_sel:[0,1] op_sel_hi:[1,1]
    v_pk_mul_f32 v[174:175], v[174:175], v[20:21] op_sel:[0,1] op_sel_hi:[1,1]
    v_pk_mul_f32 v[176:177], v[176:177], v[20:21] op_sel:[0,1] op_sel_hi:[1,1]
    v_pk_mul_f32 v[178:179], v[178:179], v[20:21] op_sel:[0,1] op_sel_hi:[1,1]
    ds_write_b128 v6, a[240:243] offset:0
    v_pk_mul_f32 v[180:181], v[180:181], v[20:21] op_sel:[0,1] op_sel_hi:[1,1]
    v_pk_mul_f32 v[182:183], v[182:183], v[20:21] op_sel:[0,1] op_sel_hi:[1,1]
    v_pk_mul_f32 v[184:185], v[184:185], v[20:21] op_sel:[0,1] op_sel_hi:[1,1]
    v_pk_mul_f32 v[186:187], v[186:187], v[20:21] op_sel:[0,1] op_sel_hi:[1,1]
    v_pk_mul_f32 v[188:189], v[188:189], v[20:21] op_sel:[0,1] op_sel_hi:[1,1]
    v_pk_mul_f32 v[190:191], v[190:191], v[20:21] op_sel:[0,1] op_sel_hi:[1,1]
    v_pk_mul_f32 v[192:193], v[192:193], v[22:23] op_sel:[0,0] op_sel_hi:[1,0]
    ds_write_b128 v6, a[244:247] offset:1024
    v_pk_mul_f32 v[194:195], v[194:195], v[22:23] op_sel:[0,0] op_sel_hi:[1,0]
    v_pk_mul_f32 v[196:197], v[196:197], v[22:23] op_sel:[0,0] op_sel_hi:[1,0]
    v_pk_mul_f32 v[198:199], v[198:199], v[22:23] op_sel:[0,0] op_sel_hi:[1,0]
    v_pk_mul_f32 v[200:201], v[200:201], v[22:23] op_sel:[0,0] op_sel_hi:[1,0]
    v_pk_mul_f32 v[202:203], v[202:203], v[22:23] op_sel:[0,0] op_sel_hi:[1,0]
    v_pk_mul_f32 v[204:205], v[204:205], v[22:23] op_sel:[0,0] op_sel_hi:[1,0]
    v_pk_mul_f32 v[206:207], v[206:207], v[22:23] op_sel:[0,0] op_sel_hi:[1,0]
    ds_write_b128 v6, a[248:251] offset:2048
    v_pk_mul_f32 v[208:209], v[208:209], v[22:23] op_sel:[0,0] op_sel_hi:[1,0]
    v_pk_mul_f32 v[210:211], v[210:211], v[22:23] op_sel:[0,0] op_sel_hi:[1,0]
    v_pk_mul_f32 v[212:213], v[212:213], v[22:23] op_sel:[0,0] op_sel_hi:[1,0]
    v_pk_mul_f32 v[214:215], v[214:215], v[22:23] op_sel:[0,0] op_sel_hi:[1,0]
    v_pk_mul_f32 v[216:217], v[216:217], v[22:23] op_sel:[0,0] op_sel_hi:[1,0]
    v_pk_mul_f32 v[218:219], v[218:219], v[22:23] op_sel:[0,0] op_sel_hi:[1,0]
    v_pk_mul_f32 v[220:221], v[220:221], v[22:23] op_sel:[0,0] op_sel_hi:[1,0]
    ds_write_b128 v6, a[252:255] offset:3072
    v_pk_mul_f32 v[222:223], v[222:223], v[22:23] op_sel:[0,0] op_sel_hi:[1,0]
    v_pk_mul_f32 v[224:225], v[224:225], v[22:23] op_sel:[0,1] op_sel_hi:[1,1]
    v_pk_mul_f32 v[226:227], v[226:227], v[22:23] op_sel:[0,1] op_sel_hi:[1,1]
    v_pk_mul_f32 v[228:229], v[228:229], v[22:23] op_sel:[0,1] op_sel_hi:[1,1]
    v_pk_mul_f32 v[230:231], v[230:231], v[22:23] op_sel:[0,1] op_sel_hi:[1,1]
    v_pk_mul_f32 v[232:233], v[232:233], v[22:23] op_sel:[0,1] op_sel_hi:[1,1]
    v_pk_mul_f32 v[234:235], v[234:235], v[22:23] op_sel:[0,1] op_sel_hi:[1,1]
    v_pk_mul_f32 v[236:237], v[236:237], v[22:23] op_sel:[0,1] op_sel_hi:[1,1]
    v_pk_mul_f32 v[238:239], v[238:239], v[22:23] op_sel:[0,1] op_sel_hi:[1,1]
    v_pk_mul_f32 v[240:241], v[240:241], v[22:23] op_sel:[0,1] op_sel_hi:[1,1]
    v_pk_mul_f32 v[242:243], v[242:243], v[22:23] op_sel:[0,1] op_sel_hi:[1,1]
    v_pk_mul_f32 v[244:245], v[244:245], v[22:23] op_sel:[0,1] op_sel_hi:[1,1]
    v_pk_mul_f32 v[246:247], v[246:247], v[22:23] op_sel:[0,1] op_sel_hi:[1,1]
    v_pk_mul_f32 v[248:249], v[248:249], v[22:23] op_sel:[0,1] op_sel_hi:[1,1]
    v_pk_mul_f32 v[250:251], v[250:251], v[22:23] op_sel:[0,1] op_sel_hi:[1,1]
    v_pk_mul_f32 v[252:253], v[252:253], v[22:23] op_sel:[0,1] op_sel_hi:[1,1]
    v_pk_mul_f32 v[254:255], v[254:255], v[22:23] op_sel:[0,1] op_sel_hi:[1,1]
    s_waitcnt lgkmcnt(0)
    s_barrier
    ds_read_b128 v[36:39], v7 offset:4096
    ds_read_b128 v[40:43], v7 offset:5120
    ds_read_b128 v[44:47], v7 offset:6144
    ds_read_b128 v[48:51], v7 offset:7168
    ds_read_b128 v[52:55], v7 offset:8192
    ds_read_b128 v[56:59], v7 offset:9216
    ds_read_b128 v[60:63], v7 offset:10240
    ds_read_b128 v[64:67], v7 offset:11264
    ds_read_b128 v[68:71], v7 offset:12288
    ds_read_b128 v[72:75], v7 offset:13312
    ds_read_b128 v[76:79], v7 offset:14336
    ds_read_b128 v[80:83], v7 offset:15360
    ds_read_b128 v[84:87], v7 offset:16384
    ds_read_b128 v[88:91], v7 offset:17408
    ds_read_b128 v[92:95], v7 offset:18432
    ds_read_b128 v[96:99], v7 offset:19456
    s_waitcnt lgkmcnt(15)
    v_pk_fma_f32 v[128:129], v[36:37], v[24:25], v[128:129] op_sel:[0,0,0] op_sel_hi:[1,0,1]
    v_pk_fma_f32 v[130:131], v[38:39], v[24:25], v[130:131] op_sel:[0,0,0] op_sel_hi:[1,0,1]
    v_cvt_pk_bf16_f32 v128, v128, v129
    v_cvt_pk_bf16_f32 v129, v130, v131
    ds_read_b128 v[36:39], v7 offset:20480
    s_waitcnt lgkmcnt(15)
    v_pk_fma_f32 v[132:133], v[40:41], v[24:25], v[132:133] op_sel:[0,0,0] op_sel_hi:[1,0,1]
    v_pk_fma_f32 v[134:135], v[42:43], v[24:25], v[134:135] op_sel:[0,0,0] op_sel_hi:[1,0,1]
    v_cvt_pk_bf16_f32 v130, v132, v133
    v_cvt_pk_bf16_f32 v131, v134, v135
    ds_read_b128 v[40:43], v7 offset:21504
    s_waitcnt lgkmcnt(15)
    v_pk_fma_f32 v[136:137], v[44:45], v[24:25], v[136:137] op_sel:[0,0,0] op_sel_hi:[1,0,1]
    v_pk_fma_f32 v[138:139], v[46:47], v[24:25], v[138:139] op_sel:[0,0,0] op_sel_hi:[1,0,1]
    v_cvt_pk_bf16_f32 v136, v136, v137
    v_cvt_pk_bf16_f32 v137, v138, v139
    ds_read_b128 v[44:47], v7 offset:22528
    s_waitcnt lgkmcnt(15)
    v_pk_fma_f32 v[140:141], v[48:49], v[24:25], v[140:141] op_sel:[0,0,0] op_sel_hi:[1,0,1]
    v_pk_fma_f32 v[142:143], v[50:51], v[24:25], v[142:143] op_sel:[0,0,0] op_sel_hi:[1,0,1]
    v_cvt_pk_bf16_f32 v138, v140, v141
    v_cvt_pk_bf16_f32 v139, v142, v143
    ds_read_b128 v[48:51], v7 offset:23552
    s_waitcnt lgkmcnt(15)
    v_pk_fma_f32 v[144:145], v[52:53], v[24:25], v[144:145] op_sel:[0,0,0] op_sel_hi:[1,0,1]
    v_pk_fma_f32 v[146:147], v[54:55], v[24:25], v[146:147] op_sel:[0,0,0] op_sel_hi:[1,0,1]
    v_cvt_pk_bf16_f32 v144, v144, v145
    v_cvt_pk_bf16_f32 v145, v146, v147
    ds_read_b128 v[52:55], v7 offset:24576
    s_waitcnt lgkmcnt(15)
    v_pk_fma_f32 v[148:149], v[56:57], v[24:25], v[148:149] op_sel:[0,0,0] op_sel_hi:[1,0,1]
    v_pk_fma_f32 v[150:151], v[58:59], v[24:25], v[150:151] op_sel:[0,0,0] op_sel_hi:[1,0,1]
    v_cvt_pk_bf16_f32 v146, v148, v149
    v_cvt_pk_bf16_f32 v147, v150, v151
    ds_read_b128 v[56:59], v7 offset:25600
    s_waitcnt lgkmcnt(15)
    v_pk_fma_f32 v[152:153], v[60:61], v[24:25], v[152:153] op_sel:[0,0,0] op_sel_hi:[1,0,1]
    v_pk_fma_f32 v[154:155], v[62:63], v[24:25], v[154:155] op_sel:[0,0,0] op_sel_hi:[1,0,1]
    v_cvt_pk_bf16_f32 v152, v152, v153
    v_cvt_pk_bf16_f32 v153, v154, v155
    ds_read_b128 v[60:63], v7 offset:26624
    s_waitcnt lgkmcnt(15)
    v_pk_fma_f32 v[156:157], v[64:65], v[24:25], v[156:157] op_sel:[0,0,0] op_sel_hi:[1,0,1]
    v_pk_fma_f32 v[158:159], v[66:67], v[24:25], v[158:159] op_sel:[0,0,0] op_sel_hi:[1,0,1]
    v_cvt_pk_bf16_f32 v154, v156, v157
    v_cvt_pk_bf16_f32 v155, v158, v159
    ds_read_b128 v[64:67], v7 offset:27648
    s_waitcnt lgkmcnt(15)
    v_pk_fma_f32 v[160:161], v[68:69], v[24:25], v[160:161] op_sel:[0,1,0] op_sel_hi:[1,1,1]
    v_pk_fma_f32 v[162:163], v[70:71], v[24:25], v[162:163] op_sel:[0,1,0] op_sel_hi:[1,1,1]
    v_cvt_pk_bf16_f32 v160, v160, v161
    v_cvt_pk_bf16_f32 v161, v162, v163
    ds_read_b128 v[68:71], v7 offset:28672
    s_waitcnt lgkmcnt(15)
    v_pk_fma_f32 v[164:165], v[72:73], v[24:25], v[164:165] op_sel:[0,1,0] op_sel_hi:[1,1,1]
    v_pk_fma_f32 v[166:167], v[74:75], v[24:25], v[166:167] op_sel:[0,1,0] op_sel_hi:[1,1,1]
    v_cvt_pk_bf16_f32 v162, v164, v165
    v_cvt_pk_bf16_f32 v163, v166, v167
    ds_read_b128 v[72:75], v7 offset:29696
    s_waitcnt lgkmcnt(15)
    v_pk_fma_f32 v[168:169], v[76:77], v[24:25], v[168:169] op_sel:[0,1,0] op_sel_hi:[1,1,1]
    v_pk_fma_f32 v[170:171], v[78:79], v[24:25], v[170:171] op_sel:[0,1,0] op_sel_hi:[1,1,1]
    v_cvt_pk_bf16_f32 v168, v168, v169
    v_cvt_pk_bf16_f32 v169, v170, v171
    ds_read_b128 v[76:79], v7 offset:30720
    s_waitcnt lgkmcnt(15)
    v_pk_fma_f32 v[172:173], v[80:81], v[24:25], v[172:173] op_sel:[0,1,0] op_sel_hi:[1,1,1]
L_pg9:
    s_cbranch_execz L_pgret
    v_pk_fma_f32 v[174:175], v[82:83], v[24:25], v[174:175] op_sel:[0,1,0] op_sel_hi:[1,1,1]
    v_cvt_pk_bf16_f32 v170, v172, v173
    v_cvt_pk_bf16_f32 v171, v174, v175
    ds_read_b128 v[80:83], v7 offset:31744
    s_waitcnt lgkmcnt(15)
    v_pk_fma_f32 v[176:177], v[84:85], v[24:25], v[176:177] op_sel:[0,1,0] op_sel_hi:[1,1,1]
    v_pk_fma_f32 v[178:179], v[86:87], v[24:25], v[178:179] op_sel:[0,1,0] op_sel_hi:[1,1,1]
    v_cvt_pk_bf16_f32 v176, v176, v177
    v_cvt_pk_bf16_f32 v177, v178, v179
    ds_read_b128 v[84:87], v7 offset:0
    s_waitcnt lgkmcnt(15)
    v_pk_fma_f32 v[180:181], v[88:89], v[24:25], v[180:181] op_sel:[0,1,0] op_sel_hi:[1,1,1]
    v_pk_fma_f32 v[182:183], v[90:91], v[24:25], v[182:183] op_sel:[0,1,0] op_sel_hi:[1,1,1]
    v_cvt_pk_bf16_f32 v178, v180, v181
    v_cvt_pk_bf16_f32 v179, v182, v183
    ds_read_b128 v[88:91], v7 offset:1024
    s_waitcnt lgkmcnt(15)
    v_pk_fma_f32 v[184:185], v[92:93], v[24:25], v[184:185] op_sel:[0,1,0] op_sel_hi:[1,1,1]
    v_pk_fma_f32 v[186:187], v[94:95], v[24:25], v[186:187] op_sel:[0,1,0] op_sel_hi:[1,1,1]
    v_cvt_pk_bf16_f32 v184, v184, v185
    v_cvt_pk_bf16_f32 v185, v186, v187
    ds_read_b128 v[92:95], v7 offset:2048
    s_waitcnt lgkmcnt(15)
    v_pk_fma_f32 v[188:189], v[96:97], v[24:25], v[188:189] op_sel:[0,1,0] op_sel_hi:[1,1,1]
    v_pk_fma_f32 v[190:191], v[98:99], v[24:25], v[190:191] op_sel:[0,1,0] op_sel_hi:[1,1,1]
    v_cvt_pk_bf16_f32 v186, v188, v189
    v_cvt_pk_bf16_f32 v187, v190, v191
    ds_read_b128 v[96:99], v7 offset:3072
    s_waitcnt lgkmcnt(0)
    s_barrier
    s_mov_b32 s61, 0
    s_add_u32 m0, s60, 0
    ds_write_b128 v10, v[128:131] offset:0
    buffer_load_dwordx4 v104, s[52:55], s61 offen offset:0 lds
    v_pk_fma_f32 v[192:193], v[36:37], v[26:27], v[192:193] op_sel:[0,0,0] op_sel_hi:[1,0,1]
    v_pk_fma_f32 v[194:195], v[38:39], v[26:27], v[194:195] op_sel:[0,0,0] op_sel_hi:[1,0,1]
    v_cvt_pk_bf16_f32 v192, v192, v193
    v_cvt_pk_bf16_f32 v193, v194, v195
    ds_write_b128 v10, v[136:139] offset:4096
    buffer_load_dwordx4 v105, s[52:55], s61 offen offset:1056 lds
    v_pk_fma_f32 v[196:197], v[40:41], v[26:27], v[196:197] op_sel:[0,0,0] op_sel_hi:[1,0,1]
    v_pk_fma_f32 v[198:199], v[42:43], v[26:27], v[198:199] op_sel:[0,0,0] op_sel_hi:[1,0,1]
    v_cvt_pk_bf16_f32 v194, v196, v197
    v_cvt_pk_bf16_f32 v195, v198, v199
    ds_write_b128 v10, v[192:195] offset:512
    ds_write_b128 v10, v[144:147] offset:8192
    buffer_load_dwordx4 v106, s[52:55], s61 offen offset:2112 lds
    v_pk_fma_f32 v[200:201], v[44:45], v[26:27], v[200:201] op_sel:[0,0,0] op_sel_hi:[1,0,1]
    v_pk_fma_f32 v[202:203], v[46:47], v[26:27], v[202:203] op_sel:[0,0,0] op_sel_hi:[1,0,1]
    v_cvt_pk_bf16_f32 v200, v200, v201
    v_cvt_pk_bf16_f32 v201, v202, v203
    ds_write_b128 v10, v[152:155] offset:12288
    buffer_load_dwordx4 v107, s[52:55], s61 offen offset:3168 lds
    v_pk_fma_f32 v[204:205], v[48:49], v[26:27], v[204:205] op_sel:[0,0,0] op_sel_hi:[1,0,1]
    v_pk_fma_f32 v[206:207], v[50:51], v[26:27], v[206:207] op_sel:[0,0,0] op_sel_hi:[1,0,1]
    v_cvt_pk_bf16_f32 v202, v204, v205
    v_cvt_pk_bf16_f32 v203, v206, v207
    ds_write_b128 v10, v[200:203] offset:4608
    s_add_u32 m0, s60, 4224
    ds_write_b128 v10, v[160:163] offset:256
    buffer_load_dwordx4 v108, s[52:55], s61 offen offset:0 lds
    v_pk_fma_f32 v[208:209], v[52:53], v[26:27], v[208:209] op_sel:[0,0,0] op_sel_hi:[1,0,1]
    v_pk_fma_f32 v[210:211], v[54:55], v[26:27], v[210:211] op_sel:[0,0,0] op_sel_hi:[1,0,1]
    v_cvt_pk_bf16_f32 v208, v208, v209
    v_cvt_pk_bf16_f32 v209, v210, v211
    ds_write_b128 v10, v[168:171] offset:4352
    buffer_load_dwordx4 v109, s[52:55], s61 offen offset:1056 lds
    v_pk_fma_f32 v[212:213], v[56:57], v[26:27], v[212:213] op_sel:[0,0,0] op_sel_hi:[1,0,1]
    v_pk_fma_f32 v[214:215], v[58:59], v[26:27], v[214:215] op_sel:[0,0,0] op_sel_hi:[1,0,1]
    v_cvt_pk_bf16_f32 v210, v212, v213
    v_cvt_pk_bf16_f32 v211, v214, v215
    ds_write_b128 v10, v[208:211] offset:8704
    ds_write_b128 v10, v[176:179] offset:8448
    buffer_load_dwordx4 v110, s[52:55], s61 offen offset:2112 lds
    v_pk_fma_f32 v[216:217], v[60:61], v[26:27], v[216:217] op_sel:[0,0,0] op_sel_hi:[1,0,1]
    v_pk_fma_f32 v[218:219], v[62:63], v[26:27], v[218:219] op_sel:[0,0,0] op_sel_hi:[1,0,1]
    v_cvt_pk_bf16_f32 v216, v216, v217
    v_cvt_pk_bf16_f32 v217, v218, v219
    ds_write_b128 v10, v[184:187] offset:12544
    buffer_load_dwordx4 v111, s[52:55], s61 offen offset:3168 lds
    v_pk_fma_f32 v[220:221], v[64:65], v[26:27], v[220:221] op_sel:[0,0,0] op_sel_hi:[1,0,1]
    v_pk_fma_f32 v[222:223], v[66:67], v[26:27], v[222:223] op_sel:[0,0,0] op_sel_hi:[1,0,1]
    v_cvt_pk_bf16_f32 v218, v220, v221
    v_cvt_pk_bf16_f32 v219, v222, v223
    ds_write_b128 v10, v[216:219] offset:12800
    s_mov_b32 s61, 28672
    s_add_u32 m0, s60, 8448
    s_nop 0
    buffer_load_dwordx4 v104, s[52:55], s61 offen offset:0 lds
    v_pk_fma_f32 v[224:225], v[68:69], v[26:27], v[224:225] op_sel:[0,1,0] op_sel_hi:[1,1,1]
    v_pk_fma_f32 v[226:227], v[70:71], v[26:27], v[226:227] op_sel:[0,1,0] op_sel_hi:[1,1,1]
    v_cvt_pk_bf16_f32 v224, v224, v225
    v_cvt_pk_bf16_f32 v225, v226, v227
    s_nop 0
    buffer_load_dwordx4 v105, s[52:55], s61 offen offset:1056 lds
    v_pk_fma_f32 v[228:229], v[72:73], v[26:27], v[228:229] op_sel:[0,1,0] op_sel_hi:[1,1,1]
    v_pk_fma_f32 v[230:231], v[74:75], v[26:27], v[230:231] op_sel:[0,1,0] op_sel_hi:[1,1,1]
    v_cvt_pk_bf16_f32 v226, v228, v229
    v_cvt_pk_bf16_f32 v227, v230, v231
    ds_write_b128 v10, v[224:227] offset:768
    s_nop 0
    buffer_load_dwordx4 v106, s[52:55], s61 offen offset:2112 lds
    v_pk_fma_f32 v[232:233], v[76:77], v[26:27], v[232:233] op_sel:[0,1,0] op_sel_hi:[1,1,1]
    v_pk_fma_f32 v[234:235], v[78:79], v[26:27], v[234:235] op_sel:[0,1,0] op_sel_hi:[1,1,1]
    v_cvt_pk_bf16_f32 v232, v232, v233
    v_cvt_pk_bf16_f32 v233, v234, v235
    s_nop 0
    buffer_load_dwordx4 v107, s[52:55], s61 offen offset:3168 lds
    v_pk_fma_f32 v[236:237], v[80:81], v[26:27], v[236:237] op_sel:[0,1,0] op_sel_hi:[1,1,1]
    v_pk_fma_f32 v[238:239], v[82:83], v[26:27], v[238:239] op_sel:[0,1,0] op_sel_hi:[1,1,1]
    v_cvt_pk_bf16_f32 v234, v236, v237
    v_cvt_pk_bf16_f32 v235, v238, v239
    ds_write_b128 v10, v[232:235] offset:4864
    s_add_u32 m0, s60, 12672
    s_nop 0
    buffer_load_dwordx4 v108, s[52:55], s61 offen offset:0 lds
    v_pk_fma_f32 v[240:241], v[84:85], v[26:27], v[240:241] op_sel:[0,1,0] op_sel_hi:[1,1,1]
    v_pk_fma_f32 v[242:243], v[86:87], v[26:27], v[242:243] op_sel:[0,1,0] op_sel_hi:[1,1,1]
    v_cvt_pk_bf16_f32 v240, v240, v241
    v_cvt_pk_bf16_f32 v241, v242, v243
    s_nop 0
    buffer_load_dwordx4 v109, s[52:55], s61 offen offset:1056 lds
    v_pk_fma_f32 v[244:245], v[88:89], v[26:27], v[244:245] op_sel:[0,1,0] op_sel_hi:[1,1,1]
    v_pk_fma_f32 v[246:247], v[90:91], v[26:27], v[246:247] op_sel:[0,1,0] op_sel_hi:[1,1,1]
    v_cvt_pk_bf16_f32 v242, v244, v245
    v_cvt_pk_bf16_f32 v243, v246, v247
    ds_write_b128 v10, v[240:243] offset:8960
    s_nop 0
    buffer_load_dwordx4 v110, s[52:55], s61 offen offset:2112 lds
    v_pk_fma_f32 v[248:249], v[92:93], v[26:27], v[248:249] op_sel:[0,1,0] op_sel_hi:[1,1,1]
    v_pk_fma_f32 v[250:251], v[94:95], v[26:27], v[250:251] op_sel:[0,1,0] op_sel_hi:[1,1,1]
    v_cvt_pk_bf16_f32 v248, v248, v249
    v_cvt_pk_bf16_f32 v249, v250, v251
    s_nop 0
    buffer_load_dwordx4 v111, s[52:55], s61 offen offset:3168 lds
    v_pk_fma_f32 v[252:253], v[96:97], v[26:27], v[252:253] op_sel:[0,1,0] op_sel_hi:[1,1,1]
    v_pk_fma_f32 v[254:255], v[98:99], v[26:27], v[254:255] op_sel:[0,1,0] op_sel_hi:[1,1,1]
    v_cvt_pk_bf16_f32 v250, v252, v253
    v_cvt_pk_bf16_f32 v251, v254, v255
    ds_write_b128 v10, v[248:251] offset:13056
    s_waitcnt vmcnt(12)
    ds_read_b64_tr_b16 v[16:17], v120 offset:0
    ds_read_b64_tr_b16 v[18:19], v120 offset:512
    ds_read_b64_tr_b16 v[20:21], v120 offset:32
    ds_read_b64_tr_b16 v[22:23], v120 offset:544
    ds_read_b64_tr_b16 v[24:25], v120 offset:64
    ds_read_b64_tr_b16 v[26:27], v120 offset:576
    ds_read_b64_tr_b16 v[28:29], v120 offset:96
    ds_read_b64_tr_b16 v[30:31], v120 offset:608
    s_waitcnt lgkmcnt(8)
    s_barrier
    ds_read_b128 v[36:39], v121 offset:0
    ds_read_b128 v[40:43], v121 offset:256
    ds_read_b128 v[44:47], v121 offset:512
    ds_read_b128 v[48:51], v121 offset:768
    s_waitcnt lgkmcnt(0)
    v_mfma_f32_16x16x32_bf16 v[128:131], v[16:19], v[36:39], 0
    v_mfma_f32_16x16x32_bf16 v[144:147], v[20:23], v[36:39], 0
    s_mov_b32 s61, 57344
    s_add_u32 m0, s60, 16896
    v_mfma_f32_16x16x32_bf16 v[148:151], v[20:23], v[40:43], 0
    buffer_load_dwordx4 v104, s[52:55], s61 offen offset:0 lds
    v_mfma_f32_16x16x32_bf16 v[132:135], v[16:19], v[40:43], 0
    v_mfma_f32_16x16x32_bf16 v[136:139], v[16:19], v[44:47], 0
    buffer_load_dwordx4 v105, s[52:55], s61 offen offset:1056 lds
    v_mfma_f32_16x16x32_bf16 v[152:155], v[20:23], v[44:47], 0
    v_mfma_f32_16x16x32_bf16 v[156:159], v[20:23], v[48:51], 0
    s_waitcnt vmcnt(10)
    ds_read_b64_tr_b16 v[20:21], v120 offset:4256
    v_mfma_f32_16x16x32_bf16 v[140:143], v[16:19], v[48:51], 0
    ds_read_b64_tr_b16 v[22:23], v120 offset:4768
    v_mfma_f32_16x16x32_bf16 v[188:191], v[28:31], v[48:51], 0
    ds_read_b64_tr_b16 v[16:17], v120 offset:4224
    v_mfma_f32_16x16x32_bf16 v[172:175], v[24:27], v[48:51], 0
    ds_read_b64_tr_b16 v[18:19], v120 offset:4736
    v_mfma_f32_16x16x32_bf16 v[168:171], v[24:27], v[44:47], 0
    buffer_load_dwordx4 v106, s[52:55], s61 offen offset:2112 lds
    v_mfma_f32_16x16x32_bf16 v[184:187], v[28:31], v[44:47], 0
    v_mfma_f32_16x16x32_bf16 v[180:183], v[28:31], v[40:43], 0
    buffer_load_dwordx4 v107, s[52:55], s61 offen offset:3168 lds
    v_mfma_f32_16x16x32_bf16 v[164:167], v[24:27], v[40:43], 0
    v_mfma_f32_16x16x32_bf16 v[160:163], v[24:27], v[36:39], 0
    ds_read_b64_tr_b16 v[24:25], v120 offset:4288
    v_mfma_f32_16x16x32_bf16 v[176:179], v[28:31], v[36:39], 0
    ds_read_b64_tr_b16 v[26:27], v120 offset:4800
    s_waitcnt lgkmcnt(2)
    v_mfma_f32_16x16x32_bf16 v[192:195], v[16:19], v[36:39], 0
    ds_read_b64_tr_b16 v[28:29], v120 offset:4320
    v_mfma_f32_16x16x32_bf16 v[208:211], v[20:23], v[36:39], 0
    ds_read_b64_tr_b16 v[30:31], v120 offset:4832
    s_add_u32 m0, s60, 0
    v_mfma_f32_16x16x32_bf16 v[212:215], v[20:23], v[40:43], 0
    buffer_load_dwordx4 v108, s[52:55], s61 offen offset:0 lds
    v_mfma_f32_16x16x32_bf16 v[196:199], v[16:19], v[40:43], 0
    ds_read_b128 v[52:55], v121 offset:4096
    v_mfma_f32_16x16x32_bf16 v[200:203], v[16:19], v[44:47], 0
    buffer_load_dwordx4 v109, s[52:55], s61 offen offset:1056 lds
    v_mfma_f32_16x16x32_bf16 v[216:219], v[20:23], v[44:47], 0
    ds_read_b128 v[56:59], v121 offset:4352
    v_mfma_f32_16x16x32_bf16 v[220:223], v[20:23], v[48:51], 0
    s_waitcnt vmcnt(10)
    ds_read_b64_tr_b16 v[20:21], v120 offset:8480
    v_mfma_f32_16x16x32_bf16 v[204:207], v[16:19], v[48:51], 0
    ds_read_b64_tr_b16 v[22:23], v120 offset:8992
    s_waitcnt lgkmcnt(4)
    v_mfma_f32_16x16x32_bf16 v[252:255], v[28:31], v[48:51], 0
    ds_read_b64_tr_b16 v[16:17], v120 offset:8448
    v_mfma_f32_16x16x32_bf16 v[236:239], v[24:27], v[48:51], 0
    ds_read_b64_tr_b16 v[18:19], v120 offset:8960
    v_mfma_f32_16x16x32_bf16 v[232:235], v[24:27], v[44:47], 0
    buffer_load_dwordx4 v110, s[52:55], s61 offen offset:2112 lds
    v_mfma_f32_16x16x32_bf16 v[248:251], v[28:31], v[44:47], 0
    ds_read_b128 v[60:63], v121 offset:4608
    v_mfma_f32_16x16x32_bf16 v[244:247], v[28:31], v[40:43], 0
    buffer_load_dwordx4 v111, s[52:55], s61 offen offset:3168 lds
    v_mfma_f32_16x16x32_bf16 v[228:231], v[24:27], v[40:43], 0
    ds_read_b128 v[64:67], v121 offset:4864
    v_mfma_f32_16x16x32_bf16 v[224:227], v[24:27], v[36:39], 0
    ds_read_b64_tr_b16 v[24:25], v120 offset:8512
    v_mfma_f32_16x16x32_bf16 v[240:243], v[28:31], v[36:39], 0
    ds_read_b64_tr_b16 v[26:27], v120 offset:9024
    s_waitcnt lgkmcnt(2)
    v_mfma_f32_16x16x32_bf16 v[128:131], v[16:19], v[52:55], v[128:131]
    ds_read_b64_tr_b16 v[28:29], v120 offset:8544
    v_mfma_f32_16x16x32_bf16 v[144:147], v[20:23], v[52:55], v[144:147]
    ds_read_b64_tr_b16 v[30:31], v120 offset:9056
    s_mov_b32 s61, 86016
    s_add_u32 m0, s60, 4224
    v_mfma_f32_16x16x32_bf16 v[148:151], v[20:23], v[56:59], v[148:151]
    buffer_load_dwordx4 v104, s[52:55], s61 offen offset:0 lds
    v_mfma_f32_16x16x32_bf16 v[132:135], v[16:19], v[56:59], v[132:135]
    v_mfma_f32_16x16x32_bf16 v[136:139], v[16:19], v[60:63], v[136:139]
    buffer_load_dwordx4 v105, s[52:55], s61 offen offset:1056 lds
    v_mfma_f32_16x16x32_bf16 v[152:155], v[20:23], v[60:63], v[152:155]
    v_mfma_f32_16x16x32_bf16 v[156:159], v[20:23], v[64:67], v[156:159]
    s_waitcnt vmcnt(10)
    ds_read_b64_tr_b16 v[20:21], v120 offset:12704
    v_mfma_f32_16x16x32_bf16 v[140:143], v[16:19], v[64:67], v[140:143]
    ds_read_b64_tr_b16 v[22:23], v120 offset:13216
    s_waitcnt lgkmcnt(2)
    v_mfma_f32_16x16x32_bf16 v[188:191], v[28:31], v[64:67], v[188:191]
    ds_read_b64_tr_b16 v[16:17], v120 offset:12672
    v_mfma_f32_16x16x32_bf16 v[172:175], v[24:27], v[64:67], v[172:175]
    ds_read_b64_tr_b16 v[18:19], v120 offset:13184
    v_mfma_f32_16x16x32_bf16 v[168:171], v[24:27], v[60:63], v[168:171]
    buffer_load_dwordx4 v106, s[52:55], s61 offen offset:2112 lds
    v_mfma_f32_16x16x32_bf16 v[184:187], v[28:31], v[60:63], v[184:187]
    v_mfma_f32_16x16x32_bf16 v[180:183], v[28:31], v[56:59], v[180:183]
    buffer_load_dwordx4 v107, s[52:55], s61 offen offset:3168 lds
    v_mfma_f32_16x16x32_bf16 v[164:167], v[24:27], v[56:59], v[164:167]
    v_mfma_f32_16x16x32_bf16 v[160:163], v[24:27], v[52:55], v[160:163]
    ds_read_b64_tr_b16 v[24:25], v120 offset:12736
    v_mfma_f32_16x16x32_bf16 v[176:179], v[28:31], v[52:55], v[176:179]
    ds_read_b64_tr_b16 v[26:27], v120 offset:13248
    s_waitcnt lgkmcnt(2)
    v_mfma_f32_16x16x32_bf16 v[192:195], v[16:19], v[52:55], v[192:195]
    ds_read_b64_tr_b16 v[28:29], v120 offset:12768
    v_mfma_f32_16x16x32_bf16 v[208:211], v[20:23], v[52:55], v[208:211]
    ds_read_b64_tr_b16 v[30:31], v120 offset:13280
    s_add_u32 m0, s60, 8448
    v_mfma_f32_16x16x32_bf16 v[212:215], v[20:23], v[56:59], v[212:215]
    buffer_load_dwordx4 v108, s[52:55], s61 offen offset:0 lds
    v_mfma_f32_16x16x32_bf16 v[196:199], v[16:19], v[56:59], v[196:199]
    ds_read_b128 v[36:39], v121 offset:8192
    v_mfma_f32_16x16x32_bf16 v[200:203], v[16:19], v[60:63], v[200:203]
    buffer_load_dwordx4 v109, s[52:55], s61 offen offset:1056 lds
    v_mfma_f32_16x16x32_bf16 v[216:219], v[20:23], v[60:63], v[216:219]
    ds_read_b128 v[40:43], v121 offset:8448
    v_mfma_f32_16x16x32_bf16 v[220:223], v[20:23], v[64:67], v[220:223]
    s_waitcnt vmcnt(10)
    ds_read_b64_tr_b16 v[20:21], v120 offset:16928
    v_mfma_f32_16x16x32_bf16 v[204:207], v[16:19], v[64:67], v[204:207]
    ds_read_b64_tr_b16 v[22:23], v120 offset:17440
    s_waitcnt lgkmcnt(4)
    v_mfma_f32_16x16x32_bf16 v[252:255], v[28:31], v[64:67], v[252:255]
    ds_read_b64_tr_b16 v[16:17], v120 offset:16896
    v_mfma_f32_16x16x32_bf16 v[236:239], v[24:27], v[64:67], v[236:239]
    ds_read_b64_tr_b16 v[18:19], v120 offset:17408
    v_mfma_f32_16x16x32_bf16 v[232:235], v[24:27], v[60:63], v[232:235]
    buffer_load_dwordx4 v110, s[52:55], s61 offen offset:2112 lds
    v_mfma_f32_16x16x32_bf16 v[248:251], v[28:31], v[60:63], v[248:251]
    ds_read_b128 v[44:47], v121 offset:8704
    v_mfma_f32_16x16x32_bf16 v[244:247], v[28:31], v[56:59], v[244:247]
    buffer_load_dwordx4 v111, s[52:55], s61 offen offset:3168 lds
    v_mfma_f32_16x16x32_bf16 v[228:231], v[24:27], v[56:59], v[228:231]
    ds_read_b128 v[48:51], v121 offset:8960
    v_mfma_f32_16x16x32_bf16 v[224:227], v[24:27], v[52:55], v[224:227]
    ds_read_b64_tr_b16 v[24:25], v120 offset:16960
    v_mfma_f32_16x16x32_bf16 v[240:243], v[28:31], v[52:55], v[240:243]
    ds_read_b64_tr_b16 v[26:27], v120 offset:17472
    s_waitcnt lgkmcnt(2)
    v_mfma_f32_16x16x32_bf16 v[128:131], v[16:19], v[36:39], v[128:131]
    ds_read_b64_tr_b16 v[28:29], v120 offset:16992
    v_mfma_f32_16x16x32_bf16 v[144:147], v[20:23], v[36:39], v[144:147]
    ds_read_b64_tr_b16 v[30:31], v120 offset:17504
    s_mov_b32 s61, 114688
    s_add_u32 m0, s60, 12672
    v_mfma_f32_16x16x32_bf16 v[148:151], v[20:23], v[40:43], v[148:151]
    buffer_load_dwordx4 v104, s[52:55], s61 offen offset:0 lds
    v_mfma_f32_16x16x32_bf16 v[132:135], v[16:19], v[40:43], v[132:135]
    v_mfma_f32_16x16x32_bf16 v[136:139], v[16:19], v[44:47], v[136:139]
    buffer_load_dwordx4 v105, s[52:55], s61 offen offset:1056 lds
    v_mfma_f32_16x16x32_bf16 v[152:155], v[20:23], v[44:47], v[152:155]
    v_mfma_f32_16x16x32_bf16 v[156:159], v[20:23], v[48:51], v[156:159]
    s_waitcnt vmcnt(10)
    ds_read_b64_tr_b16 v[20:21], v120 offset:32
    v_mfma_f32_16x16x32_bf16 v[140:143], v[16:19], v[48:51], v[140:143]
    ds_read_b64_tr_b16 v[22:23], v120 offset:544
    s_waitcnt lgkmcnt(2)
    v_mfma_f32_16x16x32_bf16 v[188:191], v[28:31], v[48:51], v[188:191]
    ds_read_b64_tr_b16 v[16:17], v120 offset:0
    v_mfma_f32_16x16x32_bf16 v[172:175], v[24:27], v[48:51], v[172:175]
    ds_read_b64_tr_b16 v[18:19], v120 offset:512
    v_mfma_f32_16x16x32_bf16 v[168:171], v[24:27], v[44:47], v[168:171]
    buffer_load_dwordx4 v106, s[52:55], s61 offen offset:2112 lds
    v_mfma_f32_16x16x32_bf16 v[184:187], v[28:31], v[44:47], v[184:187]
    v_mfma_f32_16x16x32_bf16 v[180:183], v[28:31], v[40:43], v[180:183]
    buffer_load_dwordx4 v107, s[52:55], s61 offen offset:3168 lds
    v_mfma_f32_16x16x32_bf16 v[164:167], v[24:27], v[40:43], v[164:167]
    v_mfma_f32_16x16x32_bf16 v[160:163], v[24:27], v[36:39], v[160:163]
    ds_read_b64_tr_b16 v[24:25], v120 offset:64
    v_mfma_f32_16x16x32_bf16 v[176:179], v[28:31], v[36:39], v[176:179]
    ds_read_b64_tr_b16 v[26:27], v120 offset:576
    s_waitcnt lgkmcnt(2)
    v_mfma_f32_16x16x32_bf16 v[192:195], v[16:19], v[36:39], v[192:195]
    ds_read_b64_tr_b16 v[28:29], v120 offset:96
    v_mfma_f32_16x16x32_bf16 v[208:211], v[20:23], v[36:39], v[208:211]
    ds_read_b64_tr_b16 v[30:31], v120 offset:608
    s_add_u32 m0, s60, 16896
    v_mfma_f32_16x16x32_bf16 v[212:215], v[20:23], v[40:43], v[212:215]
    buffer_load_dwordx4 v108, s[52:55], s61 offen offset:0 lds
    v_mfma_f32_16x16x32_bf16 v[196:199], v[16:19], v[40:43], v[196:199]
    ds_read_b128 v[52:55], v121 offset:12288
    v_mfma_f32_16x16x32_bf16 v[200:203], v[16:19], v[44:47], v[200:203]
    buffer_load_dwordx4 v109, s[52:55], s61 offen offset:1056 lds
    v_mfma_f32_16x16x32_bf16 v[216:219], v[20:23], v[44:47], v[216:219]
    ds_read_b128 v[56:59], v121 offset:12544
    v_mfma_f32_16x16x32_bf16 v[220:223], v[20:23], v[48:51], v[220:223]
    s_waitcnt vmcnt(10)
    ds_read_b64_tr_b16 v[20:21], v120 offset:4256
    v_mfma_f32_16x16x32_bf16 v[204:207], v[16:19], v[48:51], v[204:207]
    ds_read_b64_tr_b16 v[22:23], v120 offset:4768
    s_waitcnt lgkmcnt(4)
    v_mfma_f32_16x16x32_bf16 v[252:255], v[28:31], v[48:51], v[252:255]
    ds_read_b64_tr_b16 v[16:17], v120 offset:4224
    v_mfma_f32_16x16x32_bf16 v[236:239], v[24:27], v[48:51], v[236:239]
    ds_read_b64_tr_b16 v[18:19], v120 offset:4736
    v_mfma_f32_16x16x32_bf16 v[232:235], v[24:27], v[44:47], v[232:235]
    buffer_load_dwordx4 v110, s[52:55], s61 offen offset:2112 lds
    v_mfma_f32_16x16x32_bf16 v[248:251], v[28:31], v[44:47], v[248:251]
    ds_read_b128 v[60:63], v121 offset:12800
    v_mfma_f32_16x16x32_bf16 v[244:247], v[28:31], v[40:43], v[244:247]
    buffer_load_dwordx4 v111, s[52:55], s61 offen offset:3168 lds
    v_mfma_f32_16x16x32_bf16 v[228:231], v[24:27], v[40:43], v[228:231]
    ds_read_b128 v[64:67], v121 offset:13056
    v_mfma_f32_16x16x32_bf16 v[224:227], v[24:27], v[36:39], v[224:227]
    ds_read_b64_tr_b16 v[24:25], v120 offset:4288
    v_mfma_f32_16x16x32_bf16 v[240:243], v[28:31], v[36:39], v[240:243]
    ds_read_b64_tr_b16 v[26:27], v120 offset:4800
    s_waitcnt lgkmcnt(2)
    v_mfma_f32_16x16x32_bf16 v[128:131], v[16:19], v[52:55], v[128:131]
    ds_read_b64_tr_b16 v[28:29], v120 offset:4320
    v_mfma_f32_16x16x32_bf16 v[144:147], v[20:23], v[52:55], v[144:147]
    ds_read_b64_tr_b16 v[30:31], v120 offset:4832
    s_mov_b32 s61, 143360
    s_add_u32 m0, s60, 0
    v_mfma_f32_16x16x32_bf16 v[148:151], v[20:23], v[56:59], v[148:151]
    buffer_load_dwordx4 v104, s[52:55], s61 offen offset:0 lds
    v_mfma_f32_16x16x32_bf16 v[132:135], v[16:19], v[56:59], v[132:135]
    v_mfma_f32_16x16x32_bf16 v[136:139], v[16:19], v[60:63], v[136:139]
    buffer_load_dwordx4 v105, s[52:55], s61 offen offset:1056 lds
    v_mfma_f32_16x16x32_bf16 v[152:155], v[20:23], v[60:63], v[152:155]
    v_mfma_f32_16x16x32_bf16 v[156:159], v[20:23], v[64:67], v[156:159]
    s_waitcnt vmcnt(10)
    ds_read_b64_tr_b16 v[20:21], v120 offset:8480
    v_mfma_f32_16x16x32_bf16 v[140:143], v[16:19], v[64:67], v[140:143]
    ds_read_b64_tr_b16 v[22:23], v120 offset:8992
    s_waitcnt lgkmcnt(2)
    v_mfma_f32_16x16x32_bf16 v[188:191], v[28:31], v[64:67], v[188:191]
    ds_read_b64_tr_b16 v[16:17], v120 offset:8448
    v_mfma_f32_16x16x32_bf16 v[172:175], v[24:27], v[64:67], v[172:175]
    ds_read_b64_tr_b16 v[18:19], v120 offset:8960
    v_mfma_f32_16x16x32_bf16 v[168:171], v[24:27], v[60:63], v[168:171]
    buffer_load_dwordx4 v106, s[52:55], s61 offen offset:2112 lds
    v_mfma_f32_16x16x32_bf16 v[184:187], v[28:31], v[60:63], v[184:187]
    v_mfma_f32_16x16x32_bf16 v[180:183], v[28:31], v[56:59], v[180:183]
    buffer_load_dwordx4 v107, s[52:55], s61 offen offset:3168 lds
    v_mfma_f32_16x16x32_bf16 v[164:167], v[24:27], v[56:59], v[164:167]
    v_mfma_f32_16x16x32_bf16 v[160:163], v[24:27], v[52:55], v[160:163]
    ds_read_b64_tr_b16 v[24:25], v120 offset:8512
    v_mfma_f32_16x16x32_bf16 v[176:179], v[28:31], v[52:55], v[176:179]
    ds_read_b64_tr_b16 v[26:27], v120 offset:9024
    s_waitcnt lgkmcnt(2)
    v_mfma_f32_16x16x32_bf16 v[192:195], v[16:19], v[52:55], v[192:195]
    ds_read_b64_tr_b16 v[28:29], v120 offset:8544
    v_mfma_f32_16x16x32_bf16 v[208:211], v[20:23], v[52:55], v[208:211]
    ds_read_b64_tr_b16 v[30:31], v120 offset:9056
    s_add_u32 m0, s60, 4224
    v_mfma_f32_16x16x32_bf16 v[212:215], v[20:23], v[56:59], v[212:215]
    buffer_load_dwordx4 v108, s[52:55], s61 offen offset:0 lds
    v_mfma_f32_16x16x32_bf16 v[196:199], v[16:19], v[56:59], v[196:199]
    ds_read_b128 v[36:39], v121 offset:16384
    v_mfma_f32_16x16x32_bf16 v[200:203], v[16:19], v[60:63], v[200:203]
    buffer_load_dwordx4 v109, s[52:55], s61 offen offset:1056 lds
    v_mfma_f32_16x16x32_bf16 v[216:219], v[20:23], v[60:63], v[216:219]
    ds_read_b128 v[40:43], v121 offset:16640
    v_mfma_f32_16x16x32_bf16 v[220:223], v[20:23], v[64:67], v[220:223]
    s_waitcnt vmcnt(10)
    ds_read_b64_tr_b16 v[20:21], v120 offset:12704
    v_mfma_f32_16x16x32_bf16 v[204:207], v[16:19], v[64:67], v[204:207]
    ds_read_b64_tr_b16 v[22:23], v120 offset:13216
    s_waitcnt lgkmcnt(4)
    v_mfma_f32_16x16x32_bf16 v[252:255], v[28:31], v[64:67], v[252:255]
    ds_read_b64_tr_b16 v[16:17], v120 offset:12672
    v_mfma_f32_16x16x32_bf16 v[236:239], v[24:27], v[64:67], v[236:239]
    ds_read_b64_tr_b16 v[18:19], v120 offset:13184
    v_mfma_f32_16x16x32_bf16 v[232:235], v[24:27], v[60:63], v[232:235]
    buffer_load_dwordx4 v110, s[52:55], s61 offen offset:2112 lds
    v_mfma_f32_16x16x32_bf16 v[248:251], v[28:31], v[60:63], v[248:251]
    ds_read_b128 v[44:47], v121 offset:16896
    v_mfma_f32_16x16x32_bf16 v[244:247], v[28:31], v[56:59], v[244:247]
    buffer_load_dwordx4 v111, s[52:55], s61 offen offset:3168 lds
    v_mfma_f32_16x16x32_bf16 v[228:231], v[24:27], v[56:59], v[228:231]
    ds_read_b128 v[48:51], v121 offset:17152
    v_mfma_f32_16x16x32_bf16 v[224:227], v[24:27], v[52:55], v[224:227]
    ds_read_b64_tr_b16 v[24:25], v120 offset:12736
    v_mfma_f32_16x16x32_bf16 v[240:243], v[28:31], v[52:55], v[240:243]
    ds_read_b64_tr_b16 v[26:27], v120 offset:13248
    s_waitcnt lgkmcnt(2)
    v_mfma_f32_16x16x32_bf16 v[128:131], v[16:19], v[36:39], v[128:131]
    ds_read_b64_tr_b16 v[28:29], v120 offset:12768
    v_mfma_f32_16x16x32_bf16 v[144:147], v[20:23], v[36:39], v[144:147]
    ds_read_b64_tr_b16 v[30:31], v120 offset:13280
    s_mov_b32 s61, 172032
    s_add_u32 m0, s60, 8448
    v_mfma_f32_16x16x32_bf16 v[148:151], v[20:23], v[40:43], v[148:151]
    buffer_load_dwordx4 v104, s[52:55], s61 offen offset:0 lds
    v_mfma_f32_16x16x32_bf16 v[132:135], v[16:19], v[40:43], v[132:135]
    v_mfma_f32_16x16x32_bf16 v[136:139], v[16:19], v[44:47], v[136:139]
    buffer_load_dwordx4 v105, s[52:55], s61 offen offset:1056 lds
    v_mfma_f32_16x16x32_bf16 v[152:155], v[20:23], v[44:47], v[152:155]
    v_mfma_f32_16x16x32_bf16 v[156:159], v[20:23], v[48:51], v[156:159]
    s_waitcnt vmcnt(10)
    ds_read_b64_tr_b16 v[20:21], v120 offset:16928
    v_mfma_f32_16x16x32_bf16 v[140:143], v[16:19], v[48:51], v[140:143]
    ds_read_b64_tr_b16 v[22:23], v120 offset:17440
    s_waitcnt lgkmcnt(2)
    v_mfma_f32_16x16x32_bf16 v[188:191], v[28:31], v[48:51], v[188:191]
    ds_read_b64_tr_b16 v[16:17], v120 offset:16896
    v_mfma_f32_16x16x32_bf16 v[172:175], v[24:27], v[48:51], v[172:175]
    ds_read_b64_tr_b16 v[18:19], v120 offset:17408
    v_mfma_f32_16x16x32_bf16 v[168:171], v[24:27], v[44:47], v[168:171]
    buffer_load_dwordx4 v106, s[52:55], s61 offen offset:2112 lds
    v_mfma_f32_16x16x32_bf16 v[184:187], v[28:31], v[44:47], v[184:187]
    v_mfma_f32_16x16x32_bf16 v[180:183], v[28:31], v[40:43], v[180:183]
    buffer_load_dwordx4 v107, s[52:55], s61 offen offset:3168 lds
    v_mfma_f32_16x16x32_bf16 v[164:167], v[24:27], v[40:43], v[164:167]
    v_mfma_f32_16x16x32_bf16 v[160:163], v[24:27], v[36:39], v[160:163]
    ds_read_b64_tr_b16 v[24:25], v120 offset:16960
    v_mfma_f32_16x16x32_bf16 v[176:179], v[28:31], v[36:39], v[176:179]
    ds_read_b64_tr_b16 v[26:27], v120 offset:17472
    s_waitcnt lgkmcnt(2)
    v_mfma_f32_16x16x32_bf16 v[192:195], v[16:19], v[36:39], v[192:195]
    ds_read_b64_tr_b16 v[28:29], v120 offset:16992
    v_mfma_f32_16x16x32_bf16 v[208:211], v[20:23], v[36:39], v[208:211]
    ds_read_b64_tr_b16 v[30:31], v120 offset:17504
    s_add_u32 m0, s60, 12672
    v_mfma_f32_16x16x32_bf16 v[212:215], v[20:23], v[40:43], v[212:215]
    buffer_load_dwordx4 v108, s[52:55], s61 offen offset:0 lds
    v_mfma_f32_16x16x32_bf16 v[196:199], v[16:19], v[40:43], v[196:199]
    ds_read_b128 v[52:55], v121 offset:20480
    v_mfma_f32_16x16x32_bf16 v[200:203], v[16:19], v[44:47], v[200:203]
    buffer_load_dwordx4 v109, s[52:55], s61 offen offset:1056 lds
    v_mfma_f32_16x16x32_bf16 v[216:219], v[20:23], v[44:47], v[216:219]
    ds_read_b128 v[56:59], v121 offset:20736
    v_mfma_f32_16x16x32_bf16 v[220:223], v[20:23], v[48:51], v[220:223]
    s_waitcnt vmcnt(10)
    ds_read_b64_tr_b16 v[20:21], v120 offset:32
    v_mfma_f32_16x16x32_bf16 v[204:207], v[16:19], v[48:51], v[204:207]
    ds_read_b64_tr_b16 v[22:23], v120 offset:544
    s_waitcnt lgkmcnt(4)
    v_mfma_f32_16x16x32_bf16 v[252:255], v[28:31], v[48:51], v[252:255]
    ds_read_b64_tr_b16 v[16:17], v120 offset:0
    v_mfma_f32_16x16x32_bf16 v[236:239], v[24:27], v[48:51], v[236:239]
    ds_read_b64_tr_b16 v[18:19], v120 offset:512
    v_mfma_f32_16x16x32_bf16 v[232:235], v[24:27], v[44:47], v[232:235]
    buffer_load_dwordx4 v110, s[52:55], s61 offen offset:2112 lds
    v_mfma_f32_16x16x32_bf16 v[248:251], v[28:31], v[44:47], v[248:251]
    ds_read_b128 v[60:63], v121 offset:20992
    v_mfma_f32_16x16x32_bf16 v[244:247], v[28:31], v[40:43], v[244:247]
    buffer_load_dwordx4 v111, s[52:55], s61 offen offset:3168 lds
    v_mfma_f32_16x16x32_bf16 v[228:231], v[24:27], v[40:43], v[228:231]
    ds_read_b128 v[64:67], v121 offset:21248
    v_mfma_f32_16x16x32_bf16 v[224:227], v[24:27], v[36:39], v[224:227]
    ds_read_b64_tr_b16 v[24:25], v120 offset:64
    v_mfma_f32_16x16x32_bf16 v[240:243], v[28:31], v[36:39], v[240:243]
    ds_read_b64_tr_b16 v[26:27], v120 offset:576
    s_waitcnt lgkmcnt(2)
    v_mfma_f32_16x16x32_bf16 v[128:131], v[16:19], v[52:55], v[128:131]
    ds_read_b64_tr_b16 v[28:29], v120 offset:96
    v_mfma_f32_16x16x32_bf16 v[144:147], v[20:23], v[52:55], v[144:147]
    ds_read_b64_tr_b16 v[30:31], v120 offset:608
    s_mov_b32 s61, 200704
    s_add_u32 m0, s60, 16896
    v_mfma_f32_16x16x32_bf16 v[148:151], v[20:23], v[56:59], v[148:151]
    buffer_load_dwordx4 v104, s[52:55], s61 offen offset:0 lds
    v_mfma_f32_16x16x32_bf16 v[132:135], v[16:19], v[56:59], v[132:135]
    v_mfma_f32_16x16x32_bf16 v[136:139], v[16:19], v[60:63], v[136:139]
    buffer_load_dwordx4 v105, s[52:55], s61 offen offset:1056 lds
    v_mfma_f32_16x16x32_bf16 v[152:155], v[20:23], v[60:63], v[152:155]
    v_mfma_f32_16x16x32_bf16 v[156:159], v[20:23], v[64:67], v[156:159]
    s_waitcnt vmcnt(10)
    ds_read_b64_tr_b16 v[20:21], v120 offset:4256
    v_mfma_f32_16x16x32_bf16 v[140:143], v[16:19], v[64:67], v[140:143]
    ds_read_b64_tr_b16 v[22:23], v120 offset:4768
    s_waitcnt lgkmcnt(2)
    v_mfma_f32_16x16x32_bf16 v[188:191], v[28:31], v[64:67], v[188:191]
    ds_read_b64_tr_b16 v[16:17], v120 offset:4224
    v_mfma_f32_16x16x32_bf16 v[172:175], v[24:27], v[64:67], v[172:175]
    ds_read_b64_tr_b16 v[18:19], v120 offset:4736
    v_mfma_f32_16x16x32_bf16 v[168:171], v[24:27], v[60:63], v[168:171]
    buffer_load_dwordx4 v106, s[52:55], s61 offen offset:2112 lds
    v_mfma_f32_16x16x32_bf16 v[184:187], v[28:31], v[60:63], v[184:187]
    v_mfma_f32_16x16x32_bf16 v[180:183], v[28:31], v[56:59], v[180:183]
    buffer_load_dwordx4 v107, s[52:55], s61 offen offset:3168 lds
    v_mfma_f32_16x16x32_bf16 v[164:167], v[24:27], v[56:59], v[164:167]
    v_mfma_f32_16x16x32_bf16 v[160:163], v[24:27], v[52:55], v[160:163]
    ds_read_b64_tr_b16 v[24:25], v120 offset:4288
    v_mfma_f32_16x16x32_bf16 v[176:179], v[28:31], v[52:55], v[176:179]
    ds_read_b64_tr_b16 v[26:27], v120 offset:4800
    s_waitcnt lgkmcnt(2)
    v_mfma_f32_16x16x32_bf16 v[192:195], v[16:19], v[52:55], v[192:195]
    ds_read_b64_tr_b16 v[28:29], v120 offset:4320
    v_mfma_f32_16x16x32_bf16 v[208:211], v[20:23], v[52:55], v[208:211]
    ds_read_b64_tr_b16 v[30:31], v120 offset:4832
    s_add_u32 m0, s60, 0
    v_mfma_f32_16x16x32_bf16 v[212:215], v[20:23], v[56:59], v[212:215]
    buffer_load_dwordx4 v108, s[52:55], s61 offen offset:0 lds
    v_mfma_f32_16x16x32_bf16 v[196:199], v[16:19], v[56:59], v[196:199]
L_pg10:
    s_cbranch_execz L_pgret
    ds_read_b128 v[36:39], v121 offset:24576
    v_mfma_f32_16x16x32_bf16 v[200:203], v[16:19], v[60:63], v[200:203]
    buffer_load_dwordx4 v109, s[52:55], s61 offen offset:1056 lds
    v_mfma_f32_16x16x32_bf16 v[216:219], v[20:23], v[60:63], v[216:219]
    ds_read_b128 v[40:43], v121 offset:24832
    v_mfma_f32_16x16x32_bf16 v[220:223], v[20:23], v[64:67], v[220:223]
    s_waitcnt vmcnt(10)
    ds_read_b64_tr_b16 v[20:21], v120 offset:8480
    v_mfma_f32_16x16x32_bf16 v[204:207], v[16:19], v[64:67], v[204:207]
    ds_read_b64_tr_b16 v[22:23], v120 offset:8992
    s_waitcnt lgkmcnt(4)
    v_mfma_f32_16x16x32_bf16 v[252:255], v[28:31], v[64:67], v[252:255]
    ds_read_b64_tr_b16 v[16:17], v120 offset:8448
    v_mfma_f32_16x16x32_bf16 v[236:239], v[24:27], v[64:67], v[236:239]
    ds_read_b64_tr_b16 v[18:19], v120 offset:8960
    v_mfma_f32_16x16x32_bf16 v[232:235], v[24:27], v[60:63], v[232:235]
    buffer_load_dwordx4 v110, s[52:55], s61 offen offset:2112 lds
    v_mfma_f32_16x16x32_bf16 v[248:251], v[28:31], v[60:63], v[248:251]
    ds_read_b128 v[44:47], v121 offset:25088
    v_mfma_f32_16x16x32_bf16 v[244:247], v[28:31], v[56:59], v[244:247]
    buffer_load_dwordx4 v111, s[52:55], s61 offen offset:3168 lds
    v_mfma_f32_16x16x32_bf16 v[228:231], v[24:27], v[56:59], v[228:231]
    ds_read_b128 v[48:51], v121 offset:25344
    v_mfma_f32_16x16x32_bf16 v[224:227], v[24:27], v[52:55], v[224:227]
    ds_read_b64_tr_b16 v[24:25], v120 offset:8512
    v_mfma_f32_16x16x32_bf16 v[240:243], v[28:31], v[52:55], v[240:243]
    ds_read_b64_tr_b16 v[26:27], v120 offset:9024
    s_waitcnt lgkmcnt(2)
    v_mfma_f32_16x16x32_bf16 v[128:131], v[16:19], v[36:39], v[128:131]
    ds_read_b64_tr_b16 v[28:29], v120 offset:8544
    v_mfma_f32_16x16x32_bf16 v[144:147], v[20:23], v[36:39], v[144:147]
    ds_read_b64_tr_b16 v[30:31], v120 offset:9056
    s_mov_b32 s61, 229376
    s_add_u32 m0, s60, 4224
    v_mfma_f32_16x16x32_bf16 v[148:151], v[20:23], v[40:43], v[148:151]
    buffer_load_dwordx4 v104, s[52:55], s61 offen offset:0 lds
    v_mfma_f32_16x16x32_bf16 v[132:135], v[16:19], v[40:43], v[132:135]
    v_mfma_f32_16x16x32_bf16 v[136:139], v[16:19], v[44:47], v[136:139]
    buffer_load_dwordx4 v105, s[52:55], s61 offen offset:1056 lds
    v_mfma_f32_16x16x32_bf16 v[152:155], v[20:23], v[44:47], v[152:155]
    v_mfma_f32_16x16x32_bf16 v[156:159], v[20:23], v[48:51], v[156:159]
    s_waitcnt vmcnt(10)
    ds_read_b64_tr_b16 v[20:21], v120 offset:12704
    v_mfma_f32_16x16x32_bf16 v[140:143], v[16:19], v[48:51], v[140:143]
    ds_read_b64_tr_b16 v[22:23], v120 offset:13216
    s_waitcnt lgkmcnt(2)
    v_mfma_f32_16x16x32_bf16 v[188:191], v[28:31], v[48:51], v[188:191]
    ds_read_b64_tr_b16 v[16:17], v120 offset:12672
    v_mfma_f32_16x16x32_bf16 v[172:175], v[24:27], v[48:51], v[172:175]
    ds_read_b64_tr_b16 v[18:19], v120 offset:13184
    v_mfma_f32_16x16x32_bf16 v[168:171], v[24:27], v[44:47], v[168:171]
    buffer_load_dwordx4 v106, s[52:55], s61 offen offset:2112 lds
    v_mfma_f32_16x16x32_bf16 v[184:187], v[28:31], v[44:47], v[184:187]
    v_mfma_f32_16x16x32_bf16 v[180:183], v[28:31], v[40:43], v[180:183]
    buffer_load_dwordx4 v107, s[52:55], s61 offen offset:3168 lds
    v_mfma_f32_16x16x32_bf16 v[164:167], v[24:27], v[40:43], v[164:167]
    v_mfma_f32_16x16x32_bf16 v[160:163], v[24:27], v[36:39], v[160:163]
    ds_read_b64_tr_b16 v[24:25], v120 offset:12736
    v_mfma_f32_16x16x32_bf16 v[176:179], v[28:31], v[36:39], v[176:179]
    ds_read_b64_tr_b16 v[26:27], v120 offset:13248
    s_waitcnt lgkmcnt(2)
    v_mfma_f32_16x16x32_bf16 v[192:195], v[16:19], v[36:39], v[192:195]
    ds_read_b64_tr_b16 v[28:29], v120 offset:12768
    v_mfma_f32_16x16x32_bf16 v[208:211], v[20:23], v[36:39], v[208:211]
    ds_read_b64_tr_b16 v[30:31], v120 offset:13280
    s_add_u32 m0, s60, 8448
    v_mfma_f32_16x16x32_bf16 v[212:215], v[20:23], v[40:43], v[212:215]
    buffer_load_dwordx4 v108, s[52:55], s61 offen offset:0 lds
    v_mfma_f32_16x16x32_bf16 v[196:199], v[16:19], v[40:43], v[196:199]
    ds_read_b128 v[52:55], v121 offset:28672
    v_mfma_f32_16x16x32_bf16 v[200:203], v[16:19], v[44:47], v[200:203]
    buffer_load_dwordx4 v109, s[52:55], s61 offen offset:1056 lds
    v_mfma_f32_16x16x32_bf16 v[216:219], v[20:23], v[44:47], v[216:219]
    ds_read_b128 v[56:59], v121 offset:28928
    v_mfma_f32_16x16x32_bf16 v[220:223], v[20:23], v[48:51], v[220:223]
    s_waitcnt vmcnt(10)
    ds_read_b64_tr_b16 v[20:21], v120 offset:16928
    v_mfma_f32_16x16x32_bf16 v[204:207], v[16:19], v[48:51], v[204:207]
    ds_read_b64_tr_b16 v[22:23], v120 offset:17440
    s_waitcnt lgkmcnt(4)
    v_mfma_f32_16x16x32_bf16 v[252:255], v[28:31], v[48:51], v[252:255]
    ds_read_b64_tr_b16 v[16:17], v120 offset:16896
    v_mfma_f32_16x16x32_bf16 v[236:239], v[24:27], v[48:51], v[236:239]
    ds_read_b64_tr_b16 v[18:19], v120 offset:17408
    v_mfma_f32_16x16x32_bf16 v[232:235], v[24:27], v[44:47], v[232:235]
    buffer_load_dwordx4 v110, s[52:55], s61 offen offset:2112 lds
    v_mfma_f32_16x16x32_bf16 v[248:251], v[28:31], v[44:47], v[248:251]
    ds_read_b128 v[60:63], v121 offset:29184
    v_mfma_f32_16x16x32_bf16 v[244:247], v[28:31], v[40:43], v[244:247]
    buffer_load_dwordx4 v111, s[52:55], s61 offen offset:3168 lds
    v_mfma_f32_16x16x32_bf16 v[228:231], v[24:27], v[40:43], v[228:231]
    ds_read_b128 v[64:67], v121 offset:29440
    v_mfma_f32_16x16x32_bf16 v[224:227], v[24:27], v[36:39], v[224:227]
    ds_read_b64_tr_b16 v[24:25], v120 offset:16960
    v_mfma_f32_16x16x32_bf16 v[240:243], v[28:31], v[36:39], v[240:243]
    ds_read_b64_tr_b16 v[26:27], v120 offset:17472
    s_waitcnt lgkmcnt(2)
    v_mfma_f32_16x16x32_bf16 v[128:131], v[16:19], v[52:55], v[128:131]
    ds_read_b64_tr_b16 v[28:29], v120 offset:16992
    v_mfma_f32_16x16x32_bf16 v[144:147], v[20:23], v[52:55], v[144:147]
    ds_read_b64_tr_b16 v[30:31], v120 offset:17504
    s_mov_b32 s61, 258048
    s_add_u32 m0, s60, 12672
    v_mfma_f32_16x16x32_bf16 v[148:151], v[20:23], v[56:59], v[148:151]
    buffer_load_dwordx4 v104, s[52:55], s61 offen offset:0 lds
    v_mfma_f32_16x16x32_bf16 v[132:135], v[16:19], v[56:59], v[132:135]
    v_mfma_f32_16x16x32_bf16 v[136:139], v[16:19], v[60:63], v[136:139]
    buffer_load_dwordx4 v105, s[52:55], s61 offen offset:1056 lds
    v_mfma_f32_16x16x32_bf16 v[152:155], v[20:23], v[60:63], v[152:155]
    v_mfma_f32_16x16x32_bf16 v[156:159], v[20:23], v[64:67], v[156:159]
    s_waitcnt vmcnt(10)
    ds_read_b64_tr_b16 v[20:21], v120 offset:32
    v_mfma_f32_16x16x32_bf16 v[140:143], v[16:19], v[64:67], v[140:143]
    ds_read_b64_tr_b16 v[22:23], v120 offset:544
    s_waitcnt lgkmcnt(2)
    v_mfma_f32_16x16x32_bf16 v[188:191], v[28:31], v[64:67], v[188:191]
    ds_read_b64_tr_b16 v[16:17], v120 offset:0
    v_mfma_f32_16x16x32_bf16 v[172:175], v[24:27], v[64:67], v[172:175]
    ds_read_b64_tr_b16 v[18:19], v120 offset:512
    v_mfma_f32_16x16x32_bf16 v[168:171], v[24:27], v[60:63], v[168:171]
    buffer_load_dwordx4 v106, s[52:55], s61 offen offset:2112 lds
    v_mfma_f32_16x16x32_bf16 v[184:187], v[28:31], v[60:63], v[184:187]
    v_mfma_f32_16x16x32_bf16 v[180:183], v[28:31], v[56:59], v[180:183]
    buffer_load_dwordx4 v107, s[52:55], s61 offen offset:3168 lds
    v_mfma_f32_16x16x32_bf16 v[164:167], v[24:27], v[56:59], v[164:167]
    v_mfma_f32_16x16x32_bf16 v[160:163], v[24:27], v[52:55], v[160:163]
    ds_read_b64_tr_b16 v[24:25], v120 offset:64
    v_mfma_f32_16x16x32_bf16 v[176:179], v[28:31], v[52:55], v[176:179]
    ds_read_b64_tr_b16 v[26:27], v120 offset:576
    s_waitcnt lgkmcnt(2)
    v_mfma_f32_16x16x32_bf16 v[192:195], v[16:19], v[52:55], v[192:195]
    ds_read_b64_tr_b16 v[28:29], v120 offset:96
    v_mfma_f32_16x16x32_bf16 v[208:211], v[20:23], v[52:55], v[208:211]
    ds_read_b64_tr_b16 v[30:31], v120 offset:608
    s_add_u32 m0, s60, 16896
    v_mfma_f32_16x16x32_bf16 v[212:215], v[20:23], v[56:59], v[212:215]
    buffer_load_dwordx4 v108, s[52:55], s61 offen offset:0 lds
    v_mfma_f32_16x16x32_bf16 v[196:199], v[16:19], v[56:59], v[196:199]
    ds_read_b128 v[36:39], v121 offset:32768
    v_mfma_f32_16x16x32_bf16 v[200:203], v[16:19], v[60:63], v[200:203]
    buffer_load_dwordx4 v109, s[52:55], s61 offen offset:1056 lds
    v_mfma_f32_16x16x32_bf16 v[216:219], v[20:23], v[60:63], v[216:219]
    ds_read_b128 v[40:43], v121 offset:33024
    v_mfma_f32_16x16x32_bf16 v[220:223], v[20:23], v[64:67], v[220:223]
    s_waitcnt vmcnt(10)
    ds_read_b64_tr_b16 v[20:21], v120 offset:4256
    v_mfma_f32_16x16x32_bf16 v[204:207], v[16:19], v[64:67], v[204:207]
    ds_read_b64_tr_b16 v[22:23], v120 offset:4768
    s_waitcnt lgkmcnt(4)
    v_mfma_f32_16x16x32_bf16 v[252:255], v[28:31], v[64:67], v[252:255]
    ds_read_b64_tr_b16 v[16:17], v120 offset:4224
    v_mfma_f32_16x16x32_bf16 v[236:239], v[24:27], v[64:67], v[236:239]
    ds_read_b64_tr_b16 v[18:19], v120 offset:4736
    v_mfma_f32_16x16x32_bf16 v[232:235], v[24:27], v[60:63], v[232:235]
    buffer_load_dwordx4 v110, s[52:55], s61 offen offset:2112 lds
    v_mfma_f32_16x16x32_bf16 v[248:251], v[28:31], v[60:63], v[248:251]
    ds_read_b128 v[44:47], v121 offset:33280
    v_mfma_f32_16x16x32_bf16 v[244:247], v[28:31], v[56:59], v[244:247]
    buffer_load_dwordx4 v111, s[52:55], s61 offen offset:3168 lds
    v_mfma_f32_16x16x32_bf16 v[228:231], v[24:27], v[56:59], v[228:231]
    ds_read_b128 v[48:51], v121 offset:33536
    v_mfma_f32_16x16x32_bf16 v[224:227], v[24:27], v[52:55], v[224:227]
    ds_read_b64_tr_b16 v[24:25], v120 offset:4288
    v_mfma_f32_16x16x32_bf16 v[240:243], v[28:31], v[52:55], v[240:243]
    ds_read_b64_tr_b16 v[26:27], v120 offset:4800
    s_waitcnt lgkmcnt(2)
    v_mfma_f32_16x16x32_bf16 v[128:131], v[16:19], v[36:39], v[128:131]
    ds_read_b64_tr_b16 v[28:29], v120 offset:4320
    v_mfma_f32_16x16x32_bf16 v[144:147], v[20:23], v[36:39], v[144:147]
    ds_read_b64_tr_b16 v[30:31], v120 offset:4832
    s_mov_b32 s61, 286720
    s_add_u32 m0, s60, 0
    v_mfma_f32_16x16x32_bf16 v[148:151], v[20:23], v[40:43], v[148:151]
    buffer_load_dwordx4 v104, s[52:55], s61 offen offset:0 lds
    v_mfma_f32_16x16x32_bf16 v[132:135], v[16:19], v[40:43], v[132:135]
    v_mfma_f32_16x16x32_bf16 v[136:139], v[16:19], v[44:47], v[136:139]
    buffer_load_dwordx4 v105, s[52:55], s61 offen offset:1056 lds
    v_mfma_f32_16x16x32_bf16 v[152:155], v[20:23], v[44:47], v[152:155]
    v_mfma_f32_16x16x32_bf16 v[156:159], v[20:23], v[48:51], v[156:159]
    s_waitcnt vmcnt(10)
    ds_read_b64_tr_b16 v[20:21], v120 offset:8480
    v_mfma_f32_16x16x32_bf16 v[140:143], v[16:19], v[48:51], v[140:143]
    ds_read_b64_tr_b16 v[22:23], v120 offset:8992
    s_waitcnt lgkmcnt(2)
    v_mfma_f32_16x16x32_bf16 v[188:191], v[28:31], v[48:51], v[188:191]
    ds_read_b64_tr_b16 v[16:17], v120 offset:8448
    v_mfma_f32_16x16x32_bf16 v[172:175], v[24:27], v[48:51], v[172:175]
    ds_read_b64_tr_b16 v[18:19], v120 offset:8960
    v_mfma_f32_16x16x32_bf16 v[168:171], v[24:27], v[44:47], v[168:171]
    buffer_load_dwordx4 v106, s[52:55], s61 offen offset:2112 lds
    v_mfma_f32_16x16x32_bf16 v[184:187], v[28:31], v[44:47], v[184:187]
    v_mfma_f32_16x16x32_bf16 v[180:183], v[28:31], v[40:43], v[180:183]
    buffer_load_dwordx4 v107, s[52:55], s61 offen offset:3168 lds
    v_mfma_f32_16x16x32_bf16 v[164:167], v[24:27], v[40:43], v[164:167]
    v_mfma_f32_16x16x32_bf16 v[160:163], v[24:27], v[36:39], v[160:163]
    ds_read_b64_tr_b16 v[24:25], v120 offset:8512
    v_mfma_f32_16x16x32_bf16 v[176:179], v[28:31], v[36:39], v[176:179]
    ds_read_b64_tr_b16 v[26:27], v120 offset:9024
    s_waitcnt lgkmcnt(2)
    v_mfma_f32_16x16x32_bf16 v[192:195], v[16:19], v[36:39], v[192:195]
    ds_read_b64_tr_b16 v[28:29], v120 offset:8544
    v_mfma_f32_16x16x32_bf16 v[208:211], v[20:23], v[36:39], v[208:211]
    ds_read_b64_tr_b16 v[30:31], v120 offset:9056
    s_add_u32 m0, s60, 4224
    v_mfma_f32_16x16x32_bf16 v[212:215], v[20:23], v[40:43], v[212:215]
    buffer_load_dwordx4 v108, s[52:55], s61 offen offset:0 lds
    v_mfma_f32_16x16x32_bf16 v[196:199], v[16:19], v[40:43], v[196:199]
    ds_read_b128 v[52:55], v121 offset:36864
    v_mfma_f32_16x16x32_bf16 v[200:203], v[16:19], v[44:47], v[200:203]
    buffer_load_dwordx4 v109, s[52:55], s61 offen offset:1056 lds
    v_mfma_f32_16x16x32_bf16 v[216:219], v[20:23], v[44:47], v[216:219]
    ds_read_b128 v[56:59], v121 offset:37120
    v_mfma_f32_16x16x32_bf16 v[220:223], v[20:23], v[48:51], v[220:223]
    s_waitcnt vmcnt(10)
    ds_read_b64_tr_b16 v[20:21], v120 offset:12704
    v_mfma_f32_16x16x32_bf16 v[204:207], v[16:19], v[48:51], v[204:207]
    ds_read_b64_tr_b16 v[22:23], v120 offset:13216
    s_waitcnt lgkmcnt(4)
    v_mfma_f32_16x16x32_bf16 v[252:255], v[28:31], v[48:51], v[252:255]
    ds_read_b64_tr_b16 v[16:17], v120 offset:12672
    v_mfma_f32_16x16x32_bf16 v[236:239], v[24:27], v[48:51], v[236:239]
    ds_read_b64_tr_b16 v[18:19], v120 offset:13184
    v_mfma_f32_16x16x32_bf16 v[232:235], v[24:27], v[44:47], v[232:235]
    buffer_load_dwordx4 v110, s[52:55], s61 offen offset:2112 lds
    v_mfma_f32_16x16x32_bf16 v[248:251], v[28:31], v[44:47], v[248:251]
    ds_read_b128 v[60:63], v121 offset:37376
    v_mfma_f32_16x16x32_bf16 v[244:247], v[28:31], v[40:43], v[244:247]
    buffer_load_dwordx4 v111, s[52:55], s61 offen offset:3168 lds
    v_mfma_f32_16x16x32_bf16 v[228:231], v[24:27], v[40:43], v[228:231]
    ds_read_b128 v[64:67], v121 offset:37632
    v_mfma_f32_16x16x32_bf16 v[224:227], v[24:27], v[36:39], v[224:227]
    ds_read_b64_tr_b16 v[24:25], v120 offset:12736
    v_mfma_f32_16x16x32_bf16 v[240:243], v[28:31], v[36:39], v[240:243]
    ds_read_b64_tr_b16 v[26:27], v120 offset:13248
    s_waitcnt lgkmcnt(2)
    v_mfma_f32_16x16x32_bf16 v[128:131], v[16:19], v[52:55], v[128:131]
    ds_read_b64_tr_b16 v[28:29], v120 offset:12768
    v_mfma_f32_16x16x32_bf16 v[144:147], v[20:23], v[52:55], v[144:147]
    ds_read_b64_tr_b16 v[30:31], v120 offset:13280
    s_mov_b32 s61, 315392
    s_add_u32 m0, s60, 8448
    v_mfma_f32_16x16x32_bf16 v[148:151], v[20:23], v[56:59], v[148:151]
    buffer_load_dwordx4 v104, s[52:55], s61 offen offset:0 lds
    v_mfma_f32_16x16x32_bf16 v[132:135], v[16:19], v[56:59], v[132:135]
    v_mfma_f32_16x16x32_bf16 v[136:139], v[16:19], v[60:63], v[136:139]
    buffer_load_dwordx4 v105, s[52:55], s61 offen offset:1056 lds
    v_mfma_f32_16x16x32_bf16 v[152:155], v[20:23], v[60:63], v[152:155]
    v_mfma_f32_16x16x32_bf16 v[156:159], v[20:23], v[64:67], v[156:159]
    s_waitcnt vmcnt(10)
    ds_read_b64_tr_b16 v[20:21], v120 offset:16928
    v_mfma_f32_16x16x32_bf16 v[140:143], v[16:19], v[64:67], v[140:143]
    ds_read_b64_tr_b16 v[22:23], v120 offset:17440
    s_waitcnt lgkmcnt(2)
    v_mfma_f32_16x16x32_bf16 v[188:191], v[28:31], v[64:67], v[188:191]
    ds_read_b64_tr_b16 v[16:17], v120 offset:16896
    v_mfma_f32_16x16x32_bf16 v[172:175], v[24:27], v[64:67], v[172:175]
    ds_read_b64_tr_b16 v[18:19], v120 offset:17408
    v_mfma_f32_16x16x32_bf16 v[168:171], v[24:27], v[60:63], v[168:171]
    buffer_load_dwordx4 v106, s[52:55], s61 offen offset:2112 lds
    v_mfma_f32_16x16x32_bf16 v[184:187], v[28:31], v[60:63], v[184:187]
    v_mfma_f32_16x16x32_bf16 v[180:183], v[28:31], v[56:59], v[180:183]
    buffer_load_dwordx4 v107, s[52:55], s61 offen offset:3168 lds
    v_mfma_f32_16x16x32_bf16 v[164:167], v[24:27], v[56:59], v[164:167]
    v_mfma_f32_16x16x32_bf16 v[160:163], v[24:27], v[52:55], v[160:163]
    ds_read_b64_tr_b16 v[24:25], v120 offset:16960
    v_mfma_f32_16x16x32_bf16 v[176:179], v[28:31], v[52:55], v[176:179]
    ds_read_b64_tr_b16 v[26:27], v120 offset:17472
    s_waitcnt lgkmcnt(2)
    v_mfma_f32_16x16x32_bf16 v[192:195], v[16:19], v[52:55], v[192:195]
    ds_read_b64_tr_b16 v[28:29], v120 offset:16992
    v_mfma_f32_16x16x32_bf16 v[208:211], v[20:23], v[52:55], v[208:211]
    ds_read_b64_tr_b16 v[30:31], v120 offset:17504
    s_add_u32 m0, s60, 12672
    v_mfma_f32_16x16x32_bf16 v[212:215], v[20:23], v[56:59], v[212:215]
    buffer_load_dwordx4 v108, s[52:55], s61 offen offset:0 lds
    v_mfma_f32_16x16x32_bf16 v[196:199], v[16:19], v[56:59], v[196:199]
    ds_read_b128 v[36:39], v121 offset:40960
    v_mfma_f32_16x16x32_bf16 v[200:203], v[16:19], v[60:63], v[200:203]
    buffer_load_dwordx4 v109, s[52:55], s61 offen offset:1056 lds
    v_mfma_f32_16x16x32_bf16 v[216:219], v[20:23], v[60:63], v[216:219]
    ds_read_b128 v[40:43], v121 offset:41216
    v_mfma_f32_16x16x32_bf16 v[220:223], v[20:23], v[64:67], v[220:223]
    s_waitcnt vmcnt(10)
    ds_read_b64_tr_b16 v[20:21], v120 offset:32
    v_mfma_f32_16x16x32_bf16 v[204:207], v[16:19], v[64:67], v[204:207]
    ds_read_b64_tr_b16 v[22:23], v120 offset:544
    s_waitcnt lgkmcnt(4)
    v_mfma_f32_16x16x32_bf16 v[252:255], v[28:31], v[64:67], v[252:255]
    ds_read_b64_tr_b16 v[16:17], v120 offset:0
    v_mfma_f32_16x16x32_bf16 v[236:239], v[24:27], v[64:67], v[236:239]
    ds_read_b64_tr_b16 v[18:19], v120 offset:512
    v_mfma_f32_16x16x32_bf16 v[232:235], v[24:27], v[60:63], v[232:235]
    buffer_load_dwordx4 v110, s[52:55], s61 offen offset:2112 lds
    v_mfma_f32_16x16x32_bf16 v[248:251], v[28:31], v[60:63], v[248:251]
    ds_read_b128 v[44:47], v121 offset:41472
    v_mfma_f32_16x16x32_bf16 v[244:247], v[28:31], v[56:59], v[244:247]
    buffer_load_dwordx4 v111, s[52:55], s61 offen offset:3168 lds
    v_mfma_f32_16x16x32_bf16 v[228:231], v[24:27], v[56:59], v[228:231]
    ds_read_b128 v[48:51], v121 offset:41728
    v_mfma_f32_16x16x32_bf16 v[224:227], v[24:27], v[52:55], v[224:227]
    ds_read_b64_tr_b16 v[24:25], v120 offset:64
    v_mfma_f32_16x16x32_bf16 v[240:243], v[28:31], v[52:55], v[240:243]
    ds_read_b64_tr_b16 v[26:27], v120 offset:576
    s_waitcnt lgkmcnt(2)
    v_mfma_f32_16x16x32_bf16 v[128:131], v[16:19], v[36:39], v[128:131]
    ds_read_b64_tr_b16 v[28:29], v120 offset:96
    v_mfma_f32_16x16x32_bf16 v[144:147], v[20:23], v[36:39], v[144:147]
    ds_read_b64_tr_b16 v[30:31], v120 offset:608
    s_mov_b32 s61, 344064
    s_add_u32 m0, s60, 16896
    v_mfma_f32_16x16x32_bf16 v[148:151], v[20:23], v[40:43], v[148:151]
    buffer_load_dwordx4 v104, s[52:55], s61 offen offset:0 lds
    v_mfma_f32_16x16x32_bf16 v[132:135], v[16:19], v[40:43], v[132:135]
    v_mfma_f32_16x16x32_bf16 v[136:139], v[16:19], v[44:47], v[136:139]
    buffer_load_dwordx4 v105, s[52:55], s61 offen offset:1056 lds
    v_mfma_f32_16x16x32_bf16 v[152:155], v[20:23], v[44:47], v[152:155]
    v_mfma_f32_16x16x32_bf16 v[156:159], v[20:23], v[48:51], v[156:159]
    s_waitcnt vmcnt(10)
    ds_read_b64_tr_b16 v[20:21], v120 offset:4256
    v_mfma_f32_16x16x32_bf16 v[140:143], v[16:19], v[48:51], v[140:143]
    ds_read_b64_tr_b16 v[22:23], v120 offset:4768
    s_waitcnt lgkmcnt(2)
    v_mfma_f32_16x16x32_bf16 v[188:191], v[28:31], v[48:51], v[188:191]
    ds_read_b64_tr_b16 v[16:17], v120 offset:4224
    v_mfma_f32_16x16x32_bf16 v[172:175], v[24:27], v[48:51], v[172:175]
    ds_read_b64_tr_b16 v[18:19], v120 offset:4736
    v_mfma_f32_16x16x32_bf16 v[168:171], v[24:27], v[44:47], v[168:171]
    buffer_load_dwordx4 v106, s[52:55], s61 offen offset:2112 lds
    v_mfma_f32_16x16x32_bf16 v[184:187], v[28:31], v[44:47], v[184:187]
    v_mfma_f32_16x16x32_bf16 v[180:183], v[28:31], v[40:43], v[180:183]
    buffer_load_dwordx4 v107, s[52:55], s61 offen offset:3168 lds
    v_mfma_f32_16x16x32_bf16 v[164:167], v[24:27], v[40:43], v[164:167]
    v_mfma_f32_16x16x32_bf16 v[160:163], v[24:27], v[36:39], v[160:163]
    ds_read_b64_tr_b16 v[24:25], v120 offset:4288
    v_mfma_f32_16x16x32_bf16 v[176:179], v[28:31], v[36:39], v[176:179]
    ds_read_b64_tr_b16 v[26:27], v120 offset:4800
    s_waitcnt lgkmcnt(2)
    v_mfma_f32_16x16x32_bf16 v[192:195], v[16:19], v[36:39], v[192:195]
    ds_read_b64_tr_b16 v[28:29], v120 offset:4320
    v_mfma_f32_16x16x32_bf16 v[208:211], v[20:23], v[36:39], v[208:211]
    ds_read_b64_tr_b16 v[30:31], v120 offset:4832
    s_add_u32 m0, s60, 0
    v_mfma_f32_16x16x32_bf16 v[212:215], v[20:23], v[40:43], v[212:215]
    buffer_load_dwordx4 v108, s[52:55], s61 offen offset:0 lds
    v_mfma_f32_16x16x32_bf16 v[196:199], v[16:19], v[40:43], v[196:199]
    ds_read_b128 v[52:55], v121 offset:45056
    v_mfma_f32_16x16x32_bf16 v[200:203], v[16:19], v[44:47], v[200:203]
    buffer_load_dwordx4 v109, s[52:55], s61 offen offset:1056 lds
    v_mfma_f32_16x16x32_bf16 v[216:219], v[20:23], v[44:47], v[216:219]
    ds_read_b128 v[56:59], v121 offset:45312
    v_mfma_f32_16x16x32_bf16 v[220:223], v[20:23], v[48:51], v[220:223]
    s_waitcnt vmcnt(10)
    ds_read_b64_tr_b16 v[20:21], v120 offset:8480
    v_mfma_f32_16x16x32_bf16 v[204:207], v[16:19], v[48:51], v[204:207]
    ds_read_b64_tr_b16 v[22:23], v120 offset:8992
    s_waitcnt lgkmcnt(4)
    v_mfma_f32_16x16x32_bf16 v[252:255], v[28:31], v[48:51], v[252:255]
    ds_read_b64_tr_b16 v[16:17], v120 offset:8448
    v_mfma_f32_16x16x32_bf16 v[236:239], v[24:27], v[48:51], v[236:239]
    ds_read_b64_tr_b16 v[18:19], v120 offset:8960
    v_mfma_f32_16x16x32_bf16 v[232:235], v[24:27], v[44:47], v[232:235]
    buffer_load_dwordx4 v110, s[52:55], s61 offen offset:2112 lds
    v_mfma_f32_16x16x32_bf16 v[248:251], v[28:31], v[44:47], v[248:251]
    ds_read_b128 v[60:63], v121 offset:45568
    v_mfma_f32_16x16x32_bf16 v[244:247], v[28:31], v[40:43], v[244:247]
    buffer_load_dwordx4 v111, s[52:55], s61 offen offset:3168 lds
    v_mfma_f32_16x16x32_bf16 v[228:231], v[24:27], v[40:43], v[228:231]
    ds_read_b128 v[64:67], v121 offset:45824
    v_mfma_f32_16x16x32_bf16 v[224:227], v[24:27], v[36:39], v[224:227]
    ds_read_b64_tr_b16 v[24:25], v120 offset:8512
    v_mfma_f32_16x16x32_bf16 v[240:243], v[28:31], v[36:39], v[240:243]
    ds_read_b64_tr_b16 v[26:27], v120 offset:9024
    s_waitcnt lgkmcnt(2)
    v_mfma_f32_16x16x32_bf16 v[128:131], v[16:19], v[52:55], v[128:131]
    ds_read_b64_tr_b16 v[28:29], v120 offset:8544
    v_mfma_f32_16x16x32_bf16 v[144:147], v[20:23], v[52:55], v[144:147]
    ds_read_b64_tr_b16 v[30:31], v120 offset:9056
    s_mov_b32 s61, 372736
    s_add_u32 m0, s60, 4224
    v_mfma_f32_16x16x32_bf16 v[148:151], v[20:23], v[56:59], v[148:151]
    buffer_load_dwordx4 v104, s[52:55], s61 offen offset:0 lds
    v_mfma_f32_16x16x32_bf16 v[132:135], v[16:19], v[56:59], v[132:135]
    v_mfma_f32_16x16x32_bf16 v[136:139], v[16:19], v[60:63], v[136:139]
    buffer_load_dwordx4 v105, s[52:55], s61 offen offset:1056 lds
    v_mfma_f32_16x16x32_bf16 v[152:155], v[20:23], v[60:63], v[152:155]
    v_mfma_f32_16x16x32_bf16 v[156:159], v[20:23], v[64:67], v[156:159]
    s_waitcnt vmcnt(10)
    ds_read_b64_tr_b16 v[20:21], v120 offset:12704
    v_mfma_f32_16x16x32_bf16 v[140:143], v[16:19], v[64:67], v[140:143]
    ds_read_b64_tr_b16 v[22:23], v120 offset:13216
    s_waitcnt lgkmcnt(2)
    v_mfma_f32_16x16x32_bf16 v[188:191], v[28:31], v[64:67], v[188:191]
    ds_read_b64_tr_b16 v[16:17], v120 offset:12672
    v_mfma_f32_16x16x32_bf16 v[172:175], v[24:27], v[64:67], v[172:175]
    ds_read_b64_tr_b16 v[18:19], v120 offset:13184
    v_mfma_f32_16x16x32_bf16 v[168:171], v[24:27], v[60:63], v[168:171]
    buffer_load_dwordx4 v106, s[52:55], s61 offen offset:2112 lds
    v_mfma_f32_16x16x32_bf16 v[184:187], v[28:31], v[60:63], v[184:187]
    v_mfma_f32_16x16x32_bf16 v[180:183], v[28:31], v[56:59], v[180:183]
    buffer_load_dwordx4 v107, s[52:55], s61 offen offset:3168 lds
    v_mfma_f32_16x16x32_bf16 v[164:167], v[24:27], v[56:59], v[164:167]
    v_mfma_f32_16x16x32_bf16 v[160:163], v[24:27], v[52:55], v[160:163]
    ds_read_b64_tr_b16 v[24:25], v120 offset:12736
    v_mfma_f32_16x16x32_bf16 v[176:179], v[28:31], v[52:55], v[176:179]
    ds_read_b64_tr_b16 v[26:27], v120 offset:13248
    s_waitcnt lgkmcnt(2)
    v_mfma_f32_16x16x32_bf16 v[192:195], v[16:19], v[52:55], v[192:195]
    ds_read_b64_tr_b16 v[28:29], v120 offset:12768
    v_mfma_f32_16x16x32_bf16 v[208:211], v[20:23], v[52:55], v[208:211]
    ds_read_b64_tr_b16 v[30:31], v120 offset:13280
    s_add_u32 m0, s60, 8448
    v_mfma_f32_16x16x32_bf16 v[212:215], v[20:23], v[56:59], v[212:215]
    buffer_load_dwordx4 v108, s[52:55], s61 offen offset:0 lds
    v_mfma_f32_16x16x32_bf16 v[196:199], v[16:19], v[56:59], v[196:199]
    ds_read_b128 v[36:39], v121 offset:49152
    v_mfma_f32_16x16x32_bf16 v[200:203], v[16:19], v[60:63], v[200:203]
    buffer_load_dwordx4 v109, s[52:55], s61 offen offset:1056 lds
    v_mfma_f32_16x16x32_bf16 v[216:219], v[20:23], v[60:63], v[216:219]
    ds_read_b128 v[40:43], v121 offset:49408
    v_mfma_f32_16x16x32_bf16 v[220:223], v[20:23], v[64:67], v[220:223]
    s_waitcnt vmcnt(10)
    ds_read_b64_tr_b16 v[20:21], v120 offset:16928
    v_mfma_f32_16x16x32_bf16 v[204:207], v[16:19], v[64:67], v[204:207]
    ds_read_b64_tr_b16 v[22:23], v120 offset:17440
    s_waitcnt lgkmcnt(4)
    v_mfma_f32_16x16x32_bf16 v[252:255], v[28:31], v[64:67], v[252:255]
    ds_read_b64_tr_b16 v[16:17], v120 offset:16896
    v_mfma_f32_16x16x32_bf16 v[236:239], v[24:27], v[64:67], v[236:239]
    ds_read_b64_tr_b16 v[18:19], v120 offset:17408
    v_mfma_f32_16x16x32_bf16 v[232:235], v[24:27], v[60:63], v[232:235]
    buffer_load_dwordx4 v110, s[52:55], s61 offen offset:2112 lds
    v_mfma_f32_16x16x32_bf16 v[248:251], v[28:31], v[60:63], v[248:251]
    ds_read_b128 v[44:47], v121 offset:49664
    v_mfma_f32_16x16x32_bf16 v[244:247], v[28:31], v[56:59], v[244:247]
    buffer_load_dwordx4 v111, s[52:55], s61 offen offset:3168 lds
    v_mfma_f32_16x16x32_bf16 v[228:231], v[24:27], v[56:59], v[228:231]
    ds_read_b128 v[48:51], v121 offset:49920
    v_mfma_f32_16x16x32_bf16 v[224:227], v[24:27], v[52:55], v[224:227]
    ds_read_b64_tr_b16 v[24:25], v120 offset:16960
    v_mfma_f32_16x16x32_bf16 v[240:243], v[28:31], v[52:55], v[240:243]
    ds_read_b64_tr_b16 v[26:27], v120 offset:17472
    s_waitcnt lgkmcnt(2)
    v_mfma_f32_16x16x32_bf16 v[128:131], v[16:19], v[36:39], v[128:131]
    ds_read_b64_tr_b16 v[28:29], v120 offset:16992
    v_mfma_f32_16x16x32_bf16 v[144:147], v[20:23], v[36:39], v[144:147]
    ds_read_b64_tr_b16 v[30:31], v120 offset:17504
    s_mov_b32 s61, 401408
    s_add_u32 m0, s60, 12672
    v_mfma_f32_16x16x32_bf16 v[148:151], v[20:23], v[40:43], v[148:151]
    buffer_load_dwordx4 v104, s[52:55], s61 offen offset:0 lds
    v_mfma_f32_16x16x32_bf16 v[132:135], v[16:19], v[40:43], v[132:135]
    v_mfma_f32_16x16x32_bf16 v[136:139], v[16:19], v[44:47], v[136:139]
    buffer_load_dwordx4 v105, s[52:55], s61 offen offset:1056 lds
    v_mfma_f32_16x16x32_bf16 v[152:155], v[20:23], v[44:47], v[152:155]
    v_mfma_f32_16x16x32_bf16 v[156:159], v[20:23], v[48:51], v[156:159]
    s_waitcnt vmcnt(10)
    ds_read_b64_tr_b16 v[20:21], v120 offset:32
    v_mfma_f32_16x16x32_bf16 v[140:143], v[16:19], v[48:51], v[140:143]
    ds_read_b64_tr_b16 v[22:23], v120 offset:544
    s_waitcnt lgkmcnt(2)
    v_mfma_f32_16x16x32_bf16 v[188:191], v[28:31], v[48:51], v[188:191]
    ds_read_b64_tr_b16 v[16:17], v120 offset:0
    v_mfma_f32_16x16x32_bf16 v[172:175], v[24:27], v[48:51], v[172:175]
    ds_read_b64_tr_b16 v[18:19], v120 offset:512
    v_mfma_f32_16x16x32_bf16 v[168:171], v[24:27], v[44:47], v[168:171]
    buffer_load_dwordx4 v106, s[52:55], s61 offen offset:2112 lds
    v_mfma_f32_16x16x32_bf16 v[184:187], v[28:31], v[44:47], v[184:187]
    v_mfma_f32_16x16x32_bf16 v[180:183], v[28:31], v[40:43], v[180:183]
    buffer_load_dwordx4 v107, s[52:55], s61 offen offset:3168 lds
    v_mfma_f32_16x16x32_bf16 v[164:167], v[24:27], v[40:43], v[164:167]
    v_mfma_f32_16x16x32_bf16 v[160:163], v[24:27], v[36:39], v[160:163]
    ds_read_b64_tr_b16 v[24:25], v120 offset:64
    v_mfma_f32_16x16x32_bf16 v[176:179], v[28:31], v[36:39], v[176:179]
    ds_read_b64_tr_b16 v[26:27], v120 offset:576
    s_waitcnt lgkmcnt(2)
    v_mfma_f32_16x16x32_bf16 v[192:195], v[16:19], v[36:39], v[192:195]
    ds_read_b64_tr_b16 v[28:29], v120 offset:96
    v_mfma_f32_16x16x32_bf16 v[208:211], v[20:23], v[36:39], v[208:211]
    ds_read_b64_tr_b16 v[30:31], v120 offset:608
    s_mov_b32 s61, 430080
    s_add_u32 m0, s60, 16896
    v_mfma_f32_16x16x32_bf16 v[212:215], v[20:23], v[40:43], v[212:215]
    buffer_load_dwordx4 v104, s[52:55], s61 offen offset:0 lds
    v_mfma_f32_16x16x32_bf16 v[196:199], v[16:19], v[40:43], v[196:199]
    ds_read_b128 v[52:55], v121 offset:53248
    v_mfma_f32_16x16x32_bf16 v[200:203], v[16:19], v[44:47], v[200:203]
    buffer_load_dwordx4 v105, s[52:55], s61 offen offset:1056 lds
    v_mfma_f32_16x16x32_bf16 v[216:219], v[20:23], v[44:47], v[216:219]
    ds_read_b128 v[56:59], v121 offset:53504
    v_mfma_f32_16x16x32_bf16 v[220:223], v[20:23], v[48:51], v[220:223]
    s_waitcnt vmcnt(10)
    ds_read_b64_tr_b16 v[20:21], v120 offset:4256
    v_mfma_f32_16x16x32_bf16 v[204:207], v[16:19], v[48:51], v[204:207]
    ds_read_b64_tr_b16 v[22:23], v120 offset:4768
    s_waitcnt lgkmcnt(4)
    v_mfma_f32_16x16x32_bf16 v[252:255], v[28:31], v[48:51], v[252:255]
    ds_read_b64_tr_b16 v[16:17], v120 offset:4224
    v_mfma_f32_16x16x32_bf16 v[236:239], v[24:27], v[48:51], v[236:239]
    ds_read_b64_tr_b16 v[18:19], v120 offset:4736
    v_mfma_f32_16x16x32_bf16 v[232:235], v[24:27], v[44:47], v[232:235]
    buffer_load_dwordx4 v106, s[52:55], s61 offen offset:2112 lds
    v_mfma_f32_16x16x32_bf16 v[248:251], v[28:31], v[44:47], v[248:251]
    ds_read_b128 v[60:63], v121 offset:53760
    v_mfma_f32_16x16x32_bf16 v[244:247], v[28:31], v[40:43], v[244:247]
    buffer_load_dwordx4 v107, s[52:55], s61 offen offset:3168 lds
    v_mfma_f32_16x16x32_bf16 v[228:231], v[24:27], v[40:43], v[228:231]
    ds_read_b128 v[64:67], v121 offset:54016
    v_mfma_f32_16x16x32_bf16 v[224:227], v[24:27], v[36:39], v[224:227]
    ds_read_b64_tr_b16 v[24:25], v120 offset:4288
    v_mfma_f32_16x16x32_bf16 v[240:243], v[28:31], v[36:39], v[240:243]
    ds_read_b64_tr_b16 v[26:27], v120 offset:4800
    s_waitcnt lgkmcnt(2)
    v_mfma_f32_16x16x32_bf16 v[128:131], v[16:19], v[52:55], v[128:131]
    ds_read_b64_tr_b16 v[28:29], v120 offset:4320
    v_mfma_f32_16x16x32_bf16 v[144:147], v[20:23], v[52:55], v[144:147]
    ds_read_b64_tr_b16 v[30:31], v120 offset:4832
    s_mov_b32 s61, 401408
    s_add_u32 m0, s60, 0
    v_mfma_f32_16x16x32_bf16 v[148:151], v[20:23], v[56:59], v[148:151]
    buffer_load_dwordx4 v108, s[52:55], s61 offen offset:0 lds
    v_mfma_f32_16x16x32_bf16 v[132:135], v[16:19], v[56:59], v[132:135]
    v_mfma_f32_16x16x32_bf16 v[136:139], v[16:19], v[60:63], v[136:139]
    buffer_load_dwordx4 v109, s[52:55], s61 offen offset:1056 lds
    v_mfma_f32_16x16x32_bf16 v[152:155], v[20:23], v[60:63], v[152:155]
    v_mfma_f32_16x16x32_bf16 v[156:159], v[20:23], v[64:67], v[156:159]
    s_waitcnt vmcnt(10)
    ds_read_b64_tr_b16 v[20:21], v120 offset:8480
    v_mfma_f32_16x16x32_bf16 v[140:143], v[16:19], v[64:67], v[140:143]
    ds_read_b64_tr_b16 v[22:23], v120 offset:8992
    s_waitcnt lgkmcnt(2)
    v_mfma_f32_16x16x32_bf16 v[188:191], v[28:31], v[64:67], v[188:191]
    ds_read_b64_tr_b16 v[16:17], v120 offset:8448
    v_mfma_f32_16x16x32_bf16 v[172:175], v[24:27], v[64:67], v[172:175]
    ds_read_b64_tr_b16 v[18:19], v120 offset:8960
    v_mfma_f32_16x16x32_bf16 v[168:171], v[24:27], v[60:63], v[168:171]
    buffer_load_dwordx4 v110, s[52:55], s61 offen offset:2112 lds
    v_mfma_f32_16x16x32_bf16 v[184:187], v[28:31], v[60:63], v[184:187]
L_pg11:
    s_cbranch_execz L_pgret
    v_mfma_f32_16x16x32_bf16 v[180:183], v[28:31], v[56:59], v[180:183]
    buffer_load_dwordx4 v111, s[52:55], s61 offen offset:3168 lds
    v_mfma_f32_16x16x32_bf16 v[164:167], v[24:27], v[56:59], v[164:167]
    v_mfma_f32_16x16x32_bf16 v[160:163], v[24:27], v[52:55], v[160:163]
    ds_read_b64_tr_b16 v[24:25], v120 offset:8512
    v_mfma_f32_16x16x32_bf16 v[176:179], v[28:31], v[52:55], v[176:179]
    ds_read_b64_tr_b16 v[26:27], v120 offset:9024
    s_waitcnt lgkmcnt(2)
    v_mfma_f32_16x16x32_bf16 v[192:195], v[16:19], v[52:55], v[192:195]
    ds_read_b64_tr_b16 v[28:29], v120 offset:8544
    v_mfma_f32_16x16x32_bf16 v[208:211], v[20:23], v[52:55], v[208:211]
    ds_read_b64_tr_b16 v[30:31], v120 offset:9056
    s_mov_b32 s61, 430080
    s_add_u32 m0, s60, 4224
    v_mfma_f32_16x16x32_bf16 v[212:215], v[20:23], v[56:59], v[212:215]
    buffer_load_dwordx4 v108, s[52:55], s61 offen offset:0 lds
    v_mfma_f32_16x16x32_bf16 v[196:199], v[16:19], v[56:59], v[196:199]
    ds_read_b128 v[36:39], v121 offset:57344
    v_mfma_f32_16x16x32_bf16 v[200:203], v[16:19], v[60:63], v[200:203]
    buffer_load_dwordx4 v109, s[52:55], s61 offen offset:1056 lds
    v_mfma_f32_16x16x32_bf16 v[216:219], v[20:23], v[60:63], v[216:219]
    ds_read_b128 v[40:43], v121 offset:57600
    v_mfma_f32_16x16x32_bf16 v[220:223], v[20:23], v[64:67], v[220:223]
    s_waitcnt vmcnt(10)
    ds_read_b64_tr_b16 v[20:21], v120 offset:12704
    v_mfma_f32_16x16x32_bf16 v[204:207], v[16:19], v[64:67], v[204:207]
    ds_read_b64_tr_b16 v[22:23], v120 offset:13216
    s_waitcnt lgkmcnt(4)
    v_mfma_f32_16x16x32_bf16 v[252:255], v[28:31], v[64:67], v[252:255]
    ds_read_b64_tr_b16 v[16:17], v120 offset:12672
    v_mfma_f32_16x16x32_bf16 v[236:239], v[24:27], v[64:67], v[236:239]
    ds_read_b64_tr_b16 v[18:19], v120 offset:13184
    v_mfma_f32_16x16x32_bf16 v[232:235], v[24:27], v[60:63], v[232:235]
    buffer_load_dwordx4 v110, s[52:55], s61 offen offset:2112 lds
    v_mfma_f32_16x16x32_bf16 v[248:251], v[28:31], v[60:63], v[248:251]
    ds_read_b128 v[44:47], v121 offset:57856
    v_mfma_f32_16x16x32_bf16 v[244:247], v[28:31], v[56:59], v[244:247]
    buffer_load_dwordx4 v111, s[52:55], s61 offen offset:3168 lds
    v_mfma_f32_16x16x32_bf16 v[228:231], v[24:27], v[56:59], v[228:231]
    ds_read_b128 v[48:51], v121 offset:58112
    v_mfma_f32_16x16x32_bf16 v[224:227], v[24:27], v[52:55], v[224:227]
    ds_read_b64_tr_b16 v[24:25], v120 offset:12736
    v_mfma_f32_16x16x32_bf16 v[240:243], v[28:31], v[52:55], v[240:243]
    ds_read_b64_tr_b16 v[26:27], v120 offset:13248
    s_waitcnt lgkmcnt(2)
    v_mfma_f32_16x16x32_bf16 v[128:131], v[16:19], v[36:39], v[128:131]
    ds_read_b64_tr_b16 v[28:29], v120 offset:12768
    v_mfma_f32_16x16x32_bf16 v[144:147], v[20:23], v[36:39], v[144:147]
    ds_read_b64_tr_b16 v[30:31], v120 offset:13280
    v_mfma_f32_16x16x32_bf16 v[148:151], v[20:23], v[40:43], v[148:151]
    v_mfma_f32_16x16x32_bf16 v[132:135], v[16:19], v[40:43], v[132:135]
    ds_read_b128 v[52:55], v121 offset:61440
    v_mfma_f32_16x16x32_bf16 v[136:139], v[16:19], v[44:47], v[136:139]
    v_mfma_f32_16x16x32_bf16 v[152:155], v[20:23], v[44:47], v[152:155]
    ds_read_b128 v[56:59], v121 offset:61696
    v_mfma_f32_16x16x32_bf16 v[156:159], v[20:23], v[48:51], v[156:159]
    s_waitcnt vmcnt(8)
    ds_read_b64_tr_b16 v[20:21], v120 offset:16928
    v_mfma_f32_16x16x32_bf16 v[140:143], v[16:19], v[48:51], v[140:143]
    ds_read_b64_tr_b16 v[22:23], v120 offset:17440
    s_waitcnt lgkmcnt(4)
    v_mfma_f32_16x16x32_bf16 v[188:191], v[28:31], v[48:51], v[188:191]
    ds_read_b64_tr_b16 v[16:17], v120 offset:16896
    v_mfma_f32_16x16x32_bf16 v[172:175], v[24:27], v[48:51], v[172:175]
    ds_read_b64_tr_b16 v[18:19], v120 offset:17408
    v_mfma_f32_16x16x32_bf16 v[168:171], v[24:27], v[44:47], v[168:171]
    v_mfma_f32_16x16x32_bf16 v[184:187], v[28:31], v[44:47], v[184:187]
    ds_read_b128 v[60:63], v121 offset:61952
    v_mfma_f32_16x16x32_bf16 v[180:183], v[28:31], v[40:43], v[180:183]
    v_mfma_f32_16x16x32_bf16 v[164:167], v[24:27], v[40:43], v[164:167]
    ds_read_b128 v[64:67], v121 offset:62208
    v_mfma_f32_16x16x32_bf16 v[160:163], v[24:27], v[36:39], v[160:163]
    ds_read_b64_tr_b16 v[24:25], v120 offset:16960
    v_mfma_f32_16x16x32_bf16 v[176:179], v[28:31], v[36:39], v[176:179]
    ds_read_b64_tr_b16 v[26:27], v120 offset:17472
    s_waitcnt lgkmcnt(2)
    v_mfma_f32_16x16x32_bf16 v[128:131], v[16:19], v[52:55], v[128:131]
    ds_read_b64_tr_b16 v[28:29], v120 offset:16992
    v_mfma_f32_16x16x32_bf16 v[144:147], v[20:23], v[52:55], v[144:147]
    ds_read_b64_tr_b16 v[30:31], v120 offset:17504
    v_mfma_f32_16x16x32_bf16 v[148:151], v[20:23], v[56:59], v[148:151]
    v_mfma_f32_16x16x32_bf16 v[132:135], v[16:19], v[56:59], v[132:135]
    v_mfma_f32_16x16x32_bf16 v[136:139], v[16:19], v[60:63], v[136:139]
    v_mfma_f32_16x16x32_bf16 v[152:155], v[20:23], v[60:63], v[152:155]
    v_mfma_f32_16x16x32_bf16 v[156:159], v[20:23], v[64:67], v[156:159]
    s_waitcnt vmcnt(4)
    ds_read_b64_tr_b16 v[20:21], v120 offset:32
    v_mfma_f32_16x16x32_bf16 v[140:143], v[16:19], v[64:67], v[140:143]
    ds_read_b64_tr_b16 v[22:23], v120 offset:544
    s_waitcnt lgkmcnt(2)
    v_mfma_f32_16x16x32_bf16 v[188:191], v[28:31], v[64:67], v[188:191]
    ds_read_b64_tr_b16 v[16:17], v120 offset:0
    v_mfma_f32_16x16x32_bf16 v[172:175], v[24:27], v[64:67], v[172:175]
    ds_read_b64_tr_b16 v[18:19], v120 offset:512
    v_mfma_f32_16x16x32_bf16 v[168:171], v[24:27], v[60:63], v[168:171]
    v_mfma_f32_16x16x32_bf16 v[184:187], v[28:31], v[60:63], v[184:187]
    v_mfma_f32_16x16x32_bf16 v[180:183], v[28:31], v[56:59], v[180:183]
    v_mfma_f32_16x16x32_bf16 v[164:167], v[24:27], v[56:59], v[164:167]
    v_mfma_f32_16x16x32_bf16 v[160:163], v[24:27], v[52:55], v[160:163]
    ds_read_b64_tr_b16 v[24:25], v120 offset:64
    v_mfma_f32_16x16x32_bf16 v[176:179], v[28:31], v[52:55], v[176:179]
    ds_read_b64_tr_b16 v[26:27], v120 offset:576
    s_lshl_b32 s27, s19, 5
    s_add_u32 s27, s27, s20
    s_mul_i32 s27, s27, 57344
    s_lshl_b32 s28, s16, 14
    s_add_u32 s27, s27, s28
    s_add_u32 s30, s27, 16777216
    v_lshlrev_b32 v100, 4, v0
    s_movk_i32 s29, 0x1000
    s_cmp_eq_u32 s16, 3
    s_cselect_b32 s29, 0x40000000, s29
    s_waitcnt lgkmcnt(2)
    v_mfma_f32_16x16x32_bf16 v[192:195], v[16:19], v[36:39], v[192:195]
    ds_read_b64_tr_b16 v[28:29], v120 offset:96
    v_cvt_pk_bf16_f32 v128, v128, v129
    v_mfma_f32_16x16x32_bf16 v[208:211], v[20:23], v[36:39], v[208:211]
    ds_read_b64_tr_b16 v[30:31], v120 offset:608
    v_cvt_pk_bf16_f32 v129, v130, v131
    v_mfma_f32_16x16x32_bf16 v[212:215], v[20:23], v[40:43], v[212:215]
    v_cvt_pk_bf16_f32 v130, v144, v145
    v_cvt_pk_bf16_f32 v131, v146, v147
    v_mfma_f32_16x16x32_bf16 v[196:199], v[16:19], v[40:43], v[196:199]
    buffer_store_dwordx4 v[128:131], v100, s[12:15], s30 offen offset:0 sc1
    v_cvt_pk_bf16_f32 v132, v132, v133
    v_mfma_f32_16x16x32_bf16 v[200:203], v[16:19], v[44:47], v[200:203]
    v_cvt_pk_bf16_f32 v133, v134, v135
    v_cvt_pk_bf16_f32 v134, v148, v149
    v_mfma_f32_16x16x32_bf16 v[216:219], v[20:23], v[44:47], v[216:219]
    v_cvt_pk_bf16_f32 v135, v150, v151
    v_cvt_pk_bf16_f32 v136, v136, v137
    v_mfma_f32_16x16x32_bf16 v[220:223], v[20:23], v[48:51], v[220:223]
    s_waitcnt vmcnt(1)
    ds_read_b64_tr_b16 v[20:21], v120 offset:4256
    buffer_store_dwordx4 v[132:135], v100, s[12:15], s30 offen offset:1024 sc1
    v_mfma_f32_16x16x32_bf16 v[204:207], v[16:19], v[48:51], v[204:207]
    ds_read_b64_tr_b16 v[22:23], v120 offset:4768
    v_cvt_pk_bf16_f32 v137, v138, v139
    s_waitcnt lgkmcnt(2)
    v_mfma_f32_16x16x32_bf16 v[252:255], v[28:31], v[48:51], v[252:255]
    ds_read_b64_tr_b16 v[16:17], v120 offset:4224
    v_cvt_pk_bf16_f32 v138, v152, v153
    v_mfma_f32_16x16x32_bf16 v[236:239], v[24:27], v[48:51], v[236:239]
    ds_read_b64_tr_b16 v[18:19], v120 offset:4736
    v_cvt_pk_bf16_f32 v139, v154, v155
    v_mfma_f32_16x16x32_bf16 v[232:235], v[24:27], v[44:47], v[232:235]
    buffer_store_dwordx4 v[136:139], v100, s[12:15], s30 offen offset:2048 sc1
    v_cvt_pk_bf16_f32 v140, v140, v141
    v_mfma_f32_16x16x32_bf16 v[248:251], v[28:31], v[44:47], v[248:251]
    v_cvt_pk_bf16_f32 v141, v142, v143
    v_cvt_pk_bf16_f32 v142, v156, v157
    v_mfma_f32_16x16x32_bf16 v[244:247], v[28:31], v[40:43], v[244:247]
    v_cvt_pk_bf16_f32 v143, v158, v159
    v_cvt_pk_bf16_f32 v160, v160, v161
    v_mfma_f32_16x16x32_bf16 v[228:231], v[24:27], v[40:43], v[228:231]
    buffer_store_dwordx4 v[140:143], v100, s[12:15], s30 offen offset:3072 sc1
    v_cvt_pk_bf16_f32 v161, v162, v163
    v_mfma_f32_16x16x32_bf16 v[224:227], v[24:27], v[36:39], v[224:227]
    ds_read_b64_tr_b16 v[24:25], v120 offset:4288
    v_cvt_pk_bf16_f32 v162, v176, v177
    v_mfma_f32_16x16x32_bf16 v[240:243], v[28:31], v[36:39], v[240:243]
    ds_read_b64_tr_b16 v[26:27], v120 offset:4800
    v_cvt_pk_bf16_f32 v163, v178, v179
    s_add_u32 s30, s30, 0x1000
    s_waitcnt lgkmcnt(2)
    v_mfma_f32_16x16x32_bf16 v[192:195], v[16:19], v[52:55], v[192:195]
    ds_read_b64_tr_b16 v[28:29], v120 offset:4320
    buffer_store_dwordx4 v[160:163], v100, s[12:15], s30 offen offset:0 sc1
    v_mfma_f32_16x16x32_bf16 v[208:211], v[20:23], v[52:55], v[208:211]
    ds_read_b64_tr_b16 v[30:31], v120 offset:4832
    v_cvt_pk_bf16_f32 v164, v164, v165
    v_mfma_f32_16x16x32_bf16 v[212:215], v[20:23], v[56:59], v[212:215]
    v_cvt_pk_bf16_f32 v165, v166, v167
    v_cvt_pk_bf16_f32 v166, v180, v181
    v_mfma_f32_16x16x32_bf16 v[196:199], v[16:19], v[56:59], v[196:199]
    v_cvt_pk_bf16_f32 v167, v182, v183
    buffer_store_dwordx4 v[164:167], v100, s[12:15], s30 offen offset:1024 sc1
    v_mfma_f32_16x16x32_bf16 v[200:203], v[16:19], v[60:63], v[200:203]
    v_cvt_pk_bf16_f32 v168, v168, v169
    v_cvt_pk_bf16_f32 v169, v170, v171
    v_mfma_f32_16x16x32_bf16 v[216:219], v[20:23], v[60:63], v[216:219]
    v_cvt_pk_bf16_f32 v170, v184, v185
    v_cvt_pk_bf16_f32 v171, v186, v187
    v_mfma_f32_16x16x32_bf16 v[220:223], v[20:23], v[64:67], v[220:223]
    buffer_store_dwordx4 v[168:171], v100, s[12:15], s30 offen offset:2048 sc1
    v_cvt_pk_bf16_f32 v172, v172, v173
    v_mfma_f32_16x16x32_bf16 v[204:207], v[16:19], v[64:67], v[204:207]
    v_cvt_pk_bf16_f32 v173, v174, v175
    v_cvt_pk_bf16_f32 v174, v188, v189
    s_waitcnt lgkmcnt(0)
    v_mfma_f32_16x16x32_bf16 v[252:255], v[28:31], v[64:67], v[252:255]
    v_cvt_pk_bf16_f32 v175, v190, v191
    v_mfma_f32_16x16x32_bf16 v[236:239], v[24:27], v[64:67], v[236:239]
    buffer_store_dwordx4 v[172:175], v100, s[12:15], s30 offen offset:3072 sc1
    v_mfma_f32_16x16x32_bf16 v[232:235], v[24:27], v[60:63], v[232:235]
    v_mfma_f32_16x16x32_bf16 v[248:251], v[28:31], v[60:63], v[248:251]
    v_mfma_f32_16x16x32_bf16 v[244:247], v[28:31], v[56:59], v[244:247]
    v_mfma_f32_16x16x32_bf16 v[228:231], v[24:27], v[56:59], v[228:231]
    v_mfma_f32_16x16x32_bf16 v[224:227], v[24:27], v[52:55], v[224:227]
    v_mfma_f32_16x16x32_bf16 v[240:243], v[28:31], v[52:55], v[240:243]
    s_nop 4
    v_cvt_pk_bf16_f32 v192, v192, v193
    v_cvt_pk_bf16_f32 v193, v194, v195
    v_cvt_pk_bf16_f32 v194, v208, v209
    v_cvt_pk_bf16_f32 v195, v210, v211
    s_add_u32 s30, s30, s29
    buffer_store_dwordx4 v[192:195], v100, s[12:15], s30 offen offset:0 sc1
    v_cvt_pk_bf16_f32 v196, v196, v197
    v_cvt_pk_bf16_f32 v197, v198, v199
    v_cvt_pk_bf16_f32 v198, v212, v213
    v_cvt_pk_bf16_f32 v199, v214, v215
    buffer_store_dwordx4 v[196:199], v100, s[12:15], s30 offen offset:1024 sc1
    v_cvt_pk_bf16_f32 v200, v200, v201
    v_cvt_pk_bf16_f32 v201, v202, v203
    v_cvt_pk_bf16_f32 v202, v216, v217
    v_cvt_pk_bf16_f32 v203, v218, v219
    buffer_store_dwordx4 v[200:203], v100, s[12:15], s30 offen offset:2048 sc1
    v_cvt_pk_bf16_f32 v204, v204, v205
    v_cvt_pk_bf16_f32 v205, v206, v207
    v_cvt_pk_bf16_f32 v206, v220, v221
    v_cvt_pk_bf16_f32 v207, v222, v223
    buffer_store_dwordx4 v[204:207], v100, s[12:15], s30 offen offset:3072 sc1
    v_cvt_pk_bf16_f32 v224, v224, v225
    v_cvt_pk_bf16_f32 v225, v226, v227
    v_cvt_pk_bf16_f32 v226, v240, v241
    v_cvt_pk_bf16_f32 v227, v242, v243
    s_add_u32 s30, s30, 0x1000
    buffer_store_dwordx4 v[224:227], v100, s[12:15], s30 offen offset:0 sc1
    v_cvt_pk_bf16_f32 v228, v228, v229
    v_cvt_pk_bf16_f32 v229, v230, v231
    v_cvt_pk_bf16_f32 v230, v244, v245
    v_cvt_pk_bf16_f32 v231, v246, v247
    buffer_store_dwordx4 v[228:231], v100, s[12:15], s30 offen offset:1024 sc1
    v_cvt_pk_bf16_f32 v232, v232, v233
    v_cvt_pk_bf16_f32 v233, v234, v235
    v_cvt_pk_bf16_f32 v234, v248, v249
    v_cvt_pk_bf16_f32 v235, v250, v251
    buffer_store_dwordx4 v[232:235], v100, s[12:15], s30 offen offset:2048 sc1
    v_cvt_pk_bf16_f32 v236, v236, v237
    v_cvt_pk_bf16_f32 v237, v238, v239
    v_cvt_pk_bf16_f32 v238, v252, v253
    v_cvt_pk_bf16_f32 v239, v254, v255
    buffer_store_dwordx4 v[236:239], v100, s[12:15], s30 offen offset:3072 sc1
    s_mov_b32 s31, 0xffff0000
    s_mov_b32 s22, 0x3f80
    s_mov_b32 s23, 0x3f800000
    s_lshl_b32 s26, s20, 10
    s_add_u32 s26, s26, 50331648
    s_lshl_b32 s27, s19, 7
    s_add_u32 s27, s27, s26
    s_lshl_b32 s28, s19, 2
    s_add_u32 s28, s28, s26
    v_mov_b32 v5, 1
    v_lshlrev_b32 v2, 7, v0
    v_bfe_u32 v6, v0, 4, 1
    v_mad_u32_u24 v4, v6, 24, v4
    v_mad_u32_u24 v33, v6, 24, v33
    v_accvgpr_read_b32 v36, a0
    v_accvgpr_read_b32 v37, a1
    v_accvgpr_read_b32 v38, a2
    v_accvgpr_read_b32 v39, a3
    v_accvgpr_read_b32 v40, a4
    v_accvgpr_read_b32 v41, a5
    v_accvgpr_read_b32 v42, a6
    v_accvgpr_read_b32 v43, a7
    v_accvgpr_read_b32 v44, a8
    v_accvgpr_read_b32 v45, a9
    v_accvgpr_read_b32 v46, a10
    v_accvgpr_read_b32 v47, a11
    v_accvgpr_read_b32 v48, a12
    v_accvgpr_read_b32 v49, a13
    v_accvgpr_read_b32 v50, a14
    v_accvgpr_read_b32 v51, a15
    v_accvgpr_read_b32 v52, a16
    v_accvgpr_read_b32 v53, a17
    v_accvgpr_read_b32 v54, a18
    v_accvgpr_read_b32 v55, a19
    v_accvgpr_read_b32 v56, a20
    v_accvgpr_read_b32 v57, a21
    v_accvgpr_read_b32 v58, a22
    v_accvgpr_read_b32 v59, a23
    v_accvgpr_read_b32 v60, a24
    v_accvgpr_read_b32 v61, a25
    v_accvgpr_read_b32 v62, a26
    v_accvgpr_read_b32 v63, a27
    v_accvgpr_read_b32 v24, a28
    v_accvgpr_read_b32 v25, a29
    v_accvgpr_read_b32 v26, a30
    v_accvgpr_read_b32 v27, a31
    v_lshlrev_b32 v8, 16, v36
    v_and_b32 v9, s31, v36
    v_lshlrev_b32 v10, 16, v37
    v_and_b32 v11, s31, v37
    v_lshlrev_b32 v12, 16, v38
    v_and_b32 v13, s31, v38
    v_lshlrev_b32 v14, 16, v39
    v_and_b32 v15, s31, v39
    v_dot2c_f32_bf16 v8, s22, v40
    v_dot2c_f32_bf16 v9, s23, v40
    v_dot2c_f32_bf16 v10, s22, v41
    v_dot2c_f32_bf16 v11, s23, v41
    v_dot2c_f32_bf16 v12, s22, v42
    v_dot2c_f32_bf16 v13, s23, v42
    v_dot2c_f32_bf16 v14, s22, v43
    v_dot2c_f32_bf16 v15, s23, v43
    v_dot2c_f32_bf16 v8, s22, v44
    v_dot2c_f32_bf16 v9, s23, v44
    v_dot2c_f32_bf16 v10, s22, v45
    v_dot2c_f32_bf16 v11, s23, v45
    v_dot2c_f32_bf16 v12, s22, v46
    v_dot2c_f32_bf16 v13, s23, v46
    v_dot2c_f32_bf16 v14, s22, v47
    v_dot2c_f32_bf16 v15, s23, v47
    v_dot2c_f32_bf16 v8, s22, v48
    v_dot2c_f32_bf16 v9, s23, v48
    v_dot2c_f32_bf16 v10, s22, v49
    v_dot2c_f32_bf16 v11, s23, v49
    v_dot2c_f32_bf16 v12, s22, v50
    v_dot2c_f32_bf16 v13, s23, v50
    v_dot2c_f32_bf16 v14, s22, v51
    v_dot2c_f32_bf16 v15, s23, v51
    v_dot2c_f32_bf16 v8, s22, v52
    v_dot2c_f32_bf16 v9, s23, v52
    v_dot2c_f32_bf16 v10, s22, v53
    v_dot2c_f32_bf16 v11, s23, v53
    v_dot2c_f32_bf16 v12, s22, v54
    v_dot2c_f32_bf16 v13, s23, v54
    v_dot2c_f32_bf16 v14, s22, v55
    v_dot2c_f32_bf16 v15, s23, v55
    v_dot2c_f32_bf16 v8, s22, v56
    v_dot2c_f32_bf16 v9, s23, v56
    v_dot2c_f32_bf16 v10, s22, v57
    v_dot2c_f32_bf16 v11, s23, v57
    v_dot2c_f32_bf16 v12, s22, v58
    v_dot2c_f32_bf16 v13, s23, v58
    v_dot2c_f32_bf16 v14, s22, v59
    v_dot2c_f32_bf16 v15, s23, v59
    v_dot2c_f32_bf16 v8, s22, v60
    v_dot2c_f32_bf16 v9, s23, v60
    v_dot2c_f32_bf16 v10, s22, v61
    v_dot2c_f32_bf16 v11, s23, v61
    v_dot2c_f32_bf16 v12, s22, v62
    v_dot2c_f32_bf16 v13, s23, v62
    v_dot2c_f32_bf16 v14, s22, v63
    v_dot2c_f32_bf16 v15, s23, v63
    s_nop 2
    v_mul_f32 v8, 0x42f5fdf0, v8
    v_mul_f32 v9, 0x42f5fdf0, v9
    v_mul_f32 v10, 0x42f5fdf0, v10
    v_mul_f32 v11, 0x42f5fdf0, v11
    v_mul_f32 v12, 0x42f5fdf0, v12
    v_mul_f32 v13, 0x42f5fdf0, v13
    v_mul_f32 v14, 0x42f5fdf0, v14
    v_mul_f32 v15, 0x42f5fdf0, v15
    v_cvt_pk_bf16_f32 v112, v8, v9
    v_cvt_pk_bf16_f32 v113, v10, v11
    v_cvt_pk_bf16_f32 v114, v12, v13
    v_cvt_pk_bf16_f32 v115, v14, v15
    v_lshlrev_b32 v8, 16, v112
    v_and_b32 v9, s31, v112
    v_lshlrev_b32 v10, 16, v113
    v_and_b32 v11, s31, v113
    v_lshlrev_b32 v12, 16, v114
    v_and_b32 v13, s31, v114
    v_lshlrev_b32 v14, 16, v115
    v_and_b32 v15, s31, v115
    v_mul_f32 v112, 0xbfb8aa3b, v8
    v_mul_f32 v113, 0xbfb8aa3b, v9
    v_mul_f32 v114, 0xbfb8aa3b, v10
    v_mul_f32 v115, 0xbfb8aa3b, v11
    v_mul_f32 v116, 0xbfb8aa3b, v12
    v_mul_f32 v117, 0xbfb8aa3b, v13
    v_mul_f32 v118, 0xbfb8aa3b, v14
    v_mul_f32 v119, 0xbfb8aa3b, v15
    v_exp_f32 v112, v112
    v_exp_f32 v113, v113
    v_exp_f32 v114, v114
    v_exp_f32 v115, v115
    v_exp_f32 v116, v116
    v_exp_f32 v117, v117
    v_exp_f32 v118, v118
    v_exp_f32 v119, v119
    v_add_f32 v112, 1.0, v112
    v_add_f32 v113, 1.0, v113
    v_add_f32 v114, 1.0, v114
    v_add_f32 v115, 1.0, v115
    v_add_f32 v116, 1.0, v116
    v_add_f32 v117, 1.0, v117
    v_add_f32 v118, 1.0, v118
    v_add_f32 v119, 1.0, v119
    v_rcp_f32 v112, v112
    v_rcp_f32 v113, v113
    v_rcp_f32 v114, v114
    v_rcp_f32 v115, v115
    v_rcp_f32 v116, v116
    v_rcp_f32 v117, v117
    v_rcp_f32 v118, v118
    v_rcp_f32 v119, v119
    v_mul_f32 v8, v8, v112
    v_mul_f32 v9, v9, v113
    v_mul_f32 v10, v10, v114
    v_mul_f32 v11, v11, v115
    v_mul_f32 v12, v12, v116
    v_mul_f32 v13, v13, v117
    v_mul_f32 v14, v14, v118
    v_mul_f32 v15, v15, v119
    v_cvt_pk_bf16_f32 v112, v8, v9
    v_cvt_pk_bf16_f32 v113, v10, v11
    v_cvt_pk_bf16_f32 v114, v12, v13
    v_cvt_pk_bf16_f32 v115, v14, v15
    v_lshlrev_b32 v8, 16, v112
    v_and_b32 v9, s31, v112
    v_lshlrev_b32 v10, 16, v113
    v_and_b32 v11, s31, v113
    v_lshlrev_b32 v12, 16, v114
    v_and_b32 v13, s31, v114
    v_lshlrev_b32 v14, 16, v115
    v_and_b32 v15, s31, v115
    s_waitcnt vmcnt(0)
    s_barrier
    s_cmp_lg_u32 s16, 0
    s_cbranch_scc1 L_noflag
    s_mov_b64 exec, 1
    buffer_store_dword v5, off, s[12:15], s27 sc1
    s_mov_b64 exec, 0xff
    buffer_load_dword v6, v2, s[12:15], s26 offen sc1
    s_mov_b64 exec, -1
L_noflag:
    v_accvgpr_read_b32 v36, a32
    v_accvgpr_read_b32 v37, a33
    v_accvgpr_read_b32 v38, a34
    v_accvgpr_read_b32 v39, a35
    v_accvgpr_read_b32 v40, a36
    v_accvgpr_read_b32 v41, a37
    v_accvgpr_read_b32 v42, a38
    v_accvgpr_read_b32 v43, a39
    v_accvgpr_read_b32 v44, a40
    v_accvgpr_read_b32 v45, a41
    v_accvgpr_read_b32 v46, a42
    v_accvgpr_read_b32 v47, a43
    v_accvgpr_read_b32 v48, a44
    v_accvgpr_read_b32 v49, a45
    v_accvgpr_read_b32 v50, a46
    v_accvgpr_read_b32 v51, a47
    v_accvgpr_read_b32 v52, a48
    v_accvgpr_read_b32 v53, a49
    v_accvgpr_read_b32 v54, a50
    v_accvgpr_read_b32 v55, a51
    v_accvgpr_read_b32 v56, a52
    v_accvgpr_read_b32 v57, a53
    v_accvgpr_read_b32 v58, a54
    v_accvgpr_read_b32 v59, a55
    v_accvgpr_read_b32 v60, a56
    v_accvgpr_read_b32 v61, a57
    v_accvgpr_read_b32 v62, a58
    v_accvgpr_read_b32 v63, a59
    v_accvgpr_read_b32 v28, a60
    v_accvgpr_read_b32 v29, a61
    v_accvgpr_read_b32 v30, a62
    v_accvgpr_read_b32 v31, a63
    v_lshlrev_b32 v104, 16, v36
    v_and_b32 v105, s31, v36
    v_lshlrev_b32 v106, 16, v37
    v_and_b32 v107, s31, v37
    v_lshlrev_b32 v108, 16, v38
    v_and_b32 v109, s31, v38
    v_lshlrev_b32 v110, 16, v39
    v_and_b32 v111, s31, v39
    v_dot2c_f32_bf16 v104, s22, v40
    v_dot2c_f32_bf16 v105, s23, v40
    v_dot2c_f32_bf16 v106, s22, v41
    v_dot2c_f32_bf16 v107, s23, v41
    v_dot2c_f32_bf16 v108, s22, v42
    v_dot2c_f32_bf16 v109, s23, v42
    v_dot2c_f32_bf16 v110, s22, v43
    v_dot2c_f32_bf16 v111, s23, v43
    v_dot2c_f32_bf16 v104, s22, v44
    v_dot2c_f32_bf16 v105, s23, v44
    v_dot2c_f32_bf16 v106, s22, v45
    v_dot2c_f32_bf16 v107, s23, v45
    v_dot2c_f32_bf16 v108, s22, v46
    v_dot2c_f32_bf16 v109, s23, v46
    v_dot2c_f32_bf16 v110, s22, v47
    v_dot2c_f32_bf16 v111, s23, v47
    v_dot2c_f32_bf16 v104, s22, v48
    v_dot2c_f32_bf16 v105, s23, v48
    v_dot2c_f32_bf16 v106, s22, v49
    v_dot2c_f32_bf16 v107, s23, v49
    v_dot2c_f32_bf16 v108, s22, v50
    v_dot2c_f32_bf16 v109, s23, v50
    v_dot2c_f32_bf16 v110, s22, v51
    v_dot2c_f32_bf16 v111, s23, v51
    v_dot2c_f32_bf16 v104, s22, v52
    v_dot2c_f32_bf16 v105, s23, v52
    v_dot2c_f32_bf16 v106, s22, v53
    v_dot2c_f32_bf16 v107, s23, v53
    v_dot2c_f32_bf16 v108, s22, v54
    v_dot2c_f32_bf16 v109, s23, v54
    v_dot2c_f32_bf16 v110, s22, v55
    v_dot2c_f32_bf16 v111, s23, v55
    v_dot2c_f32_bf16 v104, s22, v56
    v_dot2c_f32_bf16 v105, s23, v56
    v_dot2c_f32_bf16 v106, s22, v57
    v_dot2c_f32_bf16 v107, s23, v57
    v_dot2c_f32_bf16 v108, s22, v58
    v_dot2c_f32_bf16 v109, s23, v58
    v_dot2c_f32_bf16 v110, s22, v59
    v_dot2c_f32_bf16 v111, s23, v59
    v_dot2c_f32_bf16 v104, s22, v60
    v_dot2c_f32_bf16 v105, s23, v60
    v_dot2c_f32_bf16 v106, s22, v61
    v_dot2c_f32_bf16 v107, s23, v61
    v_dot2c_f32_bf16 v108, s22, v62
    v_dot2c_f32_bf16 v109, s23, v62
    v_dot2c_f32_bf16 v110, s22, v63
    v_dot2c_f32_bf16 v111, s23, v63
    s_nop 2
    v_mul_f32 v104, 0x42f5fdf0, v104
    v_mul_f32 v105, 0x42f5fdf0, v105
    v_mul_f32 v106, 0x42f5fdf0, v106
    v_mul_f32 v107, 0x42f5fdf0, v107
    v_mul_f32 v108, 0x42f5fdf0, v108
    v_mul_f32 v109, 0x42f5fdf0, v109
    v_mul_f32 v110, 0x42f5fdf0, v110
    v_mul_f32 v111, 0x42f5fdf0, v111
    v_cvt_pk_bf16_f32 v112, v104, v105
    v_cvt_pk_bf16_f32 v113, v106, v107
    v_cvt_pk_bf16_f32 v114, v108, v109
    v_cvt_pk_bf16_f32 v115, v110, v111
    v_lshlrev_b32 v104, 16, v112
    v_and_b32 v105, s31, v112
    v_lshlrev_b32 v106, 16, v113
    v_and_b32 v107, s31, v113
    v_lshlrev_b32 v108, 16, v114
    v_and_b32 v109, s31, v114
    v_lshlrev_b32 v110, 16, v115
    v_and_b32 v111, s31, v115
    v_mul_f32 v112, 0xbfb8aa3b, v104
    v_mul_f32 v113, 0xbfb8aa3b, v105
    v_mul_f32 v114, 0xbfb8aa3b, v106
    v_mul_f32 v115, 0xbfb8aa3b, v107
    v_mul_f32 v116, 0xbfb8aa3b, v108
    v_mul_f32 v117, 0xbfb8aa3b, v109
    v_mul_f32 v118, 0xbfb8aa3b, v110
    v_mul_f32 v119, 0xbfb8aa3b, v111
    v_exp_f32 v112, v112
    v_exp_f32 v113, v113
    v_exp_f32 v114, v114
    v_exp_f32 v115, v115
    v_exp_f32 v116, v116
    v_exp_f32 v117, v117
    v_exp_f32 v118, v118
    v_exp_f32 v119, v119
    v_add_f32 v112, 1.0, v112
    v_add_f32 v113, 1.0, v113
    v_add_f32 v114, 1.0, v114
    v_add_f32 v115, 1.0, v115
    v_add_f32 v116, 1.0, v116
    v_add_f32 v117, 1.0, v117
    v_add_f32 v118, 1.0, v118
    v_add_f32 v119, 1.0, v119
    v_rcp_f32 v112, v112
    v_rcp_f32 v113, v113
    v_rcp_f32 v114, v114
    v_rcp_f32 v115, v115
    v_rcp_f32 v116, v116
    v_rcp_f32 v117, v117
    v_rcp_f32 v118, v118
    v_rcp_f32 v119, v119
    v_mul_f32 v104, v104, v112
    v_mul_f32 v105, v105, v113
    v_mul_f32 v106, v106, v114
    v_mul_f32 v107, v107, v115
    v_mul_f32 v108, v108, v116
    v_mul_f32 v109, v109, v117
    v_mul_f32 v110, v110, v118
    v_mul_f32 v111, v111, v119
    v_cvt_pk_bf16_f32 v112, v104, v105
    v_cvt_pk_bf16_f32 v113, v106, v107
    v_cvt_pk_bf16_f32 v114, v108, v109
    v_cvt_pk_bf16_f32 v115, v110, v111
    v_lshlrev_b32 v104, 16, v112
    v_and_b32 v105, s31, v112
    v_lshlrev_b32 v106, 16, v113
    v_and_b32 v107, s31, v113
    v_lshlrev_b32 v108, 16, v114
    v_and_b32 v109, s31, v114
    v_lshlrev_b32 v110, 16, v115
    v_and_b32 v111, s31, v115
    s_cmp_lg_u32 s16, 0
    s_cbranch_scc1 L_flagok
    s_mov_b32 s28, 0
    s_mov_b64 exec, 0xff
L_spinS:
    s_add_u32 s28, s28, 1
    s_waitcnt vmcnt(0)
    v_cmp_ne_u32 vcc, 1, v6
    s_cmp_gt_u32 s28, 0x8000
    s_cbranch_scc1 L_spinS_end
    s_cbranch_vccz L_spinS_end
    buffer_load_dword v6, v2, s[12:15], s26 offen sc1
    s_branch L_spinS
L_spinS_end:
    s_mov_b64 exec, -1
L_flagok:
    s_barrier
    s_add_u32 s27, s24, 16777216
    buffer_load_dwordx4 v[128:131], v1, s[12:15], s27 offen sc1
    s_add_u32 s27, s27, 1835008
    buffer_load_dwordx4 v[132:135], v1, s[12:15], s27 offen sc1
    s_add_u32 s27, s27, 1835008
    buffer_load_dwordx4 v[136:139], v1, s[12:15], s27 offen sc1
    s_add_u32 s27, s27, 1835008
    buffer_load_dwordx4 v[140:143], v1, s[12:15], s27 offen sc1
    s_add_u32 s27, s27, 1835008
    buffer_load_dwordx4 v[144:147], v1, s[12:15], s27 offen sc1
    s_add_u32 s27, s27, 1835008
    buffer_load_dwordx4 v[148:151], v1, s[12:15], s27 offen sc1
    s_add_u32 s27, s27, 1835008
    buffer_load_dwordx4 v[152:155], v1, s[12:15], s27 offen sc1
    s_add_u32 s27, s27, 1835008
    buffer_load_dwordx4 v[156:159], v1, s[12:15], s27 offen sc1
    s_add_u32 s27, s24, 16777216
    buffer_load_dwordx4 v[160:163], v3, s[12:15], s27 offen sc1
    s_add_u32 s27, s27, 1835008
    buffer_load_dwordx4 v[164:167], v3, s[12:15], s27 offen sc1
    s_add_u32 s27, s27, 1835008
    buffer_load_dwordx4 v[168:171], v3, s[12:15], s27 offen sc1
    s_add_u32 s27, s27, 1835008
    buffer_load_dwordx4 v[172:175], v3, s[12:15], s27 offen sc1
    s_add_u32 s27, s27, 1835008
    buffer_load_dwordx4 v[176:179], v3, s[12:15], s27 offen sc1
    s_add_u32 s27, s27, 1835008
    buffer_load_dwordx4 v[180:183], v3, s[12:15], s27 offen sc1
    s_add_u32 s27, s27, 1835008
    buffer_load_dwordx4 v[184:187], v3, s[12:15], s27 offen sc1
    s_add_u32 s27, s27, 1835008
    buffer_load_dwordx4 v[188:191], v3, s[12:15], s27 offen sc1
    s_waitcnt vmcnt(15)
    v_lshlrev_b32 v92, 16, v128
    v_and_b32 v93, s31, v128
    v_lshlrev_b32 v94, 16, v129
    v_and_b32 v95, s31, v129
    v_lshlrev_b32 v96, 16, v130
    v_and_b32 v97, s31, v130
    v_lshlrev_b32 v98, 16, v131
    v_and_b32 v99, s31, v131
    s_waitcnt vmcnt(14)
    v_dot2c_f32_bf16 v92, s22, v132
    v_dot2c_f32_bf16 v93, s23, v132
    v_dot2c_f32_bf16 v94, s22, v133
L_pg12:
    s_cbranch_execz L_pgret
    v_dot2c_f32_bf16 v95, s23, v133
    v_dot2c_f32_bf16 v96, s22, v134
    v_dot2c_f32_bf16 v97, s23, v134
    v_dot2c_f32_bf16 v98, s22, v135
    v_dot2c_f32_bf16 v99, s23, v135
    s_waitcnt vmcnt(13)
    v_dot2c_f32_bf16 v92, s22, v136
    v_dot2c_f32_bf16 v93, s23, v136
    v_dot2c_f32_bf16 v94, s22, v137
    v_dot2c_f32_bf16 v95, s23, v137
    v_dot2c_f32_bf16 v96, s22, v138
    v_dot2c_f32_bf16 v97, s23, v138
    v_dot2c_f32_bf16 v98, s22, v139
    v_dot2c_f32_bf16 v99, s23, v139
    s_waitcnt vmcnt(12)
    v_dot2c_f32_bf16 v92, s22, v140
    v_dot2c_f32_bf16 v93, s23, v140
    v_dot2c_f32_bf16 v94, s22, v141
    v_dot2c_f32_bf16 v95, s23, v141
    v_dot2c_f32_bf16 v96, s22, v142
    v_dot2c_f32_bf16 v97, s23, v142
    v_dot2c_f32_bf16 v98, s22, v143
    v_dot2c_f32_bf16 v99, s23, v143
    s_waitcnt vmcnt(11)
    v_dot2c_f32_bf16 v92, s22, v144
    v_dot2c_f32_bf16 v93, s23, v144
    v_dot2c_f32_bf16 v94, s22, v145
    v_dot2c_f32_bf16 v95, s23, v145
    v_dot2c_f32_bf16 v96, s22, v146
    v_dot2c_f32_bf16 v97, s23, v146
    v_dot2c_f32_bf16 v98, s22, v147
    v_dot2c_f32_bf16 v99, s23, v147
    s_waitcnt vmcnt(10)
    v_dot2c_f32_bf16 v92, s22, v148
    v_dot2c_f32_bf16 v93, s23, v148
    v_dot2c_f32_bf16 v94, s22, v149
    v_dot2c_f32_bf16 v95, s23, v149
    v_dot2c_f32_bf16 v96, s22, v150
    v_dot2c_f32_bf16 v97, s23, v150
    v_dot2c_f32_bf16 v98, s22, v151
    v_dot2c_f32_bf16 v99, s23, v151
    s_waitcnt vmcnt(9)
    v_dot2c_f32_bf16 v92, s22, v152
    v_dot2c_f32_bf16 v93, s23, v152
    v_dot2c_f32_bf16 v94, s22, v153
    v_dot2c_f32_bf16 v95, s23, v153
    v_dot2c_f32_bf16 v96, s22, v154
    v_dot2c_f32_bf16 v97, s23, v154
    v_dot2c_f32_bf16 v98, s22, v155
    v_dot2c_f32_bf16 v99, s23, v155
    s_waitcnt vmcnt(8)
    v_dot2c_f32_bf16 v92, s22, v156
    v_dot2c_f32_bf16 v93, s23, v156
    v_dot2c_f32_bf16 v94, s22, v157
    v_dot2c_f32_bf16 v95, s23, v157
    v_dot2c_f32_bf16 v96, s22, v158
    v_dot2c_f32_bf16 v97, s23, v158
    v_dot2c_f32_bf16 v98, s22, v159
    v_dot2c_f32_bf16 v99, s23, v159
    s_nop 2
    v_lshlrev_b32 v112, 16, v24
    v_and_b32 v113, s31, v24
    v_lshlrev_b32 v114, 16, v25
    v_and_b32 v115, s31, v25
    v_lshlrev_b32 v116, 16, v26
    v_and_b32 v117, s31, v26
    v_lshlrev_b32 v118, 16, v27
    v_and_b32 v119, s31, v27
    v_pk_fma_f32 v[92:93], v[92:93], v[8:9], v[112:113]
    v_pk_fma_f32 v[94:95], v[94:95], v[10:11], v[114:115]
    v_pk_fma_f32 v[96:97], v[96:97], v[12:13], v[116:117]
    v_pk_fma_f32 v[98:99], v[98:99], v[14:15], v[118:119]
    v_cvt_pk_bf16_f32 v24, v92, v93
    v_cvt_pk_bf16_f32 v25, v94, v95
    v_cvt_pk_bf16_f32 v26, v96, v97
    v_cvt_pk_bf16_f32 v27, v98, v99
    s_nop 1
    v_permlane16_swap_b32 v24, v26
    v_permlane16_swap_b32 v25, v27
    buffer_store_dwordx4 v[24:27], v4, s[40:43], s25 offen
    s_waitcnt vmcnt(8)
    v_lshlrev_b32 v92, 16, v160
    v_and_b32 v93, s31, v160
    v_lshlrev_b32 v94, 16, v161
    v_and_b32 v95, s31, v161
    v_lshlrev_b32 v96, 16, v162
    v_and_b32 v97, s31, v162
    v_lshlrev_b32 v98, 16, v163
    v_and_b32 v99, s31, v163
    s_waitcnt vmcnt(7)
    v_dot2c_f32_bf16 v92, s22, v164
    v_dot2c_f32_bf16 v93, s23, v164
    v_dot2c_f32_bf16 v94, s22, v165
    v_dot2c_f32_bf16 v95, s23, v165
    v_dot2c_f32_bf16 v96, s22, v166
    v_dot2c_f32_bf16 v97, s23, v166
    v_dot2c_f32_bf16 v98, s22, v167
    v_dot2c_f32_bf16 v99, s23, v167
    s_waitcnt vmcnt(6)
    v_dot2c_f32_bf16 v92, s22, v168
    v_dot2c_f32_bf16 v93, s23, v168
    v_dot2c_f32_bf16 v94, s22, v169
    v_dot2c_f32_bf16 v95, s23, v169
    v_dot2c_f32_bf16 v96, s22, v170
    v_dot2c_f32_bf16 v97, s23, v170
    v_dot2c_f32_bf16 v98, s22, v171
    v_dot2c_f32_bf16 v99, s23, v171
    s_waitcnt vmcnt(5)
    v_dot2c_f32_bf16 v92, s22, v172
    v_dot2c_f32_bf16 v93, s23, v172
    v_dot2c_f32_bf16 v94, s22, v173
    v_dot2c_f32_bf16 v95, s23, v173
    v_dot2c_f32_bf16 v96, s22, v174
    v_dot2c_f32_bf16 v97, s23, v174
    v_dot2c_f32_bf16 v98, s22, v175
    v_dot2c_f32_bf16 v99, s23, v175
    s_waitcnt vmcnt(4)
    v_dot2c_f32_bf16 v92, s22, v176
    v_dot2c_f32_bf16 v93, s23, v176
    v_dot2c_f32_bf16 v94, s22, v177
    v_dot2c_f32_bf16 v95, s23, v177
    v_dot2c_f32_bf16 v96, s22, v178
    v_dot2c_f32_bf16 v97, s23, v178
    v_dot2c_f32_bf16 v98, s22, v179
    v_dot2c_f32_bf16 v99, s23, v179
    s_waitcnt vmcnt(3)
    v_dot2c_f32_bf16 v92, s22, v180
    v_dot2c_f32_bf16 v93, s23, v180
    v_dot2c_f32_bf16 v94, s22, v181
    v_dot2c_f32_bf16 v95, s23, v181
    v_dot2c_f32_bf16 v96, s22, v182
    v_dot2c_f32_bf16 v97, s23, v182
    v_dot2c_f32_bf16 v98, s22, v183
    v_dot2c_f32_bf16 v99, s23, v183
    s_waitcnt vmcnt(2)
    v_dot2c_f32_bf16 v92, s22, v184
    v_dot2c_f32_bf16 v93, s23, v184
    v_dot2c_f32_bf16 v94, s22, v185
    v_dot2c_f32_bf16 v95, s23, v185
    v_dot2c_f32_bf16 v96, s22, v186
    v_dot2c_f32_bf16 v97, s23, v186
    v_dot2c_f32_bf16 v98, s22, v187
    v_dot2c_f32_bf16 v99, s23, v187
    s_waitcnt vmcnt(1)
    v_dot2c_f32_bf16 v92, s22, v188
    v_dot2c_f32_bf16 v93, s23, v188
    v_dot2c_f32_bf16 v94, s22, v189
    v_dot2c_f32_bf16 v95, s23, v189
    v_dot2c_f32_bf16 v96, s22, v190
    v_dot2c_f32_bf16 v97, s23, v190
    v_dot2c_f32_bf16 v98, s22, v191
    v_dot2c_f32_bf16 v99, s23, v191
    s_nop 2
    v_lshlrev_b32 v112, 16, v28
    v_and_b32 v113, s31, v28
    v_lshlrev_b32 v114, 16, v29
    v_and_b32 v115, s31, v29
    v_lshlrev_b32 v116, 16, v30
    v_and_b32 v117, s31, v30
    v_lshlrev_b32 v118, 16, v31
    v_and_b32 v119, s31, v31
    v_pk_fma_f32 v[92:93], v[92:93], v[104:105], v[112:113]
    v_pk_fma_f32 v[94:95], v[94:95], v[106:107], v[114:115]
    v_pk_fma_f32 v[96:97], v[96:97], v[108:109], v[116:117]
    v_pk_fma_f32 v[98:99], v[98:99], v[110:111], v[118:119]
    v_cvt_pk_bf16_f32 v28, v92, v93
    v_cvt_pk_bf16_f32 v29, v94, v95
    v_cvt_pk_bf16_f32 v30, v96, v97
    v_cvt_pk_bf16_f32 v31, v98, v99
    s_nop 1
    v_permlane16_swap_b32 v28, v30
    v_permlane16_swap_b32 v29, v31
    buffer_store_dwordx4 v[28:31], v33, s[40:43], s25 offen
L_done:
    s_endpgm
L_hot_end:
L_sig:
    s_lshl_b32 s27, s20, 2
    s_cmp_eq_u32 s26, 0
    s_cbranch_scc1 L_sig0
    buffer_load_dword v5, off, s[36:39], s27 offset:64 sc1
    s_add_u32 s28, s27, s16
    s_mul_i32 s28, s28, 3584
    v_lshlrev_b32 v36, 7, v0
    s_mov_b64 exec, 0xfffffff
    buffer_load_dword v34, v36, s[52:55], s28 offen
    s_mov_b64 exec, -1
    s_getpc_b64 s[28:29]
L_pc2:
    s_sub_u32 s28, s28, L_pc2 - L_okD
    s_subb_u32 s29, s29, 0
    s_add_u32 s27, s27, s16
    s_lshl_b32 s27, s27, 1
    v_add_u32 v36, s27, v0
    v_min_u32 v36, (L_hot_end - L_okD) / 128, v36
    v_lshlrev_b32 v36, 7, v36
    v_mov_b32 v37, s29
    v_add_co_u32 v36, vcc, s28, v36
    s_nop 1
    v_addc_co_u32 v37, vcc, 0, v37, vcc
    s_mov_b64 exec, 3
    global_load_dword v34, v[36:37], off
    s_mov_b64 exec, -1
    s_branch L_sigback
L_sig0:
    s_cmp_lg_u32 s16, 0
    s_cbranch_scc1 L_sigback
    v_mov_b32 v36, 1
    s_mov_b64 exec, 1
    buffer_atomic_add v36, off, s[36:39], s27 offset:64 sc1
    s_mov_b64 exec, -1
    s_branch L_sigback
L_spinD:
    s_mov_b32 s28, 0
    s_lshl_b32 s27, s20, 2
L_spinD1:
    s_sleep 4
    buffer_load_dword v5, off, s[36:39], s27 offset:64 sc1
    s_add_u32 s28, s28, 1
    s_waitcnt vmcnt(0)
    v_readfirstlane_b32 s29, v5
    s_cmp_gt_u32 s28, 0x8000
    s_cbranch_scc1 L_okD
    s_cmp_ge_u32 s29, 8
    s_cbranch_scc0 L_spinD1
    s_branch L_okD
L_rare1:
    s_lshl_b32 s27, s26, 1
    s_add_u32 s27, s27, 1
    s_lshl_b32 s27, s27, 14
    s_add_u32 s28, s27, 8192
    v_and_b32 v6, 15, v0
    v_lshlrev_b32 v6, 9, v6
    v_lshrrev_b32 v7, 4, v0
    v_lshl_add_u32 v6, v7, 4, v6
    buffer_load_dwordx4 v[36:39], v6, s[4:7], s27 offen offset:0
    buffer_load_dwordx4 v[40:43], v6, s[4:7], s28 offen offset:0
    s_waitcnt vmcnt(0)
    v_mfma_f32_16x16x32_bf16 v[96:99], v[36:39], a[0:3], v[48:51]
    v_mfma_f32_16x16x32_bf16 v[104:107], v[36:39], a[32:35], v[52:55]
    v_mfma_f32_16x16x32_bf16 v[112:115], v[36:39], a[64:67], v[56:59]
    v_mfma_f32_16x16x32_bf16 v[120:123], v[36:39], a[96:99], v[60:63]
    v_mfma_f32_16x16x32_bf16 v[100:103], v[40:43], a[0:3], v[48:51]
    v_mfma_f32_16x16x32_bf16 v[108:111], v[40:43], a[32:35], v[52:55]
    v_mfma_f32_16x16x32_bf16 v[116:119], v[40:43], a[64:67], v[56:59]
    v_mfma_f32_16x16x32_bf16 v[124:127], v[40:43], a[96:99], v[60:63]
    buffer_load_dwordx4 v[36:39], v6, s[4:7], s27 offen offset:64
    buffer_load_dwordx4 v[40:43], v6, s[4:7], s28 offen offset:64
    s_waitcnt vmcnt(0)
    v_mfma_f32_16x16x32_bf16 v[96:99], v[36:39], a[4:7], v[96:99]
    v_mfma_f32_16x16x32_bf16 v[104:107], v[36:39], a[36:39], v[104:107]
    v_mfma_f32_16x16x32_bf16 v[112:115], v[36:39], a[68:71], v[112:115]
    v_mfma_f32_16x16x32_bf16 v[120:123], v[36:39], a[100:103], v[120:123]
    v_mfma_f32_16x16x32_bf16 v[100:103], v[40:43], a[4:7], v[100:103]
    v_mfma_f32_16x16x32_bf16 v[108:111], v[40:43], a[36:39], v[108:111]
    v_mfma_f32_16x16x32_bf16 v[116:119], v[40:43], a[68:71], v[116:119]
    v_mfma_f32_16x16x32_bf16 v[124:127], v[40:43], a[100:103], v[124:127]
    buffer_load_dwordx4 v[36:39], v6, s[4:7], s27 offen offset:128
    buffer_load_dwordx4 v[40:43], v6, s[4:7], s28 offen offset:128
    s_waitcnt vmcnt(0)
    v_mfma_f32_16x16x32_bf16 v[96:99], v[36:39], a[8:11], v[96:99]
    v_mfma_f32_16x16x32_bf16 v[104:107], v[36:39], a[40:43], v[104:107]
    v_mfma_f32_16x16x32_bf16 v[112:115], v[36:39], a[72:75], v[112:115]
    v_mfma_f32_16x16x32_bf16 v[120:123], v[36:39], a[104:107], v[120:123]
    v_mfma_f32_16x16x32_bf16 v[100:103], v[40:43], a[8:11], v[100:103]
    v_mfma_f32_16x16x32_bf16 v[108:111], v[40:43], a[40:43], v[108:111]
    v_mfma_f32_16x16x32_bf16 v[116:119], v[40:43], a[72:75], v[116:119]
    v_mfma_f32_16x16x32_bf16 v[124:127], v[40:43], a[104:107], v[124:127]
    buffer_load_dwordx4 v[36:39], v6, s[4:7], s27 offen offset:192
    buffer_load_dwordx4 v[40:43], v6, s[4:7], s28 offen offset:192
    s_waitcnt vmcnt(0)
    v_mfma_f32_16x16x32_bf16 v[96:99], v[36:39], a[12:15], v[96:99]
    v_mfma_f32_16x16x32_bf16 v[104:107], v[36:39], a[44:47], v[104:107]
    v_mfma_f32_16x16x32_bf16 v[112:115], v[36:39], a[76:79], v[112:115]
    v_mfma_f32_16x16x32_bf16 v[120:123], v[36:39], a[108:111], v[120:123]
    v_mfma_f32_16x16x32_bf16 v[100:103], v[40:43], a[12:15], v[100:103]
    v_mfma_f32_16x16x32_bf16 v[108:111], v[40:43], a[44:47], v[108:111]
    v_mfma_f32_16x16x32_bf16 v[116:119], v[40:43], a[76:79], v[116:119]
    v_mfma_f32_16x16x32_bf16 v[124:127], v[40:43], a[108:111], v[124:127]
    buffer_load_dwordx4 v[36:39], v6, s[4:7], s27 offen offset:256
    buffer_load_dwordx4 v[40:43], v6, s[4:7], s28 offen offset:256
    s_waitcnt vmcnt(0)
    v_mfma_f32_16x16x32_bf16 v[96:99], v[36:39], a[16:19], v[96:99]
    v_mfma_f32_16x16x32_bf16 v[104:107], v[36:39], a[48:51], v[104:107]
    v_mfma_f32_16x16x32_bf16 v[112:115], v[36:39], a[80:83], v[112:115]
    v_mfma_f32_16x16x32_bf16 v[120:123], v[36:39], a[112:115], v[120:123]
    v_mfma_f32_16x16x32_bf16 v[100:103], v[40:43], a[16:19], v[100:103]
    v_mfma_f32_16x16x32_bf16 v[108:111], v[40:43], a[48:51], v[108:111]
    v_mfma_f32_16x16x32_bf16 v[116:119], v[40:43], a[80:83], v[116:119]
    v_mfma_f32_16x16x32_bf16 v[124:127], v[40:43], a[112:115], v[124:127]
    buffer_load_dwordx4 v[36:39], v6, s[4:7], s27 offen offset:320
    buffer_load_dwordx4 v[40:43], v6, s[4:7], s28 offen offset:320
    s_waitcnt vmcnt(0)
    v_mfma_f32_16x16x32_bf16 v[96:99], v[36:39], a[20:23], v[96:99]
    v_mfma_f32_16x16x32_bf16 v[104:107], v[36:39], a[52:55], v[104:107]
    v_mfma_f32_16x16x32_bf16 v[112:115], v[36:39], a[84:87], v[112:115]
    v_mfma_f32_16x16x32_bf16 v[120:123], v[36:39], a[116:119], v[120:123]
    v_mfma_f32_16x16x32_bf16 v[100:103], v[40:43], a[20:23], v[100:103]
    v_mfma_f32_16x16x32_bf16 v[108:111], v[40:43], a[52:55], v[108:111]
    v_mfma_f32_16x16x32_bf16 v[116:119], v[40:43], a[84:87], v[116:119]
    v_mfma_f32_16x16x32_bf16 v[124:127], v[40:43], a[116:119], v[124:127]
    buffer_load_dwordx4 v[36:39], v6, s[4:7], s27 offen offset:384
    buffer_load_dwordx4 v[40:43], v6, s[4:7], s28 offen offset:384
    s_waitcnt vmcnt(0)
    v_mfma_f32_16x16x32_bf16 v[96:99], v[36:39], a[24:27], v[96:99]
    v_mfma_f32_16x16x32_bf16 v[104:107], v[36:39], a[56:59], v[104:107]
    v_mfma_f32_16x16x32_bf16 v[112:115], v[36:39], a[88:91], v[112:115]
    v_mfma_f32_16x16x32_bf16 v[120:123], v[36:39], a[120:123], v[120:123]
    v_mfma_f32_16x16x32_bf16 v[100:103], v[40:43], a[24:27], v[100:103]
    v_mfma_f32_16x16x32_bf16 v[108:111], v[40:43], a[56:59], v[108:111]
    v_mfma_f32_16x16x32_bf16 v[116:119], v[40:43], a[88:91], v[116:119]
    v_mfma_f32_16x16x32_bf16 v[124:127], v[40:43], a[120:123], v[124:127]
    buffer_load_dwordx4 v[36:39], v6, s[4:7], s27 offen offset:448
    buffer_load_dwordx4 v[40:43], v6, s[4:7], s28 offen offset:448
    s_waitcnt vmcnt(0)
    v_mfma_f32_16x16x32_bf16 v[96:99], v[36:39], a[28:31], v[96:99]
    v_mfma_f32_16x16x32_bf16 v[104:107], v[36:39], a[60:63], v[104:107]
    v_mfma_f32_16x16x32_bf16 v[112:115], v[36:39], a[92:95], v[112:115]
    v_mfma_f32_16x16x32_bf16 v[120:123], v[36:39], a[124:127], v[120:123]
    v_mfma_f32_16x16x32_bf16 v[100:103], v[40:43], a[28:31], v[100:103]
    v_mfma_f32_16x16x32_bf16 v[108:111], v[40:43], a[60:63], v[108:111]
    v_mfma_f32_16x16x32_bf16 v[116:119], v[40:43], a[92:95], v[116:119]
    v_mfma_f32_16x16x32_bf16 v[124:127], v[40:43], a[124:127], v[124:127]
    s_nop 7
    v_frexp_exp_i32_f32 v7, v12
    v_cvt_f32_i32 v7, v7
    v_max3_f32 v6, v96, v97, v98
    v_max3_f32 v6, v6, v99, v100
    v_max3_f32 v6, v6, v101, v102
    v_max3_f32 v6, v6, v103, v7
    v_mov_b32 v7, v6
    s_nop 1
    v_permlane16_swap_b32 v7, v6
    s_nop 1
    v_max_f32 v6, v6, v7
    v_mov_b32 v7, v6
    s_nop 1
    v_permlane32_swap_b32 v7, v6
    s_nop 1
    v_max_f32 v6, v6, v7
    v_max_f32 v6, 0, v6
    v_ceil_f32 v6, v6
    v_cvt_i32_f32 v7, -v6
    v_ldexp_f32 v7, 1.0, v7
    v_sub_f32 v48, v48, v6
    v_sub_f32 v49, v49, v6
    v_sub_f32 v50, v50, v6
    v_sub_f32 v51, v51, v6
    v_sub_f32 v96, v96, v6
    v_sub_f32 v64, v64, v6
    v_sub_f32 v97, v97, v6
    v_sub_f32 v65, v65, v6
    v_sub_f32 v98, v98, v6
    v_sub_f32 v66, v66, v6
    v_sub_f32 v99, v99, v6
    v_sub_f32 v67, v67, v6
    v_sub_f32 v100, v100, v6
    v_sub_f32 v68, v68, v6
    v_sub_f32 v101, v101, v6
    v_sub_f32 v69, v69, v6
    v_sub_f32 v102, v102, v6
    v_sub_f32 v70, v70, v6
    v_sub_f32 v103, v103, v6
    v_sub_f32 v71, v71, v6
    v_mul_f32 v44, v12, v7
    v_exp_f32 v96, v96
    v_exp_f32 v97, v97
    v_exp_f32 v98, v98
    v_exp_f32 v99, v99
    v_exp_f32 v100, v100
    v_exp_f32 v101, v101
    v_exp_f32 v102, v102
    v_exp_f32 v103, v103
    s_nop 0
    v_add_f32 v44, v44, v96
    v_add_f32 v44, v44, v97
    v_add_f32 v44, v44, v98
    v_add_f32 v44, v44, v99
    v_add_f32 v44, v44, v100
    v_add_f32 v44, v44, v101
    v_add_f32 v44, v44, v102
    v_add_f32 v44, v44, v103
    v_cvt_pk_bf16_f32 v96, v96, v97
    v_cvt_pk_bf16_f32 v97, v98, v99
    v_cvt_pk_bf16_f32 v98, v100, v101
    v_cvt_pk_bf16_f32 v99, v102, v103
    v_mul_f32 v128, v128, v7
    v_mul_f32 v129, v129, v7
    v_mul_f32 v130, v130, v7
    v_mul_f32 v131, v131, v7
    v_mul_f32 v132, v132, v7
    v_mul_f32 v133, v133, v7
    v_mul_f32 v134, v134, v7
    v_mul_f32 v135, v135, v7
    v_mul_f32 v136, v136, v7
    v_mul_f32 v137, v137, v7
    v_mul_f32 v138, v138, v7
    v_mul_f32 v139, v139, v7
    v_mul_f32 v140, v140, v7
    v_mul_f32 v141, v141, v7
    v_mul_f32 v142, v142, v7
    v_mul_f32 v143, v143, v7
    v_mul_f32 v144, v144, v7
    v_mul_f32 v145, v145, v7
    v_mul_f32 v146, v146, v7
    v_mul_f32 v147, v147, v7
    v_mul_f32 v148, v148, v7
    v_mul_f32 v149, v149, v7
    v_mul_f32 v150, v150, v7
    v_mul_f32 v151, v151, v7
    v_mul_f32 v152, v152, v7
    v_mul_f32 v153, v153, v7
    v_mul_f32 v154, v154, v7
    v_mul_f32 v155, v155, v7
    v_mul_f32 v156, v156, v7
    v_mul_f32 v157, v157, v7
    v_mul_f32 v158, v158, v7
    v_mul_f32 v159, v159, v7
    v_accvgpr_read_b32 v8, a128
    v_accvgpr_read_b32 v9, a129
    v_accvgpr_read_b32 v10, a130
    v_accvgpr_read_b32 v11, a131
    v_mul_f32 v8, v8, v7
    v_mul_f32 v9, v9, v7
    v_mul_f32 v10, v10, v7
    v_mul_f32 v11, v11, v7
    v_accvgpr_write_b32 a128, v8
    v_accvgpr_write_b32 a129, v9
    v_accvgpr_write_b32 a130, v10
    v_accvgpr_write_b32 a131, v11
    v_accvgpr_read_b32 v8, a132
    v_accvgpr_read_b32 v9, a133
    v_accvgpr_read_b32 v10, a134
    v_accvgpr_read_b32 v11, a135
    v_mul_f32 v8, v8, v7
    v_mul_f32 v9, v9, v7
    v_mul_f32 v10, v10, v7
    v_mul_f32 v11, v11, v7
    v_accvgpr_write_b32 a132, v8
    v_accvgpr_write_b32 a133, v9
    v_accvgpr_write_b32 a134, v10
    v_accvgpr_write_b32 a135, v11
    v_accvgpr_read_b32 v8, a136
    v_accvgpr_read_b32 v9, a137
    v_accvgpr_read_b32 v10, a138
    v_accvgpr_read_b32 v11, a139
    v_mul_f32 v8, v8, v7
    v_mul_f32 v9, v9, v7
    v_mul_f32 v10, v10, v7
    v_mul_f32 v11, v11, v7
    v_accvgpr_write_b32 a136, v8
    v_accvgpr_write_b32 a137, v9
    v_accvgpr_write_b32 a138, v10
    v_accvgpr_write_b32 a139, v11
    v_accvgpr_read_b32 v8, a140
    v_accvgpr_read_b32 v9, a141
    v_accvgpr_read_b32 v10, a142
    v_accvgpr_read_b32 v11, a143
    v_mul_f32 v8, v8, v7
    v_mul_f32 v9, v9, v7
    v_mul_f32 v10, v10, v7
    v_mul_f32 v11, v11, v7
    v_accvgpr_write_b32 a140, v8
    v_accvgpr_write_b32 a141, v9
    v_accvgpr_write_b32 a142, v10
    v_accvgpr_write_b32 a143, v11
    v_accvgpr_read_b32 v8, a144
    v_accvgpr_read_b32 v9, a145
    v_accvgpr_read_b32 v10, a146
    v_accvgpr_read_b32 v11, a147
    v_mul_f32 v8, v8, v7
    v_mul_f32 v9, v9, v7
    v_mul_f32 v10, v10, v7
    v_mul_f32 v11, v11, v7
    v_accvgpr_write_b32 a144, v8
    v_accvgpr_write_b32 a145, v9
    v_accvgpr_write_b32 a146, v10
    v_accvgpr_write_b32 a147, v11
    v_accvgpr_read_b32 v8, a148
    v_accvgpr_read_b32 v9, a149
    v_accvgpr_read_b32 v10, a150
    v_accvgpr_read_b32 v11, a151
    v_mul_f32 v8, v8, v7
    v_mul_f32 v9, v9, v7
    v_mul_f32 v10, v10, v7
    v_mul_f32 v11, v11, v7
    v_accvgpr_write_b32 a148, v8
    v_accvgpr_write_b32 a149, v9
    v_accvgpr_write_b32 a150, v10
    v_accvgpr_write_b32 a151, v11
    v_accvgpr_read_b32 v8, a152
    v_accvgpr_read_b32 v9, a153
    v_accvgpr_read_b32 v10, a154
    v_accvgpr_read_b32 v11, a155
    v_mul_f32 v8, v8, v7
    v_mul_f32 v9, v9, v7
    v_mul_f32 v10, v10, v7
    v_mul_f32 v11, v11, v7
    v_accvgpr_write_b32 a152, v8
    v_accvgpr_write_b32 a153, v9
    v_accvgpr_write_b32 a154, v10
    v_accvgpr_write_b32 a155, v11
    v_accvgpr_read_b32 v8, a156
    v_accvgpr_read_b32 v9, a157
    v_accvgpr_read_b32 v10, a158
    v_accvgpr_read_b32 v11, a159
    v_mul_f32 v8, v8, v7
    v_mul_f32 v9, v9, v7
    v_mul_f32 v10, v10, v7
    v_mul_f32 v11, v11, v7
    v_accvgpr_write_b32 a156, v8
    v_accvgpr_write_b32 a157, v9
    v_accvgpr_write_b32 a158, v10
    v_accvgpr_write_b32 a159, v11
    v_frexp_exp_i32_f32 v7, v13
    v_cvt_f32_i32 v7, v7
    v_max3_f32 v6, v104, v105, v106
    v_max3_f32 v6, v6, v107, v108
    v_max3_f32 v6, v6, v109, v110
    v_max3_f32 v6, v6, v111, v7
    v_mov_b32 v7, v6
    s_nop 1
    v_permlane16_swap_b32 v7, v6
    s_nop 1
    v_max_f32 v6, v6, v7
    v_mov_b32 v7, v6
    s_nop 1
    v_permlane32_swap_b32 v7, v6
    s_nop 1
    v_max_f32 v6, v6, v7
    v_max_f32 v6, 0, v6
    v_ceil_f32 v6, v6
    v_cvt_i32_f32 v7, -v6
    v_ldexp_f32 v7, 1.0, v7
    v_sub_f32 v52, v52, v6
    v_sub_f32 v53, v53, v6
    v_sub_f32 v54, v54, v6
    v_sub_f32 v55, v55, v6
    v_sub_f32 v104, v104, v6
    v_sub_f32 v72, v72, v6
    v_sub_f32 v105, v105, v6
    v_sub_f32 v73, v73, v6
    v_sub_f32 v106, v106, v6
    v_sub_f32 v74, v74, v6
    v_sub_f32 v107, v107, v6
    v_sub_f32 v75, v75, v6
    v_sub_f32 v108, v108, v6
    v_sub_f32 v76, v76, v6
    v_sub_f32 v109, v109, v6
    v_sub_f32 v77, v77, v6
    v_sub_f32 v110, v110, v6
    v_sub_f32 v78, v78, v6
    v_sub_f32 v111, v111, v6
    v_sub_f32 v79, v79, v6
    v_mul_f32 v45, v13, v7
    v_exp_f32 v104, v104
    v_exp_f32 v105, v105
    v_exp_f32 v106, v106
    v_exp_f32 v107, v107
    v_exp_f32 v108, v108
    v_exp_f32 v109, v109
    v_exp_f32 v110, v110
    v_exp_f32 v111, v111
    s_nop 0
    v_add_f32 v45, v45, v104
    v_add_f32 v45, v45, v105
    v_add_f32 v45, v45, v106
    v_add_f32 v45, v45, v107
    v_add_f32 v45, v45, v108
    v_add_f32 v45, v45, v109
    v_add_f32 v45, v45, v110
    v_add_f32 v45, v45, v111
    v_cvt_pk_bf16_f32 v104, v104, v105
    v_cvt_pk_bf16_f32 v105, v106, v107
    v_cvt_pk_bf16_f32 v106, v108, v109
    v_cvt_pk_bf16_f32 v107, v110, v111
    v_mul_f32 v160, v160, v7
    v_mul_f32 v161, v161, v7
    v_mul_f32 v162, v162, v7
    v_mul_f32 v163, v163, v7
    v_mul_f32 v164, v164, v7
    v_mul_f32 v165, v165, v7
    v_mul_f32 v166, v166, v7
    v_mul_f32 v167, v167, v7
    v_mul_f32 v168, v168, v7
    v_mul_f32 v169, v169, v7
    v_mul_f32 v170, v170, v7
    v_mul_f32 v171, v171, v7
    v_mul_f32 v172, v172, v7
    v_mul_f32 v173, v173, v7
    v_mul_f32 v174, v174, v7
    v_mul_f32 v175, v175, v7
    v_mul_f32 v176, v176, v7
    v_mul_f32 v177, v177, v7
    v_mul_f32 v178, v178, v7
    v_mul_f32 v179, v179, v7
    v_mul_f32 v180, v180, v7
    v_mul_f32 v181, v181, v7
    v_mul_f32 v182, v182, v7
    v_mul_f32 v183, v183, v7
    v_mul_f32 v184, v184, v7
    v_mul_f32 v185, v185, v7
    v_mul_f32 v186, v186, v7
    v_mul_f32 v187, v187, v7
    v_mul_f32 v188, v188, v7
    v_mul_f32 v189, v189, v7
    v_mul_f32 v190, v190, v7
    v_mul_f32 v191, v191, v7
    v_accvgpr_read_b32 v8, a160
    v_accvgpr_read_b32 v9, a161
    v_accvgpr_read_b32 v10, a162
    v_accvgpr_read_b32 v11, a163
    v_mul_f32 v8, v8, v7
    v_mul_f32 v9, v9, v7
    v_mul_f32 v10, v10, v7
    v_mul_f32 v11, v11, v7
    v_accvgpr_write_b32 a160, v8
    v_accvgpr_write_b32 a161, v9
    v_accvgpr_write_b32 a162, v10
    v_accvgpr_write_b32 a163, v11
    v_accvgpr_read_b32 v8, a164
    v_accvgpr_read_b32 v9, a165
    v_accvgpr_read_b32 v10, a166
    v_accvgpr_read_b32 v11, a167
    v_mul_f32 v8, v8, v7
    v_mul_f32 v9, v9, v7
    v_mul_f32 v10, v10, v7
    v_mul_f32 v11, v11, v7
    v_accvgpr_write_b32 a164, v8
    v_accvgpr_write_b32 a165, v9
    v_accvgpr_write_b32 a166, v10
    v_accvgpr_write_b32 a167, v11
    v_accvgpr_read_b32 v8, a168
    v_accvgpr_read_b32 v9, a169
    v_accvgpr_read_b32 v10, a170
    v_accvgpr_read_b32 v11, a171
    v_mul_f32 v8, v8, v7
    v_mul_f32 v9, v9, v7
    v_mul_f32 v10, v10, v7
    v_mul_f32 v11, v11, v7
    v_accvgpr_write_b32 a168, v8
    v_accvgpr_write_b32 a169, v9
    v_accvgpr_write_b32 a170, v10
    v_accvgpr_write_b32 a171, v11
    v_accvgpr_read_b32 v8, a172
    v_accvgpr_read_b32 v9, a173
    v_accvgpr_read_b32 v10, a174
    v_accvgpr_read_b32 v11, a175
    v_mul_f32 v8, v8, v7
    v_mul_f32 v9, v9, v7
    v_mul_f32 v10, v10, v7
    v_mul_f32 v11, v11, v7
    v_accvgpr_write_b32 a172, v8
    v_accvgpr_write_b32 a173, v9
    v_accvgpr_write_b32 a174, v10
    v_accvgpr_write_b32 a175, v11
    v_accvgpr_read_b32 v8, a176
    v_accvgpr_read_b32 v9, a177
    v_accvgpr_read_b32 v10, a178
    v_accvgpr_read_b32 v11, a179
    v_mul_f32 v8, v8, v7
    v_mul_f32 v9, v9, v7
    v_mul_f32 v10, v10, v7
    v_mul_f32 v11, v11, v7
    v_accvgpr_write_b32 a176, v8
    v_accvgpr_write_b32 a177, v9
    v_accvgpr_write_b32 a178, v10
    v_accvgpr_write_b32 a179, v11
    v_accvgpr_read_b32 v8, a180
    v_accvgpr_read_b32 v9, a181
    v_accvgpr_read_b32 v10, a182
    v_accvgpr_read_b32 v11, a183
    v_mul_f32 v8, v8, v7
    v_mul_f32 v9, v9, v7
    v_mul_f32 v10, v10, v7
    v_mul_f32 v11, v11, v7
    v_accvgpr_write_b32 a180, v8
    v_accvgpr_write_b32 a181, v9
    v_accvgpr_write_b32 a182, v10
    v_accvgpr_write_b32 a183, v11
    v_accvgpr_read_b32 v8, a184
    v_accvgpr_read_b32 v9, a185
    v_accvgpr_read_b32 v10, a186
    v_accvgpr_read_b32 v11, a187
    v_mul_f32 v8, v8, v7
    v_mul_f32 v9, v9, v7
    v_mul_f32 v10, v10, v7
    v_mul_f32 v11, v11, v7
    v_accvgpr_write_b32 a184, v8
    v_accvgpr_write_b32 a185, v9
    v_accvgpr_write_b32 a186, v10
    v_accvgpr_write_b32 a187, v11
    v_accvgpr_read_b32 v8, a188
    v_accvgpr_read_b32 v9, a189
    v_accvgpr_read_b32 v10, a190
    v_accvgpr_read_b32 v11, a191
    v_mul_f32 v8, v8, v7
    v_mul_f32 v9, v9, v7
    v_mul_f32 v10, v10, v7
    v_mul_f32 v11, v11, v7
    v_accvgpr_write_b32 a188, v8
    v_accvgpr_write_b32 a189, v9
    v_accvgpr_write_b32 a190, v10
    v_accvgpr_write_b32 a191, v11
    v_frexp_exp_i32_f32 v7, v14
    v_cvt_f32_i32 v7, v7
    v_max3_f32 v6, v112, v113, v114
    v_max3_f32 v6, v6, v115, v116
    v_max3_f32 v6, v6, v117, v118
    v_max3_f32 v6, v6, v119, v7
    v_mov_b32 v7, v6
    s_nop 1
    v_permlane16_swap_b32 v7, v6
    s_nop 1
    v_max_f32 v6, v6, v7
    v_mov_b32 v7, v6
    s_nop 1
    v_permlane32_swap_b32 v7, v6
    s_nop 1
    v_max_f32 v6, v6, v7
    v_max_f32 v6, 0, v6
    v_ceil_f32 v6, v6
    v_cvt_i32_f32 v7, -v6
    v_ldexp_f32 v7, 1.0, v7
    v_sub_f32 v56, v56, v6
    v_sub_f32 v57, v57, v6
    v_sub_f32 v58, v58, v6
    v_sub_f32 v59, v59, v6
    v_sub_f32 v112, v112, v6
    v_sub_f32 v80, v80, v6
    v_sub_f32 v113, v113, v6
    v_sub_f32 v81, v81, v6
    v_sub_f32 v114, v114, v6
    v_sub_f32 v82, v82, v6
    v_sub_f32 v115, v115, v6
    v_sub_f32 v83, v83, v6
    v_sub_f32 v116, v116, v6
    v_sub_f32 v84, v84, v6
    v_sub_f32 v117, v117, v6
    v_sub_f32 v85, v85, v6
    v_sub_f32 v118, v118, v6
    v_sub_f32 v86, v86, v6
    v_sub_f32 v119, v119, v6
    v_sub_f32 v87, v87, v6
    v_mul_f32 v46, v14, v7
    v_exp_f32 v112, v112
    v_exp_f32 v113, v113
    v_exp_f32 v114, v114
    v_exp_f32 v115, v115
    v_exp_f32 v116, v116
    v_exp_f32 v117, v117
    v_exp_f32 v118, v118
    v_exp_f32 v119, v119
    s_nop 0
    v_add_f32 v46, v46, v112
    v_add_f32 v46, v46, v113
    v_add_f32 v46, v46, v114
    v_add_f32 v46, v46, v115
    v_add_f32 v46, v46, v116
    v_add_f32 v46, v46, v117
    v_add_f32 v46, v46, v118
    v_add_f32 v46, v46, v119
    v_cvt_pk_bf16_f32 v112, v112, v113
    v_cvt_pk_bf16_f32 v113, v114, v115
    v_cvt_pk_bf16_f32 v114, v116, v117
    v_cvt_pk_bf16_f32 v115, v118, v119
    v_mul_f32 v192, v192, v7
    v_mul_f32 v193, v193, v7
    v_mul_f32 v194, v194, v7
    v_mul_f32 v195, v195, v7
    v_mul_f32 v196, v196, v7
    v_mul_f32 v197, v197, v7
    v_mul_f32 v198, v198, v7
    v_mul_f32 v199, v199, v7
    v_mul_f32 v200, v200, v7
    v_mul_f32 v201, v201, v7
    v_mul_f32 v202, v202, v7
    v_mul_f32 v203, v203, v7
    v_mul_f32 v204, v204, v7
    v_mul_f32 v205, v205, v7
    v_mul_f32 v206, v206, v7
    v_mul_f32 v207, v207, v7
    v_mul_f32 v208, v208, v7
    v_mul_f32 v209, v209, v7
    v_mul_f32 v210, v210, v7
    v_mul_f32 v211, v211, v7
    v_mul_f32 v212, v212, v7
    v_mul_f32 v213, v213, v7
    v_mul_f32 v214, v214, v7
    v_mul_f32 v215, v215, v7
    v_mul_f32 v216, v216, v7
    v_mul_f32 v217, v217, v7
    v_mul_f32 v218, v218, v7
    v_mul_f32 v219, v219, v7
    v_mul_f32 v220, v220, v7
    v_mul_f32 v221, v221, v7
    v_mul_f32 v222, v222, v7
    v_mul_f32 v223, v223, v7
    v_accvgpr_read_b32 v8, a192
    v_accvgpr_read_b32 v9, a193
    v_accvgpr_read_b32 v10, a194
    v_accvgpr_read_b32 v11, a195
    v_mul_f32 v8, v8, v7
    v_mul_f32 v9, v9, v7
    v_mul_f32 v10, v10, v7
    v_mul_f32 v11, v11, v7
    v_accvgpr_write_b32 a192, v8
    v_accvgpr_write_b32 a193, v9
    v_accvgpr_write_b32 a194, v10
    v_accvgpr_write_b32 a195, v11
    v_accvgpr_read_b32 v8, a196
    v_accvgpr_read_b32 v9, a197
    v_accvgpr_read_b32 v10, a198
    v_accvgpr_read_b32 v11, a199
    v_mul_f32 v8, v8, v7
    v_mul_f32 v9, v9, v7
    v_mul_f32 v10, v10, v7
    v_mul_f32 v11, v11, v7
    v_accvgpr_write_b32 a196, v8
    v_accvgpr_write_b32 a197, v9
    v_accvgpr_write_b32 a198, v10
    v_accvgpr_write_b32 a199, v11
    v_accvgpr_read_b32 v8, a200
    v_accvgpr_read_b32 v9, a201
    v_accvgpr_read_b32 v10, a202
    v_accvgpr_read_b32 v11, a203
    v_mul_f32 v8, v8, v7
    v_mul_f32 v9, v9, v7
    v_mul_f32 v10, v10, v7
    v_mul_f32 v11, v11, v7
    v_accvgpr_write_b32 a200, v8
    v_accvgpr_write_b32 a201, v9
    v_accvgpr_write_b32 a202, v10
    v_accvgpr_write_b32 a203, v11
    v_accvgpr_read_b32 v8, a204
    v_accvgpr_read_b32 v9, a205
    v_accvgpr_read_b32 v10, a206
    v_accvgpr_read_b32 v11, a207
    v_mul_f32 v8, v8, v7
    v_mul_f32 v9, v9, v7
    v_mul_f32 v10, v10, v7
    v_mul_f32 v11, v11, v7
    v_accvgpr_write_b32 a204, v8
    v_accvgpr_write_b32 a205, v9
    v_accvgpr_write_b32 a206, v10
    v_accvgpr_write_b32 a207, v11
    v_accvgpr_read_b32 v8, a208
    v_accvgpr_read_b32 v9, a209
    v_accvgpr_read_b32 v10, a210
    v_accvgpr_read_b32 v11, a211
    v_mul_f32 v8, v8, v7
    v_mul_f32 v9, v9, v7
    v_mul_f32 v10, v10, v7
    v_mul_f32 v11, v11, v7
    v_accvgpr_write_b32 a208, v8
    v_accvgpr_write_b32 a209, v9
    v_accvgpr_write_b32 a210, v10
    v_accvgpr_write_b32 a211, v11
    v_accvgpr_read_b32 v8, a212
    v_accvgpr_read_b32 v9, a213
    v_accvgpr_read_b32 v10, a214
    v_accvgpr_read_b32 v11, a215
    v_mul_f32 v8, v8, v7
    v_mul_f32 v9, v9, v7
    v_mul_f32 v10, v10, v7
    v_mul_f32 v11, v11, v7
    v_accvgpr_write_b32 a212, v8
    v_accvgpr_write_b32 a213, v9
    v_accvgpr_write_b32 a214, v10
    v_accvgpr_write_b32 a215, v11
    v_accvgpr_read_b32 v8, a216
    v_accvgpr_read_b32 v9, a217
    v_accvgpr_read_b32 v10, a218
    v_accvgpr_read_b32 v11, a219
    v_mul_f32 v8, v8, v7
    v_mul_f32 v9, v9, v7
    v_mul_f32 v10, v10, v7
    v_mul_f32 v11, v11, v7
    v_accvgpr_write_b32 a216, v8
    v_accvgpr_write_b32 a217, v9
    v_accvgpr_write_b32 a218, v10
    v_accvgpr_write_b32 a219, v11
    v_accvgpr_read_b32 v8, a220
    v_accvgpr_read_b32 v9, a221
    v_accvgpr_read_b32 v10, a222
    v_accvgpr_read_b32 v11, a223
    v_mul_f32 v8, v8, v7
    v_mul_f32 v9, v9, v7
    v_mul_f32 v10, v10, v7
    v_mul_f32 v11, v11, v7
    v_accvgpr_write_b32 a220, v8
    v_accvgpr_write_b32 a221, v9
    v_accvgpr_write_b32 a222, v10
    v_accvgpr_write_b32 a223, v11
    v_frexp_exp_i32_f32 v7, v15
    v_cvt_f32_i32 v7, v7
    v_max3_f32 v6, v120, v121, v122
    v_max3_f32 v6, v6, v123, v124
    v_max3_f32 v6, v6, v125, v126
    v_max3_f32 v6, v6, v127, v7
    v_mov_b32 v7, v6
    s_nop 1
    v_permlane16_swap_b32 v7, v6
    s_nop 1
    v_max_f32 v6, v6, v7
    v_mov_b32 v7, v6
    s_nop 1
    v_permlane32_swap_b32 v7, v6
    s_nop 1
    v_max_f32 v6, v6, v7
    v_max_f32 v6, 0, v6
    v_ceil_f32 v6, v6
    v_cvt_i32_f32 v7, -v6
    v_ldexp_f32 v7, 1.0, v7
    v_sub_f32 v60, v60, v6
    v_sub_f32 v61, v61, v6
    v_sub_f32 v62, v62, v6
    v_sub_f32 v63, v63, v6
    v_sub_f32 v120, v120, v6
    v_sub_f32 v88, v88, v6
    v_sub_f32 v121, v121, v6
    v_sub_f32 v89, v89, v6
    v_sub_f32 v122, v122, v6
    v_sub_f32 v90, v90, v6
    v_sub_f32 v123, v123, v6
    v_sub_f32 v91, v91, v6
    v_sub_f32 v124, v124, v6
    v_sub_f32 v92, v92, v6
    v_sub_f32 v125, v125, v6
    v_sub_f32 v93, v93, v6
    v_sub_f32 v126, v126, v6
    v_sub_f32 v94, v94, v6
    v_sub_f32 v127, v127, v6
    v_sub_f32 v95, v95, v6
    v_mul_f32 v47, v15, v7
    v_exp_f32 v120, v120
    v_exp_f32 v121, v121
    v_exp_f32 v122, v122
    v_exp_f32 v123, v123
    v_exp_f32 v124, v124
    v_exp_f32 v125, v125
    v_exp_f32 v126, v126
    v_exp_f32 v127, v127
    s_nop 0
    v_add_f32 v47, v47, v120
    v_add_f32 v47, v47, v121
    v_add_f32 v47, v47, v122
    v_add_f32 v47, v47, v123
    v_add_f32 v47, v47, v124
    v_add_f32 v47, v47, v125
    v_add_f32 v47, v47, v126
    v_add_f32 v47, v47, v127
    v_cvt_pk_bf16_f32 v120, v120, v121
    v_cvt_pk_bf16_f32 v121, v122, v123
    v_cvt_pk_bf16_f32 v122, v124, v125
    v_cvt_pk_bf16_f32 v123, v126, v127
    v_mul_f32 v224, v224, v7
    v_mul_f32 v225, v225, v7
    v_mul_f32 v226, v226, v7
    v_mul_f32 v227, v227, v7
    v_mul_f32 v228, v228, v7
    v_mul_f32 v229, v229, v7
    v_mul_f32 v230, v230, v7
    v_mul_f32 v231, v231, v7
    v_mul_f32 v232, v232, v7
    v_mul_f32 v233, v233, v7
    v_mul_f32 v234, v234, v7
    v_mul_f32 v235, v235, v7
    v_mul_f32 v236, v236, v7
    v_mul_f32 v237, v237, v7
    v_mul_f32 v238, v238, v7
    v_mul_f32 v239, v239, v7
    v_mul_f32 v240, v240, v7
    v_mul_f32 v241, v241, v7
    v_mul_f32 v242, v242, v7
    v_mul_f32 v243, v243, v7
    v_mul_f32 v244, v244, v7
    v_mul_f32 v245, v245, v7
    v_mul_f32 v246, v246, v7
    v_mul_f32 v247, v247, v7
    v_mul_f32 v248, v248, v7
    v_mul_f32 v249, v249, v7
    v_mul_f32 v250, v250, v7
    v_mul_f32 v251, v251, v7
    v_mul_f32 v252, v252, v7
    v_mul_f32 v253, v253, v7
    v_mul_f32 v254, v254, v7
    v_mul_f32 v255, v255, v7
    v_accvgpr_read_b32 v8, a224
    v_accvgpr_read_b32 v9, a225
    v_accvgpr_read_b32 v10, a226
    v_accvgpr_read_b32 v11, a227
    v_mul_f32 v8, v8, v7
    v_mul_f32 v9, v9, v7
    v_mul_f32 v10, v10, v7
    v_mul_f32 v11, v11, v7
    v_accvgpr_write_b32 a224, v8
    v_accvgpr_write_b32 a225, v9
    v_accvgpr_write_b32 a226, v10
    v_accvgpr_write_b32 a227, v11
    v_accvgpr_read_b32 v8, a228
    v_accvgpr_read_b32 v9, a229
    v_accvgpr_read_b32 v10, a230
    v_accvgpr_read_b32 v11, a231
    v_mul_f32 v8, v8, v7
    v_mul_f32 v9, v9, v7
    v_mul_f32 v10, v10, v7
    v_mul_f32 v11, v11, v7
    v_accvgpr_write_b32 a228, v8
    v_accvgpr_write_b32 a229, v9
    v_accvgpr_write_b32 a230, v10
    v_accvgpr_write_b32 a231, v11
    v_accvgpr_read_b32 v8, a232
    v_accvgpr_read_b32 v9, a233
    v_accvgpr_read_b32 v10, a234
    v_accvgpr_read_b32 v11, a235
    v_mul_f32 v8, v8, v7
    v_mul_f32 v9, v9, v7
    v_mul_f32 v10, v10, v7
    v_mul_f32 v11, v11, v7
    v_accvgpr_write_b32 a232, v8
    v_accvgpr_write_b32 a233, v9
    v_accvgpr_write_b32 a234, v10
    v_accvgpr_write_b32 a235, v11
    v_accvgpr_read_b32 v8, a236
    v_accvgpr_read_b32 v9, a237
    v_accvgpr_read_b32 v10, a238
    v_accvgpr_read_b32 v11, a239
    v_mul_f32 v8, v8, v7
    v_mul_f32 v9, v9, v7
    v_mul_f32 v10, v10, v7
    v_mul_f32 v11, v11, v7
    v_accvgpr_write_b32 a236, v8
    v_accvgpr_write_b32 a237, v9
    v_accvgpr_write_b32 a238, v10
    v_accvgpr_write_b32 a239, v11
    v_accvgpr_read_b32 v8, a240
    v_accvgpr_read_b32 v9, a241
    v_accvgpr_read_b32 v10, a242
    v_accvgpr_read_b32 v11, a243
    v_mul_f32 v8, v8, v7
    v_mul_f32 v9, v9, v7
    v_mul_f32 v10, v10, v7
    v_mul_f32 v11, v11, v7
    v_accvgpr_write_b32 a240, v8
    v_accvgpr_write_b32 a241, v9
    v_accvgpr_write_b32 a242, v10
    v_accvgpr_write_b32 a243, v11
    v_accvgpr_read_b32 v8, a244
    v_accvgpr_read_b32 v9, a245
    v_accvgpr_read_b32 v10, a246
    v_accvgpr_read_b32 v11, a247
    v_mul_f32 v8, v8, v7
    v_mul_f32 v9, v9, v7
    v_mul_f32 v10, v10, v7
    v_mul_f32 v11, v11, v7
    v_accvgpr_write_b32 a244, v8
    v_accvgpr_write_b32 a245, v9
    v_accvgpr_write_b32 a246, v10
    v_accvgpr_write_b32 a247, v11
    v_accvgpr_read_b32 v8, a248
    v_accvgpr_read_b32 v9, a249
    v_accvgpr_read_b32 v10, a250
    v_accvgpr_read_b32 v11, a251
    v_mul_f32 v8, v8, v7
    v_mul_f32 v9, v9, v7
    v_mul_f32 v10, v10, v7
    v_mul_f32 v11, v11, v7
    v_accvgpr_write_b32 a248, v8
    v_accvgpr_write_b32 a249, v9
    v_accvgpr_write_b32 a250, v10
    v_accvgpr_write_b32 a251, v11
    v_accvgpr_read_b32 v8, a252
    v_accvgpr_read_b32 v9, a253
    v_accvgpr_read_b32 v10, a254
    v_accvgpr_read_b32 v11, a255
    v_mul_f32 v8, v8, v7
    v_mul_f32 v9, v9, v7
    v_mul_f32 v10, v10, v7
    v_mul_f32 v11, v11, v7
    v_accvgpr_write_b32 a252, v8
    v_accvgpr_write_b32 a253, v9
    v_accvgpr_write_b32 a254, v10
    v_accvgpr_write_b32 a255, v11
    v_subrev_u32 v6, 32, v3
    v_subrev_u32 v7, 64, v3
    v_subrev_u32 v8, 96, v3
    v_subrev_u32 v9, 32, v4
    v_subrev_u32 v10, 64, v4
    v_subrev_u32 v11, 96, v4
    s_nop 1
    s_branch L_back1
L_rare2:
    s_lshl_b32 s27, s26, 1
    s_add_u32 s27, s27, 2
    s_lshl_b32 s27, s27, 14
    s_add_u32 s28, s27, 8192
    v_and_b32 v6, 15, v0
    v_lshlrev_b32 v6, 9, v6
    v_lshrrev_b32 v7, 4, v0
    v_lshl_add_u32 v6, v7, 4, v6
    buffer_load_dwordx4 v[36:39], v6, s[4:7], s27 offen offset:0
    buffer_load_dwordx4 v[40:43], v6, s[4:7], s28 offen offset:0
    s_waitcnt vmcnt(0)
    v_mfma_f32_16x16x32_bf16 v[64:67], v[36:39], a[0:3], v[48:51]
    v_mfma_f32_16x16x32_bf16 v[72:75], v[36:39], a[32:35], v[52:55]
    v_mfma_f32_16x16x32_bf16 v[80:83], v[36:39], a[64:67], v[56:59]
    v_mfma_f32_16x16x32_bf16 v[88:91], v[36:39], a[96:99], v[60:63]
    v_mfma_f32_16x16x32_bf16 v[68:71], v[40:43], a[0:3], v[48:51]
    v_mfma_f32_16x16x32_bf16 v[76:79], v[40:43], a[32:35], v[52:55]
    v_mfma_f32_16x16x32_bf16 v[84:87], v[40:43], a[64:67], v[56:59]
    v_mfma_f32_16x16x32_bf16 v[92:95], v[40:43], a[96:99], v[60:63]
    buffer_load_dwordx4 v[36:39], v6, s[4:7], s27 offen offset:64
    buffer_load_dwordx4 v[40:43], v6, s[4:7], s28 offen offset:64
    s_waitcnt vmcnt(0)
    v_mfma_f32_16x16x32_bf16 v[64:67], v[36:39], a[4:7], v[64:67]
    v_mfma_f32_16x16x32_bf16 v[72:75], v[36:39], a[36:39], v[72:75]
    v_mfma_f32_16x16x32_bf16 v[80:83], v[36:39], a[68:71], v[80:83]
    v_mfma_f32_16x16x32_bf16 v[88:91], v[36:39], a[100:103], v[88:91]
    v_mfma_f32_16x16x32_bf16 v[68:71], v[40:43], a[4:7], v[68:71]
    v_mfma_f32_16x16x32_bf16 v[76:79], v[40:43], a[36:39], v[76:79]
    v_mfma_f32_16x16x32_bf16 v[84:87], v[40:43], a[68:71], v[84:87]
    v_mfma_f32_16x16x32_bf16 v[92:95], v[40:43], a[100:103], v[92:95]
    buffer_load_dwordx4 v[36:39], v6, s[4:7], s27 offen offset:128
    buffer_load_dwordx4 v[40:43], v6, s[4:7], s28 offen offset:128
    s_waitcnt vmcnt(0)
    v_mfma_f32_16x16x32_bf16 v[64:67], v[36:39], a[8:11], v[64:67]
    v_mfma_f32_16x16x32_bf16 v[72:75], v[36:39], a[40:43], v[72:75]
    v_mfma_f32_16x16x32_bf16 v[80:83], v[36:39], a[72:75], v[80:83]
    v_mfma_f32_16x16x32_bf16 v[88:91], v[36:39], a[104:107], v[88:91]
    v_mfma_f32_16x16x32_bf16 v[68:71], v[40:43], a[8:11], v[68:71]
    v_mfma_f32_16x16x32_bf16 v[76:79], v[40:43], a[40:43], v[76:79]
    v_mfma_f32_16x16x32_bf16 v[84:87], v[40:43], a[72:75], v[84:87]
    v_mfma_f32_16x16x32_bf16 v[92:95], v[40:43], a[104:107], v[92:95]
    buffer_load_dwordx4 v[36:39], v6, s[4:7], s27 offen offset:192
    buffer_load_dwordx4 v[40:43], v6, s[4:7], s28 offen offset:192
    s_waitcnt vmcnt(0)
    v_mfma_f32_16x16x32_bf16 v[64:67], v[36:39], a[12:15], v[64:67]
    v_mfma_f32_16x16x32_bf16 v[72:75], v[36:39], a[44:47], v[72:75]
    v_mfma_f32_16x16x32_bf16 v[80:83], v[36:39], a[76:79], v[80:83]
    v_mfma_f32_16x16x32_bf16 v[88:91], v[36:39], a[108:111], v[88:91]
    v_mfma_f32_16x16x32_bf16 v[68:71], v[40:43], a[12:15], v[68:71]
    v_mfma_f32_16x16x32_bf16 v[76:79], v[40:43], a[44:47], v[76:79]
    v_mfma_f32_16x16x32_bf16 v[84:87], v[40:43], a[76:79], v[84:87]
    v_mfma_f32_16x16x32_bf16 v[92:95], v[40:43], a[108:111], v[92:95]
    buffer_load_dwordx4 v[36:39], v6, s[4:7], s27 offen offset:256
    buffer_load_dwordx4 v[40:43], v6, s[4:7], s28 offen offset:256
    s_waitcnt vmcnt(0)
    v_mfma_f32_16x16x32_bf16 v[64:67], v[36:39], a[16:19], v[64:67]
    v_mfma_f32_16x16x32_bf16 v[72:75], v[36:39], a[48:51], v[72:75]
    v_mfma_f32_16x16x32_bf16 v[80:83], v[36:39], a[80:83], v[80:83]
    v_mfma_f32_16x16x32_bf16 v[88:91], v[36:39], a[112:115], v[88:91]
    v_mfma_f32_16x16x32_bf16 v[68:71], v[40:43], a[16:19], v[68:71]
    v_mfma_f32_16x16x32_bf16 v[76:79], v[40:43], a[48:51], v[76:79]
    v_mfma_f32_16x16x32_bf16 v[84:87], v[40:43], a[80:83], v[84:87]
    v_mfma_f32_16x16x32_bf16 v[92:95], v[40:43], a[112:115], v[92:95]
    buffer_load_dwordx4 v[36:39], v6, s[4:7], s27 offen offset:320
    buffer_load_dwordx4 v[40:43], v6, s[4:7], s28 offen offset:320
    s_waitcnt vmcnt(0)
    v_mfma_f32_16x16x32_bf16 v[64:67], v[36:39], a[20:23], v[64:67]
    v_mfma_f32_16x16x32_bf16 v[72:75], v[36:39], a[52:55], v[72:75]
    v_mfma_f32_16x16x32_bf16 v[80:83], v[36:39], a[84:87], v[80:83]
    v_mfma_f32_16x16x32_bf16 v[88:91], v[36:39], a[116:119], v[88:91]
    v_mfma_f32_16x16x32_bf16 v[68:71], v[40:43], a[20:23], v[68:71]
    v_mfma_f32_16x16x32_bf16 v[76:79], v[40:43], a[52:55], v[76:79]
    v_mfma_f32_16x16x32_bf16 v[84:87], v[40:43], a[84:87], v[84:87]
    v_mfma_f32_16x16x32_bf16 v[92:95], v[40:43], a[116:119], v[92:95]
    buffer_load_dwordx4 v[36:39], v6, s[4:7], s27 offen offset:384
    buffer_load_dwordx4 v[40:43], v6, s[4:7], s28 offen offset:384
    s_waitcnt vmcnt(0)
    v_mfma_f32_16x16x32_bf16 v[64:67], v[36:39], a[24:27], v[64:67]
    v_mfma_f32_16x16x32_bf16 v[72:75], v[36:39], a[56:59], v[72:75]
    v_mfma_f32_16x16x32_bf16 v[80:83], v[36:39], a[88:91], v[80:83]
    v_mfma_f32_16x16x32_bf16 v[88:91], v[36:39], a[120:123], v[88:91]
    v_mfma_f32_16x16x32_bf16 v[68:71], v[40:43], a[24:27], v[68:71]
    v_mfma_f32_16x16x32_bf16 v[76:79], v[40:43], a[56:59], v[76:79]
    v_mfma_f32_16x16x32_bf16 v[84:87], v[40:43], a[88:91], v[84:87]
    v_mfma_f32_16x16x32_bf16 v[92:95], v[40:43], a[120:123], v[92:95]
    buffer_load_dwordx4 v[36:39], v6, s[4:7], s27 offen offset:448
    buffer_load_dwordx4 v[40:43], v6, s[4:7], s28 offen offset:448
    s_waitcnt vmcnt(0)
    v_mfma_f32_16x16x32_bf16 v[64:67], v[36:39], a[28:31], v[64:67]
    v_mfma_f32_16x16x32_bf16 v[72:75], v[36:39], a[60:63], v[72:75]
    v_mfma_f32_16x16x32_bf16 v[80:83], v[36:39], a[92:95], v[80:83]
    v_mfma_f32_16x16x32_bf16 v[88:91], v[36:39], a[124:127], v[88:91]
    v_mfma_f32_16x16x32_bf16 v[68:71], v[40:43], a[28:31], v[68:71]
    v_mfma_f32_16x16x32_bf16 v[76:79], v[40:43], a[60:63], v[76:79]
    v_mfma_f32_16x16x32_bf16 v[84:87], v[40:43], a[92:95], v[84:87]
    v_mfma_f32_16x16x32_bf16 v[92:95], v[40:43], a[124:127], v[92:95]
    s_nop 7
    v_frexp_exp_i32_f32 v7, v44
    v_cvt_f32_i32 v7, v7
    v_max3_f32 v6, v64, v65, v66
    v_max3_f32 v6, v6, v67, v68
    v_max3_f32 v6, v6, v69, v70
    v_max3_f32 v6, v6, v71, v7
    v_mov_b32 v7, v6
    s_nop 1
    v_permlane16_swap_b32 v7, v6
    s_nop 1
    v_max_f32 v6, v6, v7
    v_mov_b32 v7, v6
    s_nop 1
    v_permlane32_swap_b32 v7, v6
    s_nop 1
    v_max_f32 v6, v6, v7
    v_max_f32 v6, 0, v6
    v_ceil_f32 v6, v6
    v_cvt_i32_f32 v7, -v6
    v_ldexp_f32 v7, 1.0, v7
    v_sub_f32 v48, v48, v6
    v_sub_f32 v49, v49, v6
    v_sub_f32 v50, v50, v6
    v_sub_f32 v51, v51, v6
    v_sub_f32 v64, v64, v6
    v_sub_f32 v96, v96, v6
    v_sub_f32 v65, v65, v6
    v_sub_f32 v97, v97, v6
    v_sub_f32 v66, v66, v6
    v_sub_f32 v98, v98, v6
    v_sub_f32 v67, v67, v6
    v_sub_f32 v99, v99, v6
    v_sub_f32 v68, v68, v6
    v_sub_f32 v100, v100, v6
    v_sub_f32 v69, v69, v6
    v_sub_f32 v101, v101, v6
    v_sub_f32 v70, v70, v6
    v_sub_f32 v102, v102, v6
    v_sub_f32 v71, v71, v6
    v_sub_f32 v103, v103, v6
    v_mul_f32 v12, v44, v7
    v_exp_f32 v64, v64
    v_exp_f32 v65, v65
    v_exp_f32 v66, v66
    v_exp_f32 v67, v67
    v_exp_f32 v68, v68
    v_exp_f32 v69, v69
    v_exp_f32 v70, v70
    v_exp_f32 v71, v71
    s_nop 0
    v_add_f32 v12, v12, v64
    v_add_f32 v12, v12, v65
    v_add_f32 v12, v12, v66
    v_add_f32 v12, v12, v67
    v_add_f32 v12, v12, v68
    v_add_f32 v12, v12, v69
    v_add_f32 v12, v12, v70
    v_add_f32 v12, v12, v71
    v_cvt_pk_bf16_f32 v64, v64, v65
    v_cvt_pk_bf16_f32 v65, v66, v67
    v_cvt_pk_bf16_f32 v66, v68, v69
    v_cvt_pk_bf16_f32 v67, v70, v71
    v_mul_f32 v128, v128, v7
    v_mul_f32 v129, v129, v7
    v_mul_f32 v130, v130, v7
    v_mul_f32 v131, v131, v7
    v_mul_f32 v132, v132, v7
    v_mul_f32 v133, v133, v7
    v_mul_f32 v134, v134, v7
    v_mul_f32 v135, v135, v7
    v_mul_f32 v136, v136, v7
    v_mul_f32 v137, v137, v7
    v_mul_f32 v138, v138, v7
    v_mul_f32 v139, v139, v7
    v_mul_f32 v140, v140, v7
    v_mul_f32 v141, v141, v7
    v_mul_f32 v142, v142, v7
    v_mul_f32 v143, v143, v7
    v_mul_f32 v144, v144, v7
    v_mul_f32 v145, v145, v7
    v_mul_f32 v146, v146, v7
    v_mul_f32 v147, v147, v7
    v_mul_f32 v148, v148, v7
    v_mul_f32 v149, v149, v7
    v_mul_f32 v150, v150, v7
    v_mul_f32 v151, v151, v7
    v_mul_f32 v152, v152, v7
    v_mul_f32 v153, v153, v7
    v_mul_f32 v154, v154, v7
    v_mul_f32 v155, v155, v7
    v_mul_f32 v156, v156, v7
    v_mul_f32 v157, v157, v7
    v_mul_f32 v158, v158, v7
    v_mul_f32 v159, v159, v7
    v_accvgpr_read_b32 v8, a128
    v_accvgpr_read_b32 v9, a129
    v_accvgpr_read_b32 v10, a130
    v_accvgpr_read_b32 v11, a131
    v_mul_f32 v8, v8, v7
    v_mul_f32 v9, v9, v7
    v_mul_f32 v10, v10, v7
    v_mul_f32 v11, v11, v7
    v_accvgpr_write_b32 a128, v8
    v_accvgpr_write_b32 a129, v9
    v_accvgpr_write_b32 a130, v10
    v_accvgpr_write_b32 a131, v11
    v_accvgpr_read_b32 v8, a132
    v_accvgpr_read_b32 v9, a133
    v_accvgpr_read_b32 v10, a134
    v_accvgpr_read_b32 v11, a135
    v_mul_f32 v8, v8, v7
    v_mul_f32 v9, v9, v7
    v_mul_f32 v10, v10, v7
    v_mul_f32 v11, v11, v7
    v_accvgpr_write_b32 a132, v8
    v_accvgpr_write_b32 a133, v9
    v_accvgpr_write_b32 a134, v10
    v_accvgpr_write_b32 a135, v11
    v_accvgpr_read_b32 v8, a136
    v_accvgpr_read_b32 v9, a137
    v_accvgpr_read_b32 v10, a138
    v_accvgpr_read_b32 v11, a139
    v_mul_f32 v8, v8, v7
    v_mul_f32 v9, v9, v7
    v_mul_f32 v10, v10, v7
    v_mul_f32 v11, v11, v7
    v_accvgpr_write_b32 a136, v8
    v_accvgpr_write_b32 a137, v9
    v_accvgpr_write_b32 a138, v10
    v_accvgpr_write_b32 a139, v11
    v_accvgpr_read_b32 v8, a140
    v_accvgpr_read_b32 v9, a141
    v_accvgpr_read_b32 v10, a142
    v_accvgpr_read_b32 v11, a143
    v_mul_f32 v8, v8, v7
    v_mul_f32 v9, v9, v7
    v_mul_f32 v10, v10, v7
    v_mul_f32 v11, v11, v7
    v_accvgpr_write_b32 a140, v8
    v_accvgpr_write_b32 a141, v9
    v_accvgpr_write_b32 a142, v10
    v_accvgpr_write_b32 a143, v11
    v_accvgpr_read_b32 v8, a144
    v_accvgpr_read_b32 v9, a145
    v_accvgpr_read_b32 v10, a146
    v_accvgpr_read_b32 v11, a147
    v_mul_f32 v8, v8, v7
    v_mul_f32 v9, v9, v7
    v_mul_f32 v10, v10, v7
    v_mul_f32 v11, v11, v7
    v_accvgpr_write_b32 a144, v8
    v_accvgpr_write_b32 a145, v9
    v_accvgpr_write_b32 a146, v10
    v_accvgpr_write_b32 a147, v11
    v_accvgpr_read_b32 v8, a148
    v_accvgpr_read_b32 v9, a149
    v_accvgpr_read_b32 v10, a150
    v_accvgpr_read_b32 v11, a151
    v_mul_f32 v8, v8, v7
    v_mul_f32 v9, v9, v7
    v_mul_f32 v10, v10, v7
    v_mul_f32 v11, v11, v7
    v_accvgpr_write_b32 a148, v8
    v_accvgpr_write_b32 a149, v9
    v_accvgpr_write_b32 a150, v10
    v_accvgpr_write_b32 a151, v11
    v_accvgpr_read_b32 v8, a152
    v_accvgpr_read_b32 v9, a153
    v_accvgpr_read_b32 v10, a154
    v_accvgpr_read_b32 v11, a155
    v_mul_f32 v8, v8, v7
    v_mul_f32 v9, v9, v7
    v_mul_f32 v10, v10, v7
    v_mul_f32 v11, v11, v7
    v_accvgpr_write_b32 a152, v8
    v_accvgpr_write_b32 a153, v9
    v_accvgpr_write_b32 a154, v10
    v_accvgpr_write_b32 a155, v11
    v_accvgpr_read_b32 v8, a156
    v_accvgpr_read_b32 v9, a157
    v_accvgpr_read_b32 v10, a158
    v_accvgpr_read_b32 v11, a159
    v_mul_f32 v8, v8, v7
    v_mul_f32 v9, v9, v7
    v_mul_f32 v10, v10, v7
    v_mul_f32 v11, v11, v7
    v_accvgpr_write_b32 a156, v8
    v_accvgpr_write_b32 a157, v9
    v_accvgpr_write_b32 a158, v10
    v_accvgpr_write_b32 a159, v11
    v_frexp_exp_i32_f32 v7, v45
    v_cvt_f32_i32 v7, v7
    v_max3_f32 v6, v72, v73, v74
    v_max3_f32 v6, v6, v75, v76
    v_max3_f32 v6, v6, v77, v78
    v_max3_f32 v6, v6, v79, v7
    v_mov_b32 v7, v6
    s_nop 1
    v_permlane16_swap_b32 v7, v6
    s_nop 1
    v_max_f32 v6, v6, v7
    v_mov_b32 v7, v6
    s_nop 1
    v_permlane32_swap_b32 v7, v6
    s_nop 1
    v_max_f32 v6, v6, v7
    v_max_f32 v6, 0, v6
    v_ceil_f32 v6, v6
    v_cvt_i32_f32 v7, -v6
    v_ldexp_f32 v7, 1.0, v7
    v_sub_f32 v52, v52, v6
    v_sub_f32 v53, v53, v6
    v_sub_f32 v54, v54, v6
    v_sub_f32 v55, v55, v6
    v_sub_f32 v72, v72, v6
    v_sub_f32 v104, v104, v6
    v_sub_f32 v73, v73, v6
    v_sub_f32 v105, v105, v6
    v_sub_f32 v74, v74, v6
    v_sub_f32 v106, v106, v6
    v_sub_f32 v75, v75, v6
    v_sub_f32 v107, v107, v6
    v_sub_f32 v76, v76, v6
    v_sub_f32 v108, v108, v6
    v_sub_f32 v77, v77, v6
    v_sub_f32 v109, v109, v6
    v_sub_f32 v78, v78, v6
    v_sub_f32 v110, v110, v6
    v_sub_f32 v79, v79, v6
    v_sub_f32 v111, v111, v6
    v_mul_f32 v13, v45, v7
    v_exp_f32 v72, v72
    v_exp_f32 v73, v73
    v_exp_f32 v74, v74
    v_exp_f32 v75, v75
    v_exp_f32 v76, v76
    v_exp_f32 v77, v77
    v_exp_f32 v78, v78
    v_exp_f32 v79, v79
    s_nop 0
    v_add_f32 v13, v13, v72
    v_add_f32 v13, v13, v73
    v_add_f32 v13, v13, v74
    v_add_f32 v13, v13, v75
    v_add_f32 v13, v13, v76
    v_add_f32 v13, v13, v77
    v_add_f32 v13, v13, v78
    v_add_f32 v13, v13, v79
    v_cvt_pk_bf16_f32 v72, v72, v73
    v_cvt_pk_bf16_f32 v73, v74, v75
    v_cvt_pk_bf16_f32 v74, v76, v77
    v_cvt_pk_bf16_f32 v75, v78, v79
    v_mul_f32 v160, v160, v7
    v_mul_f32 v161, v161, v7
    v_mul_f32 v162, v162, v7
    v_mul_f32 v163, v163, v7
    v_mul_f32 v164, v164, v7
    v_mul_f32 v165, v165, v7
    v_mul_f32 v166, v166, v7
    v_mul_f32 v167, v167, v7
    v_mul_f32 v168, v168, v7
    v_mul_f32 v169, v169, v7
    v_mul_f32 v170, v170, v7
    v_mul_f32 v171, v171, v7
    v_mul_f32 v172, v172, v7
    v_mul_f32 v173, v173, v7
    v_mul_f32 v174, v174, v7
    v_mul_f32 v175, v175, v7
    v_mul_f32 v176, v176, v7
    v_mul_f32 v177, v177, v7
    v_mul_f32 v178, v178, v7
    v_mul_f32 v179, v179, v7
    v_mul_f32 v180, v180, v7
    v_mul_f32 v181, v181, v7
    v_mul_f32 v182, v182, v7
    v_mul_f32 v183, v183, v7
    v_mul_f32 v184, v184, v7
    v_mul_f32 v185, v185, v7
    v_mul_f32 v186, v186, v7
    v_mul_f32 v187, v187, v7
    v_mul_f32 v188, v188, v7
    v_mul_f32 v189, v189, v7
    v_mul_f32 v190, v190, v7
    v_mul_f32 v191, v191, v7
    v_accvgpr_read_b32 v8, a160
    v_accvgpr_read_b32 v9, a161
    v_accvgpr_read_b32 v10, a162
    v_accvgpr_read_b32 v11, a163
    v_mul_f32 v8, v8, v7
    v_mul_f32 v9, v9, v7
    v_mul_f32 v10, v10, v7
    v_mul_f32 v11, v11, v7
    v_accvgpr_write_b32 a160, v8
    v_accvgpr_write_b32 a161, v9
    v_accvgpr_write_b32 a162, v10
    v_accvgpr_write_b32 a163, v11
    v_accvgpr_read_b32 v8, a164
    v_accvgpr_read_b32 v9, a165
    v_accvgpr_read_b32 v10, a166
    v_accvgpr_read_b32 v11, a167
    v_mul_f32 v8, v8, v7
    v_mul_f32 v9, v9, v7
    v_mul_f32 v10, v10, v7
    v_mul_f32 v11, v11, v7
    v_accvgpr_write_b32 a164, v8
    v_accvgpr_write_b32 a165, v9
    v_accvgpr_write_b32 a166, v10
    v_accvgpr_write_b32 a167, v11
    v_accvgpr_read_b32 v8, a168
    v_accvgpr_read_b32 v9, a169
    v_accvgpr_read_b32 v10, a170
    v_accvgpr_read_b32 v11, a171
    v_mul_f32 v8, v8, v7
    v_mul_f32 v9, v9, v7
    v_mul_f32 v10, v10, v7
    v_mul_f32 v11, v11, v7
    v_accvgpr_write_b32 a168, v8
    v_accvgpr_write_b32 a169, v9
    v_accvgpr_write_b32 a170, v10
    v_accvgpr_write_b32 a171, v11
    v_accvgpr_read_b32 v8, a172
    v_accvgpr_read_b32 v9, a173
    v_accvgpr_read_b32 v10, a174
    v_accvgpr_read_b32 v11, a175
    v_mul_f32 v8, v8, v7
    v_mul_f32 v9, v9, v7
    v_mul_f32 v10, v10, v7
    v_mul_f32 v11, v11, v7
    v_accvgpr_write_b32 a172, v8
    v_accvgpr_write_b32 a173, v9
    v_accvgpr_write_b32 a174, v10
    v_accvgpr_write_b32 a175, v11
    v_accvgpr_read_b32 v8, a176
    v_accvgpr_read_b32 v9, a177
    v_accvgpr_read_b32 v10, a178
    v_accvgpr_read_b32 v11, a179
    v_mul_f32 v8, v8, v7
    v_mul_f32 v9, v9, v7
    v_mul_f32 v10, v10, v7
    v_mul_f32 v11, v11, v7
    v_accvgpr_write_b32 a176, v8
    v_accvgpr_write_b32 a177, v9
    v_accvgpr_write_b32 a178, v10
    v_accvgpr_write_b32 a179, v11
    v_accvgpr_read_b32 v8, a180
    v_accvgpr_read_b32 v9, a181
    v_accvgpr_read_b32 v10, a182
    v_accvgpr_read_b32 v11, a183
    v_mul_f32 v8, v8, v7
    v_mul_f32 v9, v9, v7
    v_mul_f32 v10, v10, v7
    v_mul_f32 v11, v11, v7
    v_accvgpr_write_b32 a180, v8
    v_accvgpr_write_b32 a181, v9
    v_accvgpr_write_b32 a182, v10
    v_accvgpr_write_b32 a183, v11
    v_accvgpr_read_b32 v8, a184
    v_accvgpr_read_b32 v9, a185
    v_accvgpr_read_b32 v10, a186
    v_accvgpr_read_b32 v11, a187
    v_mul_f32 v8, v8, v7
    v_mul_f32 v9, v9, v7
    v_mul_f32 v10, v10, v7
    v_mul_f32 v11, v11, v7
    v_accvgpr_write_b32 a184, v8
    v_accvgpr_write_b32 a185, v9
    v_accvgpr_write_b32 a186, v10
    v_accvgpr_write_b32 a187, v11
    v_accvgpr_read_b32 v8, a188
    v_accvgpr_read_b32 v9, a189
    v_accvgpr_read_b32 v10, a190
    v_accvgpr_read_b32 v11, a191
    v_mul_f32 v8, v8, v7
    v_mul_f32 v9, v9, v7
    v_mul_f32 v10, v10, v7
    v_mul_f32 v11, v11, v7
    v_accvgpr_write_b32 a188, v8
    v_accvgpr_write_b32 a189, v9
    v_accvgpr_write_b32 a190, v10
    v_accvgpr_write_b32 a191, v11
    v_frexp_exp_i32_f32 v7, v46
    v_cvt_f32_i32 v7, v7
    v_max3_f32 v6, v80, v81, v82
    v_max3_f32 v6, v6, v83, v84
    v_max3_f32 v6, v6, v85, v86
    v_max3_f32 v6, v6, v87, v7
    v_mov_b32 v7, v6
    s_nop 1
    v_permlane16_swap_b32 v7, v6
    s_nop 1
    v_max_f32 v6, v6, v7
    v_mov_b32 v7, v6
    s_nop 1
    v_permlane32_swap_b32 v7, v6
    s_nop 1
    v_max_f32 v6, v6, v7
    v_max_f32 v6, 0, v6
    v_ceil_f32 v6, v6
    v_cvt_i32_f32 v7, -v6
    v_ldexp_f32 v7, 1.0, v7
    v_sub_f32 v56, v56, v6
    v_sub_f32 v57, v57, v6
    v_sub_f32 v58, v58, v6
    v_sub_f32 v59, v59, v6
    v_sub_f32 v80, v80, v6
    v_sub_f32 v112, v112, v6
    v_sub_f32 v81, v81, v6
    v_sub_f32 v113, v113, v6
    v_sub_f32 v82, v82, v6
    v_sub_f32 v114, v114, v6
    v_sub_f32 v83, v83, v6
    v_sub_f32 v115, v115, v6
    v_sub_f32 v84, v84, v6
    v_sub_f32 v116, v116, v6
    v_sub_f32 v85, v85, v6
    v_sub_f32 v117, v117, v6
    v_sub_f32 v86, v86, v6
    v_sub_f32 v118, v118, v6
    v_sub_f32 v87, v87, v6
    v_sub_f32 v119, v119, v6
    v_mul_f32 v14, v46, v7
    v_exp_f32 v80, v80
    v_exp_f32 v81, v81
    v_exp_f32 v82, v82
    v_exp_f32 v83, v83
    v_exp_f32 v84, v84
    v_exp_f32 v85, v85
    v_exp_f32 v86, v86
    v_exp_f32 v87, v87
    s_nop 0
    v_add_f32 v14, v14, v80
    v_add_f32 v14, v14, v81
    v_add_f32 v14, v14, v82
    v_add_f32 v14, v14, v83
    v_add_f32 v14, v14, v84
    v_add_f32 v14, v14, v85
    v_add_f32 v14, v14, v86
    v_add_f32 v14, v14, v87
    v_cvt_pk_bf16_f32 v80, v80, v81
    v_cvt_pk_bf16_f32 v81, v82, v83
    v_cvt_pk_bf16_f32 v82, v84, v85
    v_cvt_pk_bf16_f32 v83, v86, v87
    v_mul_f32 v192, v192, v7
    v_mul_f32 v193, v193, v7
    v_mul_f32 v194, v194, v7
    v_mul_f32 v195, v195, v7
    v_mul_f32 v196, v196, v7
    v_mul_f32 v197, v197, v7
    v_mul_f32 v198, v198, v7
    v_mul_f32 v199, v199, v7
    v_mul_f32 v200, v200, v7
    v_mul_f32 v201, v201, v7
    v_mul_f32 v202, v202, v7
    v_mul_f32 v203, v203, v7
    v_mul_f32 v204, v204, v7
    v_mul_f32 v205, v205, v7
    v_mul_f32 v206, v206, v7
    v_mul_f32 v207, v207, v7
    v_mul_f32 v208, v208, v7
    v_mul_f32 v209, v209, v7
    v_mul_f32 v210, v210, v7
    v_mul_f32 v211, v211, v7
    v_mul_f32 v212, v212, v7
    v_mul_f32 v213, v213, v7
    v_mul_f32 v214, v214, v7
    v_mul_f32 v215, v215, v7
    v_mul_f32 v216, v216, v7
    v_mul_f32 v217, v217, v7
    v_mul_f32 v218, v218, v7
    v_mul_f32 v219, v219, v7
    v_mul_f32 v220, v220, v7
    v_mul_f32 v221, v221, v7
    v_mul_f32 v222, v222, v7
    v_mul_f32 v223, v223, v7
    v_accvgpr_read_b32 v8, a192
    v_accvgpr_read_b32 v9, a193
    v_accvgpr_read_b32 v10, a194
    v_accvgpr_read_b32 v11, a195
    v_mul_f32 v8, v8, v7
    v_mul_f32 v9, v9, v7
    v_mul_f32 v10, v10, v7
    v_mul_f32 v11, v11, v7
    v_accvgpr_write_b32 a192, v8
    v_accvgpr_write_b32 a193, v9
    v_accvgpr_write_b32 a194, v10
    v_accvgpr_write_b32 a195, v11
    v_accvgpr_read_b32 v8, a196
    v_accvgpr_read_b32 v9, a197
    v_accvgpr_read_b32 v10, a198
    v_accvgpr_read_b32 v11, a199
    v_mul_f32 v8, v8, v7
    v_mul_f32 v9, v9, v7
    v_mul_f32 v10, v10, v7
    v_mul_f32 v11, v11, v7
    v_accvgpr_write_b32 a196, v8
    v_accvgpr_write_b32 a197, v9
    v_accvgpr_write_b32 a198, v10
    v_accvgpr_write_b32 a199, v11
    v_accvgpr_read_b32 v8, a200
    v_accvgpr_read_b32 v9, a201
    v_accvgpr_read_b32 v10, a202
    v_accvgpr_read_b32 v11, a203
    v_mul_f32 v8, v8, v7
    v_mul_f32 v9, v9, v7
    v_mul_f32 v10, v10, v7
    v_mul_f32 v11, v11, v7
    v_accvgpr_write_b32 a200, v8
    v_accvgpr_write_b32 a201, v9
    v_accvgpr_write_b32 a202, v10
    v_accvgpr_write_b32 a203, v11
    v_accvgpr_read_b32 v8, a204
    v_accvgpr_read_b32 v9, a205
    v_accvgpr_read_b32 v10, a206
    v_accvgpr_read_b32 v11, a207
    v_mul_f32 v8, v8, v7
    v_mul_f32 v9, v9, v7
    v_mul_f32 v10, v10, v7
    v_mul_f32 v11, v11, v7
    v_accvgpr_write_b32 a204, v8
    v_accvgpr_write_b32 a205, v9
    v_accvgpr_write_b32 a206, v10
    v_accvgpr_write_b32 a207, v11
    v_accvgpr_read_b32 v8, a208
    v_accvgpr_read_b32 v9, a209
    v_accvgpr_read_b32 v10, a210
    v_accvgpr_read_b32 v11, a211
    v_mul_f32 v8, v8, v7
    v_mul_f32 v9, v9, v7
    v_mul_f32 v10, v10, v7
    v_mul_f32 v11, v11, v7
    v_accvgpr_write_b32 a208, v8
    v_accvgpr_write_b32 a209, v9
    v_accvgpr_write_b32 a210, v10
    v_accvgpr_write_b32 a211, v11
    v_accvgpr_read_b32 v8, a212
    v_accvgpr_read_b32 v9, a213
    v_accvgpr_read_b32 v10, a214
    v_accvgpr_read_b32 v11, a215
    v_mul_f32 v8, v8, v7
    v_mul_f32 v9, v9, v7
    v_mul_f32 v10, v10, v7
    v_mul_f32 v11, v11, v7
    v_accvgpr_write_b32 a212, v8
    v_accvgpr_write_b32 a213, v9
    v_accvgpr_write_b32 a214, v10
    v_accvgpr_write_b32 a215, v11
    v_accvgpr_read_b32 v8, a216
    v_accvgpr_read_b32 v9, a217
    v_accvgpr_read_b32 v10, a218
    v_accvgpr_read_b32 v11, a219
    v_mul_f32 v8, v8, v7
    v_mul_f32 v9, v9, v7
    v_mul_f32 v10, v10, v7
    v_mul_f32 v11, v11, v7
    v_accvgpr_write_b32 a216, v8
    v_accvgpr_write_b32 a217, v9
    v_accvgpr_write_b32 a218, v10
    v_accvgpr_write_b32 a219, v11
    v_accvgpr_read_b32 v8, a220
    v_accvgpr_read_b32 v9, a221
    v_accvgpr_read_b32 v10, a222
    v_accvgpr_read_b32 v11, a223
    v_mul_f32 v8, v8, v7
    v_mul_f32 v9, v9, v7
    v_mul_f32 v10, v10, v7
    v_mul_f32 v11, v11, v7
    v_accvgpr_write_b32 a220, v8
    v_accvgpr_write_b32 a221, v9
    v_accvgpr_write_b32 a222, v10
    v_accvgpr_write_b32 a223, v11
    v_frexp_exp_i32_f32 v7, v47
    v_cvt_f32_i32 v7, v7
    v_max3_f32 v6, v88, v89, v90
    v_max3_f32 v6, v6, v91, v92
    v_max3_f32 v6, v6, v93, v94
    v_max3_f32 v6, v6, v95, v7
    v_mov_b32 v7, v6
    s_nop 1
    v_permlane16_swap_b32 v7, v6
    s_nop 1
    v_max_f32 v6, v6, v7
    v_mov_b32 v7, v6
    s_nop 1
    v_permlane32_swap_b32 v7, v6
    s_nop 1
    v_max_f32 v6, v6, v7
    v_max_f32 v6, 0, v6
    v_ceil_f32 v6, v6
    v_cvt_i32_f32 v7, -v6
    v_ldexp_f32 v7, 1.0, v7
    v_sub_f32 v60, v60, v6
    v_sub_f32 v61, v61, v6
    v_sub_f32 v62, v62, v6
    v_sub_f32 v63, v63, v6
    v_sub_f32 v88, v88, v6
    v_sub_f32 v120, v120, v6
    v_sub_f32 v89, v89, v6
    v_sub_f32 v121, v121, v6
    v_sub_f32 v90, v90, v6
    v_sub_f32 v122, v122, v6
    v_sub_f32 v91, v91, v6
    v_sub_f32 v123, v123, v6
    v_sub_f32 v92, v92, v6
    v_sub_f32 v124, v124, v6
    v_sub_f32 v93, v93, v6
    v_sub_f32 v125, v125, v6
    v_sub_f32 v94, v94, v6
    v_sub_f32 v126, v126, v6
    v_sub_f32 v95, v95, v6
    v_sub_f32 v127, v127, v6
    v_mul_f32 v15, v47, v7
    v_exp_f32 v88, v88
    v_exp_f32 v89, v89
    v_exp_f32 v90, v90
    v_exp_f32 v91, v91
    v_exp_f32 v92, v92
    v_exp_f32 v93, v93
    v_exp_f32 v94, v94
    v_exp_f32 v95, v95
    s_nop 0
    v_add_f32 v15, v15, v88
    v_add_f32 v15, v15, v89
    v_add_f32 v15, v15, v90
    v_add_f32 v15, v15, v91
    v_add_f32 v15, v15, v92
    v_add_f32 v15, v15, v93
    v_add_f32 v15, v15, v94
    v_add_f32 v15, v15, v95
    v_cvt_pk_bf16_f32 v88, v88, v89
    v_cvt_pk_bf16_f32 v89, v90, v91
    v_cvt_pk_bf16_f32 v90, v92, v93
    v_cvt_pk_bf16_f32 v91, v94, v95
    v_mul_f32 v224, v224, v7
    v_mul_f32 v225, v225, v7
    v_mul_f32 v226, v226, v7
    v_mul_f32 v227, v227, v7
    v_mul_f32 v228, v228, v7
    v_mul_f32 v229, v229, v7
    v_mul_f32 v230, v230, v7
    v_mul_f32 v231, v231, v7
    v_mul_f32 v232, v232, v7
    v_mul_f32 v233, v233, v7
    v_mul_f32 v234, v234, v7
    v_mul_f32 v235, v235, v7
    v_mul_f32 v236, v236, v7
    v_mul_f32 v237, v237, v7
    v_mul_f32 v238, v238, v7
    v_mul_f32 v239, v239, v7
    v_mul_f32 v240, v240, v7
    v_mul_f32 v241, v241, v7
    v_mul_f32 v242, v242, v7
    v_mul_f32 v243, v243, v7
    v_mul_f32 v244, v244, v7
    v_mul_f32 v245, v245, v7
    v_mul_f32 v246, v246, v7
    v_mul_f32 v247, v247, v7
    v_mul_f32 v248, v248, v7
    v_mul_f32 v249, v249, v7
    v_mul_f32 v250, v250, v7
    v_mul_f32 v251, v251, v7
    v_mul_f32 v252, v252, v7
    v_mul_f32 v253, v253, v7
    v_mul_f32 v254, v254, v7
    v_mul_f32 v255, v255, v7
    v_accvgpr_read_b32 v8, a224
    v_accvgpr_read_b32 v9, a225
    v_accvgpr_read_b32 v10, a226
    v_accvgpr_read_b32 v11, a227
    v_mul_f32 v8, v8, v7
    v_mul_f32 v9, v9, v7
    v_mul_f32 v10, v10, v7
    v_mul_f32 v11, v11, v7
    v_accvgpr_write_b32 a224, v8
    v_accvgpr_write_b32 a225, v9
    v_accvgpr_write_b32 a226, v10
    v_accvgpr_write_b32 a227, v11
    v_accvgpr_read_b32 v8, a228
    v_accvgpr_read_b32 v9, a229
    v_accvgpr_read_b32 v10, a230
    v_accvgpr_read_b32 v11, a231
    v_mul_f32 v8, v8, v7
    v_mul_f32 v9, v9, v7
    v_mul_f32 v10, v10, v7
    v_mul_f32 v11, v11, v7
    v_accvgpr_write_b32 a228, v8
    v_accvgpr_write_b32 a229, v9
    v_accvgpr_write_b32 a230, v10
    v_accvgpr_write_b32 a231, v11
    v_accvgpr_read_b32 v8, a232
    v_accvgpr_read_b32 v9, a233
    v_accvgpr_read_b32 v10, a234
    v_accvgpr_read_b32 v11, a235
    v_mul_f32 v8, v8, v7
    v_mul_f32 v9, v9, v7
    v_mul_f32 v10, v10, v7
    v_mul_f32 v11, v11, v7
    v_accvgpr_write_b32 a232, v8
    v_accvgpr_write_b32 a233, v9
    v_accvgpr_write_b32 a234, v10
    v_accvgpr_write_b32 a235, v11
    v_accvgpr_read_b32 v8, a236
    v_accvgpr_read_b32 v9, a237
    v_accvgpr_read_b32 v10, a238
    v_accvgpr_read_b32 v11, a239
    v_mul_f32 v8, v8, v7
    v_mul_f32 v9, v9, v7
    v_mul_f32 v10, v10, v7
    v_mul_f32 v11, v11, v7
    v_accvgpr_write_b32 a236, v8
    v_accvgpr_write_b32 a237, v9
    v_accvgpr_write_b32 a238, v10
    v_accvgpr_write_b32 a239, v11
    v_accvgpr_read_b32 v8, a240
    v_accvgpr_read_b32 v9, a241
    v_accvgpr_read_b32 v10, a242
    v_accvgpr_read_b32 v11, a243
    v_mul_f32 v8, v8, v7
    v_mul_f32 v9, v9, v7
    v_mul_f32 v10, v10, v7
    v_mul_f32 v11, v11, v7
    v_accvgpr_write_b32 a240, v8
    v_accvgpr_write_b32 a241, v9
    v_accvgpr_write_b32 a242, v10
    v_accvgpr_write_b32 a243, v11
    v_accvgpr_read_b32 v8, a244
    v_accvgpr_read_b32 v9, a245
    v_accvgpr_read_b32 v10, a246
    v_accvgpr_read_b32 v11, a247
    v_mul_f32 v8, v8, v7
    v_mul_f32 v9, v9, v7
    v_mul_f32 v10, v10, v7
    v_mul_f32 v11, v11, v7
    v_accvgpr_write_b32 a244, v8
    v_accvgpr_write_b32 a245, v9
    v_accvgpr_write_b32 a246, v10
    v_accvgpr_write_b32 a247, v11
    v_accvgpr_read_b32 v8, a248
    v_accvgpr_read_b32 v9, a249
    v_accvgpr_read_b32 v10, a250
    v_accvgpr_read_b32 v11, a251
    v_mul_f32 v8, v8, v7
    v_mul_f32 v9, v9, v7
    v_mul_f32 v10, v10, v7
    v_mul_f32 v11, v11, v7
    v_accvgpr_write_b32 a248, v8
    v_accvgpr_write_b32 a249, v9
    v_accvgpr_write_b32 a250, v10
    v_accvgpr_write_b32 a251, v11
    v_accvgpr_read_b32 v8, a252
    v_accvgpr_read_b32 v9, a253
    v_accvgpr_read_b32 v10, a254
    v_accvgpr_read_b32 v11, a255
    v_mul_f32 v8, v8, v7
    v_mul_f32 v9, v9, v7
    v_mul_f32 v10, v10, v7
    v_mul_f32 v11, v11, v7
    v_accvgpr_write_b32 a252, v8
    v_accvgpr_write_b32 a253, v9
    v_accvgpr_write_b32 a254, v10
    v_accvgpr_write_b32 a255, v11
    v_subrev_u32 v6, 32, v3
    v_subrev_u32 v7, 64, v3
    v_subrev_u32 v8, 96, v3
    v_subrev_u32 v9, 32, v4
    v_subrev_u32 v10, 64, v4
    v_subrev_u32 v11, 96, v4
    s_nop 1
    s_branch L_back2
L_rare3:
    s_mov_b32 s27, 507904
    s_add_u32 s28, s27, 8192
    v_and_b32 v6, 15, v0
    v_lshlrev_b32 v6, 9, v6
    v_lshrrev_b32 v7, 4, v0
    v_lshl_add_u32 v6, v7, 4, v6
    buffer_load_dwordx4 v[36:39], v6, s[4:7], s27 offen offset:0
    buffer_load_dwordx4 v[40:43], v6, s[4:7], s28 offen offset:0
    s_waitcnt vmcnt(0)
    v_mfma_f32_16x16x32_bf16 v[96:99], v[36:39], a[0:3], v[48:51]
    v_mfma_f32_16x16x32_bf16 v[104:107], v[36:39], a[32:35], v[52:55]
    v_mfma_f32_16x16x32_bf16 v[112:115], v[36:39], a[64:67], v[56:59]
    v_mfma_f32_16x16x32_bf16 v[120:123], v[36:39], a[96:99], v[60:63]
    v_mfma_f32_16x16x32_bf16 v[100:103], v[40:43], a[0:3], v[48:51]
    v_mfma_f32_16x16x32_bf16 v[108:111], v[40:43], a[32:35], v[52:55]
    v_mfma_f32_16x16x32_bf16 v[116:119], v[40:43], a[64:67], v[56:59]
    v_mfma_f32_16x16x32_bf16 v[124:127], v[40:43], a[96:99], v[60:63]
    buffer_load_dwordx4 v[36:39], v6, s[4:7], s27 offen offset:64
    buffer_load_dwordx4 v[40:43], v6, s[4:7], s28 offen offset:64
    s_waitcnt vmcnt(0)
    v_mfma_f32_16x16x32_bf16 v[96:99], v[36:39], a[4:7], v[96:99]
    v_mfma_f32_16x16x32_bf16 v[104:107], v[36:39], a[36:39], v[104:107]
    v_mfma_f32_16x16x32_bf16 v[112:115], v[36:39], a[68:71], v[112:115]
    v_mfma_f32_16x16x32_bf16 v[120:123], v[36:39], a[100:103], v[120:123]
    v_mfma_f32_16x16x32_bf16 v[100:103], v[40:43], a[4:7], v[100:103]
    v_mfma_f32_16x16x32_bf16 v[108:111], v[40:43], a[36:39], v[108:111]
    v_mfma_f32_16x16x32_bf16 v[116:119], v[40:43], a[68:71], v[116:119]
    v_mfma_f32_16x16x32_bf16 v[124:127], v[40:43], a[100:103], v[124:127]
    buffer_load_dwordx4 v[36:39], v6, s[4:7], s27 offen offset:128
    buffer_load_dwordx4 v[40:43], v6, s[4:7], s28 offen offset:128
    s_waitcnt vmcnt(0)
    v_mfma_f32_16x16x32_bf16 v[96:99], v[36:39], a[8:11], v[96:99]
    v_mfma_f32_16x16x32_bf16 v[104:107], v[36:39], a[40:43], v[104:107]
    v_mfma_f32_16x16x32_bf16 v[112:115], v[36:39], a[72:75], v[112:115]
    v_mfma_f32_16x16x32_bf16 v[120:123], v[36:39], a[104:107], v[120:123]
    v_mfma_f32_16x16x32_bf16 v[100:103], v[40:43], a[8:11], v[100:103]
    v_mfma_f32_16x16x32_bf16 v[108:111], v[40:43], a[40:43], v[108:111]
    v_mfma_f32_16x16x32_bf16 v[116:119], v[40:43], a[72:75], v[116:119]
    v_mfma_f32_16x16x32_bf16 v[124:127], v[40:43], a[104:107], v[124:127]
    buffer_load_dwordx4 v[36:39], v6, s[4:7], s27 offen offset:192
    buffer_load_dwordx4 v[40:43], v6, s[4:7], s28 offen offset:192
    s_waitcnt vmcnt(0)
    v_mfma_f32_16x16x32_bf16 v[96:99], v[36:39], a[12:15], v[96:99]
    v_mfma_f32_16x16x32_bf16 v[104:107], v[36:39], a[44:47], v[104:107]
    v_mfma_f32_16x16x32_bf16 v[112:115], v[36:39], a[76:79], v[112:115]
    v_mfma_f32_16x16x32_bf16 v[120:123], v[36:39], a[108:111], v[120:123]
    v_mfma_f32_16x16x32_bf16 v[100:103], v[40:43], a[12:15], v[100:103]
    v_mfma_f32_16x16x32_bf16 v[108:111], v[40:43], a[44:47], v[108:111]
    v_mfma_f32_16x16x32_bf16 v[116:119], v[40:43], a[76:79], v[116:119]
    v_mfma_f32_16x16x32_bf16 v[124:127], v[40:43], a[108:111], v[124:127]
    buffer_load_dwordx4 v[36:39], v6, s[4:7], s27 offen offset:256
    buffer_load_dwordx4 v[40:43], v6, s[4:7], s28 offen offset:256
    s_waitcnt vmcnt(0)
    v_mfma_f32_16x16x32_bf16 v[96:99], v[36:39], a[16:19], v[96:99]
    v_mfma_f32_16x16x32_bf16 v[104:107], v[36:39], a[48:51], v[104:107]
    v_mfma_f32_16x16x32_bf16 v[112:115], v[36:39], a[80:83], v[112:115]
    v_mfma_f32_16x16x32_bf16 v[120:123], v[36:39], a[112:115], v[120:123]
    v_mfma_f32_16x16x32_bf16 v[100:103], v[40:43], a[16:19], v[100:103]
    v_mfma_f32_16x16x32_bf16 v[108:111], v[40:43], a[48:51], v[108:111]
    v_mfma_f32_16x16x32_bf16 v[116:119], v[40:43], a[80:83], v[116:119]
    v_mfma_f32_16x16x32_bf16 v[124:127], v[40:43], a[112:115], v[124:127]
    buffer_load_dwordx4 v[36:39], v6, s[4:7], s27 offen offset:320
    buffer_load_dwordx4 v[40:43], v6, s[4:7], s28 offen offset:320
    s_waitcnt vmcnt(0)
    v_mfma_f32_16x16x32_bf16 v[96:99], v[36:39], a[20:23], v[96:99]
    v_mfma_f32_16x16x32_bf16 v[104:107], v[36:39], a[52:55], v[104:107]
    v_mfma_f32_16x16x32_bf16 v[112:115], v[36:39], a[84:87], v[112:115]
    v_mfma_f32_16x16x32_bf16 v[120:123], v[36:39], a[116:119], v[120:123]
    v_mfma_f32_16x16x32_bf16 v[100:103], v[40:43], a[20:23], v[100:103]
    v_mfma_f32_16x16x32_bf16 v[108:111], v[40:43], a[52:55], v[108:111]
    v_mfma_f32_16x16x32_bf16 v[116:119], v[40:43], a[84:87], v[116:119]
    v_mfma_f32_16x16x32_bf16 v[124:127], v[40:43], a[116:119], v[124:127]
    buffer_load_dwordx4 v[36:39], v6, s[4:7], s27 offen offset:384
    buffer_load_dwordx4 v[40:43], v6, s[4:7], s28 offen offset:384
    s_waitcnt vmcnt(0)
    v_mfma_f32_16x16x32_bf16 v[96:99], v[36:39], a[24:27], v[96:99]
    v_mfma_f32_16x16x32_bf16 v[104:107], v[36:39], a[56:59], v[104:107]
    v_mfma_f32_16x16x32_bf16 v[112:115], v[36:39], a[88:91], v[112:115]
    v_mfma_f32_16x16x32_bf16 v[120:123], v[36:39], a[120:123], v[120:123]
    v_mfma_f32_16x16x32_bf16 v[100:103], v[40:43], a[24:27], v[100:103]
    v_mfma_f32_16x16x32_bf16 v[108:111], v[40:43], a[56:59], v[108:111]
    v_mfma_f32_16x16x32_bf16 v[116:119], v[40:43], a[88:91], v[116:119]
    v_mfma_f32_16x16x32_bf16 v[124:127], v[40:43], a[120:123], v[124:127]
    buffer_load_dwordx4 v[36:39], v6, s[4:7], s27 offen offset:448
    buffer_load_dwordx4 v[40:43], v6, s[4:7], s28 offen offset:448
    s_waitcnt vmcnt(0)
    v_mfma_f32_16x16x32_bf16 v[96:99], v[36:39], a[28:31], v[96:99]
    v_mfma_f32_16x16x32_bf16 v[104:107], v[36:39], a[60:63], v[104:107]
    v_mfma_f32_16x16x32_bf16 v[112:115], v[36:39], a[92:95], v[112:115]
    v_mfma_f32_16x16x32_bf16 v[120:123], v[36:39], a[124:127], v[120:123]
    v_mfma_f32_16x16x32_bf16 v[100:103], v[40:43], a[28:31], v[100:103]
    v_mfma_f32_16x16x32_bf16 v[108:111], v[40:43], a[60:63], v[108:111]
    v_mfma_f32_16x16x32_bf16 v[116:119], v[40:43], a[92:95], v[116:119]
    v_mfma_f32_16x16x32_bf16 v[124:127], v[40:43], a[124:127], v[124:127]
    s_nop 7
    v_frexp_exp_i32_f32 v7, v12
    v_cvt_f32_i32 v7, v7
    v_max3_f32 v6, v96, v97, v98
    v_max3_f32 v6, v6, v99, v100
    v_max3_f32 v6, v6, v101, v102
    v_max3_f32 v6, v6, v103, v7
    v_mov_b32 v7, v6
    s_nop 1
    v_permlane16_swap_b32 v7, v6
    s_nop 1
    v_max_f32 v6, v6, v7
    v_mov_b32 v7, v6
    s_nop 1
    v_permlane32_swap_b32 v7, v6
    s_nop 1
    v_max_f32 v6, v6, v7
    v_max_f32 v6, 0, v6
    v_ceil_f32 v6, v6
    v_cvt_i32_f32 v7, -v6
    v_ldexp_f32 v7, 1.0, v7
    v_sub_f32 v48, v48, v6
    v_sub_f32 v49, v49, v6
    v_sub_f32 v50, v50, v6
    v_sub_f32 v51, v51, v6
    v_sub_f32 v96, v96, v6
    v_sub_f32 v97, v97, v6
    v_sub_f32 v98, v98, v6
    v_sub_f32 v99, v99, v6
    v_sub_f32 v100, v100, v6
    v_sub_f32 v101, v101, v6
    v_sub_f32 v102, v102, v6
    v_sub_f32 v103, v103, v6
    v_mul_f32 v44, v12, v7
    v_exp_f32 v96, v96
    v_exp_f32 v97, v97
    v_exp_f32 v98, v98
    v_exp_f32 v99, v99
    v_exp_f32 v100, v100
    v_exp_f32 v101, v101
    v_exp_f32 v102, v102
    v_exp_f32 v103, v103
    s_nop 0
    v_add_f32 v44, v44, v96
    v_add_f32 v44, v44, v97
    v_add_f32 v44, v44, v98
    v_add_f32 v44, v44, v99
    v_add_f32 v44, v44, v100
    v_add_f32 v44, v44, v101
    v_add_f32 v44, v44, v102
    v_add_f32 v44, v44, v103
    v_cvt_pk_bf16_f32 v96, v96, v97
    v_cvt_pk_bf16_f32 v97, v98, v99
    v_cvt_pk_bf16_f32 v98, v100, v101
    v_cvt_pk_bf16_f32 v99, v102, v103
    v_mul_f32 v128, v128, v7
    v_mul_f32 v129, v129, v7
    v_mul_f32 v130, v130, v7
    v_mul_f32 v131, v131, v7
    v_mul_f32 v132, v132, v7
    v_mul_f32 v133, v133, v7
    v_mul_f32 v134, v134, v7
    v_mul_f32 v135, v135, v7
    v_mul_f32 v136, v136, v7
    v_mul_f32 v137, v137, v7
    v_mul_f32 v138, v138, v7
    v_mul_f32 v139, v139, v7
    v_mul_f32 v140, v140, v7
    v_mul_f32 v141, v141, v7
    v_mul_f32 v142, v142, v7
    v_mul_f32 v143, v143, v7
    v_mul_f32 v144, v144, v7
    v_mul_f32 v145, v145, v7
    v_mul_f32 v146, v146, v7
    v_mul_f32 v147, v147, v7
    v_mul_f32 v148, v148, v7
    v_mul_f32 v149, v149, v7
    v_mul_f32 v150, v150, v7
    v_mul_f32 v151, v151, v7
    v_mul_f32 v152, v152, v7
    v_mul_f32 v153, v153, v7
    v_mul_f32 v154, v154, v7
    v_mul_f32 v155, v155, v7
    v_mul_f32 v156, v156, v7
    v_mul_f32 v157, v157, v7
    v_mul_f32 v158, v158, v7
    v_mul_f32 v159, v159, v7
    v_accvgpr_read_b32 v8, a128
    v_accvgpr_read_b32 v9, a129
    v_accvgpr_read_b32 v10, a130
    v_accvgpr_read_b32 v11, a131
    v_mul_f32 v8, v8, v7
    v_mul_f32 v9, v9, v7
    v_mul_f32 v10, v10, v7
    v_mul_f32 v11, v11, v7
    v_accvgpr_write_b32 a128, v8
    v_accvgpr_write_b32 a129, v9
    v_accvgpr_write_b32 a130, v10
    v_accvgpr_write_b32 a131, v11
    v_accvgpr_read_b32 v8, a132
    v_accvgpr_read_b32 v9, a133
    v_accvgpr_read_b32 v10, a134
    v_accvgpr_read_b32 v11, a135
    v_mul_f32 v8, v8, v7
    v_mul_f32 v9, v9, v7
    v_mul_f32 v10, v10, v7
    v_mul_f32 v11, v11, v7
    v_accvgpr_write_b32 a132, v8
    v_accvgpr_write_b32 a133, v9
    v_accvgpr_write_b32 a134, v10
    v_accvgpr_write_b32 a135, v11
    v_accvgpr_read_b32 v8, a136
    v_accvgpr_read_b32 v9, a137
    v_accvgpr_read_b32 v10, a138
    v_accvgpr_read_b32 v11, a139
    v_mul_f32 v8, v8, v7
    v_mul_f32 v9, v9, v7
    v_mul_f32 v10, v10, v7
    v_mul_f32 v11, v11, v7
    v_accvgpr_write_b32 a136, v8
    v_accvgpr_write_b32 a137, v9
    v_accvgpr_write_b32 a138, v10
    v_accvgpr_write_b32 a139, v11
    v_accvgpr_read_b32 v8, a140
    v_accvgpr_read_b32 v9, a141
    v_accvgpr_read_b32 v10, a142
    v_accvgpr_read_b32 v11, a143
    v_mul_f32 v8, v8, v7
    v_mul_f32 v9, v9, v7
    v_mul_f32 v10, v10, v7
    v_mul_f32 v11, v11, v7
    v_accvgpr_write_b32 a140, v8
    v_accvgpr_write_b32 a141, v9
    v_accvgpr_write_b32 a142, v10
    v_accvgpr_write_b32 a143, v11
    v_accvgpr_read_b32 v8, a144
    v_accvgpr_read_b32 v9, a145
    v_accvgpr_read_b32 v10, a146
    v_accvgpr_read_b32 v11, a147
    v_mul_f32 v8, v8, v7
    v_mul_f32 v9, v9, v7
    v_mul_f32 v10, v10, v7
    v_mul_f32 v11, v11, v7
    v_accvgpr_write_b32 a144, v8
    v_accvgpr_write_b32 a145, v9
    v_accvgpr_write_b32 a146, v10
    v_accvgpr_write_b32 a147, v11
    v_accvgpr_read_b32 v8, a148
    v_accvgpr_read_b32 v9, a149
    v_accvgpr_read_b32 v10, a150
    v_accvgpr_read_b32 v11, a151
    v_mul_f32 v8, v8, v7
    v_mul_f32 v9, v9, v7
    v_mul_f32 v10, v10, v7
    v_mul_f32 v11, v11, v7
    v_accvgpr_write_b32 a148, v8
    v_accvgpr_write_b32 a149, v9
    v_accvgpr_write_b32 a150, v10
    v_accvgpr_write_b32 a151, v11
    v_accvgpr_read_b32 v8, a152
    v_accvgpr_read_b32 v9, a153
    v_accvgpr_read_b32 v10, a154
    v_accvgpr_read_b32 v11, a155
    v_mul_f32 v8, v8, v7
    v_mul_f32 v9, v9, v7
    v_mul_f32 v10, v10, v7
    v_mul_f32 v11, v11, v7
    v_accvgpr_write_b32 a152, v8
    v_accvgpr_write_b32 a153, v9
    v_accvgpr_write_b32 a154, v10
    v_accvgpr_write_b32 a155, v11
    v_accvgpr_read_b32 v8, a156
    v_accvgpr_read_b32 v9, a157
    v_accvgpr_read_b32 v10, a158
    v_accvgpr_read_b32 v11, a159
    v_mul_f32 v8, v8, v7
    v_mul_f32 v9, v9, v7
    v_mul_f32 v10, v10, v7
    v_mul_f32 v11, v11, v7
    v_accvgpr_write_b32 a156, v8
    v_accvgpr_write_b32 a157, v9
    v_accvgpr_write_b32 a158, v10
    v_accvgpr_write_b32 a159, v11
    v_frexp_exp_i32_f32 v7, v13
    v_cvt_f32_i32 v7, v7
    v_max3_f32 v6, v104, v105, v106
    v_max3_f32 v6, v6, v107, v108
    v_max3_f32 v6, v6, v109, v110
    v_max3_f32 v6, v6, v111, v7
    v_mov_b32 v7, v6
    s_nop 1
    v_permlane16_swap_b32 v7, v6
    s_nop 1
    v_max_f32 v6, v6, v7
    v_mov_b32 v7, v6
    s_nop 1
    v_permlane32_swap_b32 v7, v6
    s_nop 1
    v_max_f32 v6, v6, v7
    v_max_f32 v6, 0, v6
    v_ceil_f32 v6, v6
    v_cvt_i32_f32 v7, -v6
    v_ldexp_f32 v7, 1.0, v7
    v_sub_f32 v52, v52, v6
    v_sub_f32 v53, v53, v6
    v_sub_f32 v54, v54, v6
    v_sub_f32 v55, v55, v6
    v_sub_f32 v104, v104, v6
    v_sub_f32 v105, v105, v6
    v_sub_f32 v106, v106, v6
    v_sub_f32 v107, v107, v6
    v_sub_f32 v108, v108, v6
    v_sub_f32 v109, v109, v6
    v_sub_f32 v110, v110, v6
    v_sub_f32 v111, v111, v6
    v_mul_f32 v45, v13, v7
    v_exp_f32 v104, v104
    v_exp_f32 v105, v105
    v_exp_f32 v106, v106
    v_exp_f32 v107, v107
    v_exp_f32 v108, v108
    v_exp_f32 v109, v109
    v_exp_f32 v110, v110
    v_exp_f32 v111, v111
    s_nop 0
    v_add_f32 v45, v45, v104
    v_add_f32 v45, v45, v105
    v_add_f32 v45, v45, v106
    v_add_f32 v45, v45, v107
    v_add_f32 v45, v45, v108
    v_add_f32 v45, v45, v109
    v_add_f32 v45, v45, v110
    v_add_f32 v45, v45, v111
    v_cvt_pk_bf16_f32 v104, v104, v105
    v_cvt_pk_bf16_f32 v105, v106, v107
    v_cvt_pk_bf16_f32 v106, v108, v109
    v_cvt_pk_bf16_f32 v107, v110, v111
    v_mul_f32 v160, v160, v7
    v_mul_f32 v161, v161, v7
    v_mul_f32 v162, v162, v7
    v_mul_f32 v163, v163, v7
    v_mul_f32 v164, v164, v7
    v_mul_f32 v165, v165, v7
    v_mul_f32 v166, v166, v7
    v_mul_f32 v167, v167, v7
    v_mul_f32 v168, v168, v7
    v_mul_f32 v169, v169, v7
    v_mul_f32 v170, v170, v7
    v_mul_f32 v171, v171, v7
    v_mul_f32 v172, v172, v7
    v_mul_f32 v173, v173, v7
    v_mul_f32 v174, v174, v7
    v_mul_f32 v175, v175, v7
    v_mul_f32 v176, v176, v7
    v_mul_f32 v177, v177, v7
    v_mul_f32 v178, v178, v7
    v_mul_f32 v179, v179, v7
    v_mul_f32 v180, v180, v7
    v_mul_f32 v181, v181, v7
    v_mul_f32 v182, v182, v7
    v_mul_f32 v183, v183, v7
    v_mul_f32 v184, v184, v7
    v_mul_f32 v185, v185, v7
    v_mul_f32 v186, v186, v7
    v_mul_f32 v187, v187, v7
    v_mul_f32 v188, v188, v7
    v_mul_f32 v189, v189, v7
    v_mul_f32 v190, v190, v7
    v_mul_f32 v191, v191, v7
    v_accvgpr_read_b32 v8, a160
    v_accvgpr_read_b32 v9, a161
    v_accvgpr_read_b32 v10, a162
    v_accvgpr_read_b32 v11, a163
    v_mul_f32 v8, v8, v7
    v_mul_f32 v9, v9, v7
    v_mul_f32 v10, v10, v7
    v_mul_f32 v11, v11, v7
    v_accvgpr_write_b32 a160, v8
    v_accvgpr_write_b32 a161, v9
    v_accvgpr_write_b32 a162, v10
    v_accvgpr_write_b32 a163, v11
    v_accvgpr_read_b32 v8, a164
    v_accvgpr_read_b32 v9, a165
    v_accvgpr_read_b32 v10, a166
    v_accvgpr_read_b32 v11, a167
    v_mul_f32 v8, v8, v7
    v_mul_f32 v9, v9, v7
    v_mul_f32 v10, v10, v7
    v_mul_f32 v11, v11, v7
    v_accvgpr_write_b32 a164, v8
    v_accvgpr_write_b32 a165, v9
    v_accvgpr_write_b32 a166, v10
    v_accvgpr_write_b32 a167, v11
    v_accvgpr_read_b32 v8, a168
    v_accvgpr_read_b32 v9, a169
    v_accvgpr_read_b32 v10, a170
    v_accvgpr_read_b32 v11, a171
    v_mul_f32 v8, v8, v7
    v_mul_f32 v9, v9, v7
    v_mul_f32 v10, v10, v7
    v_mul_f32 v11, v11, v7
    v_accvgpr_write_b32 a168, v8
    v_accvgpr_write_b32 a169, v9
    v_accvgpr_write_b32 a170, v10
    v_accvgpr_write_b32 a171, v11
    v_accvgpr_read_b32 v8, a172
    v_accvgpr_read_b32 v9, a173
    v_accvgpr_read_b32 v10, a174
    v_accvgpr_read_b32 v11, a175
    v_mul_f32 v8, v8, v7
    v_mul_f32 v9, v9, v7
    v_mul_f32 v10, v10, v7
    v_mul_f32 v11, v11, v7
    v_accvgpr_write_b32 a172, v8
    v_accvgpr_write_b32 a173, v9
    v_accvgpr_write_b32 a174, v10
    v_accvgpr_write_b32 a175, v11
    v_accvgpr_read_b32 v8, a176
    v_accvgpr_read_b32 v9, a177
    v_accvgpr_read_b32 v10, a178
    v_accvgpr_read_b32 v11, a179
    v_mul_f32 v8, v8, v7
    v_mul_f32 v9, v9, v7
    v_mul_f32 v10, v10, v7
    v_mul_f32 v11, v11, v7
    v_accvgpr_write_b32 a176, v8
    v_accvgpr_write_b32 a177, v9
    v_accvgpr_write_b32 a178, v10
    v_accvgpr_write_b32 a179, v11
    v_accvgpr_read_b32 v8, a180
    v_accvgpr_read_b32 v9, a181
    v_accvgpr_read_b32 v10, a182
    v_accvgpr_read_b32 v11, a183
    v_mul_f32 v8, v8, v7
    v_mul_f32 v9, v9, v7
    v_mul_f32 v10, v10, v7
    v_mul_f32 v11, v11, v7
    v_accvgpr_write_b32 a180, v8
    v_accvgpr_write_b32 a181, v9
    v_accvgpr_write_b32 a182, v10
    v_accvgpr_write_b32 a183, v11
    v_accvgpr_read_b32 v8, a184
    v_accvgpr_read_b32 v9, a185
    v_accvgpr_read_b32 v10, a186
    v_accvgpr_read_b32 v11, a187
    v_mul_f32 v8, v8, v7
    v_mul_f32 v9, v9, v7
    v_mul_f32 v10, v10, v7
    v_mul_f32 v11, v11, v7
    v_accvgpr_write_b32 a184, v8
    v_accvgpr_write_b32 a185, v9
    v_accvgpr_write_b32 a186, v10
    v_accvgpr_write_b32 a187, v11
    v_accvgpr_read_b32 v8, a188
    v_accvgpr_read_b32 v9, a189
    v_accvgpr_read_b32 v10, a190
    v_accvgpr_read_b32 v11, a191
    v_mul_f32 v8, v8, v7
    v_mul_f32 v9, v9, v7
    v_mul_f32 v10, v10, v7
    v_mul_f32 v11, v11, v7
    v_accvgpr_write_b32 a188, v8
    v_accvgpr_write_b32 a189, v9
    v_accvgpr_write_b32 a190, v10
    v_accvgpr_write_b32 a191, v11
    v_frexp_exp_i32_f32 v7, v14
    v_cvt_f32_i32 v7, v7
    v_max3_f32 v6, v112, v113, v114
    v_max3_f32 v6, v6, v115, v116
    v_max3_f32 v6, v6, v117, v118
    v_max3_f32 v6, v6, v119, v7
    v_mov_b32 v7, v6
    s_nop 1
    v_permlane16_swap_b32 v7, v6
    s_nop 1
    v_max_f32 v6, v6, v7
    v_mov_b32 v7, v6
    s_nop 1
    v_permlane32_swap_b32 v7, v6
    s_nop 1
    v_max_f32 v6, v6, v7
    v_max_f32 v6, 0, v6
    v_ceil_f32 v6, v6
    v_cvt_i32_f32 v7, -v6
    v_ldexp_f32 v7, 1.0, v7
    v_sub_f32 v56, v56, v6
    v_sub_f32 v57, v57, v6
    v_sub_f32 v58, v58, v6
    v_sub_f32 v59, v59, v6
    v_sub_f32 v112, v112, v6
    v_sub_f32 v113, v113, v6
    v_sub_f32 v114, v114, v6
    v_sub_f32 v115, v115, v6
    v_sub_f32 v116, v116, v6
    v_sub_f32 v117, v117, v6
    v_sub_f32 v118, v118, v6
    v_sub_f32 v119, v119, v6
    v_mul_f32 v46, v14, v7
    v_exp_f32 v112, v112
    v_exp_f32 v113, v113
    v_exp_f32 v114, v114
    v_exp_f32 v115, v115
    v_exp_f32 v116, v116
    v_exp_f32 v117, v117
    v_exp_f32 v118, v118
    v_exp_f32 v119, v119
    s_nop 0
    v_add_f32 v46, v46, v112
    v_add_f32 v46, v46, v113
    v_add_f32 v46, v46, v114
    v_add_f32 v46, v46, v115
    v_add_f32 v46, v46, v116
    v_add_f32 v46, v46, v117
    v_add_f32 v46, v46, v118
    v_add_f32 v46, v46, v119
    v_cvt_pk_bf16_f32 v112, v112, v113
    v_cvt_pk_bf16_f32 v113, v114, v115
    v_cvt_pk_bf16_f32 v114, v116, v117
    v_cvt_pk_bf16_f32 v115, v118, v119
    v_mul_f32 v192, v192, v7
    v_mul_f32 v193, v193, v7
    v_mul_f32 v194, v194, v7
    v_mul_f32 v195, v195, v7
    v_mul_f32 v196, v196, v7
    v_mul_f32 v197, v197, v7
    v_mul_f32 v198, v198, v7
    v_mul_f32 v199, v199, v7
    v_mul_f32 v200, v200, v7
    v_mul_f32 v201, v201, v7
    v_mul_f32 v202, v202, v7
    v_mul_f32 v203, v203, v7
    v_mul_f32 v204, v204, v7
    v_mul_f32 v205, v205, v7
    v_mul_f32 v206, v206, v7
    v_mul_f32 v207, v207, v7
    v_mul_f32 v208, v208, v7
    v_mul_f32 v209, v209, v7
    v_mul_f32 v210, v210, v7
    v_mul_f32 v211, v211, v7
    v_mul_f32 v212, v212, v7
    v_mul_f32 v213, v213, v7
    v_mul_f32 v214, v214, v7
    v_mul_f32 v215, v215, v7
    v_mul_f32 v216, v216, v7
    v_mul_f32 v217, v217, v7
    v_mul_f32 v218, v218, v7
    v_mul_f32 v219, v219, v7
    v_mul_f32 v220, v220, v7
    v_mul_f32 v221, v221, v7
    v_mul_f32 v222, v222, v7
    v_mul_f32 v223, v223, v7
    v_accvgpr_read_b32 v8, a192
    v_accvgpr_read_b32 v9, a193
    v_accvgpr_read_b32 v10, a194
    v_accvgpr_read_b32 v11, a195
    v_mul_f32 v8, v8, v7
    v_mul_f32 v9, v9, v7
    v_mul_f32 v10, v10, v7
    v_mul_f32 v11, v11, v7
    v_accvgpr_write_b32 a192, v8
    v_accvgpr_write_b32 a193, v9
    v_accvgpr_write_b32 a194, v10
    v_accvgpr_write_b32 a195, v11
    v_accvgpr_read_b32 v8, a196
    v_accvgpr_read_b32 v9, a197
    v_accvgpr_read_b32 v10, a198
    v_accvgpr_read_b32 v11, a199
    v_mul_f32 v8, v8, v7
    v_mul_f32 v9, v9, v7
    v_mul_f32 v10, v10, v7
    v_mul_f32 v11, v11, v7
    v_accvgpr_write_b32 a196, v8
    v_accvgpr_write_b32 a197, v9
    v_accvgpr_write_b32 a198, v10
    v_accvgpr_write_b32 a199, v11
    v_accvgpr_read_b32 v8, a200
    v_accvgpr_read_b32 v9, a201
    v_accvgpr_read_b32 v10, a202
    v_accvgpr_read_b32 v11, a203
    v_mul_f32 v8, v8, v7
    v_mul_f32 v9, v9, v7
    v_mul_f32 v10, v10, v7
    v_mul_f32 v11, v11, v7
    v_accvgpr_write_b32 a200, v8
    v_accvgpr_write_b32 a201, v9
    v_accvgpr_write_b32 a202, v10
    v_accvgpr_write_b32 a203, v11
    v_accvgpr_read_b32 v8, a204
    v_accvgpr_read_b32 v9, a205
    v_accvgpr_read_b32 v10, a206
    v_accvgpr_read_b32 v11, a207
    v_mul_f32 v8, v8, v7
    v_mul_f32 v9, v9, v7
    v_mul_f32 v10, v10, v7
    v_mul_f32 v11, v11, v7
    v_accvgpr_write_b32 a204, v8
    v_accvgpr_write_b32 a205, v9
    v_accvgpr_write_b32 a206, v10
    v_accvgpr_write_b32 a207, v11
    v_accvgpr_read_b32 v8, a208
    v_accvgpr_read_b32 v9, a209
    v_accvgpr_read_b32 v10, a210
    v_accvgpr_read_b32 v11, a211
    v_mul_f32 v8, v8, v7
    v_mul_f32 v9, v9, v7
    v_mul_f32 v10, v10, v7
    v_mul_f32 v11, v11, v7
    v_accvgpr_write_b32 a208, v8
    v_accvgpr_write_b32 a209, v9
    v_accvgpr_write_b32 a210, v10
    v_accvgpr_write_b32 a211, v11
    v_accvgpr_read_b32 v8, a212
    v_accvgpr_read_b32 v9, a213
    v_accvgpr_read_b32 v10, a214
    v_accvgpr_read_b32 v11, a215
    v_mul_f32 v8, v8, v7
    v_mul_f32 v9, v9, v7
    v_mul_f32 v10, v10, v7
    v_mul_f32 v11, v11, v7
    v_accvgpr_write_b32 a212, v8
    v_accvgpr_write_b32 a213, v9
    v_accvgpr_write_b32 a214, v10
    v_accvgpr_write_b32 a215, v11
    v_accvgpr_read_b32 v8, a216
    v_accvgpr_read_b32 v9, a217
    v_accvgpr_read_b32 v10, a218
    v_accvgpr_read_b32 v11, a219
    v_mul_f32 v8, v8, v7
    v_mul_f32 v9, v9, v7
    v_mul_f32 v10, v10, v7
    v_mul_f32 v11, v11, v7
    v_accvgpr_write_b32 a216, v8
    v_accvgpr_write_b32 a217, v9
    v_accvgpr_write_b32 a218, v10
    v_accvgpr_write_b32 a219, v11
    v_accvgpr_read_b32 v8, a220
    v_accvgpr_read_b32 v9, a221
    v_accvgpr_read_b32 v10, a222
    v_accvgpr_read_b32 v11, a223
    v_mul_f32 v8, v8, v7
    v_mul_f32 v9, v9, v7
    v_mul_f32 v10, v10, v7
    v_mul_f32 v11, v11, v7
    v_accvgpr_write_b32 a220, v8
    v_accvgpr_write_b32 a221, v9
    v_accvgpr_write_b32 a222, v10
    v_accvgpr_write_b32 a223, v11
    v_frexp_exp_i32_f32 v7, v15
    v_cvt_f32_i32 v7, v7
    v_max3_f32 v6, v120, v121, v122
    v_max3_f32 v6, v6, v123, v124
    v_max3_f32 v6, v6, v125, v126
    v_max3_f32 v6, v6, v127, v7
    v_mov_b32 v7, v6
    s_nop 1
    v_permlane16_swap_b32 v7, v6
    s_nop 1
    v_max_f32 v6, v6, v7
    v_mov_b32 v7, v6
    s_nop 1
    v_permlane32_swap_b32 v7, v6
    s_nop 1
    v_max_f32 v6, v6, v7
    v_max_f32 v6, 0, v6
    v_ceil_f32 v6, v6
    v_cvt_i32_f32 v7, -v6
    v_ldexp_f32 v7, 1.0, v7
    v_sub_f32 v60, v60, v6
    v_sub_f32 v61, v61, v6
    v_sub_f32 v62, v62, v6
    v_sub_f32 v63, v63, v6
    v_sub_f32 v120, v120, v6
    v_sub_f32 v121, v121, v6
    v_sub_f32 v122, v122, v6
    v_sub_f32 v123, v123, v6
    v_sub_f32 v124, v124, v6
    v_sub_f32 v125, v125, v6
    v_sub_f32 v126, v126, v6
    v_sub_f32 v127, v127, v6
    v_mul_f32 v47, v15, v7
    v_exp_f32 v120, v120
    v_exp_f32 v121, v121
    v_exp_f32 v122, v122
    v_exp_f32 v123, v123
    v_exp_f32 v124, v124
    v_exp_f32 v125, v125
    v_exp_f32 v126, v126
    v_exp_f32 v127, v127
    s_nop 0
    v_add_f32 v47, v47, v120
    v_add_f32 v47, v47, v121
    v_add_f32 v47, v47, v122
    v_add_f32 v47, v47, v123
    v_add_f32 v47, v47, v124
    v_add_f32 v47, v47, v125
    v_add_f32 v47, v47, v126
    v_add_f32 v47, v47, v127
    v_cvt_pk_bf16_f32 v120, v120, v121
    v_cvt_pk_bf16_f32 v121, v122, v123
    v_cvt_pk_bf16_f32 v122, v124, v125
    v_cvt_pk_bf16_f32 v123, v126, v127
    v_mul_f32 v224, v224, v7
    v_mul_f32 v225, v225, v7
    v_mul_f32 v226, v226, v7
    v_mul_f32 v227, v227, v7
    v_mul_f32 v228, v228, v7
    v_mul_f32 v229, v229, v7
    v_mul_f32 v230, v230, v7
    v_mul_f32 v231, v231, v7
    v_mul_f32 v232, v232, v7
    v_mul_f32 v233, v233, v7
    v_mul_f32 v234, v234, v7
    v_mul_f32 v235, v235, v7
    v_mul_f32 v236, v236, v7
    v_mul_f32 v237, v237, v7
    v_mul_f32 v238, v238, v7
    v_mul_f32 v239, v239, v7
    v_mul_f32 v240, v240, v7
    v_mul_f32 v241, v241, v7
    v_mul_f32 v242, v242, v7
    v_mul_f32 v243, v243, v7
    v_mul_f32 v244, v244, v7
    v_mul_f32 v245, v245, v7
    v_mul_f32 v246, v246, v7
    v_mul_f32 v247, v247, v7
    v_mul_f32 v248, v248, v7
    v_mul_f32 v249, v249, v7
    v_mul_f32 v250, v250, v7
    v_mul_f32 v251, v251, v7
    v_mul_f32 v252, v252, v7
    v_mul_f32 v253, v253, v7
    v_mul_f32 v254, v254, v7
    v_mul_f32 v255, v255, v7
    v_accvgpr_read_b32 v8, a224
    v_accvgpr_read_b32 v9, a225
    v_accvgpr_read_b32 v10, a226
    v_accvgpr_read_b32 v11, a227
    v_mul_f32 v8, v8, v7
    v_mul_f32 v9, v9, v7
    v_mul_f32 v10, v10, v7
    v_mul_f32 v11, v11, v7
    v_accvgpr_write_b32 a224, v8
    v_accvgpr_write_b32 a225, v9
    v_accvgpr_write_b32 a226, v10
    v_accvgpr_write_b32 a227, v11
    v_accvgpr_read_b32 v8, a228
    v_accvgpr_read_b32 v9, a229
    v_accvgpr_read_b32 v10, a230
    v_accvgpr_read_b32 v11, a231
    v_mul_f32 v8, v8, v7
    v_mul_f32 v9, v9, v7
    v_mul_f32 v10, v10, v7
    v_mul_f32 v11, v11, v7
    v_accvgpr_write_b32 a228, v8
    v_accvgpr_write_b32 a229, v9
    v_accvgpr_write_b32 a230, v10
    v_accvgpr_write_b32 a231, v11
    v_accvgpr_read_b32 v8, a232
    v_accvgpr_read_b32 v9, a233
    v_accvgpr_read_b32 v10, a234
    v_accvgpr_read_b32 v11, a235
    v_mul_f32 v8, v8, v7
    v_mul_f32 v9, v9, v7
    v_mul_f32 v10, v10, v7
    v_mul_f32 v11, v11, v7
    v_accvgpr_write_b32 a232, v8
    v_accvgpr_write_b32 a233, v9
    v_accvgpr_write_b32 a234, v10
    v_accvgpr_write_b32 a235, v11
    v_accvgpr_read_b32 v8, a236
    v_accvgpr_read_b32 v9, a237
    v_accvgpr_read_b32 v10, a238
    v_accvgpr_read_b32 v11, a239
    v_mul_f32 v8, v8, v7
    v_mul_f32 v9, v9, v7
    v_mul_f32 v10, v10, v7
    v_mul_f32 v11, v11, v7
    v_accvgpr_write_b32 a236, v8
    v_accvgpr_write_b32 a237, v9
    v_accvgpr_write_b32 a238, v10
    v_accvgpr_write_b32 a239, v11
    v_accvgpr_read_b32 v8, a240
    v_accvgpr_read_b32 v9, a241
    v_accvgpr_read_b32 v10, a242
    v_accvgpr_read_b32 v11, a243
    v_mul_f32 v8, v8, v7
    v_mul_f32 v9, v9, v7
    v_mul_f32 v10, v10, v7
    v_mul_f32 v11, v11, v7
    v_accvgpr_write_b32 a240, v8
    v_accvgpr_write_b32 a241, v9
    v_accvgpr_write_b32 a242, v10
    v_accvgpr_write_b32 a243, v11
    v_accvgpr_read_b32 v8, a244
    v_accvgpr_read_b32 v9, a245
    v_accvgpr_read_b32 v10, a246
    v_accvgpr_read_b32 v11, a247
    v_mul_f32 v8, v8, v7
    v_mul_f32 v9, v9, v7
    v_mul_f32 v10, v10, v7
    v_mul_f32 v11, v11, v7
    v_accvgpr_write_b32 a244, v8
    v_accvgpr_write_b32 a245, v9
    v_accvgpr_write_b32 a246, v10
    v_accvgpr_write_b32 a247, v11
    v_accvgpr_read_b32 v8, a248
    v_accvgpr_read_b32 v9, a249
    v_accvgpr_read_b32 v10, a250
    v_accvgpr_read_b32 v11, a251
    v_mul_f32 v8, v8, v7
    v_mul_f32 v9, v9, v7
    v_mul_f32 v10, v10, v7
    v_mul_f32 v11, v11, v7
    v_accvgpr_write_b32 a248, v8
    v_accvgpr_write_b32 a249, v9
    v_accvgpr_write_b32 a250, v10
    v_accvgpr_write_b32 a251, v11
    v_accvgpr_read_b32 v8, a252
    v_accvgpr_read_b32 v9, a253
    v_accvgpr_read_b32 v10, a254
    v_accvgpr_read_b32 v11, a255
    v_mul_f32 v8, v8, v7
    v_mul_f32 v9, v9, v7
    v_mul_f32 v10, v10, v7
    v_mul_f32 v11, v11, v7
    v_accvgpr_write_b32 a252, v8
    v_accvgpr_write_b32 a253, v9
    v_accvgpr_write_b32 a254, v10
    v_accvgpr_write_b32 a255, v11
    s_nop 1
    s_branch L_back3
.section .rodata,"a"
.p2align 6
.amdhsa_kernel recurrent_scan__gqa_block_cached__glu_gated_bilinear__prompt_kernel
  .amdhsa_next_free_vgpr 512
  .amdhsa_next_free_sgpr 102
  .amdhsa_accum_offset 256
  .amdhsa_group_segment_fixed_size 0
  .amdhsa_kernarg_size 96
  .amdhsa_user_sgpr_count 2
  .amdhsa_user_sgpr_kernarg_segment_ptr 1
  .amdhsa_system_sgpr_workgroup_id_x 1
.end_amdhsa_kernel
```
